```python
import torch

def _softmax(x, axis=-1):
    return torch.softmax(x, dim=axis)
def _gelu(x):
    return torch.nn.functional.gelu(x, approximate="tanh")
def _silu(x):
    return torch.nn.functional.silu(x)
def _sigmoid(x):
    return torch.sigmoid(x)
def _layernorm(x, axis=-1, eps=1e-5):
    m = x.mean(dim=axis, keepdim=True)
    v = x.var(dim=axis, keepdim=True, unbiased=False)
    return (x - m) / torch.sqrt(v + eps)
def _scatter_add(tgt, idx, src, axis=0):
    return tgt.clone().index_add_(axis, idx, src)
def _segment_sum(src, seg, n):
    out = torch.zeros((n,) + src.shape[1:], dtype=src.dtype)
    return out.index_add_(0, seg, src)
def _pad(x, pw):
    flat = tuple(v for pair in reversed(pw) for v in pair)
    return torch.nn.functional.pad(x, flat)

kernel_name = 'interleave_layers__linear_attn_block__sliding_block__prompt'

def setup_inputs():

    _w = (lambda a: (lambda t: t.to(torch.bfloat16) if t.is_floating_point() else t)(torch.as_tensor(a)))
    def _A_setup():
        B, S, D = 1, 2048, 1024
        return {
            "x": _w((lambda *s: torch.randn(*s, dtype=torch.bfloat16) * 0.05)(B, S, D)),
            "wqkv": _w((lambda *s: torch.randn(*s, dtype=torch.bfloat16) * 0.05)(D, 3 * D)),
            "wo": _w((lambda *s: torch.randn(*s, dtype=torch.bfloat16) * 0.05)(D, D)),
        }
    _A_in = _A_setup()

    def _B_setup():
        B, S, D = 1, 2048, 1024
        return {
            "x": _w((lambda *s: torch.randn(*s, dtype=torch.bfloat16) * 0.05)(B, S, D)),
            "wqkv": _w((lambda *s: torch.randn(*s, dtype=torch.bfloat16) * 0.05)(D, 3 * D)),
            "wo": _w((lambda *s: torch.randn(*s, dtype=torch.bfloat16) * 0.05)(D, D)),
        }
    _B_in = _B_setup()

    return {
        "A_x": _A_in["x"],
        "A_wqkv": _A_in["wqkv"],
        "A_wo": _A_in["wo"],
        "B_x": _B_in["x"],
        "B_wqkv": _B_in["wqkv"],
        "B_wo": _B_in["wo"],
    }

def reference(A_x, A_wqkv, A_wo, B_x, B_wqkv, B_wo):
    def _A_ref(x, wqkv, wo):
        B, S, D = x.shape
        H = 32; Dh = D // H
        qkv = (lambda x, *d: x.permute(*d))((x @ wqkv).reshape(B, S, 3, H, Dh), 2, 0, 3, 1, 4)
        q, k, v = qkv[0], qkv[1], qkv[2]
        phi = lambda t: torch.where(t > 0, t + 1, torch.exp(t)) + 1e-6
        pq, pk = phi(q), phi(k)
        kv = torch.einsum("bhsd,bhse->bhde", pk, v)
        z = torch.einsum("bhsd->bhd", pk)
        num = torch.einsum("bhqd,bhde->bhqe", pq, kv)
        den = torch.einsum("bhqd,bhd->bhq", pq, z)[..., None] + 1e-6
        o = num / den
        return (lambda x, *d: x.permute(*d))(o, 0, 2, 1, 3).reshape(B, S, D) @ wo

    def _B_ref(x, wqkv, wo):
        B, S, D = x.shape
        H = 32; Dh = D // H; W = 256
        qkv = (lambda x, *d: x.permute(*d))((x @ wqkv).reshape(B, S, 3, H, Dh), 2, 0, 3, 1, 4)
        q, k, v = qkv[0], qkv[1], qkv[2]
        scores = torch.einsum("bhqd,bhkd->bhqk", q, k) * (Dh ** -0.5)
        idx = torch.arange(S)
        mask = (idx[:, None] - idx[None, :] >= 0) & (idx[:, None] - idx[None, :] < W)
        scores = torch.where(mask[None, None], scores, -1e9)
        p = _softmax(scores, axis=-1)
        o = torch.einsum("bhqk,bhkd->bhqd", p, v)
        return (lambda x, *d: x.permute(*d))(o, 0, 2, 1, 3).reshape(B, S, D) @ wo

    x = A_x
    x = x + _A_ref(_layernorm(x, axis=-1), A_wqkv, A_wo)
    x = x + _B_ref(_layernorm(x, axis=-1), B_wqkv, B_wo)
    x = x + _A_ref(_layernorm(x, axis=-1), A_wqkv, A_wo)
    x = x + _B_ref(_layernorm(x, axis=-1), B_wqkv, B_wo)
    return x
```

```asm
; @launch kernel=ln0_kernel grid=(512,1,1) block=(256,1,1) lds=0
; @launch kernel=gemmq0_kernel grid=(256,1,1) block=(512,1,1) lds=122880
; @launch kernel=kvpart0_kernel grid=(256,1,1) block=(256,1,1) lds=32768
; @launch kernel=linapply0_kernel grid=(256,1,1) block=(256,1,1) lds=4096
; @launch kernel=gemmo0_kernel grid=(256,1,1) block=(512,1,1) lds=73728
; @launch kernel=ln1_kernel grid=(512,1,1) block=(256,1,1) lds=0
; @launch kernel=gemmq1_kernel grid=(256,1,1) block=(512,1,1) lds=122880
; @launch kernel=slide1_kernel grid=(256,1,1) block=(256,1,1) lds=8192
; @launch kernel=gemmo1_kernel grid=(256,1,1) block=(512,1,1) lds=73728
; @launch kernel=ln2_kernel grid=(512,1,1) block=(256,1,1) lds=0
; @launch kernel=gemmq2_kernel grid=(256,1,1) block=(512,1,1) lds=122880
; @launch kernel=kvpart2_kernel grid=(256,1,1) block=(256,1,1) lds=32768
; @launch kernel=linapply2_kernel grid=(256,1,1) block=(256,1,1) lds=4096
; @launch kernel=gemmo2_kernel grid=(256,1,1) block=(512,1,1) lds=73728
; @launch kernel=ln3_kernel grid=(512,1,1) block=(256,1,1) lds=0
; @launch kernel=gemmq3_kernel grid=(256,1,1) block=(512,1,1) lds=122880
; @launch kernel=slide3_kernel grid=(256,1,1) block=(256,1,1) lds=8192
; @launch kernel=gemmo3_kernel grid=(256,1,1) block=(512,1,1) lds=73728
.amdgcn_target "amdgcn-amd-amdhsa--gfx950"
.text
.globl ln0_kernel
.p2align 8
.type ln0_kernel,@function
ln0_kernel:
  s_cmp_ge_u32 s2, 512
  s_cbranch_scc1 L_ln0_kernel_end
  s_load_dwordx16 s[4:19], s[0:1], 0
  s_load_dwordx2 s[20:21], s[0:1], 64
  s_waitcnt lgkmcnt(0)
  s_mov_b32 s24, s4
  s_and_b32 s25, s5, 0xffff
  s_mov_b32 s26, 4194304
  s_mov_b32 s27, 0x00020000
  s_mov_b32 s28, s20
  s_and_b32 s29, s21, 0xffff
  s_mov_b32 s30, 4194304
  s_mov_b32 s31, 0x00020000
  v_lshrrev_b32 v1, 6, v0
  v_and_b32 v2, 63, v0
  s_lshl_b32 s3, s2, 2
  v_add_u32 v3, s3, v1
  v_lshlrev_b32 v4, 11, v3
  v_lshl_add_u32 v4, v2, 4, v4
  buffer_load_dwordx4 v[8:11], v4, s[24:27], 0 offen
  buffer_load_dwordx4 v[12:15], v4, s[24:27], 0 offen offset:1024
  s_waitcnt vmcnt(0)
  v_lshlrev_b32 v16, 16, v8
  v_and_b32 v17, 0xffff0000, v8
  v_lshlrev_b32 v18, 16, v9
  v_and_b32 v19, 0xffff0000, v9
  v_lshlrev_b32 v20, 16, v10
  v_and_b32 v21, 0xffff0000, v10
  v_lshlrev_b32 v22, 16, v11
  v_and_b32 v23, 0xffff0000, v11
  v_lshlrev_b32 v24, 16, v12
  v_and_b32 v25, 0xffff0000, v12
  v_lshlrev_b32 v26, 16, v13
  v_and_b32 v27, 0xffff0000, v13
  v_lshlrev_b32 v28, 16, v14
  v_and_b32 v29, 0xffff0000, v14
  v_lshlrev_b32 v30, 16, v15
  v_and_b32 v31, 0xffff0000, v15
  v_add_f32 v32, v16, v17
  v_add_f32 v32, v32, v18
  v_add_f32 v32, v32, v19
  v_add_f32 v32, v32, v20
  v_add_f32 v32, v32, v21
  v_add_f32 v32, v32, v22
  v_add_f32 v32, v32, v23
  v_add_f32 v32, v32, v24
  v_add_f32 v32, v32, v25
  v_add_f32 v32, v32, v26
  v_add_f32 v32, v32, v27
  v_add_f32 v32, v32, v28
  v_add_f32 v32, v32, v29
  v_add_f32 v32, v32, v30
  v_add_f32 v32, v32, v31
  v_xor_b32 v41, 1, v2
  v_lshlrev_b32 v41, 2, v41
  ds_bpermute_b32 v40, v41, v32
  s_waitcnt lgkmcnt(0)
  v_add_f32 v32, v32, v40
  v_xor_b32 v41, 2, v2
  v_lshlrev_b32 v41, 2, v41
  ds_bpermute_b32 v40, v41, v32
  s_waitcnt lgkmcnt(0)
  v_add_f32 v32, v32, v40
  v_xor_b32 v41, 4, v2
  v_lshlrev_b32 v41, 2, v41
  ds_bpermute_b32 v40, v41, v32
  s_waitcnt lgkmcnt(0)
  v_add_f32 v32, v32, v40
  v_xor_b32 v41, 8, v2
  v_lshlrev_b32 v41, 2, v41
  ds_bpermute_b32 v40, v41, v32
  s_waitcnt lgkmcnt(0)
  v_add_f32 v32, v32, v40
  v_xor_b32 v41, 16, v2
  v_lshlrev_b32 v41, 2, v41
  ds_bpermute_b32 v40, v41, v32
  s_waitcnt lgkmcnt(0)
  v_add_f32 v32, v32, v40
  v_xor_b32 v41, 32, v2
  v_lshlrev_b32 v41, 2, v41
  ds_bpermute_b32 v40, v41, v32
  s_waitcnt lgkmcnt(0)
  v_add_f32 v32, v32, v40
  v_mul_f32 v32, 0x3a800000, v32
  v_sub_f32 v34, v16, v32
  v_mul_f32 v33, v34, v34
  v_sub_f32 v34, v17, v32
  v_fma_f32 v33, v34, v34, v33
  v_sub_f32 v34, v18, v32
  v_fma_f32 v33, v34, v34, v33
  v_sub_f32 v34, v19, v32
  v_fma_f32 v33, v34, v34, v33
  v_sub_f32 v34, v20, v32
  v_fma_f32 v33, v34, v34, v33
  v_sub_f32 v34, v21, v32
  v_fma_f32 v33, v34, v34, v33
  v_sub_f32 v34, v22, v32
  v_fma_f32 v33, v34, v34, v33
  v_sub_f32 v34, v23, v32
  v_fma_f32 v33, v34, v34, v33
  v_sub_f32 v34, v24, v32
  v_fma_f32 v33, v34, v34, v33
  v_sub_f32 v34, v25, v32
  v_fma_f32 v33, v34, v34, v33
  v_sub_f32 v34, v26, v32
  v_fma_f32 v33, v34, v34, v33
  v_sub_f32 v34, v27, v32
  v_fma_f32 v33, v34, v34, v33
  v_sub_f32 v34, v28, v32
  v_fma_f32 v33, v34, v34, v33
  v_sub_f32 v34, v29, v32
  v_fma_f32 v33, v34, v34, v33
  v_sub_f32 v34, v30, v32
  v_fma_f32 v33, v34, v34, v33
  v_sub_f32 v34, v31, v32
  v_fma_f32 v33, v34, v34, v33
  v_xor_b32 v41, 1, v2
  v_lshlrev_b32 v41, 2, v41
  ds_bpermute_b32 v40, v41, v33
  s_waitcnt lgkmcnt(0)
  v_add_f32 v33, v33, v40
  v_xor_b32 v41, 2, v2
  v_lshlrev_b32 v41, 2, v41
  ds_bpermute_b32 v40, v41, v33
  s_waitcnt lgkmcnt(0)
  v_add_f32 v33, v33, v40
  v_xor_b32 v41, 4, v2
  v_lshlrev_b32 v41, 2, v41
  ds_bpermute_b32 v40, v41, v33
  s_waitcnt lgkmcnt(0)
  v_add_f32 v33, v33, v40
  v_xor_b32 v41, 8, v2
  v_lshlrev_b32 v41, 2, v41
  ds_bpermute_b32 v40, v41, v33
  s_waitcnt lgkmcnt(0)
  v_add_f32 v33, v33, v40
  v_xor_b32 v41, 16, v2
  v_lshlrev_b32 v41, 2, v41
  ds_bpermute_b32 v40, v41, v33
  s_waitcnt lgkmcnt(0)
  v_add_f32 v33, v33, v40
  v_xor_b32 v41, 32, v2
  v_lshlrev_b32 v41, 2, v41
  ds_bpermute_b32 v40, v41, v33
  s_waitcnt lgkmcnt(0)
  v_add_f32 v33, v33, v40
  v_mul_f32 v33, 0x3a800000, v33
  v_cvt_pk_bf16_f32 v32, v32, v32
  v_and_b32 v32, 0xffff0000, v32
  v_cvt_pk_bf16_f32 v33, v33, v33
  v_and_b32 v33, 0xffff0000, v33
  v_add_f32 v33, 0x3727c5ac, v33
  v_cvt_pk_bf16_f32 v33, v33, v33
  v_and_b32 v33, 0xffff0000, v33
  v_sqrt_f32 v33, v33
  s_nop 0
  v_cvt_pk_bf16_f32 v33, v33, v33
  v_and_b32 v33, 0xffff0000, v33
  v_rcp_f32 v35, v33
  s_nop 0
  v_sub_f32 v16, v16, v32
  v_cvt_pk_bf16_f32 v16, v16, v16
  v_and_b32 v16, 0xffff0000, v16
  v_mul_f32 v36, v16, v35
  v_fma_f32 v37, -v36, v33, v16
  v_fma_f32 v16, v37, v35, v36
  v_sub_f32 v17, v17, v32
  v_cvt_pk_bf16_f32 v17, v17, v17
  v_and_b32 v17, 0xffff0000, v17
  v_mul_f32 v36, v17, v35
  v_fma_f32 v37, -v36, v33, v17
  v_fma_f32 v17, v37, v35, v36
  v_sub_f32 v18, v18, v32
  v_cvt_pk_bf16_f32 v18, v18, v18
  v_and_b32 v18, 0xffff0000, v18
  v_mul_f32 v36, v18, v35
  v_fma_f32 v37, -v36, v33, v18
  v_fma_f32 v18, v37, v35, v36
  v_sub_f32 v19, v19, v32
  v_cvt_pk_bf16_f32 v19, v19, v19
  v_and_b32 v19, 0xffff0000, v19
  v_mul_f32 v36, v19, v35
  v_fma_f32 v37, -v36, v33, v19
  v_fma_f32 v19, v37, v35, v36
  v_sub_f32 v20, v20, v32
  v_cvt_pk_bf16_f32 v20, v20, v20
  v_and_b32 v20, 0xffff0000, v20
  v_mul_f32 v36, v20, v35
  v_fma_f32 v37, -v36, v33, v20
  v_fma_f32 v20, v37, v35, v36
  v_sub_f32 v21, v21, v32
  v_cvt_pk_bf16_f32 v21, v21, v21
  v_and_b32 v21, 0xffff0000, v21
  v_mul_f32 v36, v21, v35
  v_fma_f32 v37, -v36, v33, v21
  v_fma_f32 v21, v37, v35, v36
  v_sub_f32 v22, v22, v32
  v_cvt_pk_bf16_f32 v22, v22, v22
  v_and_b32 v22, 0xffff0000, v22
  v_mul_f32 v36, v22, v35
  v_fma_f32 v37, -v36, v33, v22
  v_fma_f32 v22, v37, v35, v36
  v_sub_f32 v23, v23, v32
  v_cvt_pk_bf16_f32 v23, v23, v23
  v_and_b32 v23, 0xffff0000, v23
  v_mul_f32 v36, v23, v35
  v_fma_f32 v37, -v36, v33, v23
  v_fma_f32 v23, v37, v35, v36
  v_sub_f32 v24, v24, v32
  v_cvt_pk_bf16_f32 v24, v24, v24
  v_and_b32 v24, 0xffff0000, v24
  v_mul_f32 v36, v24, v35
  v_fma_f32 v37, -v36, v33, v24
  v_fma_f32 v24, v37, v35, v36
  v_sub_f32 v25, v25, v32
  v_cvt_pk_bf16_f32 v25, v25, v25
  v_and_b32 v25, 0xffff0000, v25
  v_mul_f32 v36, v25, v35
  v_fma_f32 v37, -v36, v33, v25
  v_fma_f32 v25, v37, v35, v36
  v_sub_f32 v26, v26, v32
  v_cvt_pk_bf16_f32 v26, v26, v26
  v_and_b32 v26, 0xffff0000, v26
  v_mul_f32 v36, v26, v35
  v_fma_f32 v37, -v36, v33, v26
  v_fma_f32 v26, v37, v35, v36
  v_sub_f32 v27, v27, v32
  v_cvt_pk_bf16_f32 v27, v27, v27
  v_and_b32 v27, 0xffff0000, v27
  v_mul_f32 v36, v27, v35
  v_fma_f32 v37, -v36, v33, v27
  v_fma_f32 v27, v37, v35, v36
  v_sub_f32 v28, v28, v32
  v_cvt_pk_bf16_f32 v28, v28, v28
  v_and_b32 v28, 0xffff0000, v28
  v_mul_f32 v36, v28, v35
  v_fma_f32 v37, -v36, v33, v28
  v_fma_f32 v28, v37, v35, v36
  v_sub_f32 v29, v29, v32
  v_cvt_pk_bf16_f32 v29, v29, v29
  v_and_b32 v29, 0xffff0000, v29
  v_mul_f32 v36, v29, v35
  v_fma_f32 v37, -v36, v33, v29
  v_fma_f32 v29, v37, v35, v36
  v_sub_f32 v30, v30, v32
  v_cvt_pk_bf16_f32 v30, v30, v30
  v_and_b32 v30, 0xffff0000, v30
  v_mul_f32 v36, v30, v35
  v_fma_f32 v37, -v36, v33, v30
  v_fma_f32 v30, v37, v35, v36
  v_sub_f32 v31, v31, v32
  v_cvt_pk_bf16_f32 v31, v31, v31
  v_and_b32 v31, 0xffff0000, v31
  v_mul_f32 v36, v31, v35
  v_fma_f32 v37, -v36, v33, v31
  v_fma_f32 v31, v37, v35, v36
  v_cvt_pk_bf16_f32 v8, v16, v17
  v_cvt_pk_bf16_f32 v9, v18, v19
  v_cvt_pk_bf16_f32 v10, v20, v21
  v_cvt_pk_bf16_f32 v11, v22, v23
  v_cvt_pk_bf16_f32 v12, v24, v25
  v_cvt_pk_bf16_f32 v13, v26, v27
  v_cvt_pk_bf16_f32 v14, v28, v29
  v_cvt_pk_bf16_f32 v15, v30, v31
  buffer_store_dwordx4 v[8:11], v4, s[28:31], 0 offen
  buffer_store_dwordx4 v[12:15], v4, s[28:31], 0 offen offset:1024
L_ln0_kernel_end:
  s_endpgm
.globl gemmq0_kernel
.p2align 8
.type gemmq0_kernel,@function
gemmq0_kernel:
  s_cmp_ge_u32 s2, 256
  s_cbranch_scc1 L_gemmq0_kernel_end
  s_load_dwordx16 s[4:19], s[0:1], 0
  s_load_dwordx2 s[20:21], s[0:1], 64
  s_waitcnt lgkmcnt(0)
  s_mov_b32 s24, s20
  s_and_b32 s25, s21, 0xffff
  s_mov_b32 s26, 4194304
  s_mov_b32 s27, 0x00020000
  s_mov_b32 s28, s6
  s_and_b32 s29, s7, 0xffff
  s_mov_b32 s30, 6291456
  s_mov_b32 s31, 0x00020000
  s_add_u32 s32, s20, 4194304
  s_addc_u32 s33, s21, 0
  s_and_b32 s33, s33, 0xffff
  s_mov_b32 s34, 12582912
  s_mov_b32 s35, 0x00020000
  s_mov_b32 s3, 268435457
  s_mul_hi_u32 s40, s2, s3
  s_mul_i32 s3, s40, 16
  s_sub_u32 s41, s2, s3
  v_and_b32 v1, 63, v0
  v_lshrrev_b32 v2, 6, v0
  s_nop 0
  v_readfirstlane_b32 s42, v2
  v_lshrrev_b32 v14, 3, v1
  v_and_b32 v15, 7, v1
  v_xor_b32 v3, v14, v15
  v_lshlrev_b32 v4, 11, v14
  v_lshl_add_u32 v4, v3, 4, v4
  v_bfe_u32 v3, v1, 4, 1
  v_and_b32 v5, 1, v2
  v_lshl_add_u32 v3, v5, 1, v3
  v_lshrrev_b32 v5, 1, v15
  v_xor_b32 v3, v3, v5
  v_lshlrev_b32 v3, 1, v3
  v_and_b32 v5, 1, v15
  v_or_b32 v3, v3, v5
  v_lshl_add_u32 v5, v2, 3, v14
  v_mul_u32_u24 v5, 6144, v5
  v_lshl_add_u32 v5, v3, 4, v5
  s_mul_i32 s44, s40, 262144
  s_lshl_b32 s3, s42, 14
  s_add_u32 s44, s44, s3
  s_add_u32 s45, s44, 131072
  s_mul_i32 s46, s41, 384
  s_add_u32 s47, s46, 128
  s_add_u32 s48, s46, 256
  s_lshl_b32 s43, s42, 10
  v_and_b32 v6, 3, v2
  v_lshrrev_b32 v7, 2, v2
  v_and_b32 v14, 15, v1
  v_lshrrev_b32 v15, 4, v1
  v_mul_u32_u24 v8, 64, v7
  v_add_u32 v8, v8, v14
  v_lshlrev_b32 v8, 7, v8
  v_and_b32 v3, 7, v1
  v_xor_b32 v3, v3, v15
  v_lshl_add_u32 v9, v3, 4, v8
  v_xor_b32 v3, 4, v3
  v_lshl_add_u32 v8, v3, 4, v8
  v_mov_b32 v3, v9
  v_mov_b32 v9, v8
  v_mov_b32 v8, v3
  v_bfe_u32 v3, v1, 2, 2
  v_lshl_add_u32 v10, v15, 3, v3
  v_lshlrev_b32 v10, 7, v10
  v_and_b32 v11, 3, v1
  v_lshl_add_u32 v10, v11, 3, v10
  v_lshrrev_b32 v3, 1, v3
  v_and_b32 v11, 1, v15
  v_lshl_add_u32 v3, v11, 1, v3
  v_mul_u32_u24 v11, 3, v6
  v_add_u32 v120, 0, v11
  v_and_b32 v121, 3, v120
  v_xor_b32 v121, v121, v3
  v_lshlrev_b32 v121, 5, v121
  v_lshrrev_b32 v120, 2, v120
  v_lshl_add_u32 v121, v120, 13, v121
  v_add_u32 v122, v10, v121
  v_add_u32 v122, 16384, v122
  v_add_u32 v120, 1, v11
  v_and_b32 v121, 3, v120
  v_xor_b32 v121, v121, v3
  v_lshlrev_b32 v121, 5, v121
  v_lshrrev_b32 v120, 2, v120
  v_lshl_add_u32 v121, v120, 13, v121
  v_add_u32 v123, v10, v121
  v_add_u32 v123, 16384, v123
  v_add_u32 v120, 2, v11
  v_and_b32 v121, 3, v120
  v_xor_b32 v121, v121, v3
  v_lshlrev_b32 v121, 5, v121
  v_lshrrev_b32 v120, 2, v120
  v_lshl_add_u32 v121, v120, 13, v121
  v_add_u32 v124, v10, v121
  v_add_u32 v124, 16384, v124
  v_add_u32 v128, 0, v8
  v_add_u32 v129, 0, v9
  v_add_u32 v134, 0, v122
  v_add_u32 v135, 0, v123
  v_add_u32 v136, 0, v124
  v_add_u32 v130, 40960, v8
  v_add_u32 v131, 40960, v9
  v_add_u32 v137, 40960, v122
  v_add_u32 v138, 40960, v123
  v_add_u32 v139, 40960, v124
  v_add_u32 v132, 81920, v8
  v_add_u32 v133, 81920, v9
  v_add_u32 v140, 81920, v122
  v_add_u32 v141, 81920, v123
  v_add_u32 v142, 81920, v124
  s_mul_i32 s3, s40, 128
  v_mul_u32_u24 v13, 64, v7
  v_add_u32 v13, v13, v14
  v_add_u32 v13, s3, v13
  v_mul_u32_u24 v13, 6144, v13
  s_mul_i32 s3, s41, 384
  v_mul_u32_u24 v3, 96, v6
  v_add_u32 v13, v13, v3
  v_lshl_add_u32 v13, v15, 3, v13
  v_add_u32 v13, s3, v13
  v_mov_b32 v72, 0
  v_mov_b32 v73, 0
  v_mov_b32 v74, 0
  v_mov_b32 v75, 0
  v_mov_b32 v76, 0
  v_mov_b32 v77, 0
  v_mov_b32 v78, 0
  v_mov_b32 v79, 0
  v_mov_b32 v80, 0
  v_mov_b32 v81, 0
  v_mov_b32 v82, 0
  v_mov_b32 v83, 0
  v_mov_b32 v84, 0
  v_mov_b32 v85, 0
  v_mov_b32 v86, 0
  v_mov_b32 v87, 0
  v_mov_b32 v88, 0
  v_mov_b32 v89, 0
  v_mov_b32 v90, 0
  v_mov_b32 v91, 0
  v_mov_b32 v92, 0
  v_mov_b32 v93, 0
  v_mov_b32 v94, 0
  v_mov_b32 v95, 0
  v_mov_b32 v96, 0
  v_mov_b32 v97, 0
  v_mov_b32 v98, 0
  v_mov_b32 v99, 0
  v_mov_b32 v100, 0
  v_mov_b32 v101, 0
  v_mov_b32 v102, 0
  v_mov_b32 v103, 0
  v_mov_b32 v104, 0
  v_mov_b32 v105, 0
  v_mov_b32 v106, 0
  v_mov_b32 v107, 0
  v_mov_b32 v108, 0
  v_mov_b32 v109, 0
  v_mov_b32 v110, 0
  v_mov_b32 v111, 0
  v_mov_b32 v112, 0
  v_mov_b32 v113, 0
  v_mov_b32 v114, 0
  v_mov_b32 v115, 0
  v_mov_b32 v116, 0
  v_mov_b32 v117, 0
  v_mov_b32 v118, 0
  v_mov_b32 v119, 0
  s_add_u32 m0, s43, 0
  s_nop 0
  buffer_load_dwordx4 v4, s[24:27], s44 offen lds
  s_add_u32 s44, s44, 128
  s_add_u32 m0, s43, 8192
  s_nop 0
  buffer_load_dwordx4 v4, s[24:27], s45 offen lds
  s_add_u32 s45, s45, 128
  s_add_u32 m0, s43, 16384
  s_nop 0
  buffer_load_dwordx4 v5, s[28:31], s46 offen lds
  s_add_u32 s46, s46, 393216
  s_add_u32 m0, s43, 24576
  s_nop 0
  buffer_load_dwordx4 v5, s[28:31], s47 offen lds
  s_add_u32 s47, s47, 393216
  s_add_u32 m0, s43, 32768
  s_nop 0
  buffer_load_dwordx4 v5, s[28:31], s48 offen lds
  s_add_u32 s48, s48, 393216
  s_add_u32 m0, s43, 40960
  s_nop 0
  buffer_load_dwordx4 v4, s[24:27], s44 offen lds
  s_add_u32 s44, s44, 128
  s_add_u32 m0, s43, 49152
  s_nop 0
  buffer_load_dwordx4 v4, s[24:27], s45 offen lds
  s_add_u32 s45, s45, 128
  s_add_u32 m0, s43, 57344
  s_nop 0
  buffer_load_dwordx4 v5, s[28:31], s46 offen lds
  s_add_u32 s46, s46, 393216
  s_add_u32 m0, s43, 65536
  s_nop 0
  buffer_load_dwordx4 v5, s[28:31], s47 offen lds
  s_add_u32 s47, s47, 393216
  s_add_u32 m0, s43, 73728
  s_nop 0
  buffer_load_dwordx4 v5, s[28:31], s48 offen lds
  s_add_u32 s48, s48, 393216
  s_waitcnt vmcnt(5)
  s_barrier
  s_add_u32 m0, s43, 81920
  s_nop 0
  buffer_load_dwordx4 v4, s[24:27], s44 offen lds
  s_add_u32 s44, s44, 128
  s_add_u32 m0, s43, 90112
  s_nop 0
  buffer_load_dwordx4 v4, s[24:27], s45 offen lds
  s_add_u32 s45, s45, 128
  s_add_u32 m0, s43, 98304
  s_nop 0
  buffer_load_dwordx4 v5, s[28:31], s46 offen lds
  s_add_u32 s46, s46, 393216
  s_add_u32 m0, s43, 106496
  s_nop 0
  buffer_load_dwordx4 v5, s[28:31], s47 offen lds
  s_add_u32 s47, s47, 393216
  s_add_u32 m0, s43, 114688
  s_nop 0
  buffer_load_dwordx4 v5, s[28:31], s48 offen lds
  s_add_u32 s48, s48, 393216
  ds_read_b128 v[16:19], v128 offset:0
  ds_read_b128 v[20:23], v128 offset:2048
  ds_read_b128 v[24:27], v128 offset:4096
  ds_read_b128 v[28:31], v128 offset:6144
  ds_read_b64_tr_b16 v[48:49], v134 offset:0
  ds_read_b64_tr_b16 v[50:51], v134 offset:512
  ds_read_b64_tr_b16 v[52:53], v135 offset:0
  ds_read_b64_tr_b16 v[54:55], v135 offset:512
  ds_read_b64_tr_b16 v[56:57], v136 offset:0
  ds_read_b64_tr_b16 v[58:59], v136 offset:512
  ds_read_b128 v[32:35], v129 offset:0
  ds_read_b128 v[36:39], v129 offset:2048
  ds_read_b128 v[40:43], v129 offset:4096
  ds_read_b128 v[44:47], v129 offset:6144
  ds_read_b64_tr_b16 v[60:61], v134 offset:4096
  ds_read_b64_tr_b16 v[62:63], v134 offset:4608
  ds_read_b64_tr_b16 v[64:65], v135 offset:4096
  ds_read_b64_tr_b16 v[66:67], v135 offset:4608
  ds_read_b64_tr_b16 v[68:69], v136 offset:4096
  ds_read_b64_tr_b16 v[70:71], v136 offset:4608
  s_waitcnt lgkmcnt(10)
  v_mfma_f32_16x16x32_bf16 v[72:75], v[48:51], v[16:19], v[72:75]
  v_mfma_f32_16x16x32_bf16 v[76:79], v[52:55], v[16:19], v[76:79]
  v_mfma_f32_16x16x32_bf16 v[80:83], v[56:59], v[16:19], v[80:83]
  v_mfma_f32_16x16x32_bf16 v[84:87], v[48:51], v[20:23], v[84:87]
  v_mfma_f32_16x16x32_bf16 v[88:91], v[52:55], v[20:23], v[88:91]
  v_mfma_f32_16x16x32_bf16 v[92:95], v[56:59], v[20:23], v[92:95]
  v_mfma_f32_16x16x32_bf16 v[96:99], v[48:51], v[24:27], v[96:99]
  v_mfma_f32_16x16x32_bf16 v[100:103], v[52:55], v[24:27], v[100:103]
  v_mfma_f32_16x16x32_bf16 v[104:107], v[56:59], v[24:27], v[104:107]
  v_mfma_f32_16x16x32_bf16 v[108:111], v[48:51], v[28:31], v[108:111]
  v_mfma_f32_16x16x32_bf16 v[112:115], v[52:55], v[28:31], v[112:115]
  v_mfma_f32_16x16x32_bf16 v[116:119], v[56:59], v[28:31], v[116:119]
  s_waitcnt lgkmcnt(0)
  v_mfma_f32_16x16x32_bf16 v[72:75], v[60:63], v[32:35], v[72:75]
  v_mfma_f32_16x16x32_bf16 v[76:79], v[64:67], v[32:35], v[76:79]
  v_mfma_f32_16x16x32_bf16 v[80:83], v[68:71], v[32:35], v[80:83]
  v_mfma_f32_16x16x32_bf16 v[84:87], v[60:63], v[36:39], v[84:87]
  v_mfma_f32_16x16x32_bf16 v[88:91], v[64:67], v[36:39], v[88:91]
  v_mfma_f32_16x16x32_bf16 v[92:95], v[68:71], v[36:39], v[92:95]
  v_mfma_f32_16x16x32_bf16 v[96:99], v[60:63], v[40:43], v[96:99]
  v_mfma_f32_16x16x32_bf16 v[100:103], v[64:67], v[40:43], v[100:103]
  v_mfma_f32_16x16x32_bf16 v[104:107], v[68:71], v[40:43], v[104:107]
  v_mfma_f32_16x16x32_bf16 v[108:111], v[60:63], v[44:47], v[108:111]
  v_mfma_f32_16x16x32_bf16 v[112:115], v[64:67], v[44:47], v[112:115]
  v_mfma_f32_16x16x32_bf16 v[116:119], v[68:71], v[44:47], v[116:119]
  s_waitcnt vmcnt(5)
  s_barrier
  s_add_u32 m0, s43, 0
  s_nop 0
  buffer_load_dwordx4 v4, s[24:27], s44 offen lds
  s_add_u32 s44, s44, 128
  s_add_u32 m0, s43, 8192
  s_nop 0
  buffer_load_dwordx4 v4, s[24:27], s45 offen lds
  s_add_u32 s45, s45, 128
  s_add_u32 m0, s43, 16384
  s_nop 0
  buffer_load_dwordx4 v5, s[28:31], s46 offen lds
  s_add_u32 s46, s46, 393216
  s_add_u32 m0, s43, 24576
  s_nop 0
  buffer_load_dwordx4 v5, s[28:31], s47 offen lds
  s_add_u32 s47, s47, 393216
  s_add_u32 m0, s43, 32768
  s_nop 0
  buffer_load_dwordx4 v5, s[28:31], s48 offen lds
  s_add_u32 s48, s48, 393216
  ds_read_b128 v[16:19], v130 offset:0
  ds_read_b128 v[20:23], v130 offset:2048
  ds_read_b128 v[24:27], v130 offset:4096
  ds_read_b128 v[28:31], v130 offset:6144
  ds_read_b64_tr_b16 v[48:49], v137 offset:0
  ds_read_b64_tr_b16 v[50:51], v137 offset:512
  ds_read_b64_tr_b16 v[52:53], v138 offset:0
  ds_read_b64_tr_b16 v[54:55], v138 offset:512
  ds_read_b64_tr_b16 v[56:57], v139 offset:0
  ds_read_b64_tr_b16 v[58:59], v139 offset:512
  ds_read_b128 v[32:35], v131 offset:0
  ds_read_b128 v[36:39], v131 offset:2048
  ds_read_b128 v[40:43], v131 offset:4096
  ds_read_b128 v[44:47], v131 offset:6144
  ds_read_b64_tr_b16 v[60:61], v137 offset:4096
  ds_read_b64_tr_b16 v[62:63], v137 offset:4608
  ds_read_b64_tr_b16 v[64:65], v138 offset:4096
  ds_read_b64_tr_b16 v[66:67], v138 offset:4608
  ds_read_b64_tr_b16 v[68:69], v139 offset:4096
  ds_read_b64_tr_b16 v[70:71], v139 offset:4608
  s_waitcnt lgkmcnt(10)
  v_mfma_f32_16x16x32_bf16 v[72:75], v[48:51], v[16:19], v[72:75]
  v_mfma_f32_16x16x32_bf16 v[76:79], v[52:55], v[16:19], v[76:79]
  v_mfma_f32_16x16x32_bf16 v[80:83], v[56:59], v[16:19], v[80:83]
  v_mfma_f32_16x16x32_bf16 v[84:87], v[48:51], v[20:23], v[84:87]
  v_mfma_f32_16x16x32_bf16 v[88:91], v[52:55], v[20:23], v[88:91]
  v_mfma_f32_16x16x32_bf16 v[92:95], v[56:59], v[20:23], v[92:95]
  v_mfma_f32_16x16x32_bf16 v[96:99], v[48:51], v[24:27], v[96:99]
  v_mfma_f32_16x16x32_bf16 v[100:103], v[52:55], v[24:27], v[100:103]
  v_mfma_f32_16x16x32_bf16 v[104:107], v[56:59], v[24:27], v[104:107]
  v_mfma_f32_16x16x32_bf16 v[108:111], v[48:51], v[28:31], v[108:111]
  v_mfma_f32_16x16x32_bf16 v[112:115], v[52:55], v[28:31], v[112:115]
  v_mfma_f32_16x16x32_bf16 v[116:119], v[56:59], v[28:31], v[116:119]
  s_waitcnt lgkmcnt(0)
  v_mfma_f32_16x16x32_bf16 v[72:75], v[60:63], v[32:35], v[72:75]
  v_mfma_f32_16x16x32_bf16 v[76:79], v[64:67], v[32:35], v[76:79]
  v_mfma_f32_16x16x32_bf16 v[80:83], v[68:71], v[32:35], v[80:83]
  v_mfma_f32_16x16x32_bf16 v[84:87], v[60:63], v[36:39], v[84:87]
  v_mfma_f32_16x16x32_bf16 v[88:91], v[64:67], v[36:39], v[88:91]
  v_mfma_f32_16x16x32_bf16 v[92:95], v[68:71], v[36:39], v[92:95]
  v_mfma_f32_16x16x32_bf16 v[96:99], v[60:63], v[40:43], v[96:99]
  v_mfma_f32_16x16x32_bf16 v[100:103], v[64:67], v[40:43], v[100:103]
  v_mfma_f32_16x16x32_bf16 v[104:107], v[68:71], v[40:43], v[104:107]
  v_mfma_f32_16x16x32_bf16 v[108:111], v[60:63], v[44:47], v[108:111]
  v_mfma_f32_16x16x32_bf16 v[112:115], v[64:67], v[44:47], v[112:115]
  v_mfma_f32_16x16x32_bf16 v[116:119], v[68:71], v[44:47], v[116:119]
  s_waitcnt vmcnt(5)
  s_barrier
  s_add_u32 m0, s43, 40960
  s_nop 0
  buffer_load_dwordx4 v4, s[24:27], s44 offen lds
  s_add_u32 s44, s44, 128
  s_add_u32 m0, s43, 49152
  s_nop 0
  buffer_load_dwordx4 v4, s[24:27], s45 offen lds
  s_add_u32 s45, s45, 128
  s_add_u32 m0, s43, 57344
  s_nop 0
  buffer_load_dwordx4 v5, s[28:31], s46 offen lds
  s_add_u32 s46, s46, 393216
  s_add_u32 m0, s43, 65536
  s_nop 0
  buffer_load_dwordx4 v5, s[28:31], s47 offen lds
  s_add_u32 s47, s47, 393216
  s_add_u32 m0, s43, 73728
  s_nop 0
  buffer_load_dwordx4 v5, s[28:31], s48 offen lds
  s_add_u32 s48, s48, 393216
  ds_read_b128 v[16:19], v132 offset:0
  ds_read_b128 v[20:23], v132 offset:2048
  ds_read_b128 v[24:27], v132 offset:4096
  ds_read_b128 v[28:31], v132 offset:6144
  ds_read_b64_tr_b16 v[48:49], v140 offset:0
  ds_read_b64_tr_b16 v[50:51], v140 offset:512
  ds_read_b64_tr_b16 v[52:53], v141 offset:0
  ds_read_b64_tr_b16 v[54:55], v141 offset:512
  ds_read_b64_tr_b16 v[56:57], v142 offset:0
  ds_read_b64_tr_b16 v[58:59], v142 offset:512
  ds_read_b128 v[32:35], v133 offset:0
  ds_read_b128 v[36:39], v133 offset:2048
  ds_read_b128 v[40:43], v133 offset:4096
  ds_read_b128 v[44:47], v133 offset:6144
  ds_read_b64_tr_b16 v[60:61], v140 offset:4096
  ds_read_b64_tr_b16 v[62:63], v140 offset:4608
  ds_read_b64_tr_b16 v[64:65], v141 offset:4096
  ds_read_b64_tr_b16 v[66:67], v141 offset:4608
  ds_read_b64_tr_b16 v[68:69], v142 offset:4096
  ds_read_b64_tr_b16 v[70:71], v142 offset:4608
  s_waitcnt lgkmcnt(10)
  v_mfma_f32_16x16x32_bf16 v[72:75], v[48:51], v[16:19], v[72:75]
  v_mfma_f32_16x16x32_bf16 v[76:79], v[52:55], v[16:19], v[76:79]
  v_mfma_f32_16x16x32_bf16 v[80:83], v[56:59], v[16:19], v[80:83]
  v_mfma_f32_16x16x32_bf16 v[84:87], v[48:51], v[20:23], v[84:87]
  v_mfma_f32_16x16x32_bf16 v[88:91], v[52:55], v[20:23], v[88:91]
  v_mfma_f32_16x16x32_bf16 v[92:95], v[56:59], v[20:23], v[92:95]
  v_mfma_f32_16x16x32_bf16 v[96:99], v[48:51], v[24:27], v[96:99]
  v_mfma_f32_16x16x32_bf16 v[100:103], v[52:55], v[24:27], v[100:103]
  v_mfma_f32_16x16x32_bf16 v[104:107], v[56:59], v[24:27], v[104:107]
  v_mfma_f32_16x16x32_bf16 v[108:111], v[48:51], v[28:31], v[108:111]
  v_mfma_f32_16x16x32_bf16 v[112:115], v[52:55], v[28:31], v[112:115]
  v_mfma_f32_16x16x32_bf16 v[116:119], v[56:59], v[28:31], v[116:119]
  s_waitcnt lgkmcnt(0)
  v_mfma_f32_16x16x32_bf16 v[72:75], v[60:63], v[32:35], v[72:75]
  v_mfma_f32_16x16x32_bf16 v[76:79], v[64:67], v[32:35], v[76:79]
  v_mfma_f32_16x16x32_bf16 v[80:83], v[68:71], v[32:35], v[80:83]
  v_mfma_f32_16x16x32_bf16 v[84:87], v[60:63], v[36:39], v[84:87]
  v_mfma_f32_16x16x32_bf16 v[88:91], v[64:67], v[36:39], v[88:91]
  v_mfma_f32_16x16x32_bf16 v[92:95], v[68:71], v[36:39], v[92:95]
  v_mfma_f32_16x16x32_bf16 v[96:99], v[60:63], v[40:43], v[96:99]
  v_mfma_f32_16x16x32_bf16 v[100:103], v[64:67], v[40:43], v[100:103]
  v_mfma_f32_16x16x32_bf16 v[104:107], v[68:71], v[40:43], v[104:107]
  v_mfma_f32_16x16x32_bf16 v[108:111], v[60:63], v[44:47], v[108:111]
  v_mfma_f32_16x16x32_bf16 v[112:115], v[64:67], v[44:47], v[112:115]
  v_mfma_f32_16x16x32_bf16 v[116:119], v[68:71], v[44:47], v[116:119]
  s_waitcnt vmcnt(5)
  s_barrier
  s_add_u32 m0, s43, 81920
  s_nop 0
  buffer_load_dwordx4 v4, s[24:27], s44 offen lds
  s_add_u32 s44, s44, 128
  s_add_u32 m0, s43, 90112
  s_nop 0
  buffer_load_dwordx4 v4, s[24:27], s45 offen lds
  s_add_u32 s45, s45, 128
  s_add_u32 m0, s43, 98304
  s_nop 0
  buffer_load_dwordx4 v5, s[28:31], s46 offen lds
  s_add_u32 s46, s46, 393216
  s_add_u32 m0, s43, 106496
  s_nop 0
  buffer_load_dwordx4 v5, s[28:31], s47 offen lds
  s_add_u32 s47, s47, 393216
  s_add_u32 m0, s43, 114688
  s_nop 0
  buffer_load_dwordx4 v5, s[28:31], s48 offen lds
  s_add_u32 s48, s48, 393216
  ds_read_b128 v[16:19], v128 offset:0
  ds_read_b128 v[20:23], v128 offset:2048
  ds_read_b128 v[24:27], v128 offset:4096
  ds_read_b128 v[28:31], v128 offset:6144
  ds_read_b64_tr_b16 v[48:49], v134 offset:0
  ds_read_b64_tr_b16 v[50:51], v134 offset:512
  ds_read_b64_tr_b16 v[52:53], v135 offset:0
  ds_read_b64_tr_b16 v[54:55], v135 offset:512
  ds_read_b64_tr_b16 v[56:57], v136 offset:0
  ds_read_b64_tr_b16 v[58:59], v136 offset:512
  ds_read_b128 v[32:35], v129 offset:0
  ds_read_b128 v[36:39], v129 offset:2048
  ds_read_b128 v[40:43], v129 offset:4096
  ds_read_b128 v[44:47], v129 offset:6144
  ds_read_b64_tr_b16 v[60:61], v134 offset:4096
  ds_read_b64_tr_b16 v[62:63], v134 offset:4608
  ds_read_b64_tr_b16 v[64:65], v135 offset:4096
  ds_read_b64_tr_b16 v[66:67], v135 offset:4608
  ds_read_b64_tr_b16 v[68:69], v136 offset:4096
  ds_read_b64_tr_b16 v[70:71], v136 offset:4608
  s_waitcnt lgkmcnt(10)
  v_mfma_f32_16x16x32_bf16 v[72:75], v[48:51], v[16:19], v[72:75]
  v_mfma_f32_16x16x32_bf16 v[76:79], v[52:55], v[16:19], v[76:79]
  v_mfma_f32_16x16x32_bf16 v[80:83], v[56:59], v[16:19], v[80:83]
  v_mfma_f32_16x16x32_bf16 v[84:87], v[48:51], v[20:23], v[84:87]
  v_mfma_f32_16x16x32_bf16 v[88:91], v[52:55], v[20:23], v[88:91]
  v_mfma_f32_16x16x32_bf16 v[92:95], v[56:59], v[20:23], v[92:95]
  v_mfma_f32_16x16x32_bf16 v[96:99], v[48:51], v[24:27], v[96:99]
  v_mfma_f32_16x16x32_bf16 v[100:103], v[52:55], v[24:27], v[100:103]
  v_mfma_f32_16x16x32_bf16 v[104:107], v[56:59], v[24:27], v[104:107]
  v_mfma_f32_16x16x32_bf16 v[108:111], v[48:51], v[28:31], v[108:111]
  v_mfma_f32_16x16x32_bf16 v[112:115], v[52:55], v[28:31], v[112:115]
  v_mfma_f32_16x16x32_bf16 v[116:119], v[56:59], v[28:31], v[116:119]
  s_waitcnt lgkmcnt(0)
  v_mfma_f32_16x16x32_bf16 v[72:75], v[60:63], v[32:35], v[72:75]
  v_mfma_f32_16x16x32_bf16 v[76:79], v[64:67], v[32:35], v[76:79]
  v_mfma_f32_16x16x32_bf16 v[80:83], v[68:71], v[32:35], v[80:83]
  v_mfma_f32_16x16x32_bf16 v[84:87], v[60:63], v[36:39], v[84:87]
  v_mfma_f32_16x16x32_bf16 v[88:91], v[64:67], v[36:39], v[88:91]
  v_mfma_f32_16x16x32_bf16 v[92:95], v[68:71], v[36:39], v[92:95]
  v_mfma_f32_16x16x32_bf16 v[96:99], v[60:63], v[40:43], v[96:99]
  v_mfma_f32_16x16x32_bf16 v[100:103], v[64:67], v[40:43], v[100:103]
  v_mfma_f32_16x16x32_bf16 v[104:107], v[68:71], v[40:43], v[104:107]
  v_mfma_f32_16x16x32_bf16 v[108:111], v[60:63], v[44:47], v[108:111]
  v_mfma_f32_16x16x32_bf16 v[112:115], v[64:67], v[44:47], v[112:115]
  v_mfma_f32_16x16x32_bf16 v[116:119], v[68:71], v[44:47], v[116:119]
  s_waitcnt vmcnt(5)
  s_barrier
  s_add_u32 m0, s43, 0
  s_nop 0
  buffer_load_dwordx4 v4, s[24:27], s44 offen lds
  s_add_u32 s44, s44, 128
  s_add_u32 m0, s43, 8192
  s_nop 0
  buffer_load_dwordx4 v4, s[24:27], s45 offen lds
  s_add_u32 s45, s45, 128
  s_add_u32 m0, s43, 16384
  s_nop 0
  buffer_load_dwordx4 v5, s[28:31], s46 offen lds
  s_add_u32 s46, s46, 393216
  s_add_u32 m0, s43, 24576
  s_nop 0
  buffer_load_dwordx4 v5, s[28:31], s47 offen lds
  s_add_u32 s47, s47, 393216
  s_add_u32 m0, s43, 32768
  s_nop 0
  buffer_load_dwordx4 v5, s[28:31], s48 offen lds
  s_add_u32 s48, s48, 393216
  ds_read_b128 v[16:19], v130 offset:0
  ds_read_b128 v[20:23], v130 offset:2048
  ds_read_b128 v[24:27], v130 offset:4096
  ds_read_b128 v[28:31], v130 offset:6144
  ds_read_b64_tr_b16 v[48:49], v137 offset:0
  ds_read_b64_tr_b16 v[50:51], v137 offset:512
  ds_read_b64_tr_b16 v[52:53], v138 offset:0
  ds_read_b64_tr_b16 v[54:55], v138 offset:512
  ds_read_b64_tr_b16 v[56:57], v139 offset:0
  ds_read_b64_tr_b16 v[58:59], v139 offset:512
  ds_read_b128 v[32:35], v131 offset:0
  ds_read_b128 v[36:39], v131 offset:2048
  ds_read_b128 v[40:43], v131 offset:4096
  ds_read_b128 v[44:47], v131 offset:6144
  ds_read_b64_tr_b16 v[60:61], v137 offset:4096
  ds_read_b64_tr_b16 v[62:63], v137 offset:4608
  ds_read_b64_tr_b16 v[64:65], v138 offset:4096
  ds_read_b64_tr_b16 v[66:67], v138 offset:4608
  ds_read_b64_tr_b16 v[68:69], v139 offset:4096
  ds_read_b64_tr_b16 v[70:71], v139 offset:4608
  s_waitcnt lgkmcnt(10)
  v_mfma_f32_16x16x32_bf16 v[72:75], v[48:51], v[16:19], v[72:75]
  v_mfma_f32_16x16x32_bf16 v[76:79], v[52:55], v[16:19], v[76:79]
  v_mfma_f32_16x16x32_bf16 v[80:83], v[56:59], v[16:19], v[80:83]
  v_mfma_f32_16x16x32_bf16 v[84:87], v[48:51], v[20:23], v[84:87]
  v_mfma_f32_16x16x32_bf16 v[88:91], v[52:55], v[20:23], v[88:91]
  v_mfma_f32_16x16x32_bf16 v[92:95], v[56:59], v[20:23], v[92:95]
  v_mfma_f32_16x16x32_bf16 v[96:99], v[48:51], v[24:27], v[96:99]
  v_mfma_f32_16x16x32_bf16 v[100:103], v[52:55], v[24:27], v[100:103]
  v_mfma_f32_16x16x32_bf16 v[104:107], v[56:59], v[24:27], v[104:107]
  v_mfma_f32_16x16x32_bf16 v[108:111], v[48:51], v[28:31], v[108:111]
  v_mfma_f32_16x16x32_bf16 v[112:115], v[52:55], v[28:31], v[112:115]
  v_mfma_f32_16x16x32_bf16 v[116:119], v[56:59], v[28:31], v[116:119]
  s_waitcnt lgkmcnt(0)
  v_mfma_f32_16x16x32_bf16 v[72:75], v[60:63], v[32:35], v[72:75]
  v_mfma_f32_16x16x32_bf16 v[76:79], v[64:67], v[32:35], v[76:79]
  v_mfma_f32_16x16x32_bf16 v[80:83], v[68:71], v[32:35], v[80:83]
  v_mfma_f32_16x16x32_bf16 v[84:87], v[60:63], v[36:39], v[84:87]
  v_mfma_f32_16x16x32_bf16 v[88:91], v[64:67], v[36:39], v[88:91]
  v_mfma_f32_16x16x32_bf16 v[92:95], v[68:71], v[36:39], v[92:95]
  v_mfma_f32_16x16x32_bf16 v[96:99], v[60:63], v[40:43], v[96:99]
  v_mfma_f32_16x16x32_bf16 v[100:103], v[64:67], v[40:43], v[100:103]
  v_mfma_f32_16x16x32_bf16 v[104:107], v[68:71], v[40:43], v[104:107]
  v_mfma_f32_16x16x32_bf16 v[108:111], v[60:63], v[44:47], v[108:111]
  v_mfma_f32_16x16x32_bf16 v[112:115], v[64:67], v[44:47], v[112:115]
  v_mfma_f32_16x16x32_bf16 v[116:119], v[68:71], v[44:47], v[116:119]
  s_waitcnt vmcnt(5)
  s_barrier
  s_add_u32 m0, s43, 40960
  s_nop 0
  buffer_load_dwordx4 v4, s[24:27], s44 offen lds
  s_add_u32 s44, s44, 128
  s_add_u32 m0, s43, 49152
  s_nop 0
  buffer_load_dwordx4 v4, s[24:27], s45 offen lds
  s_add_u32 s45, s45, 128
  s_add_u32 m0, s43, 57344
  s_nop 0
  buffer_load_dwordx4 v5, s[28:31], s46 offen lds
  s_add_u32 s46, s46, 393216
  s_add_u32 m0, s43, 65536
  s_nop 0
  buffer_load_dwordx4 v5, s[28:31], s47 offen lds
  s_add_u32 s47, s47, 393216
  s_add_u32 m0, s43, 73728
  s_nop 0
  buffer_load_dwordx4 v5, s[28:31], s48 offen lds
  s_add_u32 s48, s48, 393216
  ds_read_b128 v[16:19], v132 offset:0
  ds_read_b128 v[20:23], v132 offset:2048
  ds_read_b128 v[24:27], v132 offset:4096
  ds_read_b128 v[28:31], v132 offset:6144
  ds_read_b64_tr_b16 v[48:49], v140 offset:0
  ds_read_b64_tr_b16 v[50:51], v140 offset:512
  ds_read_b64_tr_b16 v[52:53], v141 offset:0
  ds_read_b64_tr_b16 v[54:55], v141 offset:512
  ds_read_b64_tr_b16 v[56:57], v142 offset:0
  ds_read_b64_tr_b16 v[58:59], v142 offset:512
  ds_read_b128 v[32:35], v133 offset:0
  ds_read_b128 v[36:39], v133 offset:2048
  ds_read_b128 v[40:43], v133 offset:4096
  ds_read_b128 v[44:47], v133 offset:6144
  ds_read_b64_tr_b16 v[60:61], v140 offset:4096
  ds_read_b64_tr_b16 v[62:63], v140 offset:4608
  ds_read_b64_tr_b16 v[64:65], v141 offset:4096
  ds_read_b64_tr_b16 v[66:67], v141 offset:4608
  ds_read_b64_tr_b16 v[68:69], v142 offset:4096
  ds_read_b64_tr_b16 v[70:71], v142 offset:4608
  s_waitcnt lgkmcnt(10)
  v_mfma_f32_16x16x32_bf16 v[72:75], v[48:51], v[16:19], v[72:75]
  v_mfma_f32_16x16x32_bf16 v[76:79], v[52:55], v[16:19], v[76:79]
  v_mfma_f32_16x16x32_bf16 v[80:83], v[56:59], v[16:19], v[80:83]
  v_mfma_f32_16x16x32_bf16 v[84:87], v[48:51], v[20:23], v[84:87]
  v_mfma_f32_16x16x32_bf16 v[88:91], v[52:55], v[20:23], v[88:91]
  v_mfma_f32_16x16x32_bf16 v[92:95], v[56:59], v[20:23], v[92:95]
  v_mfma_f32_16x16x32_bf16 v[96:99], v[48:51], v[24:27], v[96:99]
  v_mfma_f32_16x16x32_bf16 v[100:103], v[52:55], v[24:27], v[100:103]
  v_mfma_f32_16x16x32_bf16 v[104:107], v[56:59], v[24:27], v[104:107]
  v_mfma_f32_16x16x32_bf16 v[108:111], v[48:51], v[28:31], v[108:111]
  v_mfma_f32_16x16x32_bf16 v[112:115], v[52:55], v[28:31], v[112:115]
  v_mfma_f32_16x16x32_bf16 v[116:119], v[56:59], v[28:31], v[116:119]
  s_waitcnt lgkmcnt(0)
  v_mfma_f32_16x16x32_bf16 v[72:75], v[60:63], v[32:35], v[72:75]
  v_mfma_f32_16x16x32_bf16 v[76:79], v[64:67], v[32:35], v[76:79]
  v_mfma_f32_16x16x32_bf16 v[80:83], v[68:71], v[32:35], v[80:83]
  v_mfma_f32_16x16x32_bf16 v[84:87], v[60:63], v[36:39], v[84:87]
  v_mfma_f32_16x16x32_bf16 v[88:91], v[64:67], v[36:39], v[88:91]
  v_mfma_f32_16x16x32_bf16 v[92:95], v[68:71], v[36:39], v[92:95]
  v_mfma_f32_16x16x32_bf16 v[96:99], v[60:63], v[40:43], v[96:99]
  v_mfma_f32_16x16x32_bf16 v[100:103], v[64:67], v[40:43], v[100:103]
  v_mfma_f32_16x16x32_bf16 v[104:107], v[68:71], v[40:43], v[104:107]
  v_mfma_f32_16x16x32_bf16 v[108:111], v[60:63], v[44:47], v[108:111]
  v_mfma_f32_16x16x32_bf16 v[112:115], v[64:67], v[44:47], v[112:115]
  v_mfma_f32_16x16x32_bf16 v[116:119], v[68:71], v[44:47], v[116:119]
  s_waitcnt vmcnt(5)
  s_barrier
  s_add_u32 m0, s43, 81920
  s_nop 0
  buffer_load_dwordx4 v4, s[24:27], s44 offen lds
  s_add_u32 s44, s44, 128
  s_add_u32 m0, s43, 90112
  s_nop 0
  buffer_load_dwordx4 v4, s[24:27], s45 offen lds
  s_add_u32 s45, s45, 128
  s_add_u32 m0, s43, 98304
  s_nop 0
  buffer_load_dwordx4 v5, s[28:31], s46 offen lds
  s_add_u32 s46, s46, 393216
  s_add_u32 m0, s43, 106496
  s_nop 0
  buffer_load_dwordx4 v5, s[28:31], s47 offen lds
  s_add_u32 s47, s47, 393216
  s_add_u32 m0, s43, 114688
  s_nop 0
  buffer_load_dwordx4 v5, s[28:31], s48 offen lds
  s_add_u32 s48, s48, 393216
  ds_read_b128 v[16:19], v128 offset:0
  ds_read_b128 v[20:23], v128 offset:2048
  ds_read_b128 v[24:27], v128 offset:4096
  ds_read_b128 v[28:31], v128 offset:6144
  ds_read_b64_tr_b16 v[48:49], v134 offset:0
  ds_read_b64_tr_b16 v[50:51], v134 offset:512
  ds_read_b64_tr_b16 v[52:53], v135 offset:0
  ds_read_b64_tr_b16 v[54:55], v135 offset:512
  ds_read_b64_tr_b16 v[56:57], v136 offset:0
  ds_read_b64_tr_b16 v[58:59], v136 offset:512
  ds_read_b128 v[32:35], v129 offset:0
  ds_read_b128 v[36:39], v129 offset:2048
  ds_read_b128 v[40:43], v129 offset:4096
  ds_read_b128 v[44:47], v129 offset:6144
  ds_read_b64_tr_b16 v[60:61], v134 offset:4096
  ds_read_b64_tr_b16 v[62:63], v134 offset:4608
  ds_read_b64_tr_b16 v[64:65], v135 offset:4096
  ds_read_b64_tr_b16 v[66:67], v135 offset:4608
  ds_read_b64_tr_b16 v[68:69], v136 offset:4096
  ds_read_b64_tr_b16 v[70:71], v136 offset:4608
  s_waitcnt lgkmcnt(10)
  v_mfma_f32_16x16x32_bf16 v[72:75], v[48:51], v[16:19], v[72:75]
  v_mfma_f32_16x16x32_bf16 v[76:79], v[52:55], v[16:19], v[76:79]
  v_mfma_f32_16x16x32_bf16 v[80:83], v[56:59], v[16:19], v[80:83]
  v_mfma_f32_16x16x32_bf16 v[84:87], v[48:51], v[20:23], v[84:87]
  v_mfma_f32_16x16x32_bf16 v[88:91], v[52:55], v[20:23], v[88:91]
  v_mfma_f32_16x16x32_bf16 v[92:95], v[56:59], v[20:23], v[92:95]
  v_mfma_f32_16x16x32_bf16 v[96:99], v[48:51], v[24:27], v[96:99]
  v_mfma_f32_16x16x32_bf16 v[100:103], v[52:55], v[24:27], v[100:103]
  v_mfma_f32_16x16x32_bf16 v[104:107], v[56:59], v[24:27], v[104:107]
  v_mfma_f32_16x16x32_bf16 v[108:111], v[48:51], v[28:31], v[108:111]
  v_mfma_f32_16x16x32_bf16 v[112:115], v[52:55], v[28:31], v[112:115]
  v_mfma_f32_16x16x32_bf16 v[116:119], v[56:59], v[28:31], v[116:119]
  s_waitcnt lgkmcnt(0)
  v_mfma_f32_16x16x32_bf16 v[72:75], v[60:63], v[32:35], v[72:75]
  v_mfma_f32_16x16x32_bf16 v[76:79], v[64:67], v[32:35], v[76:79]
  v_mfma_f32_16x16x32_bf16 v[80:83], v[68:71], v[32:35], v[80:83]
  v_mfma_f32_16x16x32_bf16 v[84:87], v[60:63], v[36:39], v[84:87]
  v_mfma_f32_16x16x32_bf16 v[88:91], v[64:67], v[36:39], v[88:91]
  v_mfma_f32_16x16x32_bf16 v[92:95], v[68:71], v[36:39], v[92:95]
  v_mfma_f32_16x16x32_bf16 v[96:99], v[60:63], v[40:43], v[96:99]
  v_mfma_f32_16x16x32_bf16 v[100:103], v[64:67], v[40:43], v[100:103]
  v_mfma_f32_16x16x32_bf16 v[104:107], v[68:71], v[40:43], v[104:107]
  v_mfma_f32_16x16x32_bf16 v[108:111], v[60:63], v[44:47], v[108:111]
  v_mfma_f32_16x16x32_bf16 v[112:115], v[64:67], v[44:47], v[112:115]
  v_mfma_f32_16x16x32_bf16 v[116:119], v[68:71], v[44:47], v[116:119]
  s_waitcnt vmcnt(5)
  s_barrier
  s_add_u32 m0, s43, 0
  s_nop 0
  buffer_load_dwordx4 v4, s[24:27], s44 offen lds
  s_add_u32 s44, s44, 128
  s_add_u32 m0, s43, 8192
  s_nop 0
  buffer_load_dwordx4 v4, s[24:27], s45 offen lds
  s_add_u32 s45, s45, 128
  s_add_u32 m0, s43, 16384
  s_nop 0
  buffer_load_dwordx4 v5, s[28:31], s46 offen lds
  s_add_u32 s46, s46, 393216
  s_add_u32 m0, s43, 24576
  s_nop 0
  buffer_load_dwordx4 v5, s[28:31], s47 offen lds
  s_add_u32 s47, s47, 393216
  s_add_u32 m0, s43, 32768
  s_nop 0
  buffer_load_dwordx4 v5, s[28:31], s48 offen lds
  s_add_u32 s48, s48, 393216
  ds_read_b128 v[16:19], v130 offset:0
  ds_read_b128 v[20:23], v130 offset:2048
  ds_read_b128 v[24:27], v130 offset:4096
  ds_read_b128 v[28:31], v130 offset:6144
  ds_read_b64_tr_b16 v[48:49], v137 offset:0
  ds_read_b64_tr_b16 v[50:51], v137 offset:512
  ds_read_b64_tr_b16 v[52:53], v138 offset:0
  ds_read_b64_tr_b16 v[54:55], v138 offset:512
  ds_read_b64_tr_b16 v[56:57], v139 offset:0
  ds_read_b64_tr_b16 v[58:59], v139 offset:512
  ds_read_b128 v[32:35], v131 offset:0
  ds_read_b128 v[36:39], v131 offset:2048
  ds_read_b128 v[40:43], v131 offset:4096
  ds_read_b128 v[44:47], v131 offset:6144
  ds_read_b64_tr_b16 v[60:61], v137 offset:4096
  ds_read_b64_tr_b16 v[62:63], v137 offset:4608
  ds_read_b64_tr_b16 v[64:65], v138 offset:4096
  ds_read_b64_tr_b16 v[66:67], v138 offset:4608
  ds_read_b64_tr_b16 v[68:69], v139 offset:4096
  ds_read_b64_tr_b16 v[70:71], v139 offset:4608
  s_waitcnt lgkmcnt(10)
  v_mfma_f32_16x16x32_bf16 v[72:75], v[48:51], v[16:19], v[72:75]
  v_mfma_f32_16x16x32_bf16 v[76:79], v[52:55], v[16:19], v[76:79]
  v_mfma_f32_16x16x32_bf16 v[80:83], v[56:59], v[16:19], v[80:83]
  v_mfma_f32_16x16x32_bf16 v[84:87], v[48:51], v[20:23], v[84:87]
  v_mfma_f32_16x16x32_bf16 v[88:91], v[52:55], v[20:23], v[88:91]
  v_mfma_f32_16x16x32_bf16 v[92:95], v[56:59], v[20:23], v[92:95]
  v_mfma_f32_16x16x32_bf16 v[96:99], v[48:51], v[24:27], v[96:99]
  v_mfma_f32_16x16x32_bf16 v[100:103], v[52:55], v[24:27], v[100:103]
  v_mfma_f32_16x16x32_bf16 v[104:107], v[56:59], v[24:27], v[104:107]
  v_mfma_f32_16x16x32_bf16 v[108:111], v[48:51], v[28:31], v[108:111]
  v_mfma_f32_16x16x32_bf16 v[112:115], v[52:55], v[28:31], v[112:115]
  v_mfma_f32_16x16x32_bf16 v[116:119], v[56:59], v[28:31], v[116:119]
  s_waitcnt lgkmcnt(0)
  v_mfma_f32_16x16x32_bf16 v[72:75], v[60:63], v[32:35], v[72:75]
  v_mfma_f32_16x16x32_bf16 v[76:79], v[64:67], v[32:35], v[76:79]
  v_mfma_f32_16x16x32_bf16 v[80:83], v[68:71], v[32:35], v[80:83]
  v_mfma_f32_16x16x32_bf16 v[84:87], v[60:63], v[36:39], v[84:87]
  v_mfma_f32_16x16x32_bf16 v[88:91], v[64:67], v[36:39], v[88:91]
  v_mfma_f32_16x16x32_bf16 v[92:95], v[68:71], v[36:39], v[92:95]
  v_mfma_f32_16x16x32_bf16 v[96:99], v[60:63], v[40:43], v[96:99]
  v_mfma_f32_16x16x32_bf16 v[100:103], v[64:67], v[40:43], v[100:103]
  v_mfma_f32_16x16x32_bf16 v[104:107], v[68:71], v[40:43], v[104:107]
  v_mfma_f32_16x16x32_bf16 v[108:111], v[60:63], v[44:47], v[108:111]
  v_mfma_f32_16x16x32_bf16 v[112:115], v[64:67], v[44:47], v[112:115]
  v_mfma_f32_16x16x32_bf16 v[116:119], v[68:71], v[44:47], v[116:119]
  s_waitcnt vmcnt(5)
  s_barrier
  s_add_u32 m0, s43, 40960
  s_nop 0
  buffer_load_dwordx4 v4, s[24:27], s44 offen lds
  s_add_u32 s44, s44, 128
  s_add_u32 m0, s43, 49152
  s_nop 0
  buffer_load_dwordx4 v4, s[24:27], s45 offen lds
  s_add_u32 s45, s45, 128
  s_add_u32 m0, s43, 57344
  s_nop 0
  buffer_load_dwordx4 v5, s[28:31], s46 offen lds
  s_add_u32 s46, s46, 393216
  s_add_u32 m0, s43, 65536
  s_nop 0
  buffer_load_dwordx4 v5, s[28:31], s47 offen lds
  s_add_u32 s47, s47, 393216
  s_add_u32 m0, s43, 73728
  s_nop 0
  buffer_load_dwordx4 v5, s[28:31], s48 offen lds
  s_add_u32 s48, s48, 393216
  ds_read_b128 v[16:19], v132 offset:0
  ds_read_b128 v[20:23], v132 offset:2048
  ds_read_b128 v[24:27], v132 offset:4096
  ds_read_b128 v[28:31], v132 offset:6144
  ds_read_b64_tr_b16 v[48:49], v140 offset:0
  ds_read_b64_tr_b16 v[50:51], v140 offset:512
  ds_read_b64_tr_b16 v[52:53], v141 offset:0
  ds_read_b64_tr_b16 v[54:55], v141 offset:512
  ds_read_b64_tr_b16 v[56:57], v142 offset:0
  ds_read_b64_tr_b16 v[58:59], v142 offset:512
  ds_read_b128 v[32:35], v133 offset:0
  ds_read_b128 v[36:39], v133 offset:2048
  ds_read_b128 v[40:43], v133 offset:4096
  ds_read_b128 v[44:47], v133 offset:6144
  ds_read_b64_tr_b16 v[60:61], v140 offset:4096
  ds_read_b64_tr_b16 v[62:63], v140 offset:4608
  ds_read_b64_tr_b16 v[64:65], v141 offset:4096
  ds_read_b64_tr_b16 v[66:67], v141 offset:4608
  ds_read_b64_tr_b16 v[68:69], v142 offset:4096
  ds_read_b64_tr_b16 v[70:71], v142 offset:4608
  s_waitcnt lgkmcnt(10)
  v_mfma_f32_16x16x32_bf16 v[72:75], v[48:51], v[16:19], v[72:75]
  v_mfma_f32_16x16x32_bf16 v[76:79], v[52:55], v[16:19], v[76:79]
  v_mfma_f32_16x16x32_bf16 v[80:83], v[56:59], v[16:19], v[80:83]
  v_mfma_f32_16x16x32_bf16 v[84:87], v[48:51], v[20:23], v[84:87]
  v_mfma_f32_16x16x32_bf16 v[88:91], v[52:55], v[20:23], v[88:91]
  v_mfma_f32_16x16x32_bf16 v[92:95], v[56:59], v[20:23], v[92:95]
  v_mfma_f32_16x16x32_bf16 v[96:99], v[48:51], v[24:27], v[96:99]
  v_mfma_f32_16x16x32_bf16 v[100:103], v[52:55], v[24:27], v[100:103]
  v_mfma_f32_16x16x32_bf16 v[104:107], v[56:59], v[24:27], v[104:107]
  v_mfma_f32_16x16x32_bf16 v[108:111], v[48:51], v[28:31], v[108:111]
  v_mfma_f32_16x16x32_bf16 v[112:115], v[52:55], v[28:31], v[112:115]
  v_mfma_f32_16x16x32_bf16 v[116:119], v[56:59], v[28:31], v[116:119]
  s_waitcnt lgkmcnt(0)
  v_mfma_f32_16x16x32_bf16 v[72:75], v[60:63], v[32:35], v[72:75]
  v_mfma_f32_16x16x32_bf16 v[76:79], v[64:67], v[32:35], v[76:79]
  v_mfma_f32_16x16x32_bf16 v[80:83], v[68:71], v[32:35], v[80:83]
  v_mfma_f32_16x16x32_bf16 v[84:87], v[60:63], v[36:39], v[84:87]
  v_mfma_f32_16x16x32_bf16 v[88:91], v[64:67], v[36:39], v[88:91]
  v_mfma_f32_16x16x32_bf16 v[92:95], v[68:71], v[36:39], v[92:95]
  v_mfma_f32_16x16x32_bf16 v[96:99], v[60:63], v[40:43], v[96:99]
  v_mfma_f32_16x16x32_bf16 v[100:103], v[64:67], v[40:43], v[100:103]
  v_mfma_f32_16x16x32_bf16 v[104:107], v[68:71], v[40:43], v[104:107]
  v_mfma_f32_16x16x32_bf16 v[108:111], v[60:63], v[44:47], v[108:111]
  v_mfma_f32_16x16x32_bf16 v[112:115], v[64:67], v[44:47], v[112:115]
  v_mfma_f32_16x16x32_bf16 v[116:119], v[68:71], v[44:47], v[116:119]
  s_waitcnt vmcnt(5)
  s_barrier
  s_add_u32 m0, s43, 81920
  s_nop 0
  buffer_load_dwordx4 v4, s[24:27], s44 offen lds
  s_add_u32 s44, s44, 128
  s_add_u32 m0, s43, 90112
  s_nop 0
  buffer_load_dwordx4 v4, s[24:27], s45 offen lds
  s_add_u32 s45, s45, 128
  s_add_u32 m0, s43, 98304
  s_nop 0
  buffer_load_dwordx4 v5, s[28:31], s46 offen lds
  s_add_u32 s46, s46, 393216
  s_add_u32 m0, s43, 106496
  s_nop 0
  buffer_load_dwordx4 v5, s[28:31], s47 offen lds
  s_add_u32 s47, s47, 393216
  s_add_u32 m0, s43, 114688
  s_nop 0
  buffer_load_dwordx4 v5, s[28:31], s48 offen lds
  s_add_u32 s48, s48, 393216
  ds_read_b128 v[16:19], v128 offset:0
  ds_read_b128 v[20:23], v128 offset:2048
  ds_read_b128 v[24:27], v128 offset:4096
  ds_read_b128 v[28:31], v128 offset:6144
  ds_read_b64_tr_b16 v[48:49], v134 offset:0
  ds_read_b64_tr_b16 v[50:51], v134 offset:512
  ds_read_b64_tr_b16 v[52:53], v135 offset:0
  ds_read_b64_tr_b16 v[54:55], v135 offset:512
  ds_read_b64_tr_b16 v[56:57], v136 offset:0
  ds_read_b64_tr_b16 v[58:59], v136 offset:512
  ds_read_b128 v[32:35], v129 offset:0
  ds_read_b128 v[36:39], v129 offset:2048
  ds_read_b128 v[40:43], v129 offset:4096
  ds_read_b128 v[44:47], v129 offset:6144
  ds_read_b64_tr_b16 v[60:61], v134 offset:4096
  ds_read_b64_tr_b16 v[62:63], v134 offset:4608
  ds_read_b64_tr_b16 v[64:65], v135 offset:4096
  ds_read_b64_tr_b16 v[66:67], v135 offset:4608
  ds_read_b64_tr_b16 v[68:69], v136 offset:4096
  ds_read_b64_tr_b16 v[70:71], v136 offset:4608
  s_waitcnt lgkmcnt(10)
  v_mfma_f32_16x16x32_bf16 v[72:75], v[48:51], v[16:19], v[72:75]
  v_mfma_f32_16x16x32_bf16 v[76:79], v[52:55], v[16:19], v[76:79]
  v_mfma_f32_16x16x32_bf16 v[80:83], v[56:59], v[16:19], v[80:83]
  v_mfma_f32_16x16x32_bf16 v[84:87], v[48:51], v[20:23], v[84:87]
  v_mfma_f32_16x16x32_bf16 v[88:91], v[52:55], v[20:23], v[88:91]
  v_mfma_f32_16x16x32_bf16 v[92:95], v[56:59], v[20:23], v[92:95]
  v_mfma_f32_16x16x32_bf16 v[96:99], v[48:51], v[24:27], v[96:99]
  v_mfma_f32_16x16x32_bf16 v[100:103], v[52:55], v[24:27], v[100:103]
  v_mfma_f32_16x16x32_bf16 v[104:107], v[56:59], v[24:27], v[104:107]
  v_mfma_f32_16x16x32_bf16 v[108:111], v[48:51], v[28:31], v[108:111]
  v_mfma_f32_16x16x32_bf16 v[112:115], v[52:55], v[28:31], v[112:115]
  v_mfma_f32_16x16x32_bf16 v[116:119], v[56:59], v[28:31], v[116:119]
  s_waitcnt lgkmcnt(0)
  v_mfma_f32_16x16x32_bf16 v[72:75], v[60:63], v[32:35], v[72:75]
  v_mfma_f32_16x16x32_bf16 v[76:79], v[64:67], v[32:35], v[76:79]
  v_mfma_f32_16x16x32_bf16 v[80:83], v[68:71], v[32:35], v[80:83]
  v_mfma_f32_16x16x32_bf16 v[84:87], v[60:63], v[36:39], v[84:87]
  v_mfma_f32_16x16x32_bf16 v[88:91], v[64:67], v[36:39], v[88:91]
  v_mfma_f32_16x16x32_bf16 v[92:95], v[68:71], v[36:39], v[92:95]
  v_mfma_f32_16x16x32_bf16 v[96:99], v[60:63], v[40:43], v[96:99]
  v_mfma_f32_16x16x32_bf16 v[100:103], v[64:67], v[40:43], v[100:103]
  v_mfma_f32_16x16x32_bf16 v[104:107], v[68:71], v[40:43], v[104:107]
  v_mfma_f32_16x16x32_bf16 v[108:111], v[60:63], v[44:47], v[108:111]
  v_mfma_f32_16x16x32_bf16 v[112:115], v[64:67], v[44:47], v[112:115]
  v_mfma_f32_16x16x32_bf16 v[116:119], v[68:71], v[44:47], v[116:119]
  s_waitcnt vmcnt(5)
  s_barrier
  s_add_u32 m0, s43, 0
  s_nop 0
  buffer_load_dwordx4 v4, s[24:27], s44 offen lds
  s_add_u32 s44, s44, 128
  s_add_u32 m0, s43, 8192
  s_nop 0
  buffer_load_dwordx4 v4, s[24:27], s45 offen lds
  s_add_u32 s45, s45, 128
  s_add_u32 m0, s43, 16384
  s_nop 0
  buffer_load_dwordx4 v5, s[28:31], s46 offen lds
  s_add_u32 s46, s46, 393216
  s_add_u32 m0, s43, 24576
  s_nop 0
  buffer_load_dwordx4 v5, s[28:31], s47 offen lds
  s_add_u32 s47, s47, 393216
  s_add_u32 m0, s43, 32768
  s_nop 0
  buffer_load_dwordx4 v5, s[28:31], s48 offen lds
  s_add_u32 s48, s48, 393216
  ds_read_b128 v[16:19], v130 offset:0
  ds_read_b128 v[20:23], v130 offset:2048
  ds_read_b128 v[24:27], v130 offset:4096
  ds_read_b128 v[28:31], v130 offset:6144
  ds_read_b64_tr_b16 v[48:49], v137 offset:0
  ds_read_b64_tr_b16 v[50:51], v137 offset:512
  ds_read_b64_tr_b16 v[52:53], v138 offset:0
  ds_read_b64_tr_b16 v[54:55], v138 offset:512
  ds_read_b64_tr_b16 v[56:57], v139 offset:0
  ds_read_b64_tr_b16 v[58:59], v139 offset:512
  ds_read_b128 v[32:35], v131 offset:0
  ds_read_b128 v[36:39], v131 offset:2048
  ds_read_b128 v[40:43], v131 offset:4096
  ds_read_b128 v[44:47], v131 offset:6144
  ds_read_b64_tr_b16 v[60:61], v137 offset:4096
  ds_read_b64_tr_b16 v[62:63], v137 offset:4608
  ds_read_b64_tr_b16 v[64:65], v138 offset:4096
  ds_read_b64_tr_b16 v[66:67], v138 offset:4608
  ds_read_b64_tr_b16 v[68:69], v139 offset:4096
  ds_read_b64_tr_b16 v[70:71], v139 offset:4608
  s_waitcnt lgkmcnt(10)
  v_mfma_f32_16x16x32_bf16 v[72:75], v[48:51], v[16:19], v[72:75]
  v_mfma_f32_16x16x32_bf16 v[76:79], v[52:55], v[16:19], v[76:79]
  v_mfma_f32_16x16x32_bf16 v[80:83], v[56:59], v[16:19], v[80:83]
  v_mfma_f32_16x16x32_bf16 v[84:87], v[48:51], v[20:23], v[84:87]
  v_mfma_f32_16x16x32_bf16 v[88:91], v[52:55], v[20:23], v[88:91]
  v_mfma_f32_16x16x32_bf16 v[92:95], v[56:59], v[20:23], v[92:95]
  v_mfma_f32_16x16x32_bf16 v[96:99], v[48:51], v[24:27], v[96:99]
  v_mfma_f32_16x16x32_bf16 v[100:103], v[52:55], v[24:27], v[100:103]
  v_mfma_f32_16x16x32_bf16 v[104:107], v[56:59], v[24:27], v[104:107]
  v_mfma_f32_16x16x32_bf16 v[108:111], v[48:51], v[28:31], v[108:111]
  v_mfma_f32_16x16x32_bf16 v[112:115], v[52:55], v[28:31], v[112:115]
  v_mfma_f32_16x16x32_bf16 v[116:119], v[56:59], v[28:31], v[116:119]
  s_waitcnt lgkmcnt(0)
  v_mfma_f32_16x16x32_bf16 v[72:75], v[60:63], v[32:35], v[72:75]
  v_mfma_f32_16x16x32_bf16 v[76:79], v[64:67], v[32:35], v[76:79]
  v_mfma_f32_16x16x32_bf16 v[80:83], v[68:71], v[32:35], v[80:83]
  v_mfma_f32_16x16x32_bf16 v[84:87], v[60:63], v[36:39], v[84:87]
  v_mfma_f32_16x16x32_bf16 v[88:91], v[64:67], v[36:39], v[88:91]
  v_mfma_f32_16x16x32_bf16 v[92:95], v[68:71], v[36:39], v[92:95]
  v_mfma_f32_16x16x32_bf16 v[96:99], v[60:63], v[40:43], v[96:99]
  v_mfma_f32_16x16x32_bf16 v[100:103], v[64:67], v[40:43], v[100:103]
  v_mfma_f32_16x16x32_bf16 v[104:107], v[68:71], v[40:43], v[104:107]
  v_mfma_f32_16x16x32_bf16 v[108:111], v[60:63], v[44:47], v[108:111]
  v_mfma_f32_16x16x32_bf16 v[112:115], v[64:67], v[44:47], v[112:115]
  v_mfma_f32_16x16x32_bf16 v[116:119], v[68:71], v[44:47], v[116:119]
  s_waitcnt vmcnt(5)
  s_barrier
  s_add_u32 m0, s43, 40960
  s_nop 0
  buffer_load_dwordx4 v4, s[24:27], s44 offen lds
  s_add_u32 s44, s44, 128
  s_add_u32 m0, s43, 49152
  s_nop 0
  buffer_load_dwordx4 v4, s[24:27], s45 offen lds
  s_add_u32 s45, s45, 128
  s_add_u32 m0, s43, 57344
  s_nop 0
  buffer_load_dwordx4 v5, s[28:31], s46 offen lds
  s_add_u32 s46, s46, 393216
  s_add_u32 m0, s43, 65536
  s_nop 0
  buffer_load_dwordx4 v5, s[28:31], s47 offen lds
  s_add_u32 s47, s47, 393216
  s_add_u32 m0, s43, 73728
  s_nop 0
  buffer_load_dwordx4 v5, s[28:31], s48 offen lds
  s_add_u32 s48, s48, 393216
  ds_read_b128 v[16:19], v132 offset:0
  ds_read_b128 v[20:23], v132 offset:2048
  ds_read_b128 v[24:27], v132 offset:4096
  ds_read_b128 v[28:31], v132 offset:6144
  ds_read_b64_tr_b16 v[48:49], v140 offset:0
  ds_read_b64_tr_b16 v[50:51], v140 offset:512
  ds_read_b64_tr_b16 v[52:53], v141 offset:0
  ds_read_b64_tr_b16 v[54:55], v141 offset:512
  ds_read_b64_tr_b16 v[56:57], v142 offset:0
  ds_read_b64_tr_b16 v[58:59], v142 offset:512
  ds_read_b128 v[32:35], v133 offset:0
  ds_read_b128 v[36:39], v133 offset:2048
  ds_read_b128 v[40:43], v133 offset:4096
  ds_read_b128 v[44:47], v133 offset:6144
  ds_read_b64_tr_b16 v[60:61], v140 offset:4096
  ds_read_b64_tr_b16 v[62:63], v140 offset:4608
  ds_read_b64_tr_b16 v[64:65], v141 offset:4096
  ds_read_b64_tr_b16 v[66:67], v141 offset:4608
  ds_read_b64_tr_b16 v[68:69], v142 offset:4096
  ds_read_b64_tr_b16 v[70:71], v142 offset:4608
  s_waitcnt lgkmcnt(10)
  v_mfma_f32_16x16x32_bf16 v[72:75], v[48:51], v[16:19], v[72:75]
  v_mfma_f32_16x16x32_bf16 v[76:79], v[52:55], v[16:19], v[76:79]
  v_mfma_f32_16x16x32_bf16 v[80:83], v[56:59], v[16:19], v[80:83]
  v_mfma_f32_16x16x32_bf16 v[84:87], v[48:51], v[20:23], v[84:87]
  v_mfma_f32_16x16x32_bf16 v[88:91], v[52:55], v[20:23], v[88:91]
  v_mfma_f32_16x16x32_bf16 v[92:95], v[56:59], v[20:23], v[92:95]
  v_mfma_f32_16x16x32_bf16 v[96:99], v[48:51], v[24:27], v[96:99]
  v_mfma_f32_16x16x32_bf16 v[100:103], v[52:55], v[24:27], v[100:103]
  v_mfma_f32_16x16x32_bf16 v[104:107], v[56:59], v[24:27], v[104:107]
  v_mfma_f32_16x16x32_bf16 v[108:111], v[48:51], v[28:31], v[108:111]
  v_mfma_f32_16x16x32_bf16 v[112:115], v[52:55], v[28:31], v[112:115]
  v_mfma_f32_16x16x32_bf16 v[116:119], v[56:59], v[28:31], v[116:119]
  s_waitcnt lgkmcnt(0)
  v_mfma_f32_16x16x32_bf16 v[72:75], v[60:63], v[32:35], v[72:75]
  v_mfma_f32_16x16x32_bf16 v[76:79], v[64:67], v[32:35], v[76:79]
  v_mfma_f32_16x16x32_bf16 v[80:83], v[68:71], v[32:35], v[80:83]
  v_mfma_f32_16x16x32_bf16 v[84:87], v[60:63], v[36:39], v[84:87]
  v_mfma_f32_16x16x32_bf16 v[88:91], v[64:67], v[36:39], v[88:91]
  v_mfma_f32_16x16x32_bf16 v[92:95], v[68:71], v[36:39], v[92:95]
  v_mfma_f32_16x16x32_bf16 v[96:99], v[60:63], v[40:43], v[96:99]
  v_mfma_f32_16x16x32_bf16 v[100:103], v[64:67], v[40:43], v[100:103]
  v_mfma_f32_16x16x32_bf16 v[104:107], v[68:71], v[40:43], v[104:107]
  v_mfma_f32_16x16x32_bf16 v[108:111], v[60:63], v[44:47], v[108:111]
  v_mfma_f32_16x16x32_bf16 v[112:115], v[64:67], v[44:47], v[112:115]
  v_mfma_f32_16x16x32_bf16 v[116:119], v[68:71], v[44:47], v[116:119]
  s_waitcnt vmcnt(5)
  s_barrier
  s_add_u32 m0, s43, 81920
  s_nop 0
  buffer_load_dwordx4 v4, s[24:27], s44 offen lds
  s_add_u32 s44, s44, 128
  s_add_u32 m0, s43, 90112
  s_nop 0
  buffer_load_dwordx4 v4, s[24:27], s45 offen lds
  s_add_u32 s45, s45, 128
  s_add_u32 m0, s43, 98304
  s_nop 0
  buffer_load_dwordx4 v5, s[28:31], s46 offen lds
  s_add_u32 s46, s46, 393216
  s_add_u32 m0, s43, 106496
  s_nop 0
  buffer_load_dwordx4 v5, s[28:31], s47 offen lds
  s_add_u32 s47, s47, 393216
  s_add_u32 m0, s43, 114688
  s_nop 0
  buffer_load_dwordx4 v5, s[28:31], s48 offen lds
  s_add_u32 s48, s48, 393216
  ds_read_b128 v[16:19], v128 offset:0
  ds_read_b128 v[20:23], v128 offset:2048
  ds_read_b128 v[24:27], v128 offset:4096
  ds_read_b128 v[28:31], v128 offset:6144
  ds_read_b64_tr_b16 v[48:49], v134 offset:0
  ds_read_b64_tr_b16 v[50:51], v134 offset:512
  ds_read_b64_tr_b16 v[52:53], v135 offset:0
  ds_read_b64_tr_b16 v[54:55], v135 offset:512
  ds_read_b64_tr_b16 v[56:57], v136 offset:0
  ds_read_b64_tr_b16 v[58:59], v136 offset:512
  ds_read_b128 v[32:35], v129 offset:0
  ds_read_b128 v[36:39], v129 offset:2048
  ds_read_b128 v[40:43], v129 offset:4096
  ds_read_b128 v[44:47], v129 offset:6144
  ds_read_b64_tr_b16 v[60:61], v134 offset:4096
  ds_read_b64_tr_b16 v[62:63], v134 offset:4608
  ds_read_b64_tr_b16 v[64:65], v135 offset:4096
  ds_read_b64_tr_b16 v[66:67], v135 offset:4608
  ds_read_b64_tr_b16 v[68:69], v136 offset:4096
  ds_read_b64_tr_b16 v[70:71], v136 offset:4608
  s_waitcnt lgkmcnt(10)
  v_mfma_f32_16x16x32_bf16 v[72:75], v[48:51], v[16:19], v[72:75]
  v_mfma_f32_16x16x32_bf16 v[76:79], v[52:55], v[16:19], v[76:79]
  v_mfma_f32_16x16x32_bf16 v[80:83], v[56:59], v[16:19], v[80:83]
  v_mfma_f32_16x16x32_bf16 v[84:87], v[48:51], v[20:23], v[84:87]
  v_mfma_f32_16x16x32_bf16 v[88:91], v[52:55], v[20:23], v[88:91]
  v_mfma_f32_16x16x32_bf16 v[92:95], v[56:59], v[20:23], v[92:95]
  v_mfma_f32_16x16x32_bf16 v[96:99], v[48:51], v[24:27], v[96:99]
  v_mfma_f32_16x16x32_bf16 v[100:103], v[52:55], v[24:27], v[100:103]
  v_mfma_f32_16x16x32_bf16 v[104:107], v[56:59], v[24:27], v[104:107]
  v_mfma_f32_16x16x32_bf16 v[108:111], v[48:51], v[28:31], v[108:111]
  v_mfma_f32_16x16x32_bf16 v[112:115], v[52:55], v[28:31], v[112:115]
  v_mfma_f32_16x16x32_bf16 v[116:119], v[56:59], v[28:31], v[116:119]
  s_waitcnt lgkmcnt(0)
  v_mfma_f32_16x16x32_bf16 v[72:75], v[60:63], v[32:35], v[72:75]
  v_mfma_f32_16x16x32_bf16 v[76:79], v[64:67], v[32:35], v[76:79]
  v_mfma_f32_16x16x32_bf16 v[80:83], v[68:71], v[32:35], v[80:83]
  v_mfma_f32_16x16x32_bf16 v[84:87], v[60:63], v[36:39], v[84:87]
  v_mfma_f32_16x16x32_bf16 v[88:91], v[64:67], v[36:39], v[88:91]
  v_mfma_f32_16x16x32_bf16 v[92:95], v[68:71], v[36:39], v[92:95]
  v_mfma_f32_16x16x32_bf16 v[96:99], v[60:63], v[40:43], v[96:99]
  v_mfma_f32_16x16x32_bf16 v[100:103], v[64:67], v[40:43], v[100:103]
  v_mfma_f32_16x16x32_bf16 v[104:107], v[68:71], v[40:43], v[104:107]
  v_mfma_f32_16x16x32_bf16 v[108:111], v[60:63], v[44:47], v[108:111]
  v_mfma_f32_16x16x32_bf16 v[112:115], v[64:67], v[44:47], v[112:115]
  v_mfma_f32_16x16x32_bf16 v[116:119], v[68:71], v[44:47], v[116:119]
  s_waitcnt vmcnt(5)
  s_barrier
  s_add_u32 m0, s43, 0
  s_nop 0
  buffer_load_dwordx4 v4, s[24:27], s44 offen lds
  s_add_u32 s44, s44, 128
  s_add_u32 m0, s43, 8192
  s_nop 0
  buffer_load_dwordx4 v4, s[24:27], s45 offen lds
  s_add_u32 s45, s45, 128
  s_add_u32 m0, s43, 16384
  s_nop 0
  buffer_load_dwordx4 v5, s[28:31], s46 offen lds
  s_add_u32 s46, s46, 393216
  s_add_u32 m0, s43, 24576
  s_nop 0
  buffer_load_dwordx4 v5, s[28:31], s47 offen lds
  s_add_u32 s47, s47, 393216
  s_add_u32 m0, s43, 32768
  s_nop 0
  buffer_load_dwordx4 v5, s[28:31], s48 offen lds
  s_add_u32 s48, s48, 393216
  ds_read_b128 v[16:19], v130 offset:0
  ds_read_b128 v[20:23], v130 offset:2048
  ds_read_b128 v[24:27], v130 offset:4096
  ds_read_b128 v[28:31], v130 offset:6144
  ds_read_b64_tr_b16 v[48:49], v137 offset:0
  ds_read_b64_tr_b16 v[50:51], v137 offset:512
  ds_read_b64_tr_b16 v[52:53], v138 offset:0
  ds_read_b64_tr_b16 v[54:55], v138 offset:512
  ds_read_b64_tr_b16 v[56:57], v139 offset:0
  ds_read_b64_tr_b16 v[58:59], v139 offset:512
  ds_read_b128 v[32:35], v131 offset:0
  ds_read_b128 v[36:39], v131 offset:2048
  ds_read_b128 v[40:43], v131 offset:4096
  ds_read_b128 v[44:47], v131 offset:6144
  ds_read_b64_tr_b16 v[60:61], v137 offset:4096
  ds_read_b64_tr_b16 v[62:63], v137 offset:4608
  ds_read_b64_tr_b16 v[64:65], v138 offset:4096
  ds_read_b64_tr_b16 v[66:67], v138 offset:4608
  ds_read_b64_tr_b16 v[68:69], v139 offset:4096
  ds_read_b64_tr_b16 v[70:71], v139 offset:4608
  s_waitcnt lgkmcnt(10)
  v_mfma_f32_16x16x32_bf16 v[72:75], v[48:51], v[16:19], v[72:75]
  v_mfma_f32_16x16x32_bf16 v[76:79], v[52:55], v[16:19], v[76:79]
  v_mfma_f32_16x16x32_bf16 v[80:83], v[56:59], v[16:19], v[80:83]
  v_mfma_f32_16x16x32_bf16 v[84:87], v[48:51], v[20:23], v[84:87]
  v_mfma_f32_16x16x32_bf16 v[88:91], v[52:55], v[20:23], v[88:91]
  v_mfma_f32_16x16x32_bf16 v[92:95], v[56:59], v[20:23], v[92:95]
  v_mfma_f32_16x16x32_bf16 v[96:99], v[48:51], v[24:27], v[96:99]
  v_mfma_f32_16x16x32_bf16 v[100:103], v[52:55], v[24:27], v[100:103]
  v_mfma_f32_16x16x32_bf16 v[104:107], v[56:59], v[24:27], v[104:107]
  v_mfma_f32_16x16x32_bf16 v[108:111], v[48:51], v[28:31], v[108:111]
  v_mfma_f32_16x16x32_bf16 v[112:115], v[52:55], v[28:31], v[112:115]
  v_mfma_f32_16x16x32_bf16 v[116:119], v[56:59], v[28:31], v[116:119]
  s_waitcnt lgkmcnt(0)
  v_mfma_f32_16x16x32_bf16 v[72:75], v[60:63], v[32:35], v[72:75]
  v_mfma_f32_16x16x32_bf16 v[76:79], v[64:67], v[32:35], v[76:79]
  v_mfma_f32_16x16x32_bf16 v[80:83], v[68:71], v[32:35], v[80:83]
  v_mfma_f32_16x16x32_bf16 v[84:87], v[60:63], v[36:39], v[84:87]
  v_mfma_f32_16x16x32_bf16 v[88:91], v[64:67], v[36:39], v[88:91]
  v_mfma_f32_16x16x32_bf16 v[92:95], v[68:71], v[36:39], v[92:95]
  v_mfma_f32_16x16x32_bf16 v[96:99], v[60:63], v[40:43], v[96:99]
  v_mfma_f32_16x16x32_bf16 v[100:103], v[64:67], v[40:43], v[100:103]
  v_mfma_f32_16x16x32_bf16 v[104:107], v[68:71], v[40:43], v[104:107]
  v_mfma_f32_16x16x32_bf16 v[108:111], v[60:63], v[44:47], v[108:111]
  v_mfma_f32_16x16x32_bf16 v[112:115], v[64:67], v[44:47], v[112:115]
  v_mfma_f32_16x16x32_bf16 v[116:119], v[68:71], v[44:47], v[116:119]
  s_waitcnt vmcnt(5)
  s_barrier
  ds_read_b128 v[16:19], v132 offset:0
  ds_read_b128 v[20:23], v132 offset:2048
  ds_read_b128 v[24:27], v132 offset:4096
  ds_read_b128 v[28:31], v132 offset:6144
  ds_read_b64_tr_b16 v[48:49], v140 offset:0
  ds_read_b64_tr_b16 v[50:51], v140 offset:512
  ds_read_b64_tr_b16 v[52:53], v141 offset:0
  ds_read_b64_tr_b16 v[54:55], v141 offset:512
  ds_read_b64_tr_b16 v[56:57], v142 offset:0
  ds_read_b64_tr_b16 v[58:59], v142 offset:512
  ds_read_b128 v[32:35], v133 offset:0
  ds_read_b128 v[36:39], v133 offset:2048
  ds_read_b128 v[40:43], v133 offset:4096
  ds_read_b128 v[44:47], v133 offset:6144
  ds_read_b64_tr_b16 v[60:61], v140 offset:4096
  ds_read_b64_tr_b16 v[62:63], v140 offset:4608
  ds_read_b64_tr_b16 v[64:65], v141 offset:4096
  ds_read_b64_tr_b16 v[66:67], v141 offset:4608
  ds_read_b64_tr_b16 v[68:69], v142 offset:4096
  ds_read_b64_tr_b16 v[70:71], v142 offset:4608
  s_waitcnt lgkmcnt(10)
  v_mfma_f32_16x16x32_bf16 v[72:75], v[48:51], v[16:19], v[72:75]
  v_mfma_f32_16x16x32_bf16 v[76:79], v[52:55], v[16:19], v[76:79]
  v_mfma_f32_16x16x32_bf16 v[80:83], v[56:59], v[16:19], v[80:83]
  v_mfma_f32_16x16x32_bf16 v[84:87], v[48:51], v[20:23], v[84:87]
  v_mfma_f32_16x16x32_bf16 v[88:91], v[52:55], v[20:23], v[88:91]
  v_mfma_f32_16x16x32_bf16 v[92:95], v[56:59], v[20:23], v[92:95]
  v_mfma_f32_16x16x32_bf16 v[96:99], v[48:51], v[24:27], v[96:99]
  v_mfma_f32_16x16x32_bf16 v[100:103], v[52:55], v[24:27], v[100:103]
  v_mfma_f32_16x16x32_bf16 v[104:107], v[56:59], v[24:27], v[104:107]
  v_mfma_f32_16x16x32_bf16 v[108:111], v[48:51], v[28:31], v[108:111]
  v_mfma_f32_16x16x32_bf16 v[112:115], v[52:55], v[28:31], v[112:115]
  v_mfma_f32_16x16x32_bf16 v[116:119], v[56:59], v[28:31], v[116:119]
  s_waitcnt lgkmcnt(0)
  v_mfma_f32_16x16x32_bf16 v[72:75], v[60:63], v[32:35], v[72:75]
  v_mfma_f32_16x16x32_bf16 v[76:79], v[64:67], v[32:35], v[76:79]
  v_mfma_f32_16x16x32_bf16 v[80:83], v[68:71], v[32:35], v[80:83]
  v_mfma_f32_16x16x32_bf16 v[84:87], v[60:63], v[36:39], v[84:87]
  v_mfma_f32_16x16x32_bf16 v[88:91], v[64:67], v[36:39], v[88:91]
  v_mfma_f32_16x16x32_bf16 v[92:95], v[68:71], v[36:39], v[92:95]
  v_mfma_f32_16x16x32_bf16 v[96:99], v[60:63], v[40:43], v[96:99]
  v_mfma_f32_16x16x32_bf16 v[100:103], v[64:67], v[40:43], v[100:103]
  v_mfma_f32_16x16x32_bf16 v[104:107], v[68:71], v[40:43], v[104:107]
  v_mfma_f32_16x16x32_bf16 v[108:111], v[60:63], v[44:47], v[108:111]
  v_mfma_f32_16x16x32_bf16 v[112:115], v[64:67], v[44:47], v[112:115]
  v_mfma_f32_16x16x32_bf16 v[116:119], v[68:71], v[44:47], v[116:119]
  s_waitcnt vmcnt(0)
  s_barrier
  ds_read_b128 v[16:19], v128 offset:0
  ds_read_b128 v[20:23], v128 offset:2048
  ds_read_b128 v[24:27], v128 offset:4096
  ds_read_b128 v[28:31], v128 offset:6144
  ds_read_b64_tr_b16 v[48:49], v134 offset:0
  ds_read_b64_tr_b16 v[50:51], v134 offset:512
  ds_read_b64_tr_b16 v[52:53], v135 offset:0
  ds_read_b64_tr_b16 v[54:55], v135 offset:512
  ds_read_b64_tr_b16 v[56:57], v136 offset:0
  ds_read_b64_tr_b16 v[58:59], v136 offset:512
  ds_read_b128 v[32:35], v129 offset:0
  ds_read_b128 v[36:39], v129 offset:2048
  ds_read_b128 v[40:43], v129 offset:4096
  ds_read_b128 v[44:47], v129 offset:6144
  ds_read_b64_tr_b16 v[60:61], v134 offset:4096
  ds_read_b64_tr_b16 v[62:63], v134 offset:4608
  ds_read_b64_tr_b16 v[64:65], v135 offset:4096
  ds_read_b64_tr_b16 v[66:67], v135 offset:4608
  ds_read_b64_tr_b16 v[68:69], v136 offset:4096
  ds_read_b64_tr_b16 v[70:71], v136 offset:4608
  s_waitcnt lgkmcnt(10)
  v_mfma_f32_16x16x32_bf16 v[72:75], v[48:51], v[16:19], v[72:75]
  v_mfma_f32_16x16x32_bf16 v[76:79], v[52:55], v[16:19], v[76:79]
  v_mfma_f32_16x16x32_bf16 v[80:83], v[56:59], v[16:19], v[80:83]
  v_mfma_f32_16x16x32_bf16 v[84:87], v[48:51], v[20:23], v[84:87]
  v_mfma_f32_16x16x32_bf16 v[88:91], v[52:55], v[20:23], v[88:91]
  v_mfma_f32_16x16x32_bf16 v[92:95], v[56:59], v[20:23], v[92:95]
  v_mfma_f32_16x16x32_bf16 v[96:99], v[48:51], v[24:27], v[96:99]
  v_mfma_f32_16x16x32_bf16 v[100:103], v[52:55], v[24:27], v[100:103]
  v_mfma_f32_16x16x32_bf16 v[104:107], v[56:59], v[24:27], v[104:107]
  v_mfma_f32_16x16x32_bf16 v[108:111], v[48:51], v[28:31], v[108:111]
  v_mfma_f32_16x16x32_bf16 v[112:115], v[52:55], v[28:31], v[112:115]
  v_mfma_f32_16x16x32_bf16 v[116:119], v[56:59], v[28:31], v[116:119]
  s_waitcnt lgkmcnt(0)
  v_mfma_f32_16x16x32_bf16 v[72:75], v[60:63], v[32:35], v[72:75]
  v_mfma_f32_16x16x32_bf16 v[76:79], v[64:67], v[32:35], v[76:79]
  v_mfma_f32_16x16x32_bf16 v[80:83], v[68:71], v[32:35], v[80:83]
  v_mfma_f32_16x16x32_bf16 v[84:87], v[60:63], v[36:39], v[84:87]
  v_mfma_f32_16x16x32_bf16 v[88:91], v[64:67], v[36:39], v[88:91]
  v_mfma_f32_16x16x32_bf16 v[92:95], v[68:71], v[36:39], v[92:95]
  v_mfma_f32_16x16x32_bf16 v[96:99], v[60:63], v[40:43], v[96:99]
  v_mfma_f32_16x16x32_bf16 v[100:103], v[64:67], v[40:43], v[100:103]
  v_mfma_f32_16x16x32_bf16 v[104:107], v[68:71], v[40:43], v[104:107]
  v_mfma_f32_16x16x32_bf16 v[108:111], v[60:63], v[44:47], v[108:111]
  v_mfma_f32_16x16x32_bf16 v[112:115], v[64:67], v[44:47], v[112:115]
  v_mfma_f32_16x16x32_bf16 v[116:119], v[68:71], v[44:47], v[116:119]
  s_nop 7
  s_nop 7
  v_cvt_pk_bf16_f32 v72, v72, v73
  v_cvt_pk_bf16_f32 v73, v74, v75
  buffer_store_dwordx2 v[72:73], v13, s[32:35], 0 offen offset:0
  v_cvt_pk_bf16_f32 v76, v76, v77
  v_cvt_pk_bf16_f32 v77, v78, v79
  buffer_store_dwordx2 v[76:77], v13, s[32:35], 0 offen offset:32
  v_cvt_pk_bf16_f32 v80, v80, v81
  v_cvt_pk_bf16_f32 v81, v82, v83
  buffer_store_dwordx2 v[80:81], v13, s[32:35], 0 offen offset:64
  v_add_u32 v13, 98304, v13
  v_cvt_pk_bf16_f32 v84, v84, v85
  v_cvt_pk_bf16_f32 v85, v86, v87
  buffer_store_dwordx2 v[84:85], v13, s[32:35], 0 offen offset:0
  v_cvt_pk_bf16_f32 v88, v88, v89
  v_cvt_pk_bf16_f32 v89, v90, v91
  buffer_store_dwordx2 v[88:89], v13, s[32:35], 0 offen offset:32
  v_cvt_pk_bf16_f32 v92, v92, v93
  v_cvt_pk_bf16_f32 v93, v94, v95
  buffer_store_dwordx2 v[92:93], v13, s[32:35], 0 offen offset:64
  v_add_u32 v13, 98304, v13
  v_cvt_pk_bf16_f32 v96, v96, v97
  v_cvt_pk_bf16_f32 v97, v98, v99
  buffer_store_dwordx2 v[96:97], v13, s[32:35], 0 offen offset:0
  v_cvt_pk_bf16_f32 v100, v100, v101
  v_cvt_pk_bf16_f32 v101, v102, v103
  buffer_store_dwordx2 v[100:101], v13, s[32:35], 0 offen offset:32
  v_cvt_pk_bf16_f32 v104, v104, v105
  v_cvt_pk_bf16_f32 v105, v106, v107
  buffer_store_dwordx2 v[104:105], v13, s[32:35], 0 offen offset:64
  v_add_u32 v13, 98304, v13
  v_cvt_pk_bf16_f32 v108, v108, v109
  v_cvt_pk_bf16_f32 v109, v110, v111
  buffer_store_dwordx2 v[108:109], v13, s[32:35], 0 offen offset:0
  v_cvt_pk_bf16_f32 v112, v112, v113
  v_cvt_pk_bf16_f32 v113, v114, v115
  buffer_store_dwordx2 v[112:113], v13, s[32:35], 0 offen offset:32
  v_cvt_pk_bf16_f32 v116, v116, v117
  v_cvt_pk_bf16_f32 v117, v118, v119
  buffer_store_dwordx2 v[116:117], v13, s[32:35], 0 offen offset:64
L_gemmq0_kernel_end:
  s_endpgm
.globl kvpart0_kernel
.p2align 8
.type kvpart0_kernel,@function
kvpart0_kernel:
  s_cmp_ge_u32 s2, 256
  s_cbranch_scc1 L_kvpart0_kernel_end
  s_load_dwordx16 s[4:19], s[0:1], 0
  s_load_dwordx2 s[20:21], s[0:1], 64
  s_waitcnt lgkmcnt(0)
  s_add_u32 s24, s20, 4194304
  s_addc_u32 s25, s21, 0
  s_and_b32 s25, s25, 0xffff
  s_mov_b32 s26, 12582912
  s_mov_b32 s27, 0x00020000
  s_add_u32 s28, s20, 33554432
  s_addc_u32 s29, s21, 0
  s_and_b32 s29, s29, 0xffff
  s_mov_b32 s30, 1081344
  s_mov_b32 s31, 0x00020000
  s_lshr_b32 s40, s2, 3
  s_and_b32 s41, s2, 7
  v_and_b32 v1, 63, v0
  v_lshrrev_b32 v2, 6, v0
  v_lshrrev_b32 v3, 2, v1
  v_lshl_add_u32 v3, v2, 6, v3
  s_lshl_b32 s3, s41, 8
  v_add_u32 v3, s3, v3
  v_mul_u32_u24 v4, 6144, v3
  v_and_b32 v5, 3, v1
  v_lshl_add_u32 v4, v5, 4, v4
  s_lshl_b32 s42, s40, 6
  s_add_u32 s43, s42, 4096
  s_add_u32 s42, s42, 2048
  s_add_u32 s44, s42, 0
  buffer_load_dwordx4 v[16:19], v4, s[24:27], s44 offen
  s_add_u32 s44, s43, 0
  buffer_load_dwordx4 v[32:35], v4, s[24:27], s44 offen
  s_add_u32 s44, s42, 98304
  buffer_load_dwordx4 v[20:23], v4, s[24:27], s44 offen
  s_add_u32 s44, s43, 98304
  buffer_load_dwordx4 v[36:39], v4, s[24:27], s44 offen
  s_add_u32 s44, s42, 196608
  buffer_load_dwordx4 v[24:27], v4, s[24:27], s44 offen
  s_add_u32 s44, s43, 196608
  buffer_load_dwordx4 v[40:43], v4, s[24:27], s44 offen
  s_add_u32 s44, s42, 294912
  buffer_load_dwordx4 v[28:31], v4, s[24:27], s44 offen
  s_add_u32 s44, s43, 294912
  buffer_load_dwordx4 v[44:47], v4, s[24:27], s44 offen
  v_lshrrev_b32 v6, 2, v1
  v_lshlrev_b32 v6, 6, v6
  v_lshl_add_u32 v6, v5, 4, v6
  v_lshl_add_u32 v6, v2, 13, v6
  s_waitcnt vmcnt(0)
  v_lshlrev_b32 v60, 16, v16
  v_and_b32 v61, 0xffff0000, v16
  v_mul_f32 v62, 0x3fb8aa3b, v60
  v_exp_f32 v62, v62
  v_add_f32 v63, 1.0, v60
  v_cmp_lt_f32 vcc, 0, v60
  s_nop 1
  v_cndmask_b32 v60, v62, v63, vcc
  v_mul_f32 v62, 0x3fb8aa3b, v61
  v_exp_f32 v62, v62
  v_add_f32 v63, 1.0, v61
  v_cmp_lt_f32 vcc, 0, v61
  s_nop 1
  v_cndmask_b32 v61, v62, v63, vcc
  v_cvt_pk_bf16_f32 v62, v60, v61
  v_lshlrev_b32 v60, 16, v62
  v_and_b32 v61, 0xffff0000, v62
  v_add_f32 v60, 0x358637bd, v60
  v_add_f32 v61, 0x358637bd, v61
  v_cvt_pk_bf16_f32 v16, v60, v61
  v_lshlrev_b32 v60, 16, v17
  v_and_b32 v61, 0xffff0000, v17
  v_mul_f32 v62, 0x3fb8aa3b, v60
  v_exp_f32 v62, v62
  v_add_f32 v63, 1.0, v60
  v_cmp_lt_f32 vcc, 0, v60
  s_nop 1
  v_cndmask_b32 v60, v62, v63, vcc
  v_mul_f32 v62, 0x3fb8aa3b, v61
  v_exp_f32 v62, v62
  v_add_f32 v63, 1.0, v61
  v_cmp_lt_f32 vcc, 0, v61
  s_nop 1
  v_cndmask_b32 v61, v62, v63, vcc
  v_cvt_pk_bf16_f32 v62, v60, v61
  v_lshlrev_b32 v60, 16, v62
  v_and_b32 v61, 0xffff0000, v62
  v_add_f32 v60, 0x358637bd, v60
  v_add_f32 v61, 0x358637bd, v61
  v_cvt_pk_bf16_f32 v17, v60, v61
  v_lshlrev_b32 v60, 16, v18
  v_and_b32 v61, 0xffff0000, v18
  v_mul_f32 v62, 0x3fb8aa3b, v60
  v_exp_f32 v62, v62
  v_add_f32 v63, 1.0, v60
  v_cmp_lt_f32 vcc, 0, v60
  s_nop 1
  v_cndmask_b32 v60, v62, v63, vcc
  v_mul_f32 v62, 0x3fb8aa3b, v61
  v_exp_f32 v62, v62
  v_add_f32 v63, 1.0, v61
  v_cmp_lt_f32 vcc, 0, v61
  s_nop 1
  v_cndmask_b32 v61, v62, v63, vcc
  v_cvt_pk_bf16_f32 v62, v60, v61
  v_lshlrev_b32 v60, 16, v62
  v_and_b32 v61, 0xffff0000, v62
  v_add_f32 v60, 0x358637bd, v60
  v_add_f32 v61, 0x358637bd, v61
  v_cvt_pk_bf16_f32 v18, v60, v61
  v_lshlrev_b32 v60, 16, v19
  v_and_b32 v61, 0xffff0000, v19
  v_mul_f32 v62, 0x3fb8aa3b, v60
  v_exp_f32 v62, v62
  v_add_f32 v63, 1.0, v60
  v_cmp_lt_f32 vcc, 0, v60
  s_nop 1
  v_cndmask_b32 v60, v62, v63, vcc
  v_mul_f32 v62, 0x3fb8aa3b, v61
  v_exp_f32 v62, v62
  v_add_f32 v63, 1.0, v61
  v_cmp_lt_f32 vcc, 0, v61
  s_nop 1
  v_cndmask_b32 v61, v62, v63, vcc
  v_cvt_pk_bf16_f32 v62, v60, v61
  v_lshlrev_b32 v60, 16, v62
  v_and_b32 v61, 0xffff0000, v62
  v_add_f32 v60, 0x358637bd, v60
  v_add_f32 v61, 0x358637bd, v61
  v_cvt_pk_bf16_f32 v19, v60, v61
  v_lshlrev_b32 v60, 16, v20
  v_and_b32 v61, 0xffff0000, v20
  v_mul_f32 v62, 0x3fb8aa3b, v60
  v_exp_f32 v62, v62
  v_add_f32 v63, 1.0, v60
  v_cmp_lt_f32 vcc, 0, v60
  s_nop 1
  v_cndmask_b32 v60, v62, v63, vcc
  v_mul_f32 v62, 0x3fb8aa3b, v61
  v_exp_f32 v62, v62
  v_add_f32 v63, 1.0, v61
  v_cmp_lt_f32 vcc, 0, v61
  s_nop 1
  v_cndmask_b32 v61, v62, v63, vcc
  v_cvt_pk_bf16_f32 v62, v60, v61
  v_lshlrev_b32 v60, 16, v62
  v_and_b32 v61, 0xffff0000, v62
  v_add_f32 v60, 0x358637bd, v60
  v_add_f32 v61, 0x358637bd, v61
  v_cvt_pk_bf16_f32 v20, v60, v61
  v_lshlrev_b32 v60, 16, v21
  v_and_b32 v61, 0xffff0000, v21
  v_mul_f32 v62, 0x3fb8aa3b, v60
  v_exp_f32 v62, v62
  v_add_f32 v63, 1.0, v60
  v_cmp_lt_f32 vcc, 0, v60
  s_nop 1
  v_cndmask_b32 v60, v62, v63, vcc
  v_mul_f32 v62, 0x3fb8aa3b, v61
  v_exp_f32 v62, v62
  v_add_f32 v63, 1.0, v61
  v_cmp_lt_f32 vcc, 0, v61
  s_nop 1
  v_cndmask_b32 v61, v62, v63, vcc
  v_cvt_pk_bf16_f32 v62, v60, v61
  v_lshlrev_b32 v60, 16, v62
  v_and_b32 v61, 0xffff0000, v62
  v_add_f32 v60, 0x358637bd, v60
  v_add_f32 v61, 0x358637bd, v61
  v_cvt_pk_bf16_f32 v21, v60, v61
  v_lshlrev_b32 v60, 16, v22
  v_and_b32 v61, 0xffff0000, v22
  v_mul_f32 v62, 0x3fb8aa3b, v60
  v_exp_f32 v62, v62
  v_add_f32 v63, 1.0, v60
  v_cmp_lt_f32 vcc, 0, v60
  s_nop 1
  v_cndmask_b32 v60, v62, v63, vcc
  v_mul_f32 v62, 0x3fb8aa3b, v61
  v_exp_f32 v62, v62
  v_add_f32 v63, 1.0, v61
  v_cmp_lt_f32 vcc, 0, v61
  s_nop 1
  v_cndmask_b32 v61, v62, v63, vcc
  v_cvt_pk_bf16_f32 v62, v60, v61
  v_lshlrev_b32 v60, 16, v62
  v_and_b32 v61, 0xffff0000, v62
  v_add_f32 v60, 0x358637bd, v60
  v_add_f32 v61, 0x358637bd, v61
  v_cvt_pk_bf16_f32 v22, v60, v61
  v_lshlrev_b32 v60, 16, v23
  v_and_b32 v61, 0xffff0000, v23
  v_mul_f32 v62, 0x3fb8aa3b, v60
  v_exp_f32 v62, v62
  v_add_f32 v63, 1.0, v60
  v_cmp_lt_f32 vcc, 0, v60
  s_nop 1
  v_cndmask_b32 v60, v62, v63, vcc
  v_mul_f32 v62, 0x3fb8aa3b, v61
  v_exp_f32 v62, v62
  v_add_f32 v63, 1.0, v61
  v_cmp_lt_f32 vcc, 0, v61
  s_nop 1
  v_cndmask_b32 v61, v62, v63, vcc
  v_cvt_pk_bf16_f32 v62, v60, v61
  v_lshlrev_b32 v60, 16, v62
  v_and_b32 v61, 0xffff0000, v62
  v_add_f32 v60, 0x358637bd, v60
  v_add_f32 v61, 0x358637bd, v61
  v_cvt_pk_bf16_f32 v23, v60, v61
  v_lshlrev_b32 v60, 16, v24
  v_and_b32 v61, 0xffff0000, v24
  v_mul_f32 v62, 0x3fb8aa3b, v60
  v_exp_f32 v62, v62
  v_add_f32 v63, 1.0, v60
  v_cmp_lt_f32 vcc, 0, v60
  s_nop 1
  v_cndmask_b32 v60, v62, v63, vcc
  v_mul_f32 v62, 0x3fb8aa3b, v61
  v_exp_f32 v62, v62
  v_add_f32 v63, 1.0, v61
  v_cmp_lt_f32 vcc, 0, v61
  s_nop 1
  v_cndmask_b32 v61, v62, v63, vcc
  v_cvt_pk_bf16_f32 v62, v60, v61
  v_lshlrev_b32 v60, 16, v62
  v_and_b32 v61, 0xffff0000, v62
  v_add_f32 v60, 0x358637bd, v60
  v_add_f32 v61, 0x358637bd, v61
  v_cvt_pk_bf16_f32 v24, v60, v61
  v_lshlrev_b32 v60, 16, v25
  v_and_b32 v61, 0xffff0000, v25
  v_mul_f32 v62, 0x3fb8aa3b, v60
  v_exp_f32 v62, v62
  v_add_f32 v63, 1.0, v60
  v_cmp_lt_f32 vcc, 0, v60
  s_nop 1
  v_cndmask_b32 v60, v62, v63, vcc
  v_mul_f32 v62, 0x3fb8aa3b, v61
  v_exp_f32 v62, v62
  v_add_f32 v63, 1.0, v61
  v_cmp_lt_f32 vcc, 0, v61
  s_nop 1
  v_cndmask_b32 v61, v62, v63, vcc
  v_cvt_pk_bf16_f32 v62, v60, v61
  v_lshlrev_b32 v60, 16, v62
  v_and_b32 v61, 0xffff0000, v62
  v_add_f32 v60, 0x358637bd, v60
  v_add_f32 v61, 0x358637bd, v61
  v_cvt_pk_bf16_f32 v25, v60, v61
  v_lshlrev_b32 v60, 16, v26
  v_and_b32 v61, 0xffff0000, v26
  v_mul_f32 v62, 0x3fb8aa3b, v60
  v_exp_f32 v62, v62
  v_add_f32 v63, 1.0, v60
  v_cmp_lt_f32 vcc, 0, v60
  s_nop 1
  v_cndmask_b32 v60, v62, v63, vcc
  v_mul_f32 v62, 0x3fb8aa3b, v61
  v_exp_f32 v62, v62
  v_add_f32 v63, 1.0, v61
  v_cmp_lt_f32 vcc, 0, v61
  s_nop 1
  v_cndmask_b32 v61, v62, v63, vcc
  v_cvt_pk_bf16_f32 v62, v60, v61
  v_lshlrev_b32 v60, 16, v62
  v_and_b32 v61, 0xffff0000, v62
  v_add_f32 v60, 0x358637bd, v60
  v_add_f32 v61, 0x358637bd, v61
  v_cvt_pk_bf16_f32 v26, v60, v61
  v_lshlrev_b32 v60, 16, v27
  v_and_b32 v61, 0xffff0000, v27
  v_mul_f32 v62, 0x3fb8aa3b, v60
  v_exp_f32 v62, v62
  v_add_f32 v63, 1.0, v60
  v_cmp_lt_f32 vcc, 0, v60
  s_nop 1
  v_cndmask_b32 v60, v62, v63, vcc
  v_mul_f32 v62, 0x3fb8aa3b, v61
  v_exp_f32 v62, v62
  v_add_f32 v63, 1.0, v61
  v_cmp_lt_f32 vcc, 0, v61
  s_nop 1
  v_cndmask_b32 v61, v62, v63, vcc
  v_cvt_pk_bf16_f32 v62, v60, v61
  v_lshlrev_b32 v60, 16, v62
  v_and_b32 v61, 0xffff0000, v62
  v_add_f32 v60, 0x358637bd, v60
  v_add_f32 v61, 0x358637bd, v61
  v_cvt_pk_bf16_f32 v27, v60, v61
  v_lshlrev_b32 v60, 16, v28
  v_and_b32 v61, 0xffff0000, v28
  v_mul_f32 v62, 0x3fb8aa3b, v60
  v_exp_f32 v62, v62
  v_add_f32 v63, 1.0, v60
  v_cmp_lt_f32 vcc, 0, v60
  s_nop 1
  v_cndmask_b32 v60, v62, v63, vcc
  v_mul_f32 v62, 0x3fb8aa3b, v61
  v_exp_f32 v62, v62
  v_add_f32 v63, 1.0, v61
  v_cmp_lt_f32 vcc, 0, v61
  s_nop 1
  v_cndmask_b32 v61, v62, v63, vcc
  v_cvt_pk_bf16_f32 v62, v60, v61
  v_lshlrev_b32 v60, 16, v62
  v_and_b32 v61, 0xffff0000, v62
  v_add_f32 v60, 0x358637bd, v60
  v_add_f32 v61, 0x358637bd, v61
  v_cvt_pk_bf16_f32 v28, v60, v61
  v_lshlrev_b32 v60, 16, v29
  v_and_b32 v61, 0xffff0000, v29
  v_mul_f32 v62, 0x3fb8aa3b, v60
  v_exp_f32 v62, v62
  v_add_f32 v63, 1.0, v60
  v_cmp_lt_f32 vcc, 0, v60
  s_nop 1
  v_cndmask_b32 v60, v62, v63, vcc
  v_mul_f32 v62, 0x3fb8aa3b, v61
  v_exp_f32 v62, v62
  v_add_f32 v63, 1.0, v61
  v_cmp_lt_f32 vcc, 0, v61
  s_nop 1
  v_cndmask_b32 v61, v62, v63, vcc
  v_cvt_pk_bf16_f32 v62, v60, v61
  v_lshlrev_b32 v60, 16, v62
  v_and_b32 v61, 0xffff0000, v62
  v_add_f32 v60, 0x358637bd, v60
  v_add_f32 v61, 0x358637bd, v61
  v_cvt_pk_bf16_f32 v29, v60, v61
  v_lshlrev_b32 v60, 16, v30
  v_and_b32 v61, 0xffff0000, v30
  v_mul_f32 v62, 0x3fb8aa3b, v60
  v_exp_f32 v62, v62
  v_add_f32 v63, 1.0, v60
  v_cmp_lt_f32 vcc, 0, v60
  s_nop 1
  v_cndmask_b32 v60, v62, v63, vcc
  v_mul_f32 v62, 0x3fb8aa3b, v61
  v_exp_f32 v62, v62
  v_add_f32 v63, 1.0, v61
  v_cmp_lt_f32 vcc, 0, v61
  s_nop 1
  v_cndmask_b32 v61, v62, v63, vcc
  v_cvt_pk_bf16_f32 v62, v60, v61
  v_lshlrev_b32 v60, 16, v62
  v_and_b32 v61, 0xffff0000, v62
  v_add_f32 v60, 0x358637bd, v60
  v_add_f32 v61, 0x358637bd, v61
  v_cvt_pk_bf16_f32 v30, v60, v61
  v_lshlrev_b32 v60, 16, v31
  v_and_b32 v61, 0xffff0000, v31
  v_mul_f32 v62, 0x3fb8aa3b, v60
  v_exp_f32 v62, v62
  v_add_f32 v63, 1.0, v60
  v_cmp_lt_f32 vcc, 0, v60
  s_nop 1
  v_cndmask_b32 v60, v62, v63, vcc
  v_mul_f32 v62, 0x3fb8aa3b, v61
  v_exp_f32 v62, v62
  v_add_f32 v63, 1.0, v61
  v_cmp_lt_f32 vcc, 0, v61
  s_nop 1
  v_cndmask_b32 v61, v62, v63, vcc
  v_cvt_pk_bf16_f32 v62, v60, v61
  v_lshlrev_b32 v60, 16, v62
  v_and_b32 v61, 0xffff0000, v62
  v_add_f32 v60, 0x358637bd, v60
  v_add_f32 v61, 0x358637bd, v61
  v_cvt_pk_bf16_f32 v31, v60, v61
  ds_write_b128 v6, v[16:19] offset:0
  ds_write_b128 v6, v[32:35] offset:4096
  ds_write_b128 v6, v[20:23] offset:1024
  ds_write_b128 v6, v[36:39] offset:5120
  ds_write_b128 v6, v[24:27] offset:2048
  ds_write_b128 v6, v[40:43] offset:6144
  ds_write_b128 v6, v[28:31] offset:3072
  ds_write_b128 v6, v[44:47] offset:7168
  v_lshrrev_b32 v7, 4, v1
  v_lshlrev_b32 v7, 3, v7
  v_bfe_u32 v8, v1, 2, 2
  v_add_u32 v7, v7, v8
  v_lshlrev_b32 v7, 6, v7
  v_lshl_add_u32 v7, v5, 3, v7
  v_lshl_add_u32 v7, v2, 13, v7
  v_mov_b32 v100, 0
  v_mov_b32 v101, 0
  v_mov_b32 v102, 0
  v_mov_b32 v103, 0
  v_mov_b32 v104, 0
  v_mov_b32 v105, 0
  v_mov_b32 v106, 0
  v_mov_b32 v107, 0
  v_mov_b32 v108, 0
  v_mov_b32 v109, 0
  v_mov_b32 v110, 0
  v_mov_b32 v111, 0
  v_mov_b32 v112, 0
  v_mov_b32 v113, 0
  v_mov_b32 v114, 0
  v_mov_b32 v115, 0
  v_mov_b32 v116, 0
  v_mov_b32 v117, 0
  v_mov_b32 v118, 0
  v_mov_b32 v119, 0
  v_mov_b32 v120, 0
  v_mov_b32 v121, 0
  v_mov_b32 v122, 0
  v_mov_b32 v123, 0
  v_mov_b32 v96, 0x3f803f80
  v_mov_b32 v97, 0x3f803f80
  v_mov_b32 v98, 0x3f803f80
  v_mov_b32 v99, 0x3f803f80
  s_waitcnt lgkmcnt(0)
  ds_read_b64_tr_b16 v[64:65], v7 offset:0
  ds_read_b64_tr_b16 v[72:73], v7 offset:4096
  ds_read_b64_tr_b16 v[66:67], v7 offset:256
  ds_read_b64_tr_b16 v[74:75], v7 offset:4352
  ds_read_b64_tr_b16 v[68:69], v7 offset:32
  ds_read_b64_tr_b16 v[76:77], v7 offset:4128
  ds_read_b64_tr_b16 v[70:71], v7 offset:288
  ds_read_b64_tr_b16 v[78:79], v7 offset:4384
  s_waitcnt lgkmcnt(0)
  v_mfma_f32_16x16x32_bf16 v[100:103], v[64:67], v[72:75], v[100:103]
  v_mfma_f32_16x16x32_bf16 v[104:107], v[64:67], v[76:79], v[104:107]
  v_mfma_f32_16x16x32_bf16 v[116:119], v[64:67], v[96:99], v[116:119]
  v_mfma_f32_16x16x32_bf16 v[108:111], v[68:71], v[72:75], v[108:111]
  v_mfma_f32_16x16x32_bf16 v[112:115], v[68:71], v[76:79], v[112:115]
  v_mfma_f32_16x16x32_bf16 v[120:123], v[68:71], v[96:99], v[120:123]
  ds_read_b64_tr_b16 v[64:65], v7 offset:2048
  ds_read_b64_tr_b16 v[72:73], v7 offset:6144
  ds_read_b64_tr_b16 v[66:67], v7 offset:2304
  ds_read_b64_tr_b16 v[74:75], v7 offset:6400
  ds_read_b64_tr_b16 v[68:69], v7 offset:2080
  ds_read_b64_tr_b16 v[76:77], v7 offset:6176
  ds_read_b64_tr_b16 v[70:71], v7 offset:2336
  ds_read_b64_tr_b16 v[78:79], v7 offset:6432
  s_waitcnt lgkmcnt(0)
  v_mfma_f32_16x16x32_bf16 v[100:103], v[64:67], v[72:75], v[100:103]
  v_mfma_f32_16x16x32_bf16 v[104:107], v[64:67], v[76:79], v[104:107]
  v_mfma_f32_16x16x32_bf16 v[116:119], v[64:67], v[96:99], v[116:119]
  v_mfma_f32_16x16x32_bf16 v[108:111], v[68:71], v[72:75], v[108:111]
  v_mfma_f32_16x16x32_bf16 v[112:115], v[68:71], v[76:79], v[112:115]
  v_mfma_f32_16x16x32_bf16 v[120:123], v[68:71], v[96:99], v[120:123]
  s_nop 7
  s_nop 7
  s_barrier
  v_lshrrev_b32 v9, 4, v1
  v_lshlrev_b32 v9, 9, v9
  v_and_b32 v10, 15, v1
  v_lshl_add_u32 v9, v10, 2, v9
  v_mul_u32_u24 v11, 4352, v2
  v_add_u32 v9, v9, v11
  ds_write_b32 v9, v100 offset:0
  ds_write_b32 v9, v101 offset:128
  ds_write_b32 v9, v102 offset:256
  ds_write_b32 v9, v103 offset:384
  ds_write_b32 v9, v104 offset:64
  ds_write_b32 v9, v105 offset:192
  ds_write_b32 v9, v106 offset:320
  ds_write_b32 v9, v107 offset:448
  ds_write_b32 v9, v108 offset:2048
  ds_write_b32 v9, v109 offset:2176
  ds_write_b32 v9, v110 offset:2304
  ds_write_b32 v9, v111 offset:2432
  ds_write_b32 v9, v112 offset:2112
  ds_write_b32 v9, v113 offset:2240
  ds_write_b32 v9, v114 offset:2368
  ds_write_b32 v9, v115 offset:2496
  v_lshrrev_b32 v12, 4, v1
  v_lshlrev_b32 v12, 4, v12
  v_add_u32 v12, v12, v11
  v_cmp_eq_u32 vcc, 0, v10
  s_and_saveexec_b64 s[50:51], vcc
  ds_write_b32 v12, v116 offset:4096
  ds_write_b32 v12, v117 offset:4100
  ds_write_b32 v12, v118 offset:4104
  ds_write_b32 v12, v119 offset:4108
  ds_write_b32 v12, v120 offset:4160
  ds_write_b32 v12, v121 offset:4164
  ds_write_b32 v12, v122 offset:4168
  ds_write_b32 v12, v123 offset:4172
  s_mov_b64 exec, s[50:51]
  s_waitcnt lgkmcnt(0)
  s_barrier
  v_lshlrev_b32 v13, 2, v0
  s_mul_i32 s3, s2, 4224
  ds_read_b32 v20, v13 offset:0
  ds_read_b32 v21, v13 offset:4352
  ds_read_b32 v22, v13 offset:8704
  ds_read_b32 v23, v13 offset:13056
  s_waitcnt lgkmcnt(0)
  v_add_f32 v20, v20, v21
  v_add_f32 v22, v22, v23
  v_add_f32 v20, v20, v22
  s_add_u32 s52, s3, 0
  buffer_store_dword v20, v13, s[28:31], s52 offen
  ds_read_b32 v20, v13 offset:1024
  ds_read_b32 v21, v13 offset:5376
  ds_read_b32 v22, v13 offset:9728
  ds_read_b32 v23, v13 offset:14080
  s_waitcnt lgkmcnt(0)
  v_add_f32 v20, v20, v21
  v_add_f32 v22, v22, v23
  v_add_f32 v20, v20, v22
  s_add_u32 s52, s3, 1024
  buffer_store_dword v20, v13, s[28:31], s52 offen
  ds_read_b32 v20, v13 offset:2048
  ds_read_b32 v21, v13 offset:6400
  ds_read_b32 v22, v13 offset:10752
  ds_read_b32 v23, v13 offset:15104
  s_waitcnt lgkmcnt(0)
  v_add_f32 v20, v20, v21
  v_add_f32 v22, v22, v23
  v_add_f32 v20, v20, v22
  s_add_u32 s52, s3, 2048
  buffer_store_dword v20, v13, s[28:31], s52 offen
  ds_read_b32 v20, v13 offset:3072
  ds_read_b32 v21, v13 offset:7424
  ds_read_b32 v22, v13 offset:11776
  ds_read_b32 v23, v13 offset:16128
  s_waitcnt lgkmcnt(0)
  v_add_f32 v20, v20, v21
  v_add_f32 v22, v22, v23
  v_add_f32 v20, v20, v22
  s_add_u32 s52, s3, 3072
  buffer_store_dword v20, v13, s[28:31], s52 offen
  v_cmp_gt_u32 vcc, 32, v0
  s_and_saveexec_b64 s[50:51], vcc
  ds_read_b32 v20, v13 offset:4096
  ds_read_b32 v21, v13 offset:8448
  ds_read_b32 v22, v13 offset:12800
  ds_read_b32 v23, v13 offset:17152
  s_waitcnt lgkmcnt(0)
  v_add_f32 v20, v20, v21
  v_add_f32 v22, v22, v23
  v_add_f32 v20, v20, v22
  s_add_u32 s52, s3, 4096
  buffer_store_dword v20, v13, s[28:31], s52 offen
  s_mov_b64 exec, s[50:51]
L_kvpart0_kernel_end:
  s_endpgm
.globl linapply0_kernel
.p2align 8
.type linapply0_kernel,@function
linapply0_kernel:
  s_cmp_ge_u32 s2, 256
  s_cbranch_scc1 L_linapply0_kernel_end
  s_load_dwordx16 s[4:19], s[0:1], 0
  s_load_dwordx2 s[20:21], s[0:1], 64
  s_waitcnt lgkmcnt(0)
  s_add_u32 s24, s20, 4194304
  s_addc_u32 s25, s21, 0
  s_and_b32 s25, s25, 0xffff
  s_mov_b32 s26, 12582912
  s_mov_b32 s27, 0x00020000
  s_add_u32 s28, s20, 33554432
  s_addc_u32 s29, s21, 0
  s_and_b32 s29, s29, 0xffff
  s_mov_b32 s30, 1081344
  s_mov_b32 s31, 0x00020000
  s_add_u32 s32, s20, 16777216
  s_addc_u32 s33, s21, 0
  s_and_b32 s33, s33, 0xffff
  s_mov_b32 s34, 4194304
  s_mov_b32 s35, 0x00020000
  s_lshr_b32 s40, s2, 3
  s_and_b32 s41, s2, 7
  v_and_b32 v1, 63, v0
  v_lshrrev_b32 v2, 6, v0
  v_lshlrev_b32 v13, 2, v0
  s_mul_i32 s42, s40, 33792
  v_and_b32 v14, 31, v0
  v_lshlrev_b32 v14, 6, v14
  v_lshrrev_b32 v15, 5, v0
  v_lshl_add_u32 v14, v15, 1, v14
  s_add_u32 s3, s42, 0
  buffer_load_dword v20, v13, s[28:31], s3 offen
  s_add_u32 s3, s42, 4224
  buffer_load_dword v21, v13, s[28:31], s3 offen
  s_add_u32 s3, s42, 8448
  buffer_load_dword v22, v13, s[28:31], s3 offen
  s_add_u32 s3, s42, 12672
  buffer_load_dword v23, v13, s[28:31], s3 offen
  s_add_u32 s3, s42, 16896
  buffer_load_dword v24, v13, s[28:31], s3 offen
  s_add_u32 s3, s42, 21120
  buffer_load_dword v25, v13, s[28:31], s3 offen
  s_add_u32 s3, s42, 25344
  buffer_load_dword v26, v13, s[28:31], s3 offen
  s_add_u32 s3, s42, 29568
  buffer_load_dword v27, v13, s[28:31], s3 offen
  s_waitcnt vmcnt(0)
  v_add_f32 v20, v20, v21
  v_add_f32 v20, v20, v22
  v_add_f32 v20, v20, v23
  v_add_f32 v20, v20, v24
  v_add_f32 v20, v20, v25
  v_add_f32 v20, v20, v26
  v_add_f32 v20, v20, v27
  v_cvt_pk_bf16_f32 v20, v20, v20
  ds_write_b16 v14, v20 offset:0
  s_add_u32 s3, s42, 1024
  buffer_load_dword v20, v13, s[28:31], s3 offen
  s_add_u32 s3, s42, 5248
  buffer_load_dword v21, v13, s[28:31], s3 offen
  s_add_u32 s3, s42, 9472
  buffer_load_dword v22, v13, s[28:31], s3 offen
  s_add_u32 s3, s42, 13696
  buffer_load_dword v23, v13, s[28:31], s3 offen
  s_add_u32 s3, s42, 17920
  buffer_load_dword v24, v13, s[28:31], s3 offen
  s_add_u32 s3, s42, 22144
  buffer_load_dword v25, v13, s[28:31], s3 offen
  s_add_u32 s3, s42, 26368
  buffer_load_dword v26, v13, s[28:31], s3 offen
  s_add_u32 s3, s42, 30592
  buffer_load_dword v27, v13, s[28:31], s3 offen
  s_waitcnt vmcnt(0)
  v_add_f32 v20, v20, v21
  v_add_f32 v20, v20, v22
  v_add_f32 v20, v20, v23
  v_add_f32 v20, v20, v24
  v_add_f32 v20, v20, v25
  v_add_f32 v20, v20, v26
  v_add_f32 v20, v20, v27
  v_cvt_pk_bf16_f32 v20, v20, v20
  ds_write_b16 v14, v20 offset:16
  s_add_u32 s3, s42, 2048
  buffer_load_dword v20, v13, s[28:31], s3 offen
  s_add_u32 s3, s42, 6272
  buffer_load_dword v21, v13, s[28:31], s3 offen
  s_add_u32 s3, s42, 10496
  buffer_load_dword v22, v13, s[28:31], s3 offen
  s_add_u32 s3, s42, 14720
  buffer_load_dword v23, v13, s[28:31], s3 offen
  s_add_u32 s3, s42, 18944
  buffer_load_dword v24, v13, s[28:31], s3 offen
  s_add_u32 s3, s42, 23168
  buffer_load_dword v25, v13, s[28:31], s3 offen
  s_add_u32 s3, s42, 27392
  buffer_load_dword v26, v13, s[28:31], s3 offen
  s_add_u32 s3, s42, 31616
  buffer_load_dword v27, v13, s[28:31], s3 offen
  s_waitcnt vmcnt(0)
  v_add_f32 v20, v20, v21
  v_add_f32 v20, v20, v22
  v_add_f32 v20, v20, v23
  v_add_f32 v20, v20, v24
  v_add_f32 v20, v20, v25
  v_add_f32 v20, v20, v26
  v_add_f32 v20, v20, v27
  v_cvt_pk_bf16_f32 v20, v20, v20
  ds_write_b16 v14, v20 offset:32
  s_add_u32 s3, s42, 3072
  buffer_load_dword v20, v13, s[28:31], s3 offen
  s_add_u32 s3, s42, 7296
  buffer_load_dword v21, v13, s[28:31], s3 offen
  s_add_u32 s3, s42, 11520
  buffer_load_dword v22, v13, s[28:31], s3 offen
  s_add_u32 s3, s42, 15744
  buffer_load_dword v23, v13, s[28:31], s3 offen
  s_add_u32 s3, s42, 19968
  buffer_load_dword v24, v13, s[28:31], s3 offen
  s_add_u32 s3, s42, 24192
  buffer_load_dword v25, v13, s[28:31], s3 offen
  s_add_u32 s3, s42, 28416
  buffer_load_dword v26, v13, s[28:31], s3 offen
  s_add_u32 s3, s42, 32640
  buffer_load_dword v27, v13, s[28:31], s3 offen
  s_waitcnt vmcnt(0)
  v_add_f32 v20, v20, v21
  v_add_f32 v20, v20, v22
  v_add_f32 v20, v20, v23
  v_add_f32 v20, v20, v24
  v_add_f32 v20, v20, v25
  v_add_f32 v20, v20, v26
  v_add_f32 v20, v20, v27
  v_cvt_pk_bf16_f32 v20, v20, v20
  ds_write_b16 v14, v20 offset:48
  v_cmp_gt_u32 vcc, 32, v0
  s_and_saveexec_b64 s[50:51], vcc
  v_lshlrev_b32 v14, 1, v0
  v_add_u32 v14, 2048, v14
  s_add_u32 s3, s42, 4096
  buffer_load_dword v20, v13, s[28:31], s3 offen
  s_add_u32 s3, s42, 8320
  buffer_load_dword v21, v13, s[28:31], s3 offen
  s_add_u32 s3, s42, 12544
  buffer_load_dword v22, v13, s[28:31], s3 offen
  s_add_u32 s3, s42, 16768
  buffer_load_dword v23, v13, s[28:31], s3 offen
  s_add_u32 s3, s42, 20992
  buffer_load_dword v24, v13, s[28:31], s3 offen
  s_add_u32 s3, s42, 25216
  buffer_load_dword v25, v13, s[28:31], s3 offen
  s_add_u32 s3, s42, 29440
  buffer_load_dword v26, v13, s[28:31], s3 offen
  s_add_u32 s3, s42, 33664
  buffer_load_dword v27, v13, s[28:31], s3 offen
  s_waitcnt vmcnt(0)
  v_add_f32 v20, v20, v21
  v_add_f32 v20, v20, v22
  v_add_f32 v20, v20, v23
  v_add_f32 v20, v20, v24
  v_add_f32 v20, v20, v25
  v_add_f32 v20, v20, v26
  v_add_f32 v20, v20, v27
  v_cvt_pk_bf16_f32 v20, v20, v20
  ds_write_b16 v14, v20 offset:0
  s_mov_b64 exec, s[50:51]
  s_waitcnt lgkmcnt(0)
  s_barrier
  v_and_b32 v3, 15, v1
  v_lshrrev_b32 v4, 4, v1
  v_lshlrev_b32 v5, 6, v3
  v_lshl_add_u32 v5, v4, 4, v5
  v_lshlrev_b32 v6, 4, v4
  ds_read_b128 v[64:67], v5
  ds_read_b128 v[68:71], v5 offset:1024
  ds_read_b128 v[72:75], v6 offset:2048
  s_lshl_b32 s3, s41, 8
  v_lshl_add_u32 v7, v2, 6, v3
  v_add_u32 v7, s3, v7
  v_mul_u32_u24 v8, 6144, v7
  v_lshl_add_u32 v8, v4, 4, v8
  s_lshl_b32 s43, s40, 6
  s_add_u32 s44, s43, 0
  buffer_load_dwordx4 v[16:19], v8, s[24:27], s44 offen
  s_add_u32 s44, s43, 98304
  buffer_load_dwordx4 v[20:23], v8, s[24:27], s44 offen
  s_add_u32 s44, s43, 196608
  buffer_load_dwordx4 v[24:27], v8, s[24:27], s44 offen
  s_add_u32 s44, s43, 294912
  buffer_load_dwordx4 v[28:31], v8, s[24:27], s44 offen
  v_lshlrev_b32 v9, 11, v7
  v_lshl_add_u32 v9, v4, 3, v9
  v_add_u32 v9, s43, v9
  s_waitcnt vmcnt(0) lgkmcnt(0)
  v_lshlrev_b32 v60, 16, v16
  v_and_b32 v61, 0xffff0000, v16
  v_mul_f32 v62, 0x3fb8aa3b, v60
  v_exp_f32 v62, v62
  v_add_f32 v63, 1.0, v60
  v_cmp_lt_f32 vcc, 0, v60
  s_nop 1
  v_cndmask_b32 v60, v62, v63, vcc
  v_mul_f32 v62, 0x3fb8aa3b, v61
  v_exp_f32 v62, v62
  v_add_f32 v63, 1.0, v61
  v_cmp_lt_f32 vcc, 0, v61
  s_nop 1
  v_cndmask_b32 v61, v62, v63, vcc
  v_cvt_pk_bf16_f32 v62, v60, v61
  v_lshlrev_b32 v60, 16, v62
  v_and_b32 v61, 0xffff0000, v62
  v_add_f32 v60, 0x358637bd, v60
  v_add_f32 v61, 0x358637bd, v61
  v_cvt_pk_bf16_f32 v16, v60, v61
  v_lshlrev_b32 v60, 16, v17
  v_and_b32 v61, 0xffff0000, v17
  v_mul_f32 v62, 0x3fb8aa3b, v60
  v_exp_f32 v62, v62
  v_add_f32 v63, 1.0, v60
  v_cmp_lt_f32 vcc, 0, v60
  s_nop 1
  v_cndmask_b32 v60, v62, v63, vcc
  v_mul_f32 v62, 0x3fb8aa3b, v61
  v_exp_f32 v62, v62
  v_add_f32 v63, 1.0, v61
  v_cmp_lt_f32 vcc, 0, v61
  s_nop 1
  v_cndmask_b32 v61, v62, v63, vcc
  v_cvt_pk_bf16_f32 v62, v60, v61
  v_lshlrev_b32 v60, 16, v62
  v_and_b32 v61, 0xffff0000, v62
  v_add_f32 v60, 0x358637bd, v60
  v_add_f32 v61, 0x358637bd, v61
  v_cvt_pk_bf16_f32 v17, v60, v61
  v_lshlrev_b32 v60, 16, v18
  v_and_b32 v61, 0xffff0000, v18
  v_mul_f32 v62, 0x3fb8aa3b, v60
  v_exp_f32 v62, v62
  v_add_f32 v63, 1.0, v60
  v_cmp_lt_f32 vcc, 0, v60
  s_nop 1
  v_cndmask_b32 v60, v62, v63, vcc
  v_mul_f32 v62, 0x3fb8aa3b, v61
  v_exp_f32 v62, v62
  v_add_f32 v63, 1.0, v61
  v_cmp_lt_f32 vcc, 0, v61
  s_nop 1
  v_cndmask_b32 v61, v62, v63, vcc
  v_cvt_pk_bf16_f32 v62, v60, v61
  v_lshlrev_b32 v60, 16, v62
  v_and_b32 v61, 0xffff0000, v62
  v_add_f32 v60, 0x358637bd, v60
  v_add_f32 v61, 0x358637bd, v61
  v_cvt_pk_bf16_f32 v18, v60, v61
  v_lshlrev_b32 v60, 16, v19
  v_and_b32 v61, 0xffff0000, v19
  v_mul_f32 v62, 0x3fb8aa3b, v60
  v_exp_f32 v62, v62
  v_add_f32 v63, 1.0, v60
  v_cmp_lt_f32 vcc, 0, v60
  s_nop 1
  v_cndmask_b32 v60, v62, v63, vcc
  v_mul_f32 v62, 0x3fb8aa3b, v61
  v_exp_f32 v62, v62
  v_add_f32 v63, 1.0, v61
  v_cmp_lt_f32 vcc, 0, v61
  s_nop 1
  v_cndmask_b32 v61, v62, v63, vcc
  v_cvt_pk_bf16_f32 v62, v60, v61
  v_lshlrev_b32 v60, 16, v62
  v_and_b32 v61, 0xffff0000, v62
  v_add_f32 v60, 0x358637bd, v60
  v_add_f32 v61, 0x358637bd, v61
  v_cvt_pk_bf16_f32 v19, v60, v61
  v_lshlrev_b32 v60, 16, v20
  v_and_b32 v61, 0xffff0000, v20
  v_mul_f32 v62, 0x3fb8aa3b, v60
  v_exp_f32 v62, v62
  v_add_f32 v63, 1.0, v60
  v_cmp_lt_f32 vcc, 0, v60
  s_nop 1
  v_cndmask_b32 v60, v62, v63, vcc
  v_mul_f32 v62, 0x3fb8aa3b, v61
  v_exp_f32 v62, v62
  v_add_f32 v63, 1.0, v61
  v_cmp_lt_f32 vcc, 0, v61
  s_nop 1
  v_cndmask_b32 v61, v62, v63, vcc
  v_cvt_pk_bf16_f32 v62, v60, v61
  v_lshlrev_b32 v60, 16, v62
  v_and_b32 v61, 0xffff0000, v62
  v_add_f32 v60, 0x358637bd, v60
  v_add_f32 v61, 0x358637bd, v61
  v_cvt_pk_bf16_f32 v20, v60, v61
  v_lshlrev_b32 v60, 16, v21
  v_and_b32 v61, 0xffff0000, v21
  v_mul_f32 v62, 0x3fb8aa3b, v60
  v_exp_f32 v62, v62
  v_add_f32 v63, 1.0, v60
  v_cmp_lt_f32 vcc, 0, v60
  s_nop 1
  v_cndmask_b32 v60, v62, v63, vcc
  v_mul_f32 v62, 0x3fb8aa3b, v61
  v_exp_f32 v62, v62
  v_add_f32 v63, 1.0, v61
  v_cmp_lt_f32 vcc, 0, v61
  s_nop 1
  v_cndmask_b32 v61, v62, v63, vcc
  v_cvt_pk_bf16_f32 v62, v60, v61
  v_lshlrev_b32 v60, 16, v62
  v_and_b32 v61, 0xffff0000, v62
  v_add_f32 v60, 0x358637bd, v60
  v_add_f32 v61, 0x358637bd, v61
  v_cvt_pk_bf16_f32 v21, v60, v61
  v_lshlrev_b32 v60, 16, v22
  v_and_b32 v61, 0xffff0000, v22
  v_mul_f32 v62, 0x3fb8aa3b, v60
  v_exp_f32 v62, v62
  v_add_f32 v63, 1.0, v60
  v_cmp_lt_f32 vcc, 0, v60
  s_nop 1
  v_cndmask_b32 v60, v62, v63, vcc
  v_mul_f32 v62, 0x3fb8aa3b, v61
  v_exp_f32 v62, v62
  v_add_f32 v63, 1.0, v61
  v_cmp_lt_f32 vcc, 0, v61
  s_nop 1
  v_cndmask_b32 v61, v62, v63, vcc
  v_cvt_pk_bf16_f32 v62, v60, v61
  v_lshlrev_b32 v60, 16, v62
  v_and_b32 v61, 0xffff0000, v62
  v_add_f32 v60, 0x358637bd, v60
  v_add_f32 v61, 0x358637bd, v61
  v_cvt_pk_bf16_f32 v22, v60, v61
  v_lshlrev_b32 v60, 16, v23
  v_and_b32 v61, 0xffff0000, v23
  v_mul_f32 v62, 0x3fb8aa3b, v60
  v_exp_f32 v62, v62
  v_add_f32 v63, 1.0, v60
  v_cmp_lt_f32 vcc, 0, v60
  s_nop 1
  v_cndmask_b32 v60, v62, v63, vcc
  v_mul_f32 v62, 0x3fb8aa3b, v61
  v_exp_f32 v62, v62
  v_add_f32 v63, 1.0, v61
  v_cmp_lt_f32 vcc, 0, v61
  s_nop 1
  v_cndmask_b32 v61, v62, v63, vcc
  v_cvt_pk_bf16_f32 v62, v60, v61
  v_lshlrev_b32 v60, 16, v62
  v_and_b32 v61, 0xffff0000, v62
  v_add_f32 v60, 0x358637bd, v60
  v_add_f32 v61, 0x358637bd, v61
  v_cvt_pk_bf16_f32 v23, v60, v61
  v_lshlrev_b32 v60, 16, v24
  v_and_b32 v61, 0xffff0000, v24
  v_mul_f32 v62, 0x3fb8aa3b, v60
  v_exp_f32 v62, v62
  v_add_f32 v63, 1.0, v60
  v_cmp_lt_f32 vcc, 0, v60
  s_nop 1
  v_cndmask_b32 v60, v62, v63, vcc
  v_mul_f32 v62, 0x3fb8aa3b, v61
  v_exp_f32 v62, v62
  v_add_f32 v63, 1.0, v61
  v_cmp_lt_f32 vcc, 0, v61
  s_nop 1
  v_cndmask_b32 v61, v62, v63, vcc
  v_cvt_pk_bf16_f32 v62, v60, v61
  v_lshlrev_b32 v60, 16, v62
  v_and_b32 v61, 0xffff0000, v62
  v_add_f32 v60, 0x358637bd, v60
  v_add_f32 v61, 0x358637bd, v61
  v_cvt_pk_bf16_f32 v24, v60, v61
  v_lshlrev_b32 v60, 16, v25
  v_and_b32 v61, 0xffff0000, v25
  v_mul_f32 v62, 0x3fb8aa3b, v60
  v_exp_f32 v62, v62
  v_add_f32 v63, 1.0, v60
  v_cmp_lt_f32 vcc, 0, v60
  s_nop 1
  v_cndmask_b32 v60, v62, v63, vcc
  v_mul_f32 v62, 0x3fb8aa3b, v61
  v_exp_f32 v62, v62
  v_add_f32 v63, 1.0, v61
  v_cmp_lt_f32 vcc, 0, v61
  s_nop 1
  v_cndmask_b32 v61, v62, v63, vcc
  v_cvt_pk_bf16_f32 v62, v60, v61
  v_lshlrev_b32 v60, 16, v62
  v_and_b32 v61, 0xffff0000, v62
  v_add_f32 v60, 0x358637bd, v60
  v_add_f32 v61, 0x358637bd, v61
  v_cvt_pk_bf16_f32 v25, v60, v61
  v_lshlrev_b32 v60, 16, v26
  v_and_b32 v61, 0xffff0000, v26
  v_mul_f32 v62, 0x3fb8aa3b, v60
  v_exp_f32 v62, v62
  v_add_f32 v63, 1.0, v60
  v_cmp_lt_f32 vcc, 0, v60
  s_nop 1
  v_cndmask_b32 v60, v62, v63, vcc
  v_mul_f32 v62, 0x3fb8aa3b, v61
  v_exp_f32 v62, v62
  v_add_f32 v63, 1.0, v61
  v_cmp_lt_f32 vcc, 0, v61
  s_nop 1
  v_cndmask_b32 v61, v62, v63, vcc
  v_cvt_pk_bf16_f32 v62, v60, v61
  v_lshlrev_b32 v60, 16, v62
  v_and_b32 v61, 0xffff0000, v62
  v_add_f32 v60, 0x358637bd, v60
  v_add_f32 v61, 0x358637bd, v61
  v_cvt_pk_bf16_f32 v26, v60, v61
  v_lshlrev_b32 v60, 16, v27
  v_and_b32 v61, 0xffff0000, v27
  v_mul_f32 v62, 0x3fb8aa3b, v60
  v_exp_f32 v62, v62
  v_add_f32 v63, 1.0, v60
  v_cmp_lt_f32 vcc, 0, v60
  s_nop 1
  v_cndmask_b32 v60, v62, v63, vcc
  v_mul_f32 v62, 0x3fb8aa3b, v61
  v_exp_f32 v62, v62
  v_add_f32 v63, 1.0, v61
  v_cmp_lt_f32 vcc, 0, v61
  s_nop 1
  v_cndmask_b32 v61, v62, v63, vcc
  v_cvt_pk_bf16_f32 v62, v60, v61
  v_lshlrev_b32 v60, 16, v62
  v_and_b32 v61, 0xffff0000, v62
  v_add_f32 v60, 0x358637bd, v60
  v_add_f32 v61, 0x358637bd, v61
  v_cvt_pk_bf16_f32 v27, v60, v61
  v_lshlrev_b32 v60, 16, v28
  v_and_b32 v61, 0xffff0000, v28
  v_mul_f32 v62, 0x3fb8aa3b, v60
  v_exp_f32 v62, v62
  v_add_f32 v63, 1.0, v60
  v_cmp_lt_f32 vcc, 0, v60
  s_nop 1
  v_cndmask_b32 v60, v62, v63, vcc
  v_mul_f32 v62, 0x3fb8aa3b, v61
  v_exp_f32 v62, v62
  v_add_f32 v63, 1.0, v61
  v_cmp_lt_f32 vcc, 0, v61
  s_nop 1
  v_cndmask_b32 v61, v62, v63, vcc
  v_cvt_pk_bf16_f32 v62, v60, v61
  v_lshlrev_b32 v60, 16, v62
  v_and_b32 v61, 0xffff0000, v62
  v_add_f32 v60, 0x358637bd, v60
  v_add_f32 v61, 0x358637bd, v61
  v_cvt_pk_bf16_f32 v28, v60, v61
  v_lshlrev_b32 v60, 16, v29
  v_and_b32 v61, 0xffff0000, v29
  v_mul_f32 v62, 0x3fb8aa3b, v60
  v_exp_f32 v62, v62
  v_add_f32 v63, 1.0, v60
  v_cmp_lt_f32 vcc, 0, v60
  s_nop 1
  v_cndmask_b32 v60, v62, v63, vcc
  v_mul_f32 v62, 0x3fb8aa3b, v61
  v_exp_f32 v62, v62
  v_add_f32 v63, 1.0, v61
  v_cmp_lt_f32 vcc, 0, v61
  s_nop 1
  v_cndmask_b32 v61, v62, v63, vcc
  v_cvt_pk_bf16_f32 v62, v60, v61
  v_lshlrev_b32 v60, 16, v62
  v_and_b32 v61, 0xffff0000, v62
  v_add_f32 v60, 0x358637bd, v60
  v_add_f32 v61, 0x358637bd, v61
  v_cvt_pk_bf16_f32 v29, v60, v61
  v_lshlrev_b32 v60, 16, v30
  v_and_b32 v61, 0xffff0000, v30
  v_mul_f32 v62, 0x3fb8aa3b, v60
  v_exp_f32 v62, v62
  v_add_f32 v63, 1.0, v60
  v_cmp_lt_f32 vcc, 0, v60
  s_nop 1
  v_cndmask_b32 v60, v62, v63, vcc
  v_mul_f32 v62, 0x3fb8aa3b, v61
  v_exp_f32 v62, v62
  v_add_f32 v63, 1.0, v61
  v_cmp_lt_f32 vcc, 0, v61
  s_nop 1
  v_cndmask_b32 v61, v62, v63, vcc
  v_cvt_pk_bf16_f32 v62, v60, v61
  v_lshlrev_b32 v60, 16, v62
  v_and_b32 v61, 0xffff0000, v62
  v_add_f32 v60, 0x358637bd, v60
  v_add_f32 v61, 0x358637bd, v61
  v_cvt_pk_bf16_f32 v30, v60, v61
  v_lshlrev_b32 v60, 16, v31
  v_and_b32 v61, 0xffff0000, v31
  v_mul_f32 v62, 0x3fb8aa3b, v60
  v_exp_f32 v62, v62
  v_add_f32 v63, 1.0, v60
  v_cmp_lt_f32 vcc, 0, v60
  s_nop 1
  v_cndmask_b32 v60, v62, v63, vcc
  v_mul_f32 v62, 0x3fb8aa3b, v61
  v_exp_f32 v62, v62
  v_add_f32 v63, 1.0, v61
  v_cmp_lt_f32 vcc, 0, v61
  s_nop 1
  v_cndmask_b32 v61, v62, v63, vcc
  v_cvt_pk_bf16_f32 v62, v60, v61
  v_lshlrev_b32 v60, 16, v62
  v_and_b32 v61, 0xffff0000, v62
  v_add_f32 v60, 0x358637bd, v60
  v_add_f32 v61, 0x358637bd, v61
  v_cvt_pk_bf16_f32 v31, v60, v61
  s_nop 1
  v_mov_b32 v80, 0
  v_mov_b32 v81, 0
  v_mov_b32 v82, 0
  v_mov_b32 v83, 0
  v_mov_b32 v84, 0
  v_mov_b32 v85, 0
  v_mov_b32 v86, 0
  v_mov_b32 v87, 0
  v_mov_b32 v88, 0
  v_mov_b32 v89, 0
  v_mov_b32 v90, 0
  v_mov_b32 v91, 0
  s_nop 1
  v_mfma_f32_16x16x32_bf16 v[80:83], v[64:67], v[16:19], v[80:83]
  v_mfma_f32_16x16x32_bf16 v[84:87], v[68:71], v[16:19], v[84:87]
  v_mfma_f32_16x16x32_bf16 v[88:91], v[72:75], v[16:19], v[88:91]
  s_nop 7
  s_nop 7
  v_cvt_pk_bf16_f32 v88, v88, v88
  v_and_b32 v88, 0xffff0000, v88
  v_add_f32 v88, 0x358637bd, v88
  v_cvt_pk_bf16_f32 v88, v88, v88
  v_and_b32 v88, 0xffff0000, v88
  v_rcp_f32 v89, v88
  s_nop 0
  v_cvt_pk_bf16_f32 v80, v80, v80
  v_and_b32 v80, 0xffff0000, v80
  v_mul_f32 v90, v80, v89
  v_fma_f32 v91, -v90, v88, v80
  v_fma_f32 v80, v91, v89, v90
  v_cvt_pk_bf16_f32 v81, v81, v81
  v_and_b32 v81, 0xffff0000, v81
  v_mul_f32 v90, v81, v89
  v_fma_f32 v91, -v90, v88, v81
  v_fma_f32 v81, v91, v89, v90
  v_cvt_pk_bf16_f32 v82, v82, v82
  v_and_b32 v82, 0xffff0000, v82
  v_mul_f32 v90, v82, v89
  v_fma_f32 v91, -v90, v88, v82
  v_fma_f32 v82, v91, v89, v90
  v_cvt_pk_bf16_f32 v83, v83, v83
  v_and_b32 v83, 0xffff0000, v83
  v_mul_f32 v90, v83, v89
  v_fma_f32 v91, -v90, v88, v83
  v_fma_f32 v83, v91, v89, v90
  v_cvt_pk_bf16_f32 v84, v84, v84
  v_and_b32 v84, 0xffff0000, v84
  v_mul_f32 v90, v84, v89
  v_fma_f32 v91, -v90, v88, v84
  v_fma_f32 v84, v91, v89, v90
  v_cvt_pk_bf16_f32 v85, v85, v85
  v_and_b32 v85, 0xffff0000, v85
  v_mul_f32 v90, v85, v89
  v_fma_f32 v91, -v90, v88, v85
  v_fma_f32 v85, v91, v89, v90
  v_cvt_pk_bf16_f32 v86, v86, v86
  v_and_b32 v86, 0xffff0000, v86
  v_mul_f32 v90, v86, v89
  v_fma_f32 v91, -v90, v88, v86
  v_fma_f32 v86, v91, v89, v90
  v_cvt_pk_bf16_f32 v87, v87, v87
  v_and_b32 v87, 0xffff0000, v87
  v_mul_f32 v90, v87, v89
  v_fma_f32 v91, -v90, v88, v87
  v_fma_f32 v87, v91, v89, v90
  v_cvt_pk_bf16_f32 v80, v80, v81
  v_cvt_pk_bf16_f32 v81, v82, v83
  buffer_store_dwordx2 v[80:81], v9, s[32:35], 0 offen offset:0
  v_cvt_pk_bf16_f32 v84, v84, v85
  v_cvt_pk_bf16_f32 v85, v86, v87
  buffer_store_dwordx2 v[84:85], v9, s[32:35], 0 offen offset:32
  v_add_u32 v9, 32768, v9
  v_mov_b32 v80, 0
  v_mov_b32 v81, 0
  v_mov_b32 v82, 0
  v_mov_b32 v83, 0
  v_mov_b32 v84, 0
  v_mov_b32 v85, 0
  v_mov_b32 v86, 0
  v_mov_b32 v87, 0
  v_mov_b32 v88, 0
  v_mov_b32 v89, 0
  v_mov_b32 v90, 0
  v_mov_b32 v91, 0
  s_nop 1
  v_mfma_f32_16x16x32_bf16 v[80:83], v[64:67], v[20:23], v[80:83]
  v_mfma_f32_16x16x32_bf16 v[84:87], v[68:71], v[20:23], v[84:87]
  v_mfma_f32_16x16x32_bf16 v[88:91], v[72:75], v[20:23], v[88:91]
  s_nop 7
  s_nop 7
  v_cvt_pk_bf16_f32 v88, v88, v88
  v_and_b32 v88, 0xffff0000, v88
  v_add_f32 v88, 0x358637bd, v88
  v_cvt_pk_bf16_f32 v88, v88, v88
  v_and_b32 v88, 0xffff0000, v88
  v_rcp_f32 v89, v88
  s_nop 0
  v_cvt_pk_bf16_f32 v80, v80, v80
  v_and_b32 v80, 0xffff0000, v80
  v_mul_f32 v90, v80, v89
  v_fma_f32 v91, -v90, v88, v80
  v_fma_f32 v80, v91, v89, v90
  v_cvt_pk_bf16_f32 v81, v81, v81
  v_and_b32 v81, 0xffff0000, v81
  v_mul_f32 v90, v81, v89
  v_fma_f32 v91, -v90, v88, v81
  v_fma_f32 v81, v91, v89, v90
  v_cvt_pk_bf16_f32 v82, v82, v82
  v_and_b32 v82, 0xffff0000, v82
  v_mul_f32 v90, v82, v89
  v_fma_f32 v91, -v90, v88, v82
  v_fma_f32 v82, v91, v89, v90
  v_cvt_pk_bf16_f32 v83, v83, v83
  v_and_b32 v83, 0xffff0000, v83
  v_mul_f32 v90, v83, v89
  v_fma_f32 v91, -v90, v88, v83
  v_fma_f32 v83, v91, v89, v90
  v_cvt_pk_bf16_f32 v84, v84, v84
  v_and_b32 v84, 0xffff0000, v84
  v_mul_f32 v90, v84, v89
  v_fma_f32 v91, -v90, v88, v84
  v_fma_f32 v84, v91, v89, v90
  v_cvt_pk_bf16_f32 v85, v85, v85
  v_and_b32 v85, 0xffff0000, v85
  v_mul_f32 v90, v85, v89
  v_fma_f32 v91, -v90, v88, v85
  v_fma_f32 v85, v91, v89, v90
  v_cvt_pk_bf16_f32 v86, v86, v86
  v_and_b32 v86, 0xffff0000, v86
  v_mul_f32 v90, v86, v89
  v_fma_f32 v91, -v90, v88, v86
  v_fma_f32 v86, v91, v89, v90
  v_cvt_pk_bf16_f32 v87, v87, v87
  v_and_b32 v87, 0xffff0000, v87
  v_mul_f32 v90, v87, v89
  v_fma_f32 v91, -v90, v88, v87
  v_fma_f32 v87, v91, v89, v90
  v_cvt_pk_bf16_f32 v80, v80, v81
  v_cvt_pk_bf16_f32 v81, v82, v83
  buffer_store_dwordx2 v[80:81], v9, s[32:35], 0 offen offset:0
  v_cvt_pk_bf16_f32 v84, v84, v85
  v_cvt_pk_bf16_f32 v85, v86, v87
  buffer_store_dwordx2 v[84:85], v9, s[32:35], 0 offen offset:32
  v_add_u32 v9, 32768, v9
  v_mov_b32 v80, 0
  v_mov_b32 v81, 0
  v_mov_b32 v82, 0
  v_mov_b32 v83, 0
  v_mov_b32 v84, 0
  v_mov_b32 v85, 0
  v_mov_b32 v86, 0
  v_mov_b32 v87, 0
  v_mov_b32 v88, 0
  v_mov_b32 v89, 0
  v_mov_b32 v90, 0
  v_mov_b32 v91, 0
  s_nop 1
  v_mfma_f32_16x16x32_bf16 v[80:83], v[64:67], v[24:27], v[80:83]
  v_mfma_f32_16x16x32_bf16 v[84:87], v[68:71], v[24:27], v[84:87]
  v_mfma_f32_16x16x32_bf16 v[88:91], v[72:75], v[24:27], v[88:91]
  s_nop 7
  s_nop 7
  v_cvt_pk_bf16_f32 v88, v88, v88
  v_and_b32 v88, 0xffff0000, v88
  v_add_f32 v88, 0x358637bd, v88
  v_cvt_pk_bf16_f32 v88, v88, v88
  v_and_b32 v88, 0xffff0000, v88
  v_rcp_f32 v89, v88
  s_nop 0
  v_cvt_pk_bf16_f32 v80, v80, v80
  v_and_b32 v80, 0xffff0000, v80
  v_mul_f32 v90, v80, v89
  v_fma_f32 v91, -v90, v88, v80
  v_fma_f32 v80, v91, v89, v90
  v_cvt_pk_bf16_f32 v81, v81, v81
  v_and_b32 v81, 0xffff0000, v81
  v_mul_f32 v90, v81, v89
  v_fma_f32 v91, -v90, v88, v81
  v_fma_f32 v81, v91, v89, v90
  v_cvt_pk_bf16_f32 v82, v82, v82
  v_and_b32 v82, 0xffff0000, v82
  v_mul_f32 v90, v82, v89
  v_fma_f32 v91, -v90, v88, v82
  v_fma_f32 v82, v91, v89, v90
  v_cvt_pk_bf16_f32 v83, v83, v83
  v_and_b32 v83, 0xffff0000, v83
  v_mul_f32 v90, v83, v89
  v_fma_f32 v91, -v90, v88, v83
  v_fma_f32 v83, v91, v89, v90
  v_cvt_pk_bf16_f32 v84, v84, v84
  v_and_b32 v84, 0xffff0000, v84
  v_mul_f32 v90, v84, v89
  v_fma_f32 v91, -v90, v88, v84
  v_fma_f32 v84, v91, v89, v90
  v_cvt_pk_bf16_f32 v85, v85, v85
  v_and_b32 v85, 0xffff0000, v85
  v_mul_f32 v90, v85, v89
  v_fma_f32 v91, -v90, v88, v85
  v_fma_f32 v85, v91, v89, v90
  v_cvt_pk_bf16_f32 v86, v86, v86
  v_and_b32 v86, 0xffff0000, v86
  v_mul_f32 v90, v86, v89
  v_fma_f32 v91, -v90, v88, v86
  v_fma_f32 v86, v91, v89, v90
  v_cvt_pk_bf16_f32 v87, v87, v87
  v_and_b32 v87, 0xffff0000, v87
  v_mul_f32 v90, v87, v89
  v_fma_f32 v91, -v90, v88, v87
  v_fma_f32 v87, v91, v89, v90
  v_cvt_pk_bf16_f32 v80, v80, v81
  v_cvt_pk_bf16_f32 v81, v82, v83
  buffer_store_dwordx2 v[80:81], v9, s[32:35], 0 offen offset:0
  v_cvt_pk_bf16_f32 v84, v84, v85
  v_cvt_pk_bf16_f32 v85, v86, v87
  buffer_store_dwordx2 v[84:85], v9, s[32:35], 0 offen offset:32
  v_add_u32 v9, 32768, v9
  v_mov_b32 v80, 0
  v_mov_b32 v81, 0
  v_mov_b32 v82, 0
  v_mov_b32 v83, 0
  v_mov_b32 v84, 0
  v_mov_b32 v85, 0
  v_mov_b32 v86, 0
  v_mov_b32 v87, 0
  v_mov_b32 v88, 0
  v_mov_b32 v89, 0
  v_mov_b32 v90, 0
  v_mov_b32 v91, 0
  s_nop 1
  v_mfma_f32_16x16x32_bf16 v[80:83], v[64:67], v[28:31], v[80:83]
  v_mfma_f32_16x16x32_bf16 v[84:87], v[68:71], v[28:31], v[84:87]
  v_mfma_f32_16x16x32_bf16 v[88:91], v[72:75], v[28:31], v[88:91]
  s_nop 7
  s_nop 7
  v_cvt_pk_bf16_f32 v88, v88, v88
  v_and_b32 v88, 0xffff0000, v88
  v_add_f32 v88, 0x358637bd, v88
  v_cvt_pk_bf16_f32 v88, v88, v88
  v_and_b32 v88, 0xffff0000, v88
  v_rcp_f32 v89, v88
  s_nop 0
  v_cvt_pk_bf16_f32 v80, v80, v80
  v_and_b32 v80, 0xffff0000, v80
  v_mul_f32 v90, v80, v89
  v_fma_f32 v91, -v90, v88, v80
  v_fma_f32 v80, v91, v89, v90
  v_cvt_pk_bf16_f32 v81, v81, v81
  v_and_b32 v81, 0xffff0000, v81
  v_mul_f32 v90, v81, v89
  v_fma_f32 v91, -v90, v88, v81
  v_fma_f32 v81, v91, v89, v90
  v_cvt_pk_bf16_f32 v82, v82, v82
  v_and_b32 v82, 0xffff0000, v82
  v_mul_f32 v90, v82, v89
  v_fma_f32 v91, -v90, v88, v82
  v_fma_f32 v82, v91, v89, v90
  v_cvt_pk_bf16_f32 v83, v83, v83
  v_and_b32 v83, 0xffff0000, v83
  v_mul_f32 v90, v83, v89
  v_fma_f32 v91, -v90, v88, v83
  v_fma_f32 v83, v91, v89, v90
  v_cvt_pk_bf16_f32 v84, v84, v84
  v_and_b32 v84, 0xffff0000, v84
  v_mul_f32 v90, v84, v89
  v_fma_f32 v91, -v90, v88, v84
  v_fma_f32 v84, v91, v89, v90
  v_cvt_pk_bf16_f32 v85, v85, v85
  v_and_b32 v85, 0xffff0000, v85
  v_mul_f32 v90, v85, v89
  v_fma_f32 v91, -v90, v88, v85
  v_fma_f32 v85, v91, v89, v90
  v_cvt_pk_bf16_f32 v86, v86, v86
  v_and_b32 v86, 0xffff0000, v86
  v_mul_f32 v90, v86, v89
  v_fma_f32 v91, -v90, v88, v86
  v_fma_f32 v86, v91, v89, v90
  v_cvt_pk_bf16_f32 v87, v87, v87
  v_and_b32 v87, 0xffff0000, v87
  v_mul_f32 v90, v87, v89
  v_fma_f32 v91, -v90, v88, v87
  v_fma_f32 v87, v91, v89, v90
  v_cvt_pk_bf16_f32 v80, v80, v81
  v_cvt_pk_bf16_f32 v81, v82, v83
  buffer_store_dwordx2 v[80:81], v9, s[32:35], 0 offen offset:0
  v_cvt_pk_bf16_f32 v84, v84, v85
  v_cvt_pk_bf16_f32 v85, v86, v87
  buffer_store_dwordx2 v[84:85], v9, s[32:35], 0 offen offset:32
L_linapply0_kernel_end:
  s_endpgm
.globl gemmo0_kernel
.p2align 8
.type gemmo0_kernel,@function
gemmo0_kernel:
  s_cmp_ge_u32 s2, 256
  s_cbranch_scc1 L_gemmo0_kernel_end
  s_load_dwordx16 s[4:19], s[0:1], 0
  s_load_dwordx2 s[20:21], s[0:1], 64
  s_waitcnt lgkmcnt(0)
  s_add_u32 s24, s20, 16777216
  s_addc_u32 s25, s21, 0
  s_and_b32 s25, s25, 0xffff
  s_mov_b32 s26, 4194304
  s_mov_b32 s27, 0x00020000
  s_mov_b32 s28, s8
  s_and_b32 s29, s9, 0xffff
  s_mov_b32 s30, 2097152
  s_mov_b32 s31, 0x00020000
  s_add_u32 s32, s20, 20971520
  s_addc_u32 s33, s21, 0
  s_and_b32 s33, s33, 0xffff
  s_mov_b32 s34, 4194304
  s_mov_b32 s35, 0x00020000
  s_mov_b32 s36, s4
  s_and_b32 s37, s5, 0xffff
  s_mov_b32 s38, 4194304
  s_mov_b32 s39, 0x00020000
  s_mov_b32 s3, 268435457
  s_mul_hi_u32 s40, s2, s3
  s_mul_i32 s3, s40, 16
  s_sub_u32 s41, s2, s3
  v_and_b32 v1, 63, v0
  v_lshrrev_b32 v2, 6, v0
  s_nop 0
  v_readfirstlane_b32 s42, v2
  v_lshrrev_b32 v14, 3, v1
  v_and_b32 v15, 7, v1
  v_xor_b32 v3, v14, v15
  v_lshlrev_b32 v4, 11, v14
  v_lshl_add_u32 v4, v3, 4, v4
  v_bfe_u32 v3, v1, 4, 1
  v_and_b32 v5, 1, v2
  v_lshl_add_u32 v3, v5, 1, v3
  v_lshrrev_b32 v5, 1, v15
  v_xor_b32 v3, v3, v5
  v_lshlrev_b32 v3, 1, v3
  v_and_b32 v5, 1, v15
  v_or_b32 v3, v3, v5
  v_lshl_add_u32 v5, v2, 3, v14
  v_mul_u32_u24 v5, 2048, v5
  v_lshl_add_u32 v5, v3, 4, v5
  s_mul_i32 s44, s40, 262144
  s_lshl_b32 s3, s42, 14
  s_add_u32 s44, s44, s3
  s_add_u32 s45, s44, 131072
  s_mul_i32 s46, s41, 128
  s_lshl_b32 s43, s42, 10
  v_and_b32 v6, 1, v2
  v_lshrrev_b32 v7, 1, v2
  v_and_b32 v14, 15, v1
  v_lshrrev_b32 v15, 4, v1
  v_mul_u32_u24 v8, 32, v7
  v_add_u32 v8, v8, v14
  v_lshlrev_b32 v8, 7, v8
  v_and_b32 v3, 7, v1
  v_xor_b32 v3, v3, v15
  v_lshl_add_u32 v9, v3, 4, v8
  v_xor_b32 v3, 4, v3
  v_lshl_add_u32 v8, v3, 4, v8
  v_mov_b32 v3, v9
  v_mov_b32 v9, v8
  v_mov_b32 v8, v3
  v_bfe_u32 v3, v1, 2, 2
  v_lshl_add_u32 v10, v15, 3, v3
  v_lshlrev_b32 v10, 7, v10
  v_and_b32 v11, 3, v1
  v_lshl_add_u32 v10, v11, 3, v10
  v_lshrrev_b32 v3, 1, v3
  v_and_b32 v11, 1, v15
  v_lshl_add_u32 v3, v11, 1, v3
  v_mul_u32_u24 v11, 2, v6
  v_add_u32 v120, 0, v11
  v_and_b32 v121, 3, v120
  v_xor_b32 v121, v121, v3
  v_lshlrev_b32 v121, 5, v121
  v_lshrrev_b32 v120, 2, v120
  v_lshl_add_u32 v121, v120, 13, v121
  v_add_u32 v122, v10, v121
  v_add_u32 v122, 16384, v122
  v_add_u32 v120, 1, v11
  v_and_b32 v121, 3, v120
  v_xor_b32 v121, v121, v3
  v_lshlrev_b32 v121, 5, v121
  v_lshrrev_b32 v120, 2, v120
  v_lshl_add_u32 v121, v120, 13, v121
  v_add_u32 v123, v10, v121
  v_add_u32 v123, 16384, v123
  v_add_u32 v128, 0, v8
  v_add_u32 v129, 0, v9
  v_add_u32 v134, 0, v122
  v_add_u32 v135, 0, v123
  v_add_u32 v130, 24576, v8
  v_add_u32 v131, 24576, v9
  v_add_u32 v136, 24576, v122
  v_add_u32 v137, 24576, v123
  v_add_u32 v132, 49152, v8
  v_add_u32 v133, 49152, v9
  v_add_u32 v138, 49152, v122
  v_add_u32 v139, 49152, v123
  s_mul_i32 s3, s40, 128
  v_mul_u32_u24 v13, 32, v7
  v_add_u32 v13, v13, v14
  v_add_u32 v13, s3, v13
  v_mul_u32_u24 v13, 2048, v13
  s_mul_i32 s3, s41, 128
  v_mul_u32_u24 v3, 64, v6
  v_add_u32 v13, v13, v3
  v_lshl_add_u32 v13, v15, 3, v13
  v_add_u32 v13, s3, v13
  v_mov_b32 v72, 0
  v_mov_b32 v73, 0
  v_mov_b32 v74, 0
  v_mov_b32 v75, 0
  v_mov_b32 v76, 0
  v_mov_b32 v77, 0
  v_mov_b32 v78, 0
  v_mov_b32 v79, 0
  v_mov_b32 v80, 0
  v_mov_b32 v81, 0
  v_mov_b32 v82, 0
  v_mov_b32 v83, 0
  v_mov_b32 v84, 0
  v_mov_b32 v85, 0
  v_mov_b32 v86, 0
  v_mov_b32 v87, 0
  s_add_u32 m0, s43, 0
  s_nop 0
  buffer_load_dwordx4 v4, s[24:27], s44 offen lds
  s_add_u32 s44, s44, 128
  s_add_u32 m0, s43, 8192
  s_nop 0
  buffer_load_dwordx4 v4, s[24:27], s45 offen lds
  s_add_u32 s45, s45, 128
  s_add_u32 m0, s43, 16384
  s_nop 0
  buffer_load_dwordx4 v5, s[28:31], s46 offen lds
  s_add_u32 s46, s46, 131072
  s_add_u32 m0, s43, 24576
  s_nop 0
  buffer_load_dwordx4 v4, s[24:27], s44 offen lds
  s_add_u32 s44, s44, 128
  s_add_u32 m0, s43, 32768
  s_nop 0
  buffer_load_dwordx4 v4, s[24:27], s45 offen lds
  s_add_u32 s45, s45, 128
  s_add_u32 m0, s43, 40960
  s_nop 0
  buffer_load_dwordx4 v5, s[28:31], s46 offen lds
  s_add_u32 s46, s46, 131072
  s_waitcnt vmcnt(3)
  s_barrier
  s_add_u32 m0, s43, 49152
  s_nop 0
  buffer_load_dwordx4 v4, s[24:27], s44 offen lds
  s_add_u32 s44, s44, 128
  s_add_u32 m0, s43, 57344
  s_nop 0
  buffer_load_dwordx4 v4, s[24:27], s45 offen lds
  s_add_u32 s45, s45, 128
  s_add_u32 m0, s43, 65536
  s_nop 0
  buffer_load_dwordx4 v5, s[28:31], s46 offen lds
  s_add_u32 s46, s46, 131072
  ds_read_b128 v[16:19], v128 offset:0
  ds_read_b128 v[20:23], v128 offset:2048
  ds_read_b64_tr_b16 v[48:49], v134 offset:0
  ds_read_b64_tr_b16 v[50:51], v134 offset:512
  ds_read_b64_tr_b16 v[52:53], v135 offset:0
  ds_read_b64_tr_b16 v[54:55], v135 offset:512
  ds_read_b128 v[32:35], v129 offset:0
  ds_read_b128 v[36:39], v129 offset:2048
  ds_read_b64_tr_b16 v[60:61], v134 offset:4096
  ds_read_b64_tr_b16 v[62:63], v134 offset:4608
  ds_read_b64_tr_b16 v[64:65], v135 offset:4096
  ds_read_b64_tr_b16 v[66:67], v135 offset:4608
  s_waitcnt lgkmcnt(6)
  v_mfma_f32_16x16x32_bf16 v[72:75], v[48:51], v[16:19], v[72:75]
  v_mfma_f32_16x16x32_bf16 v[76:79], v[52:55], v[16:19], v[76:79]
  v_mfma_f32_16x16x32_bf16 v[80:83], v[48:51], v[20:23], v[80:83]
  v_mfma_f32_16x16x32_bf16 v[84:87], v[52:55], v[20:23], v[84:87]
  s_waitcnt lgkmcnt(0)
  v_mfma_f32_16x16x32_bf16 v[72:75], v[60:63], v[32:35], v[72:75]
  v_mfma_f32_16x16x32_bf16 v[76:79], v[64:67], v[32:35], v[76:79]
  v_mfma_f32_16x16x32_bf16 v[80:83], v[60:63], v[36:39], v[80:83]
  v_mfma_f32_16x16x32_bf16 v[84:87], v[64:67], v[36:39], v[84:87]
  s_waitcnt vmcnt(3)
  s_barrier
  s_add_u32 m0, s43, 0
  s_nop 0
  buffer_load_dwordx4 v4, s[24:27], s44 offen lds
  s_add_u32 s44, s44, 128
  s_add_u32 m0, s43, 8192
  s_nop 0
  buffer_load_dwordx4 v4, s[24:27], s45 offen lds
  s_add_u32 s45, s45, 128
  s_add_u32 m0, s43, 16384
  s_nop 0
  buffer_load_dwordx4 v5, s[28:31], s46 offen lds
  s_add_u32 s46, s46, 131072
  ds_read_b128 v[16:19], v130 offset:0
  ds_read_b128 v[20:23], v130 offset:2048
  ds_read_b64_tr_b16 v[48:49], v136 offset:0
  ds_read_b64_tr_b16 v[50:51], v136 offset:512
  ds_read_b64_tr_b16 v[52:53], v137 offset:0
  ds_read_b64_tr_b16 v[54:55], v137 offset:512
  ds_read_b128 v[32:35], v131 offset:0
  ds_read_b128 v[36:39], v131 offset:2048
  ds_read_b64_tr_b16 v[60:61], v136 offset:4096
  ds_read_b64_tr_b16 v[62:63], v136 offset:4608
  ds_read_b64_tr_b16 v[64:65], v137 offset:4096
  ds_read_b64_tr_b16 v[66:67], v137 offset:4608
  s_waitcnt lgkmcnt(6)
  v_mfma_f32_16x16x32_bf16 v[72:75], v[48:51], v[16:19], v[72:75]
  v_mfma_f32_16x16x32_bf16 v[76:79], v[52:55], v[16:19], v[76:79]
  v_mfma_f32_16x16x32_bf16 v[80:83], v[48:51], v[20:23], v[80:83]
  v_mfma_f32_16x16x32_bf16 v[84:87], v[52:55], v[20:23], v[84:87]
  s_waitcnt lgkmcnt(0)
  v_mfma_f32_16x16x32_bf16 v[72:75], v[60:63], v[32:35], v[72:75]
  v_mfma_f32_16x16x32_bf16 v[76:79], v[64:67], v[32:35], v[76:79]
  v_mfma_f32_16x16x32_bf16 v[80:83], v[60:63], v[36:39], v[80:83]
  v_mfma_f32_16x16x32_bf16 v[84:87], v[64:67], v[36:39], v[84:87]
  s_waitcnt vmcnt(3)
  s_barrier
  s_add_u32 m0, s43, 24576
  s_nop 0
  buffer_load_dwordx4 v4, s[24:27], s44 offen lds
  s_add_u32 s44, s44, 128
  s_add_u32 m0, s43, 32768
  s_nop 0
  buffer_load_dwordx4 v4, s[24:27], s45 offen lds
  s_add_u32 s45, s45, 128
  s_add_u32 m0, s43, 40960
  s_nop 0
  buffer_load_dwordx4 v5, s[28:31], s46 offen lds
  s_add_u32 s46, s46, 131072
  ds_read_b128 v[16:19], v132 offset:0
  ds_read_b128 v[20:23], v132 offset:2048
  ds_read_b64_tr_b16 v[48:49], v138 offset:0
  ds_read_b64_tr_b16 v[50:51], v138 offset:512
  ds_read_b64_tr_b16 v[52:53], v139 offset:0
  ds_read_b64_tr_b16 v[54:55], v139 offset:512
  ds_read_b128 v[32:35], v133 offset:0
  ds_read_b128 v[36:39], v133 offset:2048
  ds_read_b64_tr_b16 v[60:61], v138 offset:4096
  ds_read_b64_tr_b16 v[62:63], v138 offset:4608
  ds_read_b64_tr_b16 v[64:65], v139 offset:4096
  ds_read_b64_tr_b16 v[66:67], v139 offset:4608
  s_waitcnt lgkmcnt(6)
  v_mfma_f32_16x16x32_bf16 v[72:75], v[48:51], v[16:19], v[72:75]
  v_mfma_f32_16x16x32_bf16 v[76:79], v[52:55], v[16:19], v[76:79]
  v_mfma_f32_16x16x32_bf16 v[80:83], v[48:51], v[20:23], v[80:83]
  v_mfma_f32_16x16x32_bf16 v[84:87], v[52:55], v[20:23], v[84:87]
  s_waitcnt lgkmcnt(0)
  v_mfma_f32_16x16x32_bf16 v[72:75], v[60:63], v[32:35], v[72:75]
  v_mfma_f32_16x16x32_bf16 v[76:79], v[64:67], v[32:35], v[76:79]
  v_mfma_f32_16x16x32_bf16 v[80:83], v[60:63], v[36:39], v[80:83]
  v_mfma_f32_16x16x32_bf16 v[84:87], v[64:67], v[36:39], v[84:87]
  s_waitcnt vmcnt(3)
  s_barrier
  s_add_u32 m0, s43, 49152
  s_nop 0
  buffer_load_dwordx4 v4, s[24:27], s44 offen lds
  s_add_u32 s44, s44, 128
  s_add_u32 m0, s43, 57344
  s_nop 0
  buffer_load_dwordx4 v4, s[24:27], s45 offen lds
  s_add_u32 s45, s45, 128
  s_add_u32 m0, s43, 65536
  s_nop 0
  buffer_load_dwordx4 v5, s[28:31], s46 offen lds
  s_add_u32 s46, s46, 131072
  ds_read_b128 v[16:19], v128 offset:0
  ds_read_b128 v[20:23], v128 offset:2048
  ds_read_b64_tr_b16 v[48:49], v134 offset:0
  ds_read_b64_tr_b16 v[50:51], v134 offset:512
  ds_read_b64_tr_b16 v[52:53], v135 offset:0
  ds_read_b64_tr_b16 v[54:55], v135 offset:512
  ds_read_b128 v[32:35], v129 offset:0
  ds_read_b128 v[36:39], v129 offset:2048
  ds_read_b64_tr_b16 v[60:61], v134 offset:4096
  ds_read_b64_tr_b16 v[62:63], v134 offset:4608
  ds_read_b64_tr_b16 v[64:65], v135 offset:4096
  ds_read_b64_tr_b16 v[66:67], v135 offset:4608
  s_waitcnt lgkmcnt(6)
  v_mfma_f32_16x16x32_bf16 v[72:75], v[48:51], v[16:19], v[72:75]
  v_mfma_f32_16x16x32_bf16 v[76:79], v[52:55], v[16:19], v[76:79]
  v_mfma_f32_16x16x32_bf16 v[80:83], v[48:51], v[20:23], v[80:83]
  v_mfma_f32_16x16x32_bf16 v[84:87], v[52:55], v[20:23], v[84:87]
  s_waitcnt lgkmcnt(0)
  v_mfma_f32_16x16x32_bf16 v[72:75], v[60:63], v[32:35], v[72:75]
  v_mfma_f32_16x16x32_bf16 v[76:79], v[64:67], v[32:35], v[76:79]
  v_mfma_f32_16x16x32_bf16 v[80:83], v[60:63], v[36:39], v[80:83]
  v_mfma_f32_16x16x32_bf16 v[84:87], v[64:67], v[36:39], v[84:87]
  s_waitcnt vmcnt(3)
  s_barrier
  s_add_u32 m0, s43, 0
  s_nop 0
  buffer_load_dwordx4 v4, s[24:27], s44 offen lds
  s_add_u32 s44, s44, 128
  s_add_u32 m0, s43, 8192
  s_nop 0
  buffer_load_dwordx4 v4, s[24:27], s45 offen lds
  s_add_u32 s45, s45, 128
  s_add_u32 m0, s43, 16384
  s_nop 0
  buffer_load_dwordx4 v5, s[28:31], s46 offen lds
  s_add_u32 s46, s46, 131072
  ds_read_b128 v[16:19], v130 offset:0
  ds_read_b128 v[20:23], v130 offset:2048
  ds_read_b64_tr_b16 v[48:49], v136 offset:0
  ds_read_b64_tr_b16 v[50:51], v136 offset:512
  ds_read_b64_tr_b16 v[52:53], v137 offset:0
  ds_read_b64_tr_b16 v[54:55], v137 offset:512
  ds_read_b128 v[32:35], v131 offset:0
  ds_read_b128 v[36:39], v131 offset:2048
  ds_read_b64_tr_b16 v[60:61], v136 offset:4096
  ds_read_b64_tr_b16 v[62:63], v136 offset:4608
  ds_read_b64_tr_b16 v[64:65], v137 offset:4096
  ds_read_b64_tr_b16 v[66:67], v137 offset:4608
  s_waitcnt lgkmcnt(6)
  v_mfma_f32_16x16x32_bf16 v[72:75], v[48:51], v[16:19], v[72:75]
  v_mfma_f32_16x16x32_bf16 v[76:79], v[52:55], v[16:19], v[76:79]
  v_mfma_f32_16x16x32_bf16 v[80:83], v[48:51], v[20:23], v[80:83]
  v_mfma_f32_16x16x32_bf16 v[84:87], v[52:55], v[20:23], v[84:87]
  s_waitcnt lgkmcnt(0)
  v_mfma_f32_16x16x32_bf16 v[72:75], v[60:63], v[32:35], v[72:75]
  v_mfma_f32_16x16x32_bf16 v[76:79], v[64:67], v[32:35], v[76:79]
  v_mfma_f32_16x16x32_bf16 v[80:83], v[60:63], v[36:39], v[80:83]
  v_mfma_f32_16x16x32_bf16 v[84:87], v[64:67], v[36:39], v[84:87]
  s_waitcnt vmcnt(3)
  s_barrier
  s_add_u32 m0, s43, 24576
  s_nop 0
  buffer_load_dwordx4 v4, s[24:27], s44 offen lds
  s_add_u32 s44, s44, 128
  s_add_u32 m0, s43, 32768
  s_nop 0
  buffer_load_dwordx4 v4, s[24:27], s45 offen lds
  s_add_u32 s45, s45, 128
  s_add_u32 m0, s43, 40960
  s_nop 0
  buffer_load_dwordx4 v5, s[28:31], s46 offen lds
  s_add_u32 s46, s46, 131072
  ds_read_b128 v[16:19], v132 offset:0
  ds_read_b128 v[20:23], v132 offset:2048
  ds_read_b64_tr_b16 v[48:49], v138 offset:0
  ds_read_b64_tr_b16 v[50:51], v138 offset:512
  ds_read_b64_tr_b16 v[52:53], v139 offset:0
  ds_read_b64_tr_b16 v[54:55], v139 offset:512
  ds_read_b128 v[32:35], v133 offset:0
  ds_read_b128 v[36:39], v133 offset:2048
  ds_read_b64_tr_b16 v[60:61], v138 offset:4096
  ds_read_b64_tr_b16 v[62:63], v138 offset:4608
  ds_read_b64_tr_b16 v[64:65], v139 offset:4096
  ds_read_b64_tr_b16 v[66:67], v139 offset:4608
  s_waitcnt lgkmcnt(6)
  v_mfma_f32_16x16x32_bf16 v[72:75], v[48:51], v[16:19], v[72:75]
  v_mfma_f32_16x16x32_bf16 v[76:79], v[52:55], v[16:19], v[76:79]
  v_mfma_f32_16x16x32_bf16 v[80:83], v[48:51], v[20:23], v[80:83]
  v_mfma_f32_16x16x32_bf16 v[84:87], v[52:55], v[20:23], v[84:87]
  s_waitcnt lgkmcnt(0)
  v_mfma_f32_16x16x32_bf16 v[72:75], v[60:63], v[32:35], v[72:75]
  v_mfma_f32_16x16x32_bf16 v[76:79], v[64:67], v[32:35], v[76:79]
  v_mfma_f32_16x16x32_bf16 v[80:83], v[60:63], v[36:39], v[80:83]
  v_mfma_f32_16x16x32_bf16 v[84:87], v[64:67], v[36:39], v[84:87]
  s_waitcnt vmcnt(3)
  s_barrier
  s_add_u32 m0, s43, 49152
  s_nop 0
  buffer_load_dwordx4 v4, s[24:27], s44 offen lds
  s_add_u32 s44, s44, 128
  s_add_u32 m0, s43, 57344
  s_nop 0
  buffer_load_dwordx4 v4, s[24:27], s45 offen lds
  s_add_u32 s45, s45, 128
  s_add_u32 m0, s43, 65536
  s_nop 0
  buffer_load_dwordx4 v5, s[28:31], s46 offen lds
  s_add_u32 s46, s46, 131072
  ds_read_b128 v[16:19], v128 offset:0
  ds_read_b128 v[20:23], v128 offset:2048
  ds_read_b64_tr_b16 v[48:49], v134 offset:0
  ds_read_b64_tr_b16 v[50:51], v134 offset:512
  ds_read_b64_tr_b16 v[52:53], v135 offset:0
  ds_read_b64_tr_b16 v[54:55], v135 offset:512
  ds_read_b128 v[32:35], v129 offset:0
  ds_read_b128 v[36:39], v129 offset:2048
  ds_read_b64_tr_b16 v[60:61], v134 offset:4096
  ds_read_b64_tr_b16 v[62:63], v134 offset:4608
  ds_read_b64_tr_b16 v[64:65], v135 offset:4096
  ds_read_b64_tr_b16 v[66:67], v135 offset:4608
  s_waitcnt lgkmcnt(6)
  v_mfma_f32_16x16x32_bf16 v[72:75], v[48:51], v[16:19], v[72:75]
  v_mfma_f32_16x16x32_bf16 v[76:79], v[52:55], v[16:19], v[76:79]
  v_mfma_f32_16x16x32_bf16 v[80:83], v[48:51], v[20:23], v[80:83]
  v_mfma_f32_16x16x32_bf16 v[84:87], v[52:55], v[20:23], v[84:87]
  s_waitcnt lgkmcnt(0)
  v_mfma_f32_16x16x32_bf16 v[72:75], v[60:63], v[32:35], v[72:75]
  v_mfma_f32_16x16x32_bf16 v[76:79], v[64:67], v[32:35], v[76:79]
  v_mfma_f32_16x16x32_bf16 v[80:83], v[60:63], v[36:39], v[80:83]
  v_mfma_f32_16x16x32_bf16 v[84:87], v[64:67], v[36:39], v[84:87]
  s_waitcnt vmcnt(3)
  s_barrier
  s_add_u32 m0, s43, 0
  s_nop 0
  buffer_load_dwordx4 v4, s[24:27], s44 offen lds
  s_add_u32 s44, s44, 128
  s_add_u32 m0, s43, 8192
  s_nop 0
  buffer_load_dwordx4 v4, s[24:27], s45 offen lds
  s_add_u32 s45, s45, 128
  s_add_u32 m0, s43, 16384
  s_nop 0
  buffer_load_dwordx4 v5, s[28:31], s46 offen lds
  s_add_u32 s46, s46, 131072
  ds_read_b128 v[16:19], v130 offset:0
  ds_read_b128 v[20:23], v130 offset:2048
  ds_read_b64_tr_b16 v[48:49], v136 offset:0
  ds_read_b64_tr_b16 v[50:51], v136 offset:512
  ds_read_b64_tr_b16 v[52:53], v137 offset:0
  ds_read_b64_tr_b16 v[54:55], v137 offset:512
  ds_read_b128 v[32:35], v131 offset:0
  ds_read_b128 v[36:39], v131 offset:2048
  ds_read_b64_tr_b16 v[60:61], v136 offset:4096
  ds_read_b64_tr_b16 v[62:63], v136 offset:4608
  ds_read_b64_tr_b16 v[64:65], v137 offset:4096
  ds_read_b64_tr_b16 v[66:67], v137 offset:4608
  s_waitcnt lgkmcnt(6)
  v_mfma_f32_16x16x32_bf16 v[72:75], v[48:51], v[16:19], v[72:75]
  v_mfma_f32_16x16x32_bf16 v[76:79], v[52:55], v[16:19], v[76:79]
  v_mfma_f32_16x16x32_bf16 v[80:83], v[48:51], v[20:23], v[80:83]
  v_mfma_f32_16x16x32_bf16 v[84:87], v[52:55], v[20:23], v[84:87]
  s_waitcnt lgkmcnt(0)
  v_mfma_f32_16x16x32_bf16 v[72:75], v[60:63], v[32:35], v[72:75]
  v_mfma_f32_16x16x32_bf16 v[76:79], v[64:67], v[32:35], v[76:79]
  v_mfma_f32_16x16x32_bf16 v[80:83], v[60:63], v[36:39], v[80:83]
  v_mfma_f32_16x16x32_bf16 v[84:87], v[64:67], v[36:39], v[84:87]
  s_waitcnt vmcnt(3)
  s_barrier
  s_add_u32 m0, s43, 24576
  s_nop 0
  buffer_load_dwordx4 v4, s[24:27], s44 offen lds
  s_add_u32 s44, s44, 128
  s_add_u32 m0, s43, 32768
  s_nop 0
  buffer_load_dwordx4 v4, s[24:27], s45 offen lds
  s_add_u32 s45, s45, 128
  s_add_u32 m0, s43, 40960
  s_nop 0
  buffer_load_dwordx4 v5, s[28:31], s46 offen lds
  s_add_u32 s46, s46, 131072
  ds_read_b128 v[16:19], v132 offset:0
  ds_read_b128 v[20:23], v132 offset:2048
  ds_read_b64_tr_b16 v[48:49], v138 offset:0
  ds_read_b64_tr_b16 v[50:51], v138 offset:512
  ds_read_b64_tr_b16 v[52:53], v139 offset:0
  ds_read_b64_tr_b16 v[54:55], v139 offset:512
  ds_read_b128 v[32:35], v133 offset:0
  ds_read_b128 v[36:39], v133 offset:2048
  ds_read_b64_tr_b16 v[60:61], v138 offset:4096
  ds_read_b64_tr_b16 v[62:63], v138 offset:4608
  ds_read_b64_tr_b16 v[64:65], v139 offset:4096
  ds_read_b64_tr_b16 v[66:67], v139 offset:4608
  s_waitcnt lgkmcnt(6)
  v_mfma_f32_16x16x32_bf16 v[72:75], v[48:51], v[16:19], v[72:75]
  v_mfma_f32_16x16x32_bf16 v[76:79], v[52:55], v[16:19], v[76:79]
  v_mfma_f32_16x16x32_bf16 v[80:83], v[48:51], v[20:23], v[80:83]
  v_mfma_f32_16x16x32_bf16 v[84:87], v[52:55], v[20:23], v[84:87]
  s_waitcnt lgkmcnt(0)
  v_mfma_f32_16x16x32_bf16 v[72:75], v[60:63], v[32:35], v[72:75]
  v_mfma_f32_16x16x32_bf16 v[76:79], v[64:67], v[32:35], v[76:79]
  v_mfma_f32_16x16x32_bf16 v[80:83], v[60:63], v[36:39], v[80:83]
  v_mfma_f32_16x16x32_bf16 v[84:87], v[64:67], v[36:39], v[84:87]
  s_waitcnt vmcnt(3)
  s_barrier
  s_add_u32 m0, s43, 49152
  s_nop 0
  buffer_load_dwordx4 v4, s[24:27], s44 offen lds
  s_add_u32 s44, s44, 128
  s_add_u32 m0, s43, 57344
  s_nop 0
  buffer_load_dwordx4 v4, s[24:27], s45 offen lds
  s_add_u32 s45, s45, 128
  s_add_u32 m0, s43, 65536
  s_nop 0
  buffer_load_dwordx4 v5, s[28:31], s46 offen lds
  s_add_u32 s46, s46, 131072
  ds_read_b128 v[16:19], v128 offset:0
  ds_read_b128 v[20:23], v128 offset:2048
  ds_read_b64_tr_b16 v[48:49], v134 offset:0
  ds_read_b64_tr_b16 v[50:51], v134 offset:512
  ds_read_b64_tr_b16 v[52:53], v135 offset:0
  ds_read_b64_tr_b16 v[54:55], v135 offset:512
  ds_read_b128 v[32:35], v129 offset:0
  ds_read_b128 v[36:39], v129 offset:2048
  ds_read_b64_tr_b16 v[60:61], v134 offset:4096
  ds_read_b64_tr_b16 v[62:63], v134 offset:4608
  ds_read_b64_tr_b16 v[64:65], v135 offset:4096
  ds_read_b64_tr_b16 v[66:67], v135 offset:4608
  s_waitcnt lgkmcnt(6)
  v_mfma_f32_16x16x32_bf16 v[72:75], v[48:51], v[16:19], v[72:75]
  v_mfma_f32_16x16x32_bf16 v[76:79], v[52:55], v[16:19], v[76:79]
  v_mfma_f32_16x16x32_bf16 v[80:83], v[48:51], v[20:23], v[80:83]
  v_mfma_f32_16x16x32_bf16 v[84:87], v[52:55], v[20:23], v[84:87]
  s_waitcnt lgkmcnt(0)
  v_mfma_f32_16x16x32_bf16 v[72:75], v[60:63], v[32:35], v[72:75]
  v_mfma_f32_16x16x32_bf16 v[76:79], v[64:67], v[32:35], v[76:79]
  v_mfma_f32_16x16x32_bf16 v[80:83], v[60:63], v[36:39], v[80:83]
  v_mfma_f32_16x16x32_bf16 v[84:87], v[64:67], v[36:39], v[84:87]
  s_waitcnt vmcnt(3)
  s_barrier
  s_add_u32 m0, s43, 0
  s_nop 0
  buffer_load_dwordx4 v4, s[24:27], s44 offen lds
  s_add_u32 s44, s44, 128
  s_add_u32 m0, s43, 8192
  s_nop 0
  buffer_load_dwordx4 v4, s[24:27], s45 offen lds
  s_add_u32 s45, s45, 128
  s_add_u32 m0, s43, 16384
  s_nop 0
  buffer_load_dwordx4 v5, s[28:31], s46 offen lds
  s_add_u32 s46, s46, 131072
  ds_read_b128 v[16:19], v130 offset:0
  ds_read_b128 v[20:23], v130 offset:2048
  ds_read_b64_tr_b16 v[48:49], v136 offset:0
  ds_read_b64_tr_b16 v[50:51], v136 offset:512
  ds_read_b64_tr_b16 v[52:53], v137 offset:0
  ds_read_b64_tr_b16 v[54:55], v137 offset:512
  ds_read_b128 v[32:35], v131 offset:0
  ds_read_b128 v[36:39], v131 offset:2048
  ds_read_b64_tr_b16 v[60:61], v136 offset:4096
  ds_read_b64_tr_b16 v[62:63], v136 offset:4608
  ds_read_b64_tr_b16 v[64:65], v137 offset:4096
  ds_read_b64_tr_b16 v[66:67], v137 offset:4608
  s_waitcnt lgkmcnt(6)
  v_mfma_f32_16x16x32_bf16 v[72:75], v[48:51], v[16:19], v[72:75]
  v_mfma_f32_16x16x32_bf16 v[76:79], v[52:55], v[16:19], v[76:79]
  v_mfma_f32_16x16x32_bf16 v[80:83], v[48:51], v[20:23], v[80:83]
  v_mfma_f32_16x16x32_bf16 v[84:87], v[52:55], v[20:23], v[84:87]
  s_waitcnt lgkmcnt(0)
  v_mfma_f32_16x16x32_bf16 v[72:75], v[60:63], v[32:35], v[72:75]
  v_mfma_f32_16x16x32_bf16 v[76:79], v[64:67], v[32:35], v[76:79]
  v_mfma_f32_16x16x32_bf16 v[80:83], v[60:63], v[36:39], v[80:83]
  v_mfma_f32_16x16x32_bf16 v[84:87], v[64:67], v[36:39], v[84:87]
  s_waitcnt vmcnt(3)
  s_barrier
  s_add_u32 m0, s43, 24576
  s_nop 0
  buffer_load_dwordx4 v4, s[24:27], s44 offen lds
  s_add_u32 s44, s44, 128
  s_add_u32 m0, s43, 32768
  s_nop 0
  buffer_load_dwordx4 v4, s[24:27], s45 offen lds
  s_add_u32 s45, s45, 128
  s_add_u32 m0, s43, 40960
  s_nop 0
  buffer_load_dwordx4 v5, s[28:31], s46 offen lds
  s_add_u32 s46, s46, 131072
  ds_read_b128 v[16:19], v132 offset:0
  ds_read_b128 v[20:23], v132 offset:2048
  ds_read_b64_tr_b16 v[48:49], v138 offset:0
  ds_read_b64_tr_b16 v[50:51], v138 offset:512
  ds_read_b64_tr_b16 v[52:53], v139 offset:0
  ds_read_b64_tr_b16 v[54:55], v139 offset:512
  ds_read_b128 v[32:35], v133 offset:0
  ds_read_b128 v[36:39], v133 offset:2048
  ds_read_b64_tr_b16 v[60:61], v138 offset:4096
  ds_read_b64_tr_b16 v[62:63], v138 offset:4608
  ds_read_b64_tr_b16 v[64:65], v139 offset:4096
  ds_read_b64_tr_b16 v[66:67], v139 offset:4608
  s_waitcnt lgkmcnt(6)
  v_mfma_f32_16x16x32_bf16 v[72:75], v[48:51], v[16:19], v[72:75]
  v_mfma_f32_16x16x32_bf16 v[76:79], v[52:55], v[16:19], v[76:79]
  v_mfma_f32_16x16x32_bf16 v[80:83], v[48:51], v[20:23], v[80:83]
  v_mfma_f32_16x16x32_bf16 v[84:87], v[52:55], v[20:23], v[84:87]
  s_waitcnt lgkmcnt(0)
  v_mfma_f32_16x16x32_bf16 v[72:75], v[60:63], v[32:35], v[72:75]
  v_mfma_f32_16x16x32_bf16 v[76:79], v[64:67], v[32:35], v[76:79]
  v_mfma_f32_16x16x32_bf16 v[80:83], v[60:63], v[36:39], v[80:83]
  v_mfma_f32_16x16x32_bf16 v[84:87], v[64:67], v[36:39], v[84:87]
  s_waitcnt vmcnt(3)
  s_barrier
  s_add_u32 m0, s43, 49152
  s_nop 0
  buffer_load_dwordx4 v4, s[24:27], s44 offen lds
  s_add_u32 s44, s44, 128
  s_add_u32 m0, s43, 57344
  s_nop 0
  buffer_load_dwordx4 v4, s[24:27], s45 offen lds
  s_add_u32 s45, s45, 128
  s_add_u32 m0, s43, 65536
  s_nop 0
  buffer_load_dwordx4 v5, s[28:31], s46 offen lds
  s_add_u32 s46, s46, 131072
  ds_read_b128 v[16:19], v128 offset:0
  ds_read_b128 v[20:23], v128 offset:2048
  ds_read_b64_tr_b16 v[48:49], v134 offset:0
  ds_read_b64_tr_b16 v[50:51], v134 offset:512
  ds_read_b64_tr_b16 v[52:53], v135 offset:0
  ds_read_b64_tr_b16 v[54:55], v135 offset:512
  ds_read_b128 v[32:35], v129 offset:0
  ds_read_b128 v[36:39], v129 offset:2048
  ds_read_b64_tr_b16 v[60:61], v134 offset:4096
  ds_read_b64_tr_b16 v[62:63], v134 offset:4608
  ds_read_b64_tr_b16 v[64:65], v135 offset:4096
  ds_read_b64_tr_b16 v[66:67], v135 offset:4608
  s_waitcnt lgkmcnt(6)
  v_mfma_f32_16x16x32_bf16 v[72:75], v[48:51], v[16:19], v[72:75]
  v_mfma_f32_16x16x32_bf16 v[76:79], v[52:55], v[16:19], v[76:79]
  v_mfma_f32_16x16x32_bf16 v[80:83], v[48:51], v[20:23], v[80:83]
  v_mfma_f32_16x16x32_bf16 v[84:87], v[52:55], v[20:23], v[84:87]
  s_waitcnt lgkmcnt(0)
  v_mfma_f32_16x16x32_bf16 v[72:75], v[60:63], v[32:35], v[72:75]
  v_mfma_f32_16x16x32_bf16 v[76:79], v[64:67], v[32:35], v[76:79]
  v_mfma_f32_16x16x32_bf16 v[80:83], v[60:63], v[36:39], v[80:83]
  v_mfma_f32_16x16x32_bf16 v[84:87], v[64:67], v[36:39], v[84:87]
  s_waitcnt vmcnt(3)
  s_barrier
  s_add_u32 m0, s43, 0
  s_nop 0
  buffer_load_dwordx4 v4, s[24:27], s44 offen lds
  s_add_u32 s44, s44, 128
  s_add_u32 m0, s43, 8192
  s_nop 0
  buffer_load_dwordx4 v4, s[24:27], s45 offen lds
  s_add_u32 s45, s45, 128
  s_add_u32 m0, s43, 16384
  s_nop 0
  buffer_load_dwordx4 v5, s[28:31], s46 offen lds
  s_add_u32 s46, s46, 131072
  ds_read_b128 v[16:19], v130 offset:0
  ds_read_b128 v[20:23], v130 offset:2048
  ds_read_b64_tr_b16 v[48:49], v136 offset:0
  ds_read_b64_tr_b16 v[50:51], v136 offset:512
  ds_read_b64_tr_b16 v[52:53], v137 offset:0
  ds_read_b64_tr_b16 v[54:55], v137 offset:512
  ds_read_b128 v[32:35], v131 offset:0
  ds_read_b128 v[36:39], v131 offset:2048
  ds_read_b64_tr_b16 v[60:61], v136 offset:4096
  ds_read_b64_tr_b16 v[62:63], v136 offset:4608
  ds_read_b64_tr_b16 v[64:65], v137 offset:4096
  ds_read_b64_tr_b16 v[66:67], v137 offset:4608
  s_waitcnt lgkmcnt(6)
  v_mfma_f32_16x16x32_bf16 v[72:75], v[48:51], v[16:19], v[72:75]
  v_mfma_f32_16x16x32_bf16 v[76:79], v[52:55], v[16:19], v[76:79]
  v_mfma_f32_16x16x32_bf16 v[80:83], v[48:51], v[20:23], v[80:83]
  v_mfma_f32_16x16x32_bf16 v[84:87], v[52:55], v[20:23], v[84:87]
  s_waitcnt lgkmcnt(0)
  v_mfma_f32_16x16x32_bf16 v[72:75], v[60:63], v[32:35], v[72:75]
  v_mfma_f32_16x16x32_bf16 v[76:79], v[64:67], v[32:35], v[76:79]
  v_mfma_f32_16x16x32_bf16 v[80:83], v[60:63], v[36:39], v[80:83]
  v_mfma_f32_16x16x32_bf16 v[84:87], v[64:67], v[36:39], v[84:87]
  s_waitcnt vmcnt(3)
  s_barrier
  ds_read_b128 v[16:19], v132 offset:0
  ds_read_b128 v[20:23], v132 offset:2048
  ds_read_b64_tr_b16 v[48:49], v138 offset:0
  ds_read_b64_tr_b16 v[50:51], v138 offset:512
  ds_read_b64_tr_b16 v[52:53], v139 offset:0
  ds_read_b64_tr_b16 v[54:55], v139 offset:512
  ds_read_b128 v[32:35], v133 offset:0
  ds_read_b128 v[36:39], v133 offset:2048
  ds_read_b64_tr_b16 v[60:61], v138 offset:4096
  ds_read_b64_tr_b16 v[62:63], v138 offset:4608
  ds_read_b64_tr_b16 v[64:65], v139 offset:4096
  ds_read_b64_tr_b16 v[66:67], v139 offset:4608
  s_waitcnt lgkmcnt(6)
  v_mfma_f32_16x16x32_bf16 v[72:75], v[48:51], v[16:19], v[72:75]
  v_mfma_f32_16x16x32_bf16 v[76:79], v[52:55], v[16:19], v[76:79]
  v_mfma_f32_16x16x32_bf16 v[80:83], v[48:51], v[20:23], v[80:83]
  v_mfma_f32_16x16x32_bf16 v[84:87], v[52:55], v[20:23], v[84:87]
  s_waitcnt lgkmcnt(0)
  v_mfma_f32_16x16x32_bf16 v[72:75], v[60:63], v[32:35], v[72:75]
  v_mfma_f32_16x16x32_bf16 v[76:79], v[64:67], v[32:35], v[76:79]
  v_mfma_f32_16x16x32_bf16 v[80:83], v[60:63], v[36:39], v[80:83]
  v_mfma_f32_16x16x32_bf16 v[84:87], v[64:67], v[36:39], v[84:87]
  s_waitcnt vmcnt(0)
  s_barrier
  ds_read_b128 v[16:19], v128 offset:0
  ds_read_b128 v[20:23], v128 offset:2048
  ds_read_b64_tr_b16 v[48:49], v134 offset:0
  ds_read_b64_tr_b16 v[50:51], v134 offset:512
  ds_read_b64_tr_b16 v[52:53], v135 offset:0
  ds_read_b64_tr_b16 v[54:55], v135 offset:512
  ds_read_b128 v[32:35], v129 offset:0
  ds_read_b128 v[36:39], v129 offset:2048
  ds_read_b64_tr_b16 v[60:61], v134 offset:4096
  ds_read_b64_tr_b16 v[62:63], v134 offset:4608
  ds_read_b64_tr_b16 v[64:65], v135 offset:4096
  ds_read_b64_tr_b16 v[66:67], v135 offset:4608
  s_waitcnt lgkmcnt(6)
  v_mfma_f32_16x16x32_bf16 v[72:75], v[48:51], v[16:19], v[72:75]
  v_mfma_f32_16x16x32_bf16 v[76:79], v[52:55], v[16:19], v[76:79]
  v_mfma_f32_16x16x32_bf16 v[80:83], v[48:51], v[20:23], v[80:83]
  v_mfma_f32_16x16x32_bf16 v[84:87], v[52:55], v[20:23], v[84:87]
  s_waitcnt lgkmcnt(0)
  v_mfma_f32_16x16x32_bf16 v[72:75], v[60:63], v[32:35], v[72:75]
  v_mfma_f32_16x16x32_bf16 v[76:79], v[64:67], v[32:35], v[76:79]
  v_mfma_f32_16x16x32_bf16 v[80:83], v[60:63], v[36:39], v[80:83]
  v_mfma_f32_16x16x32_bf16 v[84:87], v[64:67], v[36:39], v[84:87]
  s_nop 7
  s_nop 7
  buffer_load_dwordx2 v[16:17], v13, s[36:39], 0 offen offset:0
  buffer_load_dwordx2 v[18:19], v13, s[36:39], 0 offen offset:32
  s_waitcnt vmcnt(0)
  v_cvt_pk_bf16_f32 v72, v72, v73
  v_cvt_pk_bf16_f32 v73, v74, v75
  v_lshlrev_b32 v32, 16, v72
  v_and_b32 v33, 0xffff0000, v72
  v_lshlrev_b32 v34, 16, v16
  v_and_b32 v35, 0xffff0000, v16
  v_add_f32 v32, v32, v34
  v_add_f32 v33, v33, v35
  v_cvt_pk_bf16_f32 v72, v32, v33
  v_lshlrev_b32 v32, 16, v73
  v_and_b32 v33, 0xffff0000, v73
  v_lshlrev_b32 v34, 16, v17
  v_and_b32 v35, 0xffff0000, v17
  v_add_f32 v32, v32, v34
  v_add_f32 v33, v33, v35
  v_cvt_pk_bf16_f32 v73, v32, v33
  buffer_store_dwordx2 v[72:73], v13, s[32:35], 0 offen offset:0
  v_cvt_pk_bf16_f32 v76, v76, v77
  v_cvt_pk_bf16_f32 v77, v78, v79
  v_lshlrev_b32 v32, 16, v76
  v_and_b32 v33, 0xffff0000, v76
  v_lshlrev_b32 v34, 16, v18
  v_and_b32 v35, 0xffff0000, v18
  v_add_f32 v32, v32, v34
  v_add_f32 v33, v33, v35
  v_cvt_pk_bf16_f32 v76, v32, v33
  v_lshlrev_b32 v32, 16, v77
  v_and_b32 v33, 0xffff0000, v77
  v_lshlrev_b32 v34, 16, v19
  v_and_b32 v35, 0xffff0000, v19
  v_add_f32 v32, v32, v34
  v_add_f32 v33, v33, v35
  v_cvt_pk_bf16_f32 v77, v32, v33
  buffer_store_dwordx2 v[76:77], v13, s[32:35], 0 offen offset:32
  v_add_u32 v13, 32768, v13
  buffer_load_dwordx2 v[16:17], v13, s[36:39], 0 offen offset:0
  buffer_load_dwordx2 v[18:19], v13, s[36:39], 0 offen offset:32
  s_waitcnt vmcnt(0)
  v_cvt_pk_bf16_f32 v80, v80, v81
  v_cvt_pk_bf16_f32 v81, v82, v83
  v_lshlrev_b32 v32, 16, v80
  v_and_b32 v33, 0xffff0000, v80
  v_lshlrev_b32 v34, 16, v16
  v_and_b32 v35, 0xffff0000, v16
  v_add_f32 v32, v32, v34
  v_add_f32 v33, v33, v35
  v_cvt_pk_bf16_f32 v80, v32, v33
  v_lshlrev_b32 v32, 16, v81
  v_and_b32 v33, 0xffff0000, v81
  v_lshlrev_b32 v34, 16, v17
  v_and_b32 v35, 0xffff0000, v17
  v_add_f32 v32, v32, v34
  v_add_f32 v33, v33, v35
  v_cvt_pk_bf16_f32 v81, v32, v33
  buffer_store_dwordx2 v[80:81], v13, s[32:35], 0 offen offset:0
  v_cvt_pk_bf16_f32 v84, v84, v85
  v_cvt_pk_bf16_f32 v85, v86, v87
  v_lshlrev_b32 v32, 16, v84
  v_and_b32 v33, 0xffff0000, v84
  v_lshlrev_b32 v34, 16, v18
  v_and_b32 v35, 0xffff0000, v18
  v_add_f32 v32, v32, v34
  v_add_f32 v33, v33, v35
  v_cvt_pk_bf16_f32 v84, v32, v33
  v_lshlrev_b32 v32, 16, v85
  v_and_b32 v33, 0xffff0000, v85
  v_lshlrev_b32 v34, 16, v19
  v_and_b32 v35, 0xffff0000, v19
  v_add_f32 v32, v32, v34
  v_add_f32 v33, v33, v35
  v_cvt_pk_bf16_f32 v85, v32, v33
  buffer_store_dwordx2 v[84:85], v13, s[32:35], 0 offen offset:32
L_gemmo0_kernel_end:
  s_endpgm
.globl ln1_kernel
.p2align 8
.type ln1_kernel,@function
ln1_kernel:
  s_cmp_ge_u32 s2, 512
  s_cbranch_scc1 L_ln1_kernel_end
  s_load_dwordx16 s[4:19], s[0:1], 0
  s_load_dwordx2 s[20:21], s[0:1], 64
  s_waitcnt lgkmcnt(0)
  s_add_u32 s24, s20, 20971520
  s_addc_u32 s25, s21, 0
  s_and_b32 s25, s25, 0xffff
  s_mov_b32 s26, 4194304
  s_mov_b32 s27, 0x00020000
  s_mov_b32 s28, s20
  s_and_b32 s29, s21, 0xffff
  s_mov_b32 s30, 4194304
  s_mov_b32 s31, 0x00020000
  v_lshrrev_b32 v1, 6, v0
  v_and_b32 v2, 63, v0
  s_lshl_b32 s3, s2, 2
  v_add_u32 v3, s3, v1
  v_lshlrev_b32 v4, 11, v3
  v_lshl_add_u32 v4, v2, 4, v4
  buffer_load_dwordx4 v[8:11], v4, s[24:27], 0 offen
  buffer_load_dwordx4 v[12:15], v4, s[24:27], 0 offen offset:1024
  s_waitcnt vmcnt(0)
  v_lshlrev_b32 v16, 16, v8
  v_and_b32 v17, 0xffff0000, v8
  v_lshlrev_b32 v18, 16, v9
  v_and_b32 v19, 0xffff0000, v9
  v_lshlrev_b32 v20, 16, v10
  v_and_b32 v21, 0xffff0000, v10
  v_lshlrev_b32 v22, 16, v11
  v_and_b32 v23, 0xffff0000, v11
  v_lshlrev_b32 v24, 16, v12
  v_and_b32 v25, 0xffff0000, v12
  v_lshlrev_b32 v26, 16, v13
  v_and_b32 v27, 0xffff0000, v13
  v_lshlrev_b32 v28, 16, v14
  v_and_b32 v29, 0xffff0000, v14
  v_lshlrev_b32 v30, 16, v15
  v_and_b32 v31, 0xffff0000, v15
  v_add_f32 v32, v16, v17
  v_add_f32 v32, v32, v18
  v_add_f32 v32, v32, v19
  v_add_f32 v32, v32, v20
  v_add_f32 v32, v32, v21
  v_add_f32 v32, v32, v22
  v_add_f32 v32, v32, v23
  v_add_f32 v32, v32, v24
  v_add_f32 v32, v32, v25
  v_add_f32 v32, v32, v26
  v_add_f32 v32, v32, v27
  v_add_f32 v32, v32, v28
  v_add_f32 v32, v32, v29
  v_add_f32 v32, v32, v30
  v_add_f32 v32, v32, v31
  v_xor_b32 v41, 1, v2
  v_lshlrev_b32 v41, 2, v41
  ds_bpermute_b32 v40, v41, v32
  s_waitcnt lgkmcnt(0)
  v_add_f32 v32, v32, v40
  v_xor_b32 v41, 2, v2
  v_lshlrev_b32 v41, 2, v41
  ds_bpermute_b32 v40, v41, v32
  s_waitcnt lgkmcnt(0)
  v_add_f32 v32, v32, v40
  v_xor_b32 v41, 4, v2
  v_lshlrev_b32 v41, 2, v41
  ds_bpermute_b32 v40, v41, v32
  s_waitcnt lgkmcnt(0)
  v_add_f32 v32, v32, v40
  v_xor_b32 v41, 8, v2
  v_lshlrev_b32 v41, 2, v41
  ds_bpermute_b32 v40, v41, v32
  s_waitcnt lgkmcnt(0)
  v_add_f32 v32, v32, v40
  v_xor_b32 v41, 16, v2
  v_lshlrev_b32 v41, 2, v41
  ds_bpermute_b32 v40, v41, v32
  s_waitcnt lgkmcnt(0)
  v_add_f32 v32, v32, v40
  v_xor_b32 v41, 32, v2
  v_lshlrev_b32 v41, 2, v41
  ds_bpermute_b32 v40, v41, v32
  s_waitcnt lgkmcnt(0)
  v_add_f32 v32, v32, v40
  v_mul_f32 v32, 0x3a800000, v32
  v_sub_f32 v34, v16, v32
  v_mul_f32 v33, v34, v34
  v_sub_f32 v34, v17, v32
  v_fma_f32 v33, v34, v34, v33
  v_sub_f32 v34, v18, v32
  v_fma_f32 v33, v34, v34, v33
  v_sub_f32 v34, v19, v32
  v_fma_f32 v33, v34, v34, v33
  v_sub_f32 v34, v20, v32
  v_fma_f32 v33, v34, v34, v33
  v_sub_f32 v34, v21, v32
  v_fma_f32 v33, v34, v34, v33
  v_sub_f32 v34, v22, v32
  v_fma_f32 v33, v34, v34, v33
  v_sub_f32 v34, v23, v32
  v_fma_f32 v33, v34, v34, v33
  v_sub_f32 v34, v24, v32
  v_fma_f32 v33, v34, v34, v33
  v_sub_f32 v34, v25, v32
  v_fma_f32 v33, v34, v34, v33
  v_sub_f32 v34, v26, v32
  v_fma_f32 v33, v34, v34, v33
  v_sub_f32 v34, v27, v32
  v_fma_f32 v33, v34, v34, v33
  v_sub_f32 v34, v28, v32
  v_fma_f32 v33, v34, v34, v33
  v_sub_f32 v34, v29, v32
  v_fma_f32 v33, v34, v34, v33
  v_sub_f32 v34, v30, v32
  v_fma_f32 v33, v34, v34, v33
  v_sub_f32 v34, v31, v32
  v_fma_f32 v33, v34, v34, v33
  v_xor_b32 v41, 1, v2
  v_lshlrev_b32 v41, 2, v41
  ds_bpermute_b32 v40, v41, v33
  s_waitcnt lgkmcnt(0)
  v_add_f32 v33, v33, v40
  v_xor_b32 v41, 2, v2
  v_lshlrev_b32 v41, 2, v41
  ds_bpermute_b32 v40, v41, v33
  s_waitcnt lgkmcnt(0)
  v_add_f32 v33, v33, v40
  v_xor_b32 v41, 4, v2
  v_lshlrev_b32 v41, 2, v41
  ds_bpermute_b32 v40, v41, v33
  s_waitcnt lgkmcnt(0)
  v_add_f32 v33, v33, v40
  v_xor_b32 v41, 8, v2
  v_lshlrev_b32 v41, 2, v41
  ds_bpermute_b32 v40, v41, v33
  s_waitcnt lgkmcnt(0)
  v_add_f32 v33, v33, v40
  v_xor_b32 v41, 16, v2
  v_lshlrev_b32 v41, 2, v41
  ds_bpermute_b32 v40, v41, v33
  s_waitcnt lgkmcnt(0)
  v_add_f32 v33, v33, v40
  v_xor_b32 v41, 32, v2
  v_lshlrev_b32 v41, 2, v41
  ds_bpermute_b32 v40, v41, v33
  s_waitcnt lgkmcnt(0)
  v_add_f32 v33, v33, v40
  v_mul_f32 v33, 0x3a800000, v33
  v_cvt_pk_bf16_f32 v32, v32, v32
  v_and_b32 v32, 0xffff0000, v32
  v_cvt_pk_bf16_f32 v33, v33, v33
  v_and_b32 v33, 0xffff0000, v33
  v_add_f32 v33, 0x3727c5ac, v33
  v_cvt_pk_bf16_f32 v33, v33, v33
  v_and_b32 v33, 0xffff0000, v33
  v_sqrt_f32 v33, v33
  s_nop 0
  v_cvt_pk_bf16_f32 v33, v33, v33
  v_and_b32 v33, 0xffff0000, v33
  v_rcp_f32 v35, v33
  s_nop 0
  v_sub_f32 v16, v16, v32
  v_cvt_pk_bf16_f32 v16, v16, v16
  v_and_b32 v16, 0xffff0000, v16
  v_mul_f32 v36, v16, v35
  v_fma_f32 v37, -v36, v33, v16
  v_fma_f32 v16, v37, v35, v36
  v_sub_f32 v17, v17, v32
  v_cvt_pk_bf16_f32 v17, v17, v17
  v_and_b32 v17, 0xffff0000, v17
  v_mul_f32 v36, v17, v35
  v_fma_f32 v37, -v36, v33, v17
  v_fma_f32 v17, v37, v35, v36
  v_sub_f32 v18, v18, v32
  v_cvt_pk_bf16_f32 v18, v18, v18
  v_and_b32 v18, 0xffff0000, v18
  v_mul_f32 v36, v18, v35
  v_fma_f32 v37, -v36, v33, v18
  v_fma_f32 v18, v37, v35, v36
  v_sub_f32 v19, v19, v32
  v_cvt_pk_bf16_f32 v19, v19, v19
  v_and_b32 v19, 0xffff0000, v19
  v_mul_f32 v36, v19, v35
  v_fma_f32 v37, -v36, v33, v19
  v_fma_f32 v19, v37, v35, v36
  v_sub_f32 v20, v20, v32
  v_cvt_pk_bf16_f32 v20, v20, v20
  v_and_b32 v20, 0xffff0000, v20
  v_mul_f32 v36, v20, v35
  v_fma_f32 v37, -v36, v33, v20
  v_fma_f32 v20, v37, v35, v36
  v_sub_f32 v21, v21, v32
  v_cvt_pk_bf16_f32 v21, v21, v21
  v_and_b32 v21, 0xffff0000, v21
  v_mul_f32 v36, v21, v35
  v_fma_f32 v37, -v36, v33, v21
  v_fma_f32 v21, v37, v35, v36
  v_sub_f32 v22, v22, v32
  v_cvt_pk_bf16_f32 v22, v22, v22
  v_and_b32 v22, 0xffff0000, v22
  v_mul_f32 v36, v22, v35
  v_fma_f32 v37, -v36, v33, v22
  v_fma_f32 v22, v37, v35, v36
  v_sub_f32 v23, v23, v32
  v_cvt_pk_bf16_f32 v23, v23, v23
  v_and_b32 v23, 0xffff0000, v23
  v_mul_f32 v36, v23, v35
  v_fma_f32 v37, -v36, v33, v23
  v_fma_f32 v23, v37, v35, v36
  v_sub_f32 v24, v24, v32
  v_cvt_pk_bf16_f32 v24, v24, v24
  v_and_b32 v24, 0xffff0000, v24
  v_mul_f32 v36, v24, v35
  v_fma_f32 v37, -v36, v33, v24
  v_fma_f32 v24, v37, v35, v36
  v_sub_f32 v25, v25, v32
  v_cvt_pk_bf16_f32 v25, v25, v25
  v_and_b32 v25, 0xffff0000, v25
  v_mul_f32 v36, v25, v35
  v_fma_f32 v37, -v36, v33, v25
  v_fma_f32 v25, v37, v35, v36
  v_sub_f32 v26, v26, v32
  v_cvt_pk_bf16_f32 v26, v26, v26
  v_and_b32 v26, 0xffff0000, v26
  v_mul_f32 v36, v26, v35
  v_fma_f32 v37, -v36, v33, v26
  v_fma_f32 v26, v37, v35, v36
  v_sub_f32 v27, v27, v32
  v_cvt_pk_bf16_f32 v27, v27, v27
  v_and_b32 v27, 0xffff0000, v27
  v_mul_f32 v36, v27, v35
  v_fma_f32 v37, -v36, v33, v27
  v_fma_f32 v27, v37, v35, v36
  v_sub_f32 v28, v28, v32
  v_cvt_pk_bf16_f32 v28, v28, v28
  v_and_b32 v28, 0xffff0000, v28
  v_mul_f32 v36, v28, v35
  v_fma_f32 v37, -v36, v33, v28
  v_fma_f32 v28, v37, v35, v36
  v_sub_f32 v29, v29, v32
  v_cvt_pk_bf16_f32 v29, v29, v29
  v_and_b32 v29, 0xffff0000, v29
  v_mul_f32 v36, v29, v35
  v_fma_f32 v37, -v36, v33, v29
  v_fma_f32 v29, v37, v35, v36
  v_sub_f32 v30, v30, v32
  v_cvt_pk_bf16_f32 v30, v30, v30
  v_and_b32 v30, 0xffff0000, v30
  v_mul_f32 v36, v30, v35
  v_fma_f32 v37, -v36, v33, v30
  v_fma_f32 v30, v37, v35, v36
  v_sub_f32 v31, v31, v32
  v_cvt_pk_bf16_f32 v31, v31, v31
  v_and_b32 v31, 0xffff0000, v31
  v_mul_f32 v36, v31, v35
  v_fma_f32 v37, -v36, v33, v31
  v_fma_f32 v31, v37, v35, v36
  v_cvt_pk_bf16_f32 v8, v16, v17
  v_cvt_pk_bf16_f32 v9, v18, v19
  v_cvt_pk_bf16_f32 v10, v20, v21
  v_cvt_pk_bf16_f32 v11, v22, v23
  v_cvt_pk_bf16_f32 v12, v24, v25
  v_cvt_pk_bf16_f32 v13, v26, v27
  v_cvt_pk_bf16_f32 v14, v28, v29
  v_cvt_pk_bf16_f32 v15, v30, v31
  buffer_store_dwordx4 v[8:11], v4, s[28:31], 0 offen
  buffer_store_dwordx4 v[12:15], v4, s[28:31], 0 offen offset:1024
L_ln1_kernel_end:
  s_endpgm
.globl gemmq1_kernel
.p2align 8
.type gemmq1_kernel,@function
gemmq1_kernel:
  s_cmp_ge_u32 s2, 256
  s_cbranch_scc1 L_gemmq1_kernel_end
  s_load_dwordx16 s[4:19], s[0:1], 0
  s_load_dwordx2 s[20:21], s[0:1], 64
  s_waitcnt lgkmcnt(0)
  s_mov_b32 s24, s20
  s_and_b32 s25, s21, 0xffff
  s_mov_b32 s26, 4194304
  s_mov_b32 s27, 0x00020000
  s_mov_b32 s28, s12
  s_and_b32 s29, s13, 0xffff
  s_mov_b32 s30, 6291456
  s_mov_b32 s31, 0x00020000
  s_add_u32 s32, s20, 4194304
  s_addc_u32 s33, s21, 0
  s_and_b32 s33, s33, 0xffff
  s_mov_b32 s34, 12582912
  s_mov_b32 s35, 0x00020000
  s_mov_b32 s3, 268435457
  s_mul_hi_u32 s40, s2, s3
  s_mul_i32 s3, s40, 16
  s_sub_u32 s41, s2, s3
  v_and_b32 v1, 63, v0
  v_lshrrev_b32 v2, 6, v0
  s_nop 0
  v_readfirstlane_b32 s42, v2
  v_lshrrev_b32 v14, 3, v1
  v_and_b32 v15, 7, v1
  v_xor_b32 v3, v14, v15
  v_lshlrev_b32 v4, 11, v14
  v_lshl_add_u32 v4, v3, 4, v4
  v_bfe_u32 v3, v1, 4, 1
  v_and_b32 v5, 1, v2
  v_lshl_add_u32 v3, v5, 1, v3
  v_lshrrev_b32 v5, 1, v15
  v_xor_b32 v3, v3, v5
  v_lshlrev_b32 v3, 1, v3
  v_and_b32 v5, 1, v15
  v_or_b32 v3, v3, v5
  v_lshl_add_u32 v5, v2, 3, v14
  v_mul_u32_u24 v5, 6144, v5
  v_lshl_add_u32 v5, v3, 4, v5
  s_mul_i32 s44, s40, 262144
  s_lshl_b32 s3, s42, 14
  s_add_u32 s44, s44, s3
  s_add_u32 s45, s44, 131072
  s_mul_i32 s46, s41, 384
  s_add_u32 s47, s46, 128
  s_add_u32 s48, s46, 256
  s_lshl_b32 s43, s42, 10
  v_and_b32 v6, 3, v2
  v_lshrrev_b32 v7, 2, v2
  v_and_b32 v14, 15, v1
  v_lshrrev_b32 v15, 4, v1
  v_mul_u32_u24 v8, 64, v7
  v_add_u32 v8, v8, v14
  v_lshlrev_b32 v8, 7, v8
  v_and_b32 v3, 7, v1
  v_xor_b32 v3, v3, v15
  v_lshl_add_u32 v9, v3, 4, v8
  v_xor_b32 v3, 4, v3
  v_lshl_add_u32 v8, v3, 4, v8
  v_mov_b32 v3, v9
  v_mov_b32 v9, v8
  v_mov_b32 v8, v3
  v_bfe_u32 v3, v1, 2, 2
  v_lshl_add_u32 v10, v15, 3, v3
  v_lshlrev_b32 v10, 7, v10
  v_and_b32 v11, 3, v1
  v_lshl_add_u32 v10, v11, 3, v10
  v_lshrrev_b32 v3, 1, v3
  v_and_b32 v11, 1, v15
  v_lshl_add_u32 v3, v11, 1, v3
  v_mul_u32_u24 v11, 3, v6
  v_add_u32 v120, 0, v11
  v_and_b32 v121, 3, v120
  v_xor_b32 v121, v121, v3
  v_lshlrev_b32 v121, 5, v121
  v_lshrrev_b32 v120, 2, v120
  v_lshl_add_u32 v121, v120, 13, v121
  v_add_u32 v122, v10, v121
  v_add_u32 v122, 16384, v122
  v_add_u32 v120, 1, v11
  v_and_b32 v121, 3, v120
  v_xor_b32 v121, v121, v3
  v_lshlrev_b32 v121, 5, v121
  v_lshrrev_b32 v120, 2, v120
  v_lshl_add_u32 v121, v120, 13, v121
  v_add_u32 v123, v10, v121
  v_add_u32 v123, 16384, v123
  v_add_u32 v120, 2, v11
  v_and_b32 v121, 3, v120
  v_xor_b32 v121, v121, v3
  v_lshlrev_b32 v121, 5, v121
  v_lshrrev_b32 v120, 2, v120
  v_lshl_add_u32 v121, v120, 13, v121
  v_add_u32 v124, v10, v121
  v_add_u32 v124, 16384, v124
  v_add_u32 v128, 0, v8
  v_add_u32 v129, 0, v9
  v_add_u32 v134, 0, v122
  v_add_u32 v135, 0, v123
  v_add_u32 v136, 0, v124
  v_add_u32 v130, 40960, v8
  v_add_u32 v131, 40960, v9
  v_add_u32 v137, 40960, v122
  v_add_u32 v138, 40960, v123
  v_add_u32 v139, 40960, v124
  v_add_u32 v132, 81920, v8
  v_add_u32 v133, 81920, v9
  v_add_u32 v140, 81920, v122
  v_add_u32 v141, 81920, v123
  v_add_u32 v142, 81920, v124
  s_mul_i32 s3, s40, 128
  v_mul_u32_u24 v13, 64, v7
  v_add_u32 v13, v13, v14
  v_add_u32 v13, s3, v13
  v_mul_u32_u24 v13, 6144, v13
  s_mul_i32 s3, s41, 384
  v_mul_u32_u24 v3, 96, v6
  v_add_u32 v13, v13, v3
  v_lshl_add_u32 v13, v15, 3, v13
  v_add_u32 v13, s3, v13
  v_mov_b32 v72, 0
  v_mov_b32 v73, 0
  v_mov_b32 v74, 0
  v_mov_b32 v75, 0
  v_mov_b32 v76, 0
  v_mov_b32 v77, 0
  v_mov_b32 v78, 0
  v_mov_b32 v79, 0
  v_mov_b32 v80, 0
  v_mov_b32 v81, 0
  v_mov_b32 v82, 0
  v_mov_b32 v83, 0
  v_mov_b32 v84, 0
  v_mov_b32 v85, 0
  v_mov_b32 v86, 0
  v_mov_b32 v87, 0
  v_mov_b32 v88, 0
  v_mov_b32 v89, 0
  v_mov_b32 v90, 0
  v_mov_b32 v91, 0
  v_mov_b32 v92, 0
  v_mov_b32 v93, 0
  v_mov_b32 v94, 0
  v_mov_b32 v95, 0
  v_mov_b32 v96, 0
  v_mov_b32 v97, 0
  v_mov_b32 v98, 0
  v_mov_b32 v99, 0
  v_mov_b32 v100, 0
  v_mov_b32 v101, 0
  v_mov_b32 v102, 0
  v_mov_b32 v103, 0
  v_mov_b32 v104, 0
  v_mov_b32 v105, 0
  v_mov_b32 v106, 0
  v_mov_b32 v107, 0
  v_mov_b32 v108, 0
  v_mov_b32 v109, 0
  v_mov_b32 v110, 0
  v_mov_b32 v111, 0
  v_mov_b32 v112, 0
  v_mov_b32 v113, 0
  v_mov_b32 v114, 0
  v_mov_b32 v115, 0
  v_mov_b32 v116, 0
  v_mov_b32 v117, 0
  v_mov_b32 v118, 0
  v_mov_b32 v119, 0
  s_add_u32 m0, s43, 0
  s_nop 0
  buffer_load_dwordx4 v4, s[24:27], s44 offen lds
  s_add_u32 s44, s44, 128
  s_add_u32 m0, s43, 8192
  s_nop 0
  buffer_load_dwordx4 v4, s[24:27], s45 offen lds
  s_add_u32 s45, s45, 128
  s_add_u32 m0, s43, 16384
  s_nop 0
  buffer_load_dwordx4 v5, s[28:31], s46 offen lds
  s_add_u32 s46, s46, 393216
  s_add_u32 m0, s43, 24576
  s_nop 0
  buffer_load_dwordx4 v5, s[28:31], s47 offen lds
  s_add_u32 s47, s47, 393216
  s_add_u32 m0, s43, 32768
  s_nop 0
  buffer_load_dwordx4 v5, s[28:31], s48 offen lds
  s_add_u32 s48, s48, 393216
  s_add_u32 m0, s43, 40960
  s_nop 0
  buffer_load_dwordx4 v4, s[24:27], s44 offen lds
  s_add_u32 s44, s44, 128
  s_add_u32 m0, s43, 49152
  s_nop 0
  buffer_load_dwordx4 v4, s[24:27], s45 offen lds
  s_add_u32 s45, s45, 128
  s_add_u32 m0, s43, 57344
  s_nop 0
  buffer_load_dwordx4 v5, s[28:31], s46 offen lds
  s_add_u32 s46, s46, 393216
  s_add_u32 m0, s43, 65536
  s_nop 0
  buffer_load_dwordx4 v5, s[28:31], s47 offen lds
  s_add_u32 s47, s47, 393216
  s_add_u32 m0, s43, 73728
  s_nop 0
  buffer_load_dwordx4 v5, s[28:31], s48 offen lds
  s_add_u32 s48, s48, 393216
  s_waitcnt vmcnt(5)
  s_barrier
  s_add_u32 m0, s43, 81920
  s_nop 0
  buffer_load_dwordx4 v4, s[24:27], s44 offen lds
  s_add_u32 s44, s44, 128
  s_add_u32 m0, s43, 90112
  s_nop 0
  buffer_load_dwordx4 v4, s[24:27], s45 offen lds
  s_add_u32 s45, s45, 128
  s_add_u32 m0, s43, 98304
  s_nop 0
  buffer_load_dwordx4 v5, s[28:31], s46 offen lds
  s_add_u32 s46, s46, 393216
  s_add_u32 m0, s43, 106496
  s_nop 0
  buffer_load_dwordx4 v5, s[28:31], s47 offen lds
  s_add_u32 s47, s47, 393216
  s_add_u32 m0, s43, 114688
  s_nop 0
  buffer_load_dwordx4 v5, s[28:31], s48 offen lds
  s_add_u32 s48, s48, 393216
  ds_read_b128 v[16:19], v128 offset:0
  ds_read_b128 v[20:23], v128 offset:2048
  ds_read_b128 v[24:27], v128 offset:4096
  ds_read_b128 v[28:31], v128 offset:6144
  ds_read_b64_tr_b16 v[48:49], v134 offset:0
  ds_read_b64_tr_b16 v[50:51], v134 offset:512
  ds_read_b64_tr_b16 v[52:53], v135 offset:0
  ds_read_b64_tr_b16 v[54:55], v135 offset:512
  ds_read_b64_tr_b16 v[56:57], v136 offset:0
  ds_read_b64_tr_b16 v[58:59], v136 offset:512
  ds_read_b128 v[32:35], v129 offset:0
  ds_read_b128 v[36:39], v129 offset:2048
  ds_read_b128 v[40:43], v129 offset:4096
  ds_read_b128 v[44:47], v129 offset:6144
  ds_read_b64_tr_b16 v[60:61], v134 offset:4096
  ds_read_b64_tr_b16 v[62:63], v134 offset:4608
  ds_read_b64_tr_b16 v[64:65], v135 offset:4096
  ds_read_b64_tr_b16 v[66:67], v135 offset:4608
  ds_read_b64_tr_b16 v[68:69], v136 offset:4096
  ds_read_b64_tr_b16 v[70:71], v136 offset:4608
  s_waitcnt lgkmcnt(10)
  v_mfma_f32_16x16x32_bf16 v[72:75], v[48:51], v[16:19], v[72:75]
  v_mfma_f32_16x16x32_bf16 v[76:79], v[52:55], v[16:19], v[76:79]
  v_mfma_f32_16x16x32_bf16 v[80:83], v[56:59], v[16:19], v[80:83]
  v_mfma_f32_16x16x32_bf16 v[84:87], v[48:51], v[20:23], v[84:87]
  v_mfma_f32_16x16x32_bf16 v[88:91], v[52:55], v[20:23], v[88:91]
  v_mfma_f32_16x16x32_bf16 v[92:95], v[56:59], v[20:23], v[92:95]
  v_mfma_f32_16x16x32_bf16 v[96:99], v[48:51], v[24:27], v[96:99]
  v_mfma_f32_16x16x32_bf16 v[100:103], v[52:55], v[24:27], v[100:103]
  v_mfma_f32_16x16x32_bf16 v[104:107], v[56:59], v[24:27], v[104:107]
  v_mfma_f32_16x16x32_bf16 v[108:111], v[48:51], v[28:31], v[108:111]
  v_mfma_f32_16x16x32_bf16 v[112:115], v[52:55], v[28:31], v[112:115]
  v_mfma_f32_16x16x32_bf16 v[116:119], v[56:59], v[28:31], v[116:119]
  s_waitcnt lgkmcnt(0)
  v_mfma_f32_16x16x32_bf16 v[72:75], v[60:63], v[32:35], v[72:75]
  v_mfma_f32_16x16x32_bf16 v[76:79], v[64:67], v[32:35], v[76:79]
  v_mfma_f32_16x16x32_bf16 v[80:83], v[68:71], v[32:35], v[80:83]
  v_mfma_f32_16x16x32_bf16 v[84:87], v[60:63], v[36:39], v[84:87]
  v_mfma_f32_16x16x32_bf16 v[88:91], v[64:67], v[36:39], v[88:91]
  v_mfma_f32_16x16x32_bf16 v[92:95], v[68:71], v[36:39], v[92:95]
  v_mfma_f32_16x16x32_bf16 v[96:99], v[60:63], v[40:43], v[96:99]
  v_mfma_f32_16x16x32_bf16 v[100:103], v[64:67], v[40:43], v[100:103]
  v_mfma_f32_16x16x32_bf16 v[104:107], v[68:71], v[40:43], v[104:107]
  v_mfma_f32_16x16x32_bf16 v[108:111], v[60:63], v[44:47], v[108:111]
  v_mfma_f32_16x16x32_bf16 v[112:115], v[64:67], v[44:47], v[112:115]
  v_mfma_f32_16x16x32_bf16 v[116:119], v[68:71], v[44:47], v[116:119]
  s_waitcnt vmcnt(5)
  s_barrier
  s_add_u32 m0, s43, 0
  s_nop 0
  buffer_load_dwordx4 v4, s[24:27], s44 offen lds
  s_add_u32 s44, s44, 128
  s_add_u32 m0, s43, 8192
  s_nop 0
  buffer_load_dwordx4 v4, s[24:27], s45 offen lds
  s_add_u32 s45, s45, 128
  s_add_u32 m0, s43, 16384
  s_nop 0
  buffer_load_dwordx4 v5, s[28:31], s46 offen lds
  s_add_u32 s46, s46, 393216
  s_add_u32 m0, s43, 24576
  s_nop 0
  buffer_load_dwordx4 v5, s[28:31], s47 offen lds
  s_add_u32 s47, s47, 393216
  s_add_u32 m0, s43, 32768
  s_nop 0
  buffer_load_dwordx4 v5, s[28:31], s48 offen lds
  s_add_u32 s48, s48, 393216
  ds_read_b128 v[16:19], v130 offset:0
  ds_read_b128 v[20:23], v130 offset:2048
  ds_read_b128 v[24:27], v130 offset:4096
  ds_read_b128 v[28:31], v130 offset:6144
  ds_read_b64_tr_b16 v[48:49], v137 offset:0
  ds_read_b64_tr_b16 v[50:51], v137 offset:512
  ds_read_b64_tr_b16 v[52:53], v138 offset:0
  ds_read_b64_tr_b16 v[54:55], v138 offset:512
  ds_read_b64_tr_b16 v[56:57], v139 offset:0
  ds_read_b64_tr_b16 v[58:59], v139 offset:512
  ds_read_b128 v[32:35], v131 offset:0
  ds_read_b128 v[36:39], v131 offset:2048
  ds_read_b128 v[40:43], v131 offset:4096
  ds_read_b128 v[44:47], v131 offset:6144
  ds_read_b64_tr_b16 v[60:61], v137 offset:4096
  ds_read_b64_tr_b16 v[62:63], v137 offset:4608
  ds_read_b64_tr_b16 v[64:65], v138 offset:4096
  ds_read_b64_tr_b16 v[66:67], v138 offset:4608
  ds_read_b64_tr_b16 v[68:69], v139 offset:4096
  ds_read_b64_tr_b16 v[70:71], v139 offset:4608
  s_waitcnt lgkmcnt(10)
  v_mfma_f32_16x16x32_bf16 v[72:75], v[48:51], v[16:19], v[72:75]
  v_mfma_f32_16x16x32_bf16 v[76:79], v[52:55], v[16:19], v[76:79]
  v_mfma_f32_16x16x32_bf16 v[80:83], v[56:59], v[16:19], v[80:83]
  v_mfma_f32_16x16x32_bf16 v[84:87], v[48:51], v[20:23], v[84:87]
  v_mfma_f32_16x16x32_bf16 v[88:91], v[52:55], v[20:23], v[88:91]
  v_mfma_f32_16x16x32_bf16 v[92:95], v[56:59], v[20:23], v[92:95]
  v_mfma_f32_16x16x32_bf16 v[96:99], v[48:51], v[24:27], v[96:99]
  v_mfma_f32_16x16x32_bf16 v[100:103], v[52:55], v[24:27], v[100:103]
  v_mfma_f32_16x16x32_bf16 v[104:107], v[56:59], v[24:27], v[104:107]
  v_mfma_f32_16x16x32_bf16 v[108:111], v[48:51], v[28:31], v[108:111]
  v_mfma_f32_16x16x32_bf16 v[112:115], v[52:55], v[28:31], v[112:115]
  v_mfma_f32_16x16x32_bf16 v[116:119], v[56:59], v[28:31], v[116:119]
  s_waitcnt lgkmcnt(0)
  v_mfma_f32_16x16x32_bf16 v[72:75], v[60:63], v[32:35], v[72:75]
  v_mfma_f32_16x16x32_bf16 v[76:79], v[64:67], v[32:35], v[76:79]
  v_mfma_f32_16x16x32_bf16 v[80:83], v[68:71], v[32:35], v[80:83]
  v_mfma_f32_16x16x32_bf16 v[84:87], v[60:63], v[36:39], v[84:87]
  v_mfma_f32_16x16x32_bf16 v[88:91], v[64:67], v[36:39], v[88:91]
  v_mfma_f32_16x16x32_bf16 v[92:95], v[68:71], v[36:39], v[92:95]
  v_mfma_f32_16x16x32_bf16 v[96:99], v[60:63], v[40:43], v[96:99]
  v_mfma_f32_16x16x32_bf16 v[100:103], v[64:67], v[40:43], v[100:103]
  v_mfma_f32_16x16x32_bf16 v[104:107], v[68:71], v[40:43], v[104:107]
  v_mfma_f32_16x16x32_bf16 v[108:111], v[60:63], v[44:47], v[108:111]
  v_mfma_f32_16x16x32_bf16 v[112:115], v[64:67], v[44:47], v[112:115]
  v_mfma_f32_16x16x32_bf16 v[116:119], v[68:71], v[44:47], v[116:119]
  s_waitcnt vmcnt(5)
  s_barrier
  s_add_u32 m0, s43, 40960
  s_nop 0
  buffer_load_dwordx4 v4, s[24:27], s44 offen lds
  s_add_u32 s44, s44, 128
  s_add_u32 m0, s43, 49152
  s_nop 0
  buffer_load_dwordx4 v4, s[24:27], s45 offen lds
  s_add_u32 s45, s45, 128
  s_add_u32 m0, s43, 57344
  s_nop 0
  buffer_load_dwordx4 v5, s[28:31], s46 offen lds
  s_add_u32 s46, s46, 393216
  s_add_u32 m0, s43, 65536
  s_nop 0
  buffer_load_dwordx4 v5, s[28:31], s47 offen lds
  s_add_u32 s47, s47, 393216
  s_add_u32 m0, s43, 73728
  s_nop 0
  buffer_load_dwordx4 v5, s[28:31], s48 offen lds
  s_add_u32 s48, s48, 393216
  ds_read_b128 v[16:19], v132 offset:0
  ds_read_b128 v[20:23], v132 offset:2048
  ds_read_b128 v[24:27], v132 offset:4096
  ds_read_b128 v[28:31], v132 offset:6144
  ds_read_b64_tr_b16 v[48:49], v140 offset:0
  ds_read_b64_tr_b16 v[50:51], v140 offset:512
  ds_read_b64_tr_b16 v[52:53], v141 offset:0
  ds_read_b64_tr_b16 v[54:55], v141 offset:512
  ds_read_b64_tr_b16 v[56:57], v142 offset:0
  ds_read_b64_tr_b16 v[58:59], v142 offset:512
  ds_read_b128 v[32:35], v133 offset:0
  ds_read_b128 v[36:39], v133 offset:2048
  ds_read_b128 v[40:43], v133 offset:4096
  ds_read_b128 v[44:47], v133 offset:6144
  ds_read_b64_tr_b16 v[60:61], v140 offset:4096
  ds_read_b64_tr_b16 v[62:63], v140 offset:4608
  ds_read_b64_tr_b16 v[64:65], v141 offset:4096
  ds_read_b64_tr_b16 v[66:67], v141 offset:4608
  ds_read_b64_tr_b16 v[68:69], v142 offset:4096
  ds_read_b64_tr_b16 v[70:71], v142 offset:4608
  s_waitcnt lgkmcnt(10)
  v_mfma_f32_16x16x32_bf16 v[72:75], v[48:51], v[16:19], v[72:75]
  v_mfma_f32_16x16x32_bf16 v[76:79], v[52:55], v[16:19], v[76:79]
  v_mfma_f32_16x16x32_bf16 v[80:83], v[56:59], v[16:19], v[80:83]
  v_mfma_f32_16x16x32_bf16 v[84:87], v[48:51], v[20:23], v[84:87]
  v_mfma_f32_16x16x32_bf16 v[88:91], v[52:55], v[20:23], v[88:91]
  v_mfma_f32_16x16x32_bf16 v[92:95], v[56:59], v[20:23], v[92:95]
  v_mfma_f32_16x16x32_bf16 v[96:99], v[48:51], v[24:27], v[96:99]
  v_mfma_f32_16x16x32_bf16 v[100:103], v[52:55], v[24:27], v[100:103]
  v_mfma_f32_16x16x32_bf16 v[104:107], v[56:59], v[24:27], v[104:107]
  v_mfma_f32_16x16x32_bf16 v[108:111], v[48:51], v[28:31], v[108:111]
  v_mfma_f32_16x16x32_bf16 v[112:115], v[52:55], v[28:31], v[112:115]
  v_mfma_f32_16x16x32_bf16 v[116:119], v[56:59], v[28:31], v[116:119]
  s_waitcnt lgkmcnt(0)
  v_mfma_f32_16x16x32_bf16 v[72:75], v[60:63], v[32:35], v[72:75]
  v_mfma_f32_16x16x32_bf16 v[76:79], v[64:67], v[32:35], v[76:79]
  v_mfma_f32_16x16x32_bf16 v[80:83], v[68:71], v[32:35], v[80:83]
  v_mfma_f32_16x16x32_bf16 v[84:87], v[60:63], v[36:39], v[84:87]
  v_mfma_f32_16x16x32_bf16 v[88:91], v[64:67], v[36:39], v[88:91]
  v_mfma_f32_16x16x32_bf16 v[92:95], v[68:71], v[36:39], v[92:95]
  v_mfma_f32_16x16x32_bf16 v[96:99], v[60:63], v[40:43], v[96:99]
  v_mfma_f32_16x16x32_bf16 v[100:103], v[64:67], v[40:43], v[100:103]
  v_mfma_f32_16x16x32_bf16 v[104:107], v[68:71], v[40:43], v[104:107]
  v_mfma_f32_16x16x32_bf16 v[108:111], v[60:63], v[44:47], v[108:111]
  v_mfma_f32_16x16x32_bf16 v[112:115], v[64:67], v[44:47], v[112:115]
  v_mfma_f32_16x16x32_bf16 v[116:119], v[68:71], v[44:47], v[116:119]
  s_waitcnt vmcnt(5)
  s_barrier
  s_add_u32 m0, s43, 81920
  s_nop 0
  buffer_load_dwordx4 v4, s[24:27], s44 offen lds
  s_add_u32 s44, s44, 128
  s_add_u32 m0, s43, 90112
  s_nop 0
  buffer_load_dwordx4 v4, s[24:27], s45 offen lds
  s_add_u32 s45, s45, 128
  s_add_u32 m0, s43, 98304
  s_nop 0
  buffer_load_dwordx4 v5, s[28:31], s46 offen lds
  s_add_u32 s46, s46, 393216
  s_add_u32 m0, s43, 106496
  s_nop 0
  buffer_load_dwordx4 v5, s[28:31], s47 offen lds
  s_add_u32 s47, s47, 393216
  s_add_u32 m0, s43, 114688
  s_nop 0
  buffer_load_dwordx4 v5, s[28:31], s48 offen lds
  s_add_u32 s48, s48, 393216
  ds_read_b128 v[16:19], v128 offset:0
  ds_read_b128 v[20:23], v128 offset:2048
  ds_read_b128 v[24:27], v128 offset:4096
  ds_read_b128 v[28:31], v128 offset:6144
  ds_read_b64_tr_b16 v[48:49], v134 offset:0
  ds_read_b64_tr_b16 v[50:51], v134 offset:512
  ds_read_b64_tr_b16 v[52:53], v135 offset:0
  ds_read_b64_tr_b16 v[54:55], v135 offset:512
  ds_read_b64_tr_b16 v[56:57], v136 offset:0
  ds_read_b64_tr_b16 v[58:59], v136 offset:512
  ds_read_b128 v[32:35], v129 offset:0
  ds_read_b128 v[36:39], v129 offset:2048
  ds_read_b128 v[40:43], v129 offset:4096
  ds_read_b128 v[44:47], v129 offset:6144
  ds_read_b64_tr_b16 v[60:61], v134 offset:4096
  ds_read_b64_tr_b16 v[62:63], v134 offset:4608
  ds_read_b64_tr_b16 v[64:65], v135 offset:4096
  ds_read_b64_tr_b16 v[66:67], v135 offset:4608
  ds_read_b64_tr_b16 v[68:69], v136 offset:4096
  ds_read_b64_tr_b16 v[70:71], v136 offset:4608
  s_waitcnt lgkmcnt(10)
  v_mfma_f32_16x16x32_bf16 v[72:75], v[48:51], v[16:19], v[72:75]
  v_mfma_f32_16x16x32_bf16 v[76:79], v[52:55], v[16:19], v[76:79]
  v_mfma_f32_16x16x32_bf16 v[80:83], v[56:59], v[16:19], v[80:83]
  v_mfma_f32_16x16x32_bf16 v[84:87], v[48:51], v[20:23], v[84:87]
  v_mfma_f32_16x16x32_bf16 v[88:91], v[52:55], v[20:23], v[88:91]
  v_mfma_f32_16x16x32_bf16 v[92:95], v[56:59], v[20:23], v[92:95]
  v_mfma_f32_16x16x32_bf16 v[96:99], v[48:51], v[24:27], v[96:99]
  v_mfma_f32_16x16x32_bf16 v[100:103], v[52:55], v[24:27], v[100:103]
  v_mfma_f32_16x16x32_bf16 v[104:107], v[56:59], v[24:27], v[104:107]
  v_mfma_f32_16x16x32_bf16 v[108:111], v[48:51], v[28:31], v[108:111]
  v_mfma_f32_16x16x32_bf16 v[112:115], v[52:55], v[28:31], v[112:115]
  v_mfma_f32_16x16x32_bf16 v[116:119], v[56:59], v[28:31], v[116:119]
  s_waitcnt lgkmcnt(0)
  v_mfma_f32_16x16x32_bf16 v[72:75], v[60:63], v[32:35], v[72:75]
  v_mfma_f32_16x16x32_bf16 v[76:79], v[64:67], v[32:35], v[76:79]
  v_mfma_f32_16x16x32_bf16 v[80:83], v[68:71], v[32:35], v[80:83]
  v_mfma_f32_16x16x32_bf16 v[84:87], v[60:63], v[36:39], v[84:87]
  v_mfma_f32_16x16x32_bf16 v[88:91], v[64:67], v[36:39], v[88:91]
  v_mfma_f32_16x16x32_bf16 v[92:95], v[68:71], v[36:39], v[92:95]
  v_mfma_f32_16x16x32_bf16 v[96:99], v[60:63], v[40:43], v[96:99]
  v_mfma_f32_16x16x32_bf16 v[100:103], v[64:67], v[40:43], v[100:103]
  v_mfma_f32_16x16x32_bf16 v[104:107], v[68:71], v[40:43], v[104:107]
  v_mfma_f32_16x16x32_bf16 v[108:111], v[60:63], v[44:47], v[108:111]
  v_mfma_f32_16x16x32_bf16 v[112:115], v[64:67], v[44:47], v[112:115]
  v_mfma_f32_16x16x32_bf16 v[116:119], v[68:71], v[44:47], v[116:119]
  s_waitcnt vmcnt(5)
  s_barrier
  s_add_u32 m0, s43, 0
  s_nop 0
  buffer_load_dwordx4 v4, s[24:27], s44 offen lds
  s_add_u32 s44, s44, 128
  s_add_u32 m0, s43, 8192
  s_nop 0
  buffer_load_dwordx4 v4, s[24:27], s45 offen lds
  s_add_u32 s45, s45, 128
  s_add_u32 m0, s43, 16384
  s_nop 0
  buffer_load_dwordx4 v5, s[28:31], s46 offen lds
  s_add_u32 s46, s46, 393216
  s_add_u32 m0, s43, 24576
  s_nop 0
  buffer_load_dwordx4 v5, s[28:31], s47 offen lds
  s_add_u32 s47, s47, 393216
  s_add_u32 m0, s43, 32768
  s_nop 0
  buffer_load_dwordx4 v5, s[28:31], s48 offen lds
  s_add_u32 s48, s48, 393216
  ds_read_b128 v[16:19], v130 offset:0
  ds_read_b128 v[20:23], v130 offset:2048
  ds_read_b128 v[24:27], v130 offset:4096
  ds_read_b128 v[28:31], v130 offset:6144
  ds_read_b64_tr_b16 v[48:49], v137 offset:0
  ds_read_b64_tr_b16 v[50:51], v137 offset:512
  ds_read_b64_tr_b16 v[52:53], v138 offset:0
  ds_read_b64_tr_b16 v[54:55], v138 offset:512
  ds_read_b64_tr_b16 v[56:57], v139 offset:0
  ds_read_b64_tr_b16 v[58:59], v139 offset:512
  ds_read_b128 v[32:35], v131 offset:0
  ds_read_b128 v[36:39], v131 offset:2048
  ds_read_b128 v[40:43], v131 offset:4096
  ds_read_b128 v[44:47], v131 offset:6144
  ds_read_b64_tr_b16 v[60:61], v137 offset:4096
  ds_read_b64_tr_b16 v[62:63], v137 offset:4608
  ds_read_b64_tr_b16 v[64:65], v138 offset:4096
  ds_read_b64_tr_b16 v[66:67], v138 offset:4608
  ds_read_b64_tr_b16 v[68:69], v139 offset:4096
  ds_read_b64_tr_b16 v[70:71], v139 offset:4608
  s_waitcnt lgkmcnt(10)
  v_mfma_f32_16x16x32_bf16 v[72:75], v[48:51], v[16:19], v[72:75]
  v_mfma_f32_16x16x32_bf16 v[76:79], v[52:55], v[16:19], v[76:79]
  v_mfma_f32_16x16x32_bf16 v[80:83], v[56:59], v[16:19], v[80:83]
  v_mfma_f32_16x16x32_bf16 v[84:87], v[48:51], v[20:23], v[84:87]
  v_mfma_f32_16x16x32_bf16 v[88:91], v[52:55], v[20:23], v[88:91]
  v_mfma_f32_16x16x32_bf16 v[92:95], v[56:59], v[20:23], v[92:95]
  v_mfma_f32_16x16x32_bf16 v[96:99], v[48:51], v[24:27], v[96:99]
  v_mfma_f32_16x16x32_bf16 v[100:103], v[52:55], v[24:27], v[100:103]
  v_mfma_f32_16x16x32_bf16 v[104:107], v[56:59], v[24:27], v[104:107]
  v_mfma_f32_16x16x32_bf16 v[108:111], v[48:51], v[28:31], v[108:111]
  v_mfma_f32_16x16x32_bf16 v[112:115], v[52:55], v[28:31], v[112:115]
  v_mfma_f32_16x16x32_bf16 v[116:119], v[56:59], v[28:31], v[116:119]
  s_waitcnt lgkmcnt(0)
  v_mfma_f32_16x16x32_bf16 v[72:75], v[60:63], v[32:35], v[72:75]
  v_mfma_f32_16x16x32_bf16 v[76:79], v[64:67], v[32:35], v[76:79]
  v_mfma_f32_16x16x32_bf16 v[80:83], v[68:71], v[32:35], v[80:83]
  v_mfma_f32_16x16x32_bf16 v[84:87], v[60:63], v[36:39], v[84:87]
  v_mfma_f32_16x16x32_bf16 v[88:91], v[64:67], v[36:39], v[88:91]
  v_mfma_f32_16x16x32_bf16 v[92:95], v[68:71], v[36:39], v[92:95]
  v_mfma_f32_16x16x32_bf16 v[96:99], v[60:63], v[40:43], v[96:99]
  v_mfma_f32_16x16x32_bf16 v[100:103], v[64:67], v[40:43], v[100:103]
  v_mfma_f32_16x16x32_bf16 v[104:107], v[68:71], v[40:43], v[104:107]
  v_mfma_f32_16x16x32_bf16 v[108:111], v[60:63], v[44:47], v[108:111]
  v_mfma_f32_16x16x32_bf16 v[112:115], v[64:67], v[44:47], v[112:115]
  v_mfma_f32_16x16x32_bf16 v[116:119], v[68:71], v[44:47], v[116:119]
  s_waitcnt vmcnt(5)
  s_barrier
  s_add_u32 m0, s43, 40960
  s_nop 0
  buffer_load_dwordx4 v4, s[24:27], s44 offen lds
  s_add_u32 s44, s44, 128
  s_add_u32 m0, s43, 49152
  s_nop 0
  buffer_load_dwordx4 v4, s[24:27], s45 offen lds
  s_add_u32 s45, s45, 128
  s_add_u32 m0, s43, 57344
  s_nop 0
  buffer_load_dwordx4 v5, s[28:31], s46 offen lds
  s_add_u32 s46, s46, 393216
  s_add_u32 m0, s43, 65536
  s_nop 0
  buffer_load_dwordx4 v5, s[28:31], s47 offen lds
  s_add_u32 s47, s47, 393216
  s_add_u32 m0, s43, 73728
  s_nop 0
  buffer_load_dwordx4 v5, s[28:31], s48 offen lds
  s_add_u32 s48, s48, 393216
  ds_read_b128 v[16:19], v132 offset:0
  ds_read_b128 v[20:23], v132 offset:2048
  ds_read_b128 v[24:27], v132 offset:4096
  ds_read_b128 v[28:31], v132 offset:6144
  ds_read_b64_tr_b16 v[48:49], v140 offset:0
  ds_read_b64_tr_b16 v[50:51], v140 offset:512
  ds_read_b64_tr_b16 v[52:53], v141 offset:0
  ds_read_b64_tr_b16 v[54:55], v141 offset:512
  ds_read_b64_tr_b16 v[56:57], v142 offset:0
  ds_read_b64_tr_b16 v[58:59], v142 offset:512
  ds_read_b128 v[32:35], v133 offset:0
  ds_read_b128 v[36:39], v133 offset:2048
  ds_read_b128 v[40:43], v133 offset:4096
  ds_read_b128 v[44:47], v133 offset:6144
  ds_read_b64_tr_b16 v[60:61], v140 offset:4096
  ds_read_b64_tr_b16 v[62:63], v140 offset:4608
  ds_read_b64_tr_b16 v[64:65], v141 offset:4096
  ds_read_b64_tr_b16 v[66:67], v141 offset:4608
  ds_read_b64_tr_b16 v[68:69], v142 offset:4096
  ds_read_b64_tr_b16 v[70:71], v142 offset:4608
  s_waitcnt lgkmcnt(10)
  v_mfma_f32_16x16x32_bf16 v[72:75], v[48:51], v[16:19], v[72:75]
  v_mfma_f32_16x16x32_bf16 v[76:79], v[52:55], v[16:19], v[76:79]
  v_mfma_f32_16x16x32_bf16 v[80:83], v[56:59], v[16:19], v[80:83]
  v_mfma_f32_16x16x32_bf16 v[84:87], v[48:51], v[20:23], v[84:87]
  v_mfma_f32_16x16x32_bf16 v[88:91], v[52:55], v[20:23], v[88:91]
  v_mfma_f32_16x16x32_bf16 v[92:95], v[56:59], v[20:23], v[92:95]
  v_mfma_f32_16x16x32_bf16 v[96:99], v[48:51], v[24:27], v[96:99]
  v_mfma_f32_16x16x32_bf16 v[100:103], v[52:55], v[24:27], v[100:103]
  v_mfma_f32_16x16x32_bf16 v[104:107], v[56:59], v[24:27], v[104:107]
  v_mfma_f32_16x16x32_bf16 v[108:111], v[48:51], v[28:31], v[108:111]
  v_mfma_f32_16x16x32_bf16 v[112:115], v[52:55], v[28:31], v[112:115]
  v_mfma_f32_16x16x32_bf16 v[116:119], v[56:59], v[28:31], v[116:119]
  s_waitcnt lgkmcnt(0)
  v_mfma_f32_16x16x32_bf16 v[72:75], v[60:63], v[32:35], v[72:75]
  v_mfma_f32_16x16x32_bf16 v[76:79], v[64:67], v[32:35], v[76:79]
  v_mfma_f32_16x16x32_bf16 v[80:83], v[68:71], v[32:35], v[80:83]
  v_mfma_f32_16x16x32_bf16 v[84:87], v[60:63], v[36:39], v[84:87]
  v_mfma_f32_16x16x32_bf16 v[88:91], v[64:67], v[36:39], v[88:91]
  v_mfma_f32_16x16x32_bf16 v[92:95], v[68:71], v[36:39], v[92:95]
  v_mfma_f32_16x16x32_bf16 v[96:99], v[60:63], v[40:43], v[96:99]
  v_mfma_f32_16x16x32_bf16 v[100:103], v[64:67], v[40:43], v[100:103]
  v_mfma_f32_16x16x32_bf16 v[104:107], v[68:71], v[40:43], v[104:107]
  v_mfma_f32_16x16x32_bf16 v[108:111], v[60:63], v[44:47], v[108:111]
  v_mfma_f32_16x16x32_bf16 v[112:115], v[64:67], v[44:47], v[112:115]
  v_mfma_f32_16x16x32_bf16 v[116:119], v[68:71], v[44:47], v[116:119]
  s_waitcnt vmcnt(5)
  s_barrier
  s_add_u32 m0, s43, 81920
  s_nop 0
  buffer_load_dwordx4 v4, s[24:27], s44 offen lds
  s_add_u32 s44, s44, 128
  s_add_u32 m0, s43, 90112
  s_nop 0
  buffer_load_dwordx4 v4, s[24:27], s45 offen lds
  s_add_u32 s45, s45, 128
  s_add_u32 m0, s43, 98304
  s_nop 0
  buffer_load_dwordx4 v5, s[28:31], s46 offen lds
  s_add_u32 s46, s46, 393216
  s_add_u32 m0, s43, 106496
  s_nop 0
  buffer_load_dwordx4 v5, s[28:31], s47 offen lds
  s_add_u32 s47, s47, 393216
  s_add_u32 m0, s43, 114688
  s_nop 0
  buffer_load_dwordx4 v5, s[28:31], s48 offen lds
  s_add_u32 s48, s48, 393216
  ds_read_b128 v[16:19], v128 offset:0
  ds_read_b128 v[20:23], v128 offset:2048
  ds_read_b128 v[24:27], v128 offset:4096
  ds_read_b128 v[28:31], v128 offset:6144
  ds_read_b64_tr_b16 v[48:49], v134 offset:0
  ds_read_b64_tr_b16 v[50:51], v134 offset:512
  ds_read_b64_tr_b16 v[52:53], v135 offset:0
  ds_read_b64_tr_b16 v[54:55], v135 offset:512
  ds_read_b64_tr_b16 v[56:57], v136 offset:0
  ds_read_b64_tr_b16 v[58:59], v136 offset:512
  ds_read_b128 v[32:35], v129 offset:0
  ds_read_b128 v[36:39], v129 offset:2048
  ds_read_b128 v[40:43], v129 offset:4096
  ds_read_b128 v[44:47], v129 offset:6144
  ds_read_b64_tr_b16 v[60:61], v134 offset:4096
  ds_read_b64_tr_b16 v[62:63], v134 offset:4608
  ds_read_b64_tr_b16 v[64:65], v135 offset:4096
  ds_read_b64_tr_b16 v[66:67], v135 offset:4608
  ds_read_b64_tr_b16 v[68:69], v136 offset:4096
  ds_read_b64_tr_b16 v[70:71], v136 offset:4608
  s_waitcnt lgkmcnt(10)
  v_mfma_f32_16x16x32_bf16 v[72:75], v[48:51], v[16:19], v[72:75]
  v_mfma_f32_16x16x32_bf16 v[76:79], v[52:55], v[16:19], v[76:79]
  v_mfma_f32_16x16x32_bf16 v[80:83], v[56:59], v[16:19], v[80:83]
  v_mfma_f32_16x16x32_bf16 v[84:87], v[48:51], v[20:23], v[84:87]
  v_mfma_f32_16x16x32_bf16 v[88:91], v[52:55], v[20:23], v[88:91]
  v_mfma_f32_16x16x32_bf16 v[92:95], v[56:59], v[20:23], v[92:95]
  v_mfma_f32_16x16x32_bf16 v[96:99], v[48:51], v[24:27], v[96:99]
  v_mfma_f32_16x16x32_bf16 v[100:103], v[52:55], v[24:27], v[100:103]
  v_mfma_f32_16x16x32_bf16 v[104:107], v[56:59], v[24:27], v[104:107]
  v_mfma_f32_16x16x32_bf16 v[108:111], v[48:51], v[28:31], v[108:111]
  v_mfma_f32_16x16x32_bf16 v[112:115], v[52:55], v[28:31], v[112:115]
  v_mfma_f32_16x16x32_bf16 v[116:119], v[56:59], v[28:31], v[116:119]
  s_waitcnt lgkmcnt(0)
  v_mfma_f32_16x16x32_bf16 v[72:75], v[60:63], v[32:35], v[72:75]
  v_mfma_f32_16x16x32_bf16 v[76:79], v[64:67], v[32:35], v[76:79]
  v_mfma_f32_16x16x32_bf16 v[80:83], v[68:71], v[32:35], v[80:83]
  v_mfma_f32_16x16x32_bf16 v[84:87], v[60:63], v[36:39], v[84:87]
  v_mfma_f32_16x16x32_bf16 v[88:91], v[64:67], v[36:39], v[88:91]
  v_mfma_f32_16x16x32_bf16 v[92:95], v[68:71], v[36:39], v[92:95]
  v_mfma_f32_16x16x32_bf16 v[96:99], v[60:63], v[40:43], v[96:99]
  v_mfma_f32_16x16x32_bf16 v[100:103], v[64:67], v[40:43], v[100:103]
  v_mfma_f32_16x16x32_bf16 v[104:107], v[68:71], v[40:43], v[104:107]
  v_mfma_f32_16x16x32_bf16 v[108:111], v[60:63], v[44:47], v[108:111]
  v_mfma_f32_16x16x32_bf16 v[112:115], v[64:67], v[44:47], v[112:115]
  v_mfma_f32_16x16x32_bf16 v[116:119], v[68:71], v[44:47], v[116:119]
  s_waitcnt vmcnt(5)
  s_barrier
  s_add_u32 m0, s43, 0
  s_nop 0
  buffer_load_dwordx4 v4, s[24:27], s44 offen lds
  s_add_u32 s44, s44, 128
  s_add_u32 m0, s43, 8192
  s_nop 0
  buffer_load_dwordx4 v4, s[24:27], s45 offen lds
  s_add_u32 s45, s45, 128
  s_add_u32 m0, s43, 16384
  s_nop 0
  buffer_load_dwordx4 v5, s[28:31], s46 offen lds
  s_add_u32 s46, s46, 393216
  s_add_u32 m0, s43, 24576
  s_nop 0
  buffer_load_dwordx4 v5, s[28:31], s47 offen lds
  s_add_u32 s47, s47, 393216
  s_add_u32 m0, s43, 32768
  s_nop 0
  buffer_load_dwordx4 v5, s[28:31], s48 offen lds
  s_add_u32 s48, s48, 393216
  ds_read_b128 v[16:19], v130 offset:0
  ds_read_b128 v[20:23], v130 offset:2048
  ds_read_b128 v[24:27], v130 offset:4096
  ds_read_b128 v[28:31], v130 offset:6144
  ds_read_b64_tr_b16 v[48:49], v137 offset:0
  ds_read_b64_tr_b16 v[50:51], v137 offset:512
  ds_read_b64_tr_b16 v[52:53], v138 offset:0
  ds_read_b64_tr_b16 v[54:55], v138 offset:512
  ds_read_b64_tr_b16 v[56:57], v139 offset:0
  ds_read_b64_tr_b16 v[58:59], v139 offset:512
  ds_read_b128 v[32:35], v131 offset:0
  ds_read_b128 v[36:39], v131 offset:2048
  ds_read_b128 v[40:43], v131 offset:4096
  ds_read_b128 v[44:47], v131 offset:6144
  ds_read_b64_tr_b16 v[60:61], v137 offset:4096
  ds_read_b64_tr_b16 v[62:63], v137 offset:4608
  ds_read_b64_tr_b16 v[64:65], v138 offset:4096
  ds_read_b64_tr_b16 v[66:67], v138 offset:4608
  ds_read_b64_tr_b16 v[68:69], v139 offset:4096
  ds_read_b64_tr_b16 v[70:71], v139 offset:4608
  s_waitcnt lgkmcnt(10)
  v_mfma_f32_16x16x32_bf16 v[72:75], v[48:51], v[16:19], v[72:75]
  v_mfma_f32_16x16x32_bf16 v[76:79], v[52:55], v[16:19], v[76:79]
  v_mfma_f32_16x16x32_bf16 v[80:83], v[56:59], v[16:19], v[80:83]
  v_mfma_f32_16x16x32_bf16 v[84:87], v[48:51], v[20:23], v[84:87]
  v_mfma_f32_16x16x32_bf16 v[88:91], v[52:55], v[20:23], v[88:91]
  v_mfma_f32_16x16x32_bf16 v[92:95], v[56:59], v[20:23], v[92:95]
  v_mfma_f32_16x16x32_bf16 v[96:99], v[48:51], v[24:27], v[96:99]
  v_mfma_f32_16x16x32_bf16 v[100:103], v[52:55], v[24:27], v[100:103]
  v_mfma_f32_16x16x32_bf16 v[104:107], v[56:59], v[24:27], v[104:107]
  v_mfma_f32_16x16x32_bf16 v[108:111], v[48:51], v[28:31], v[108:111]
  v_mfma_f32_16x16x32_bf16 v[112:115], v[52:55], v[28:31], v[112:115]
  v_mfma_f32_16x16x32_bf16 v[116:119], v[56:59], v[28:31], v[116:119]
  s_waitcnt lgkmcnt(0)
  v_mfma_f32_16x16x32_bf16 v[72:75], v[60:63], v[32:35], v[72:75]
  v_mfma_f32_16x16x32_bf16 v[76:79], v[64:67], v[32:35], v[76:79]
  v_mfma_f32_16x16x32_bf16 v[80:83], v[68:71], v[32:35], v[80:83]
  v_mfma_f32_16x16x32_bf16 v[84:87], v[60:63], v[36:39], v[84:87]
  v_mfma_f32_16x16x32_bf16 v[88:91], v[64:67], v[36:39], v[88:91]
  v_mfma_f32_16x16x32_bf16 v[92:95], v[68:71], v[36:39], v[92:95]
  v_mfma_f32_16x16x32_bf16 v[96:99], v[60:63], v[40:43], v[96:99]
  v_mfma_f32_16x16x32_bf16 v[100:103], v[64:67], v[40:43], v[100:103]
  v_mfma_f32_16x16x32_bf16 v[104:107], v[68:71], v[40:43], v[104:107]
  v_mfma_f32_16x16x32_bf16 v[108:111], v[60:63], v[44:47], v[108:111]
  v_mfma_f32_16x16x32_bf16 v[112:115], v[64:67], v[44:47], v[112:115]
  v_mfma_f32_16x16x32_bf16 v[116:119], v[68:71], v[44:47], v[116:119]
  s_waitcnt vmcnt(5)
  s_barrier
  s_add_u32 m0, s43, 40960
  s_nop 0
  buffer_load_dwordx4 v4, s[24:27], s44 offen lds
  s_add_u32 s44, s44, 128
  s_add_u32 m0, s43, 49152
  s_nop 0
  buffer_load_dwordx4 v4, s[24:27], s45 offen lds
  s_add_u32 s45, s45, 128
  s_add_u32 m0, s43, 57344
  s_nop 0
  buffer_load_dwordx4 v5, s[28:31], s46 offen lds
  s_add_u32 s46, s46, 393216
  s_add_u32 m0, s43, 65536
  s_nop 0
  buffer_load_dwordx4 v5, s[28:31], s47 offen lds
  s_add_u32 s47, s47, 393216
  s_add_u32 m0, s43, 73728
  s_nop 0
  buffer_load_dwordx4 v5, s[28:31], s48 offen lds
  s_add_u32 s48, s48, 393216
  ds_read_b128 v[16:19], v132 offset:0
  ds_read_b128 v[20:23], v132 offset:2048
  ds_read_b128 v[24:27], v132 offset:4096
  ds_read_b128 v[28:31], v132 offset:6144
  ds_read_b64_tr_b16 v[48:49], v140 offset:0
  ds_read_b64_tr_b16 v[50:51], v140 offset:512
  ds_read_b64_tr_b16 v[52:53], v141 offset:0
  ds_read_b64_tr_b16 v[54:55], v141 offset:512
  ds_read_b64_tr_b16 v[56:57], v142 offset:0
  ds_read_b64_tr_b16 v[58:59], v142 offset:512
  ds_read_b128 v[32:35], v133 offset:0
  ds_read_b128 v[36:39], v133 offset:2048
  ds_read_b128 v[40:43], v133 offset:4096
  ds_read_b128 v[44:47], v133 offset:6144
  ds_read_b64_tr_b16 v[60:61], v140 offset:4096
  ds_read_b64_tr_b16 v[62:63], v140 offset:4608
  ds_read_b64_tr_b16 v[64:65], v141 offset:4096
  ds_read_b64_tr_b16 v[66:67], v141 offset:4608
  ds_read_b64_tr_b16 v[68:69], v142 offset:4096
  ds_read_b64_tr_b16 v[70:71], v142 offset:4608
  s_waitcnt lgkmcnt(10)
  v_mfma_f32_16x16x32_bf16 v[72:75], v[48:51], v[16:19], v[72:75]
  v_mfma_f32_16x16x32_bf16 v[76:79], v[52:55], v[16:19], v[76:79]
  v_mfma_f32_16x16x32_bf16 v[80:83], v[56:59], v[16:19], v[80:83]
  v_mfma_f32_16x16x32_bf16 v[84:87], v[48:51], v[20:23], v[84:87]
  v_mfma_f32_16x16x32_bf16 v[88:91], v[52:55], v[20:23], v[88:91]
  v_mfma_f32_16x16x32_bf16 v[92:95], v[56:59], v[20:23], v[92:95]
  v_mfma_f32_16x16x32_bf16 v[96:99], v[48:51], v[24:27], v[96:99]
  v_mfma_f32_16x16x32_bf16 v[100:103], v[52:55], v[24:27], v[100:103]
  v_mfma_f32_16x16x32_bf16 v[104:107], v[56:59], v[24:27], v[104:107]
  v_mfma_f32_16x16x32_bf16 v[108:111], v[48:51], v[28:31], v[108:111]
  v_mfma_f32_16x16x32_bf16 v[112:115], v[52:55], v[28:31], v[112:115]
  v_mfma_f32_16x16x32_bf16 v[116:119], v[56:59], v[28:31], v[116:119]
  s_waitcnt lgkmcnt(0)
  v_mfma_f32_16x16x32_bf16 v[72:75], v[60:63], v[32:35], v[72:75]
  v_mfma_f32_16x16x32_bf16 v[76:79], v[64:67], v[32:35], v[76:79]
  v_mfma_f32_16x16x32_bf16 v[80:83], v[68:71], v[32:35], v[80:83]
  v_mfma_f32_16x16x32_bf16 v[84:87], v[60:63], v[36:39], v[84:87]
  v_mfma_f32_16x16x32_bf16 v[88:91], v[64:67], v[36:39], v[88:91]
  v_mfma_f32_16x16x32_bf16 v[92:95], v[68:71], v[36:39], v[92:95]
  v_mfma_f32_16x16x32_bf16 v[96:99], v[60:63], v[40:43], v[96:99]
  v_mfma_f32_16x16x32_bf16 v[100:103], v[64:67], v[40:43], v[100:103]
  v_mfma_f32_16x16x32_bf16 v[104:107], v[68:71], v[40:43], v[104:107]
  v_mfma_f32_16x16x32_bf16 v[108:111], v[60:63], v[44:47], v[108:111]
  v_mfma_f32_16x16x32_bf16 v[112:115], v[64:67], v[44:47], v[112:115]
  v_mfma_f32_16x16x32_bf16 v[116:119], v[68:71], v[44:47], v[116:119]
  s_waitcnt vmcnt(5)
  s_barrier
  s_add_u32 m0, s43, 81920
  s_nop 0
  buffer_load_dwordx4 v4, s[24:27], s44 offen lds
  s_add_u32 s44, s44, 128
  s_add_u32 m0, s43, 90112
  s_nop 0
  buffer_load_dwordx4 v4, s[24:27], s45 offen lds
  s_add_u32 s45, s45, 128
  s_add_u32 m0, s43, 98304
  s_nop 0
  buffer_load_dwordx4 v5, s[28:31], s46 offen lds
  s_add_u32 s46, s46, 393216
  s_add_u32 m0, s43, 106496
  s_nop 0
  buffer_load_dwordx4 v5, s[28:31], s47 offen lds
  s_add_u32 s47, s47, 393216
  s_add_u32 m0, s43, 114688
  s_nop 0
  buffer_load_dwordx4 v5, s[28:31], s48 offen lds
  s_add_u32 s48, s48, 393216
  ds_read_b128 v[16:19], v128 offset:0
  ds_read_b128 v[20:23], v128 offset:2048
  ds_read_b128 v[24:27], v128 offset:4096
  ds_read_b128 v[28:31], v128 offset:6144
  ds_read_b64_tr_b16 v[48:49], v134 offset:0
  ds_read_b64_tr_b16 v[50:51], v134 offset:512
  ds_read_b64_tr_b16 v[52:53], v135 offset:0
  ds_read_b64_tr_b16 v[54:55], v135 offset:512
  ds_read_b64_tr_b16 v[56:57], v136 offset:0
  ds_read_b64_tr_b16 v[58:59], v136 offset:512
  ds_read_b128 v[32:35], v129 offset:0
  ds_read_b128 v[36:39], v129 offset:2048
  ds_read_b128 v[40:43], v129 offset:4096
  ds_read_b128 v[44:47], v129 offset:6144
  ds_read_b64_tr_b16 v[60:61], v134 offset:4096
  ds_read_b64_tr_b16 v[62:63], v134 offset:4608
  ds_read_b64_tr_b16 v[64:65], v135 offset:4096
  ds_read_b64_tr_b16 v[66:67], v135 offset:4608
  ds_read_b64_tr_b16 v[68:69], v136 offset:4096
  ds_read_b64_tr_b16 v[70:71], v136 offset:4608
  s_waitcnt lgkmcnt(10)
  v_mfma_f32_16x16x32_bf16 v[72:75], v[48:51], v[16:19], v[72:75]
  v_mfma_f32_16x16x32_bf16 v[76:79], v[52:55], v[16:19], v[76:79]
  v_mfma_f32_16x16x32_bf16 v[80:83], v[56:59], v[16:19], v[80:83]
  v_mfma_f32_16x16x32_bf16 v[84:87], v[48:51], v[20:23], v[84:87]
  v_mfma_f32_16x16x32_bf16 v[88:91], v[52:55], v[20:23], v[88:91]
  v_mfma_f32_16x16x32_bf16 v[92:95], v[56:59], v[20:23], v[92:95]
  v_mfma_f32_16x16x32_bf16 v[96:99], v[48:51], v[24:27], v[96:99]
  v_mfma_f32_16x16x32_bf16 v[100:103], v[52:55], v[24:27], v[100:103]
  v_mfma_f32_16x16x32_bf16 v[104:107], v[56:59], v[24:27], v[104:107]
  v_mfma_f32_16x16x32_bf16 v[108:111], v[48:51], v[28:31], v[108:111]
  v_mfma_f32_16x16x32_bf16 v[112:115], v[52:55], v[28:31], v[112:115]
  v_mfma_f32_16x16x32_bf16 v[116:119], v[56:59], v[28:31], v[116:119]
  s_waitcnt lgkmcnt(0)
  v_mfma_f32_16x16x32_bf16 v[72:75], v[60:63], v[32:35], v[72:75]
  v_mfma_f32_16x16x32_bf16 v[76:79], v[64:67], v[32:35], v[76:79]
  v_mfma_f32_16x16x32_bf16 v[80:83], v[68:71], v[32:35], v[80:83]
  v_mfma_f32_16x16x32_bf16 v[84:87], v[60:63], v[36:39], v[84:87]
  v_mfma_f32_16x16x32_bf16 v[88:91], v[64:67], v[36:39], v[88:91]
  v_mfma_f32_16x16x32_bf16 v[92:95], v[68:71], v[36:39], v[92:95]
  v_mfma_f32_16x16x32_bf16 v[96:99], v[60:63], v[40:43], v[96:99]
  v_mfma_f32_16x16x32_bf16 v[100:103], v[64:67], v[40:43], v[100:103]
  v_mfma_f32_16x16x32_bf16 v[104:107], v[68:71], v[40:43], v[104:107]
  v_mfma_f32_16x16x32_bf16 v[108:111], v[60:63], v[44:47], v[108:111]
  v_mfma_f32_16x16x32_bf16 v[112:115], v[64:67], v[44:47], v[112:115]
  v_mfma_f32_16x16x32_bf16 v[116:119], v[68:71], v[44:47], v[116:119]
  s_waitcnt vmcnt(5)
  s_barrier
  s_add_u32 m0, s43, 0
  s_nop 0
  buffer_load_dwordx4 v4, s[24:27], s44 offen lds
  s_add_u32 s44, s44, 128
  s_add_u32 m0, s43, 8192
  s_nop 0
  buffer_load_dwordx4 v4, s[24:27], s45 offen lds
  s_add_u32 s45, s45, 128
  s_add_u32 m0, s43, 16384
  s_nop 0
  buffer_load_dwordx4 v5, s[28:31], s46 offen lds
  s_add_u32 s46, s46, 393216
  s_add_u32 m0, s43, 24576
  s_nop 0
  buffer_load_dwordx4 v5, s[28:31], s47 offen lds
  s_add_u32 s47, s47, 393216
  s_add_u32 m0, s43, 32768
  s_nop 0
  buffer_load_dwordx4 v5, s[28:31], s48 offen lds
  s_add_u32 s48, s48, 393216
  ds_read_b128 v[16:19], v130 offset:0
  ds_read_b128 v[20:23], v130 offset:2048
  ds_read_b128 v[24:27], v130 offset:4096
  ds_read_b128 v[28:31], v130 offset:6144
  ds_read_b64_tr_b16 v[48:49], v137 offset:0
  ds_read_b64_tr_b16 v[50:51], v137 offset:512
  ds_read_b64_tr_b16 v[52:53], v138 offset:0
  ds_read_b64_tr_b16 v[54:55], v138 offset:512
  ds_read_b64_tr_b16 v[56:57], v139 offset:0
  ds_read_b64_tr_b16 v[58:59], v139 offset:512
  ds_read_b128 v[32:35], v131 offset:0
  ds_read_b128 v[36:39], v131 offset:2048
  ds_read_b128 v[40:43], v131 offset:4096
  ds_read_b128 v[44:47], v131 offset:6144
  ds_read_b64_tr_b16 v[60:61], v137 offset:4096
  ds_read_b64_tr_b16 v[62:63], v137 offset:4608
  ds_read_b64_tr_b16 v[64:65], v138 offset:4096
  ds_read_b64_tr_b16 v[66:67], v138 offset:4608
  ds_read_b64_tr_b16 v[68:69], v139 offset:4096
  ds_read_b64_tr_b16 v[70:71], v139 offset:4608
  s_waitcnt lgkmcnt(10)
  v_mfma_f32_16x16x32_bf16 v[72:75], v[48:51], v[16:19], v[72:75]
  v_mfma_f32_16x16x32_bf16 v[76:79], v[52:55], v[16:19], v[76:79]
  v_mfma_f32_16x16x32_bf16 v[80:83], v[56:59], v[16:19], v[80:83]
  v_mfma_f32_16x16x32_bf16 v[84:87], v[48:51], v[20:23], v[84:87]
  v_mfma_f32_16x16x32_bf16 v[88:91], v[52:55], v[20:23], v[88:91]
  v_mfma_f32_16x16x32_bf16 v[92:95], v[56:59], v[20:23], v[92:95]
  v_mfma_f32_16x16x32_bf16 v[96:99], v[48:51], v[24:27], v[96:99]
  v_mfma_f32_16x16x32_bf16 v[100:103], v[52:55], v[24:27], v[100:103]
  v_mfma_f32_16x16x32_bf16 v[104:107], v[56:59], v[24:27], v[104:107]
  v_mfma_f32_16x16x32_bf16 v[108:111], v[48:51], v[28:31], v[108:111]
  v_mfma_f32_16x16x32_bf16 v[112:115], v[52:55], v[28:31], v[112:115]
  v_mfma_f32_16x16x32_bf16 v[116:119], v[56:59], v[28:31], v[116:119]
  s_waitcnt lgkmcnt(0)
  v_mfma_f32_16x16x32_bf16 v[72:75], v[60:63], v[32:35], v[72:75]
  v_mfma_f32_16x16x32_bf16 v[76:79], v[64:67], v[32:35], v[76:79]
  v_mfma_f32_16x16x32_bf16 v[80:83], v[68:71], v[32:35], v[80:83]
  v_mfma_f32_16x16x32_bf16 v[84:87], v[60:63], v[36:39], v[84:87]
  v_mfma_f32_16x16x32_bf16 v[88:91], v[64:67], v[36:39], v[88:91]
  v_mfma_f32_16x16x32_bf16 v[92:95], v[68:71], v[36:39], v[92:95]
  v_mfma_f32_16x16x32_bf16 v[96:99], v[60:63], v[40:43], v[96:99]
  v_mfma_f32_16x16x32_bf16 v[100:103], v[64:67], v[40:43], v[100:103]
  v_mfma_f32_16x16x32_bf16 v[104:107], v[68:71], v[40:43], v[104:107]
  v_mfma_f32_16x16x32_bf16 v[108:111], v[60:63], v[44:47], v[108:111]
  v_mfma_f32_16x16x32_bf16 v[112:115], v[64:67], v[44:47], v[112:115]
  v_mfma_f32_16x16x32_bf16 v[116:119], v[68:71], v[44:47], v[116:119]
  s_waitcnt vmcnt(5)
  s_barrier
  s_add_u32 m0, s43, 40960
  s_nop 0
  buffer_load_dwordx4 v4, s[24:27], s44 offen lds
  s_add_u32 s44, s44, 128
  s_add_u32 m0, s43, 49152
  s_nop 0
  buffer_load_dwordx4 v4, s[24:27], s45 offen lds
  s_add_u32 s45, s45, 128
  s_add_u32 m0, s43, 57344
  s_nop 0
  buffer_load_dwordx4 v5, s[28:31], s46 offen lds
  s_add_u32 s46, s46, 393216
  s_add_u32 m0, s43, 65536
  s_nop 0
  buffer_load_dwordx4 v5, s[28:31], s47 offen lds
  s_add_u32 s47, s47, 393216
  s_add_u32 m0, s43, 73728
  s_nop 0
  buffer_load_dwordx4 v5, s[28:31], s48 offen lds
  s_add_u32 s48, s48, 393216
  ds_read_b128 v[16:19], v132 offset:0
  ds_read_b128 v[20:23], v132 offset:2048
  ds_read_b128 v[24:27], v132 offset:4096
  ds_read_b128 v[28:31], v132 offset:6144
  ds_read_b64_tr_b16 v[48:49], v140 offset:0
  ds_read_b64_tr_b16 v[50:51], v140 offset:512
  ds_read_b64_tr_b16 v[52:53], v141 offset:0
  ds_read_b64_tr_b16 v[54:55], v141 offset:512
  ds_read_b64_tr_b16 v[56:57], v142 offset:0
  ds_read_b64_tr_b16 v[58:59], v142 offset:512
  ds_read_b128 v[32:35], v133 offset:0
  ds_read_b128 v[36:39], v133 offset:2048
  ds_read_b128 v[40:43], v133 offset:4096
  ds_read_b128 v[44:47], v133 offset:6144
  ds_read_b64_tr_b16 v[60:61], v140 offset:4096
  ds_read_b64_tr_b16 v[62:63], v140 offset:4608
  ds_read_b64_tr_b16 v[64:65], v141 offset:4096
  ds_read_b64_tr_b16 v[66:67], v141 offset:4608
  ds_read_b64_tr_b16 v[68:69], v142 offset:4096
  ds_read_b64_tr_b16 v[70:71], v142 offset:4608
  s_waitcnt lgkmcnt(10)
  v_mfma_f32_16x16x32_bf16 v[72:75], v[48:51], v[16:19], v[72:75]
  v_mfma_f32_16x16x32_bf16 v[76:79], v[52:55], v[16:19], v[76:79]
  v_mfma_f32_16x16x32_bf16 v[80:83], v[56:59], v[16:19], v[80:83]
  v_mfma_f32_16x16x32_bf16 v[84:87], v[48:51], v[20:23], v[84:87]
  v_mfma_f32_16x16x32_bf16 v[88:91], v[52:55], v[20:23], v[88:91]
  v_mfma_f32_16x16x32_bf16 v[92:95], v[56:59], v[20:23], v[92:95]
  v_mfma_f32_16x16x32_bf16 v[96:99], v[48:51], v[24:27], v[96:99]
  v_mfma_f32_16x16x32_bf16 v[100:103], v[52:55], v[24:27], v[100:103]
  v_mfma_f32_16x16x32_bf16 v[104:107], v[56:59], v[24:27], v[104:107]
  v_mfma_f32_16x16x32_bf16 v[108:111], v[48:51], v[28:31], v[108:111]
  v_mfma_f32_16x16x32_bf16 v[112:115], v[52:55], v[28:31], v[112:115]
  v_mfma_f32_16x16x32_bf16 v[116:119], v[56:59], v[28:31], v[116:119]
  s_waitcnt lgkmcnt(0)
  v_mfma_f32_16x16x32_bf16 v[72:75], v[60:63], v[32:35], v[72:75]
  v_mfma_f32_16x16x32_bf16 v[76:79], v[64:67], v[32:35], v[76:79]
  v_mfma_f32_16x16x32_bf16 v[80:83], v[68:71], v[32:35], v[80:83]
  v_mfma_f32_16x16x32_bf16 v[84:87], v[60:63], v[36:39], v[84:87]
  v_mfma_f32_16x16x32_bf16 v[88:91], v[64:67], v[36:39], v[88:91]
  v_mfma_f32_16x16x32_bf16 v[92:95], v[68:71], v[36:39], v[92:95]
  v_mfma_f32_16x16x32_bf16 v[96:99], v[60:63], v[40:43], v[96:99]
  v_mfma_f32_16x16x32_bf16 v[100:103], v[64:67], v[40:43], v[100:103]
  v_mfma_f32_16x16x32_bf16 v[104:107], v[68:71], v[40:43], v[104:107]
  v_mfma_f32_16x16x32_bf16 v[108:111], v[60:63], v[44:47], v[108:111]
  v_mfma_f32_16x16x32_bf16 v[112:115], v[64:67], v[44:47], v[112:115]
  v_mfma_f32_16x16x32_bf16 v[116:119], v[68:71], v[44:47], v[116:119]
  s_waitcnt vmcnt(5)
  s_barrier
  s_add_u32 m0, s43, 81920
  s_nop 0
  buffer_load_dwordx4 v4, s[24:27], s44 offen lds
  s_add_u32 s44, s44, 128
  s_add_u32 m0, s43, 90112
  s_nop 0
  buffer_load_dwordx4 v4, s[24:27], s45 offen lds
  s_add_u32 s45, s45, 128
  s_add_u32 m0, s43, 98304
  s_nop 0
  buffer_load_dwordx4 v5, s[28:31], s46 offen lds
  s_add_u32 s46, s46, 393216
  s_add_u32 m0, s43, 106496
  s_nop 0
  buffer_load_dwordx4 v5, s[28:31], s47 offen lds
  s_add_u32 s47, s47, 393216
  s_add_u32 m0, s43, 114688
  s_nop 0
  buffer_load_dwordx4 v5, s[28:31], s48 offen lds
  s_add_u32 s48, s48, 393216
  ds_read_b128 v[16:19], v128 offset:0
  ds_read_b128 v[20:23], v128 offset:2048
  ds_read_b128 v[24:27], v128 offset:4096
  ds_read_b128 v[28:31], v128 offset:6144
  ds_read_b64_tr_b16 v[48:49], v134 offset:0
  ds_read_b64_tr_b16 v[50:51], v134 offset:512
  ds_read_b64_tr_b16 v[52:53], v135 offset:0
  ds_read_b64_tr_b16 v[54:55], v135 offset:512
  ds_read_b64_tr_b16 v[56:57], v136 offset:0
  ds_read_b64_tr_b16 v[58:59], v136 offset:512
  ds_read_b128 v[32:35], v129 offset:0
  ds_read_b128 v[36:39], v129 offset:2048
  ds_read_b128 v[40:43], v129 offset:4096
  ds_read_b128 v[44:47], v129 offset:6144
  ds_read_b64_tr_b16 v[60:61], v134 offset:4096
  ds_read_b64_tr_b16 v[62:63], v134 offset:4608
  ds_read_b64_tr_b16 v[64:65], v135 offset:4096
  ds_read_b64_tr_b16 v[66:67], v135 offset:4608
  ds_read_b64_tr_b16 v[68:69], v136 offset:4096
  ds_read_b64_tr_b16 v[70:71], v136 offset:4608
  s_waitcnt lgkmcnt(10)
  v_mfma_f32_16x16x32_bf16 v[72:75], v[48:51], v[16:19], v[72:75]
  v_mfma_f32_16x16x32_bf16 v[76:79], v[52:55], v[16:19], v[76:79]
  v_mfma_f32_16x16x32_bf16 v[80:83], v[56:59], v[16:19], v[80:83]
  v_mfma_f32_16x16x32_bf16 v[84:87], v[48:51], v[20:23], v[84:87]
  v_mfma_f32_16x16x32_bf16 v[88:91], v[52:55], v[20:23], v[88:91]
  v_mfma_f32_16x16x32_bf16 v[92:95], v[56:59], v[20:23], v[92:95]
  v_mfma_f32_16x16x32_bf16 v[96:99], v[48:51], v[24:27], v[96:99]
  v_mfma_f32_16x16x32_bf16 v[100:103], v[52:55], v[24:27], v[100:103]
  v_mfma_f32_16x16x32_bf16 v[104:107], v[56:59], v[24:27], v[104:107]
  v_mfma_f32_16x16x32_bf16 v[108:111], v[48:51], v[28:31], v[108:111]
  v_mfma_f32_16x16x32_bf16 v[112:115], v[52:55], v[28:31], v[112:115]
  v_mfma_f32_16x16x32_bf16 v[116:119], v[56:59], v[28:31], v[116:119]
  s_waitcnt lgkmcnt(0)
  v_mfma_f32_16x16x32_bf16 v[72:75], v[60:63], v[32:35], v[72:75]
  v_mfma_f32_16x16x32_bf16 v[76:79], v[64:67], v[32:35], v[76:79]
  v_mfma_f32_16x16x32_bf16 v[80:83], v[68:71], v[32:35], v[80:83]
  v_mfma_f32_16x16x32_bf16 v[84:87], v[60:63], v[36:39], v[84:87]
  v_mfma_f32_16x16x32_bf16 v[88:91], v[64:67], v[36:39], v[88:91]
  v_mfma_f32_16x16x32_bf16 v[92:95], v[68:71], v[36:39], v[92:95]
  v_mfma_f32_16x16x32_bf16 v[96:99], v[60:63], v[40:43], v[96:99]
  v_mfma_f32_16x16x32_bf16 v[100:103], v[64:67], v[40:43], v[100:103]
  v_mfma_f32_16x16x32_bf16 v[104:107], v[68:71], v[40:43], v[104:107]
  v_mfma_f32_16x16x32_bf16 v[108:111], v[60:63], v[44:47], v[108:111]
  v_mfma_f32_16x16x32_bf16 v[112:115], v[64:67], v[44:47], v[112:115]
  v_mfma_f32_16x16x32_bf16 v[116:119], v[68:71], v[44:47], v[116:119]
  s_waitcnt vmcnt(5)
  s_barrier
  s_add_u32 m0, s43, 0
  s_nop 0
  buffer_load_dwordx4 v4, s[24:27], s44 offen lds
  s_add_u32 s44, s44, 128
  s_add_u32 m0, s43, 8192
  s_nop 0
  buffer_load_dwordx4 v4, s[24:27], s45 offen lds
  s_add_u32 s45, s45, 128
  s_add_u32 m0, s43, 16384
  s_nop 0
  buffer_load_dwordx4 v5, s[28:31], s46 offen lds
  s_add_u32 s46, s46, 393216
  s_add_u32 m0, s43, 24576
  s_nop 0
  buffer_load_dwordx4 v5, s[28:31], s47 offen lds
  s_add_u32 s47, s47, 393216
  s_add_u32 m0, s43, 32768
  s_nop 0
  buffer_load_dwordx4 v5, s[28:31], s48 offen lds
  s_add_u32 s48, s48, 393216
  ds_read_b128 v[16:19], v130 offset:0
  ds_read_b128 v[20:23], v130 offset:2048
  ds_read_b128 v[24:27], v130 offset:4096
  ds_read_b128 v[28:31], v130 offset:6144
  ds_read_b64_tr_b16 v[48:49], v137 offset:0
  ds_read_b64_tr_b16 v[50:51], v137 offset:512
  ds_read_b64_tr_b16 v[52:53], v138 offset:0
  ds_read_b64_tr_b16 v[54:55], v138 offset:512
  ds_read_b64_tr_b16 v[56:57], v139 offset:0
  ds_read_b64_tr_b16 v[58:59], v139 offset:512
  ds_read_b128 v[32:35], v131 offset:0
  ds_read_b128 v[36:39], v131 offset:2048
  ds_read_b128 v[40:43], v131 offset:4096
  ds_read_b128 v[44:47], v131 offset:6144
  ds_read_b64_tr_b16 v[60:61], v137 offset:4096
  ds_read_b64_tr_b16 v[62:63], v137 offset:4608
  ds_read_b64_tr_b16 v[64:65], v138 offset:4096
  ds_read_b64_tr_b16 v[66:67], v138 offset:4608
  ds_read_b64_tr_b16 v[68:69], v139 offset:4096
  ds_read_b64_tr_b16 v[70:71], v139 offset:4608
  s_waitcnt lgkmcnt(10)
  v_mfma_f32_16x16x32_bf16 v[72:75], v[48:51], v[16:19], v[72:75]
  v_mfma_f32_16x16x32_bf16 v[76:79], v[52:55], v[16:19], v[76:79]
  v_mfma_f32_16x16x32_bf16 v[80:83], v[56:59], v[16:19], v[80:83]
  v_mfma_f32_16x16x32_bf16 v[84:87], v[48:51], v[20:23], v[84:87]
  v_mfma_f32_16x16x32_bf16 v[88:91], v[52:55], v[20:23], v[88:91]
  v_mfma_f32_16x16x32_bf16 v[92:95], v[56:59], v[20:23], v[92:95]
  v_mfma_f32_16x16x32_bf16 v[96:99], v[48:51], v[24:27], v[96:99]
  v_mfma_f32_16x16x32_bf16 v[100:103], v[52:55], v[24:27], v[100:103]
  v_mfma_f32_16x16x32_bf16 v[104:107], v[56:59], v[24:27], v[104:107]
  v_mfma_f32_16x16x32_bf16 v[108:111], v[48:51], v[28:31], v[108:111]
  v_mfma_f32_16x16x32_bf16 v[112:115], v[52:55], v[28:31], v[112:115]
  v_mfma_f32_16x16x32_bf16 v[116:119], v[56:59], v[28:31], v[116:119]
  s_waitcnt lgkmcnt(0)
  v_mfma_f32_16x16x32_bf16 v[72:75], v[60:63], v[32:35], v[72:75]
  v_mfma_f32_16x16x32_bf16 v[76:79], v[64:67], v[32:35], v[76:79]
  v_mfma_f32_16x16x32_bf16 v[80:83], v[68:71], v[32:35], v[80:83]
  v_mfma_f32_16x16x32_bf16 v[84:87], v[60:63], v[36:39], v[84:87]
  v_mfma_f32_16x16x32_bf16 v[88:91], v[64:67], v[36:39], v[88:91]
  v_mfma_f32_16x16x32_bf16 v[92:95], v[68:71], v[36:39], v[92:95]
  v_mfma_f32_16x16x32_bf16 v[96:99], v[60:63], v[40:43], v[96:99]
  v_mfma_f32_16x16x32_bf16 v[100:103], v[64:67], v[40:43], v[100:103]
  v_mfma_f32_16x16x32_bf16 v[104:107], v[68:71], v[40:43], v[104:107]
  v_mfma_f32_16x16x32_bf16 v[108:111], v[60:63], v[44:47], v[108:111]
  v_mfma_f32_16x16x32_bf16 v[112:115], v[64:67], v[44:47], v[112:115]
  v_mfma_f32_16x16x32_bf16 v[116:119], v[68:71], v[44:47], v[116:119]
  s_waitcnt vmcnt(5)
  s_barrier
  ds_read_b128 v[16:19], v132 offset:0
  ds_read_b128 v[20:23], v132 offset:2048
  ds_read_b128 v[24:27], v132 offset:4096
  ds_read_b128 v[28:31], v132 offset:6144
  ds_read_b64_tr_b16 v[48:49], v140 offset:0
  ds_read_b64_tr_b16 v[50:51], v140 offset:512
  ds_read_b64_tr_b16 v[52:53], v141 offset:0
  ds_read_b64_tr_b16 v[54:55], v141 offset:512
  ds_read_b64_tr_b16 v[56:57], v142 offset:0
  ds_read_b64_tr_b16 v[58:59], v142 offset:512
  ds_read_b128 v[32:35], v133 offset:0
  ds_read_b128 v[36:39], v133 offset:2048
  ds_read_b128 v[40:43], v133 offset:4096
  ds_read_b128 v[44:47], v133 offset:6144
  ds_read_b64_tr_b16 v[60:61], v140 offset:4096
  ds_read_b64_tr_b16 v[62:63], v140 offset:4608
  ds_read_b64_tr_b16 v[64:65], v141 offset:4096
  ds_read_b64_tr_b16 v[66:67], v141 offset:4608
  ds_read_b64_tr_b16 v[68:69], v142 offset:4096
  ds_read_b64_tr_b16 v[70:71], v142 offset:4608
  s_waitcnt lgkmcnt(10)
  v_mfma_f32_16x16x32_bf16 v[72:75], v[48:51], v[16:19], v[72:75]
  v_mfma_f32_16x16x32_bf16 v[76:79], v[52:55], v[16:19], v[76:79]
  v_mfma_f32_16x16x32_bf16 v[80:83], v[56:59], v[16:19], v[80:83]
  v_mfma_f32_16x16x32_bf16 v[84:87], v[48:51], v[20:23], v[84:87]
  v_mfma_f32_16x16x32_bf16 v[88:91], v[52:55], v[20:23], v[88:91]
  v_mfma_f32_16x16x32_bf16 v[92:95], v[56:59], v[20:23], v[92:95]
  v_mfma_f32_16x16x32_bf16 v[96:99], v[48:51], v[24:27], v[96:99]
  v_mfma_f32_16x16x32_bf16 v[100:103], v[52:55], v[24:27], v[100:103]
  v_mfma_f32_16x16x32_bf16 v[104:107], v[56:59], v[24:27], v[104:107]
  v_mfma_f32_16x16x32_bf16 v[108:111], v[48:51], v[28:31], v[108:111]
  v_mfma_f32_16x16x32_bf16 v[112:115], v[52:55], v[28:31], v[112:115]
  v_mfma_f32_16x16x32_bf16 v[116:119], v[56:59], v[28:31], v[116:119]
  s_waitcnt lgkmcnt(0)
  v_mfma_f32_16x16x32_bf16 v[72:75], v[60:63], v[32:35], v[72:75]
  v_mfma_f32_16x16x32_bf16 v[76:79], v[64:67], v[32:35], v[76:79]
  v_mfma_f32_16x16x32_bf16 v[80:83], v[68:71], v[32:35], v[80:83]
  v_mfma_f32_16x16x32_bf16 v[84:87], v[60:63], v[36:39], v[84:87]
  v_mfma_f32_16x16x32_bf16 v[88:91], v[64:67], v[36:39], v[88:91]
  v_mfma_f32_16x16x32_bf16 v[92:95], v[68:71], v[36:39], v[92:95]
  v_mfma_f32_16x16x32_bf16 v[96:99], v[60:63], v[40:43], v[96:99]
  v_mfma_f32_16x16x32_bf16 v[100:103], v[64:67], v[40:43], v[100:103]
  v_mfma_f32_16x16x32_bf16 v[104:107], v[68:71], v[40:43], v[104:107]
  v_mfma_f32_16x16x32_bf16 v[108:111], v[60:63], v[44:47], v[108:111]
  v_mfma_f32_16x16x32_bf16 v[112:115], v[64:67], v[44:47], v[112:115]
  v_mfma_f32_16x16x32_bf16 v[116:119], v[68:71], v[44:47], v[116:119]
  s_waitcnt vmcnt(0)
  s_barrier
  ds_read_b128 v[16:19], v128 offset:0
  ds_read_b128 v[20:23], v128 offset:2048
  ds_read_b128 v[24:27], v128 offset:4096
  ds_read_b128 v[28:31], v128 offset:6144
  ds_read_b64_tr_b16 v[48:49], v134 offset:0
  ds_read_b64_tr_b16 v[50:51], v134 offset:512
  ds_read_b64_tr_b16 v[52:53], v135 offset:0
  ds_read_b64_tr_b16 v[54:55], v135 offset:512
  ds_read_b64_tr_b16 v[56:57], v136 offset:0
  ds_read_b64_tr_b16 v[58:59], v136 offset:512
  ds_read_b128 v[32:35], v129 offset:0
  ds_read_b128 v[36:39], v129 offset:2048
  ds_read_b128 v[40:43], v129 offset:4096
  ds_read_b128 v[44:47], v129 offset:6144
  ds_read_b64_tr_b16 v[60:61], v134 offset:4096
  ds_read_b64_tr_b16 v[62:63], v134 offset:4608
  ds_read_b64_tr_b16 v[64:65], v135 offset:4096
  ds_read_b64_tr_b16 v[66:67], v135 offset:4608
  ds_read_b64_tr_b16 v[68:69], v136 offset:4096
  ds_read_b64_tr_b16 v[70:71], v136 offset:4608
  s_waitcnt lgkmcnt(10)
  v_mfma_f32_16x16x32_bf16 v[72:75], v[48:51], v[16:19], v[72:75]
  v_mfma_f32_16x16x32_bf16 v[76:79], v[52:55], v[16:19], v[76:79]
  v_mfma_f32_16x16x32_bf16 v[80:83], v[56:59], v[16:19], v[80:83]
  v_mfma_f32_16x16x32_bf16 v[84:87], v[48:51], v[20:23], v[84:87]
  v_mfma_f32_16x16x32_bf16 v[88:91], v[52:55], v[20:23], v[88:91]
  v_mfma_f32_16x16x32_bf16 v[92:95], v[56:59], v[20:23], v[92:95]
  v_mfma_f32_16x16x32_bf16 v[96:99], v[48:51], v[24:27], v[96:99]
  v_mfma_f32_16x16x32_bf16 v[100:103], v[52:55], v[24:27], v[100:103]
  v_mfma_f32_16x16x32_bf16 v[104:107], v[56:59], v[24:27], v[104:107]
  v_mfma_f32_16x16x32_bf16 v[108:111], v[48:51], v[28:31], v[108:111]
  v_mfma_f32_16x16x32_bf16 v[112:115], v[52:55], v[28:31], v[112:115]
  v_mfma_f32_16x16x32_bf16 v[116:119], v[56:59], v[28:31], v[116:119]
  s_waitcnt lgkmcnt(0)
  v_mfma_f32_16x16x32_bf16 v[72:75], v[60:63], v[32:35], v[72:75]
  v_mfma_f32_16x16x32_bf16 v[76:79], v[64:67], v[32:35], v[76:79]
  v_mfma_f32_16x16x32_bf16 v[80:83], v[68:71], v[32:35], v[80:83]
  v_mfma_f32_16x16x32_bf16 v[84:87], v[60:63], v[36:39], v[84:87]
  v_mfma_f32_16x16x32_bf16 v[88:91], v[64:67], v[36:39], v[88:91]
  v_mfma_f32_16x16x32_bf16 v[92:95], v[68:71], v[36:39], v[92:95]
  v_mfma_f32_16x16x32_bf16 v[96:99], v[60:63], v[40:43], v[96:99]
  v_mfma_f32_16x16x32_bf16 v[100:103], v[64:67], v[40:43], v[100:103]
  v_mfma_f32_16x16x32_bf16 v[104:107], v[68:71], v[40:43], v[104:107]
  v_mfma_f32_16x16x32_bf16 v[108:111], v[60:63], v[44:47], v[108:111]
  v_mfma_f32_16x16x32_bf16 v[112:115], v[64:67], v[44:47], v[112:115]
  v_mfma_f32_16x16x32_bf16 v[116:119], v[68:71], v[44:47], v[116:119]
  s_nop 7
  s_nop 7
  v_cvt_pk_bf16_f32 v72, v72, v73
  v_cvt_pk_bf16_f32 v73, v74, v75
  buffer_store_dwordx2 v[72:73], v13, s[32:35], 0 offen offset:0
  v_cvt_pk_bf16_f32 v76, v76, v77
  v_cvt_pk_bf16_f32 v77, v78, v79
  buffer_store_dwordx2 v[76:77], v13, s[32:35], 0 offen offset:32
  v_cvt_pk_bf16_f32 v80, v80, v81
  v_cvt_pk_bf16_f32 v81, v82, v83
  buffer_store_dwordx2 v[80:81], v13, s[32:35], 0 offen offset:64
  v_add_u32 v13, 98304, v13
  v_cvt_pk_bf16_f32 v84, v84, v85
  v_cvt_pk_bf16_f32 v85, v86, v87
  buffer_store_dwordx2 v[84:85], v13, s[32:35], 0 offen offset:0
  v_cvt_pk_bf16_f32 v88, v88, v89
  v_cvt_pk_bf16_f32 v89, v90, v91
  buffer_store_dwordx2 v[88:89], v13, s[32:35], 0 offen offset:32
  v_cvt_pk_bf16_f32 v92, v92, v93
  v_cvt_pk_bf16_f32 v93, v94, v95
  buffer_store_dwordx2 v[92:93], v13, s[32:35], 0 offen offset:64
  v_add_u32 v13, 98304, v13
  v_cvt_pk_bf16_f32 v96, v96, v97
  v_cvt_pk_bf16_f32 v97, v98, v99
  buffer_store_dwordx2 v[96:97], v13, s[32:35], 0 offen offset:0
  v_cvt_pk_bf16_f32 v100, v100, v101
  v_cvt_pk_bf16_f32 v101, v102, v103
  buffer_store_dwordx2 v[100:101], v13, s[32:35], 0 offen offset:32
  v_cvt_pk_bf16_f32 v104, v104, v105
  v_cvt_pk_bf16_f32 v105, v106, v107
  buffer_store_dwordx2 v[104:105], v13, s[32:35], 0 offen offset:64
  v_add_u32 v13, 98304, v13
  v_cvt_pk_bf16_f32 v108, v108, v109
  v_cvt_pk_bf16_f32 v109, v110, v111
  buffer_store_dwordx2 v[108:109], v13, s[32:35], 0 offen offset:0
  v_cvt_pk_bf16_f32 v112, v112, v113
  v_cvt_pk_bf16_f32 v113, v114, v115
  buffer_store_dwordx2 v[112:113], v13, s[32:35], 0 offen offset:32
  v_cvt_pk_bf16_f32 v116, v116, v117
  v_cvt_pk_bf16_f32 v117, v118, v119
  buffer_store_dwordx2 v[116:117], v13, s[32:35], 0 offen offset:64
L_gemmq1_kernel_end:
  s_endpgm
.globl slide1_kernel
.p2align 8
.type slide1_kernel,@function
slide1_kernel:
  s_cmp_ge_u32 s2, 256
  s_cbranch_scc1 L_slide1_kernel_end
  s_load_dwordx16 s[4:19], s[0:1], 0
  s_load_dwordx2 s[20:21], s[0:1], 64
  s_waitcnt lgkmcnt(0)
  s_add_u32 s24, s20, 4194304
  s_addc_u32 s25, s21, 0
  s_and_b32 s25, s25, 0xffff
  s_mov_b32 s26, 12582912
  s_mov_b32 s27, 0x00020000
  s_add_u32 s32, s20, 16777216
  s_addc_u32 s33, s21, 0
  s_and_b32 s33, s33, 0xffff
  s_mov_b32 s34, 4194304
  s_mov_b32 s35, 0x00020000
  s_lshr_b32 s40, s2, 3
  v_and_b32 v1, 63, v0
  v_lshrrev_b32 v2, 6, v0
  s_nop 0
  v_readfirstlane_b32 s41, v2
  s_and_b32 s3, s2, 7
  s_lshl_b32 s3, s3, 2
  s_add_u32 s41, s41, s3
  s_lshl_b32 s41, s41, 6
  s_lshl_b32 s43, s40, 6
  v_and_b32 v3, 15, v1
  v_lshrrev_b32 v4, 4, v1
  v_mul_u32_u24 v5, 6144, v3
  v_lshl_add_u32 v5, v4, 4, v5
  v_lshrrev_b32 v6, 2, v1
  v_and_b32 v7, 3, v1
  v_mul_u32_u24 v8, 6144, v6
  v_lshl_add_u32 v8, v7, 4, v8
  v_lshlrev_b32 v9, 6, v6
  v_lshl_add_u32 v9, v7, 4, v9
  v_lshl_add_u32 v9, v2, 11, v9
  v_lshlrev_b32 v10, 2, v4
  v_bfe_u32 v11, v1, 2, 2
  v_add_u32 v10, v10, v11
  v_lshlrev_b32 v10, 6, v10
  v_lshl_add_u32 v10, v7, 3, v10
  v_lshl_add_u32 v10, v2, 11, v10
  v_lshlrev_b32 v12, 2, v4
  v_sub_u32 v12, v3, v12
  s_mul_i32 s44, s41, 6144
  s_add_u32 s44, s44, s43
  buffer_load_dwordx4 v[16:19], v5, s[24:27], s44 offen
  s_add_u32 s44, s44, 98304
  buffer_load_dwordx4 v[20:23], v5, s[24:27], s44 offen
  s_add_u32 s44, s44, 98304
  buffer_load_dwordx4 v[24:27], v5, s[24:27], s44 offen
  s_add_u32 s44, s44, 98304
  buffer_load_dwordx4 v[28:31], v5, s[24:27], s44 offen
  s_add_u32 s44, s44, 98304
  v_mov_b32 v104, 0
  v_mov_b32 v105, 0
  v_mov_b32 v106, 0
  v_mov_b32 v107, 0
  v_mov_b32 v108, 0
  v_mov_b32 v109, 0
  v_mov_b32 v110, 0
  v_mov_b32 v111, 0
  v_mov_b32 v112, 0
  v_mov_b32 v113, 0
  v_mov_b32 v114, 0
  v_mov_b32 v115, 0
  v_mov_b32 v116, 0
  v_mov_b32 v117, 0
  v_mov_b32 v118, 0
  v_mov_b32 v119, 0
  v_mov_b32 v120, 0
  v_mov_b32 v121, 0
  v_mov_b32 v122, 0
  v_mov_b32 v123, 0
  v_mov_b32 v124, 0
  v_mov_b32 v125, 0
  v_mov_b32 v126, 0
  v_mov_b32 v127, 0
  v_mov_b32 v128, 0
  v_mov_b32 v129, 0
  v_mov_b32 v130, 0
  v_mov_b32 v131, 0
  v_mov_b32 v132, 0
  v_mov_b32 v133, 0
  v_mov_b32 v134, 0
  v_mov_b32 v135, 0
  v_mov_b32 v136, 0xff7fffff
  v_mov_b32 v140, 0
  v_mov_b32 v137, 0xff7fffff
  v_mov_b32 v141, 0
  v_mov_b32 v138, 0xff7fffff
  v_mov_b32 v142, 0
  v_mov_b32 v139, 0xff7fffff
  v_mov_b32 v143, 0
  s_sub_u32 s42, s41, 256
  s_max_i32 s42, s42, 0
  s_add_u32 s45, s41, 64
  s_mul_i32 s44, s42, 6144
  s_add_u32 s44, s44, s43
  s_add_u32 s46, s44, 2048
  buffer_load_dwordx4 v[32:35], v5, s[24:27], s46 offen
  s_add_u32 s46, s44, 100352
  buffer_load_dwordx4 v[36:39], v5, s[24:27], s46 offen
  s_add_u32 s46, s44, 4096
  buffer_load_dwordx4 v[40:43], v8, s[24:27], s46 offen
  s_add_u32 s46, s44, 102400
  buffer_load_dwordx4 v[44:47], v8, s[24:27], s46 offen
L_slide1_kernel_loop:
  s_sub_u32 s47, s41, s42
  v_add_u32 v13, s47, v12
  s_waitcnt vmcnt(0)
  ds_write_b128 v9, v[40:43]
  ds_write_b128 v9, v[44:47] offset:1024
  v_mfma_f32_16x16x32_bf16 v[48:51], v[32:35], v[16:19], 0
  v_mfma_f32_16x16x32_bf16 v[52:55], v[32:35], v[20:23], 0
  v_mfma_f32_16x16x32_bf16 v[56:59], v[32:35], v[24:27], 0
  v_mfma_f32_16x16x32_bf16 v[60:63], v[32:35], v[28:31], 0
  v_mfma_f32_16x16x32_bf16 v[64:67], v[36:39], v[16:19], 0
  v_mfma_f32_16x16x32_bf16 v[68:71], v[36:39], v[20:23], 0
  v_mfma_f32_16x16x32_bf16 v[72:75], v[36:39], v[24:27], 0
  v_mfma_f32_16x16x32_bf16 v[76:79], v[36:39], v[28:31], 0
  s_waitcnt lgkmcnt(0)
  ds_read_b64_tr_b16 v[96:97], v10 offset:0
  ds_read_b64_tr_b16 v[98:99], v10 offset:1024
  ds_read_b64_tr_b16 v[100:101], v10 offset:32
  ds_read_b64_tr_b16 v[102:103], v10 offset:1056
  s_mul_i32 s44, s42, 6144
  s_add_u32 s44, s44, 196608
  s_add_u32 s44, s44, s43
  s_add_u32 s46, s44, 2048
  buffer_load_dwordx4 v[32:35], v5, s[24:27], s46 offen
  s_add_u32 s46, s44, 100352
  buffer_load_dwordx4 v[36:39], v5, s[24:27], s46 offen
  s_add_u32 s46, s44, 4096
  buffer_load_dwordx4 v[40:43], v8, s[24:27], s46 offen
  s_add_u32 s46, s44, 102400
  buffer_load_dwordx4 v[44:47], v8, s[24:27], s46 offen
  s_nop 7
  v_cvt_pk_bf16_f32 v48, v48, v48
  v_and_b32 v48, 0xffff0000, v48
  v_mul_f32 v48, 0x3e3504f3, v48
  v_cvt_pk_bf16_f32 v48, v48, v48
  v_and_b32 v48, 0xffff0000, v48
  v_add_u32 v148, 0, v13
  v_cmp_gt_u32 vcc, 256, v148
  v_mov_b32 v149, 0xce6e6b28
  s_nop 0
  v_cndmask_b32 v48, v149, v48, vcc
  v_cvt_pk_bf16_f32 v49, v49, v49
  v_and_b32 v49, 0xffff0000, v49
  v_mul_f32 v49, 0x3e3504f3, v49
  v_cvt_pk_bf16_f32 v49, v49, v49
  v_and_b32 v49, 0xffff0000, v49
  v_add_u32 v148, 4294967295, v13
  v_cmp_gt_u32 vcc, 256, v148
  v_mov_b32 v149, 0xce6e6b28
  s_nop 0
  v_cndmask_b32 v49, v149, v49, vcc
  v_cvt_pk_bf16_f32 v50, v50, v50
  v_and_b32 v50, 0xffff0000, v50
  v_mul_f32 v50, 0x3e3504f3, v50
  v_cvt_pk_bf16_f32 v50, v50, v50
  v_and_b32 v50, 0xffff0000, v50
  v_add_u32 v148, 4294967294, v13
  v_cmp_gt_u32 vcc, 256, v148
  v_mov_b32 v149, 0xce6e6b28
  s_nop 0
  v_cndmask_b32 v50, v149, v50, vcc
  v_cvt_pk_bf16_f32 v51, v51, v51
  v_and_b32 v51, 0xffff0000, v51
  v_mul_f32 v51, 0x3e3504f3, v51
  v_cvt_pk_bf16_f32 v51, v51, v51
  v_and_b32 v51, 0xffff0000, v51
  v_add_u32 v148, 4294967293, v13
  v_cmp_gt_u32 vcc, 256, v148
  v_mov_b32 v149, 0xce6e6b28
  s_nop 0
  v_cndmask_b32 v51, v149, v51, vcc
  v_cvt_pk_bf16_f32 v64, v64, v64
  v_and_b32 v64, 0xffff0000, v64
  v_mul_f32 v64, 0x3e3504f3, v64
  v_cvt_pk_bf16_f32 v64, v64, v64
  v_and_b32 v64, 0xffff0000, v64
  v_add_u32 v148, 4294967280, v13
  v_cmp_gt_u32 vcc, 256, v148
  v_mov_b32 v149, 0xce6e6b28
  s_nop 0
  v_cndmask_b32 v64, v149, v64, vcc
  v_cvt_pk_bf16_f32 v65, v65, v65
  v_and_b32 v65, 0xffff0000, v65
  v_mul_f32 v65, 0x3e3504f3, v65
  v_cvt_pk_bf16_f32 v65, v65, v65
  v_and_b32 v65, 0xffff0000, v65
  v_add_u32 v148, 4294967279, v13
  v_cmp_gt_u32 vcc, 256, v148
  v_mov_b32 v149, 0xce6e6b28
  s_nop 0
  v_cndmask_b32 v65, v149, v65, vcc
  v_cvt_pk_bf16_f32 v66, v66, v66
  v_and_b32 v66, 0xffff0000, v66
  v_mul_f32 v66, 0x3e3504f3, v66
  v_cvt_pk_bf16_f32 v66, v66, v66
  v_and_b32 v66, 0xffff0000, v66
  v_add_u32 v148, 4294967278, v13
  v_cmp_gt_u32 vcc, 256, v148
  v_mov_b32 v149, 0xce6e6b28
  s_nop 0
  v_cndmask_b32 v66, v149, v66, vcc
  v_cvt_pk_bf16_f32 v67, v67, v67
  v_and_b32 v67, 0xffff0000, v67
  v_mul_f32 v67, 0x3e3504f3, v67
  v_cvt_pk_bf16_f32 v67, v67, v67
  v_and_b32 v67, 0xffff0000, v67
  v_add_u32 v148, 4294967277, v13
  v_cmp_gt_u32 vcc, 256, v148
  v_mov_b32 v149, 0xce6e6b28
  s_nop 0
  v_cndmask_b32 v67, v149, v67, vcc
  v_max_f32 v150, v48, v49
  v_max_f32 v150, v150, v50
  v_max_f32 v150, v150, v51
  v_max_f32 v150, v150, v64
  v_max_f32 v150, v150, v65
  v_max_f32 v150, v150, v66
  v_max_f32 v150, v150, v67
  v_mov_b32 v151, v150
  s_nop 1
  v_permlane32_swap_b32 v150, v151
  s_nop 1
  v_max_f32 v150, v150, v151
  v_mov_b32 v151, v150
  s_nop 1
  v_permlane16_swap_b32 v150, v151
  s_nop 1
  v_max_f32 v150, v150, v151
  v_max_f32 v150, v150, v136
  v_sub_f32 v151, v136, v150
  v_mul_f32 v151, 0x3fb8aa3b, v151
  v_exp_f32 v151, v151
  v_mov_b32 v136, v150
  v_mul_f32 v152, v140, v151
  v_sub_f32 v48, v48, v150
  v_mul_f32 v48, 0x3fb8aa3b, v48
  v_exp_f32 v48, v48
  s_nop 0
  v_add_f32 v152, v152, v48
  v_sub_f32 v49, v49, v150
  v_mul_f32 v49, 0x3fb8aa3b, v49
  v_exp_f32 v49, v49
  s_nop 0
  v_add_f32 v152, v152, v49
  v_sub_f32 v50, v50, v150
  v_mul_f32 v50, 0x3fb8aa3b, v50
  v_exp_f32 v50, v50
  s_nop 0
  v_add_f32 v152, v152, v50
  v_sub_f32 v51, v51, v150
  v_mul_f32 v51, 0x3fb8aa3b, v51
  v_exp_f32 v51, v51
  s_nop 0
  v_add_f32 v152, v152, v51
  v_sub_f32 v64, v64, v150
  v_mul_f32 v64, 0x3fb8aa3b, v64
  v_exp_f32 v64, v64
  s_nop 0
  v_add_f32 v152, v152, v64
  v_sub_f32 v65, v65, v150
  v_mul_f32 v65, 0x3fb8aa3b, v65
  v_exp_f32 v65, v65
  s_nop 0
  v_add_f32 v152, v152, v65
  v_sub_f32 v66, v66, v150
  v_mul_f32 v66, 0x3fb8aa3b, v66
  v_exp_f32 v66, v66
  s_nop 0
  v_add_f32 v152, v152, v66
  v_sub_f32 v67, v67, v150
  v_mul_f32 v67, 0x3fb8aa3b, v67
  v_exp_f32 v67, v67
  s_nop 0
  v_add_f32 v152, v152, v67
  v_mov_b32 v140, v152
  v_cvt_pk_bf16_f32 v80, v48, v49
  v_cvt_pk_bf16_f32 v81, v50, v51
  v_cvt_pk_bf16_f32 v82, v64, v65
  v_cvt_pk_bf16_f32 v83, v66, v67
  v_mul_f32 v104, v104, v151
  v_mul_f32 v105, v105, v151
  v_mul_f32 v106, v106, v151
  v_mul_f32 v107, v107, v151
  v_mul_f32 v120, v120, v151
  v_mul_f32 v121, v121, v151
  v_mul_f32 v122, v122, v151
  v_mul_f32 v123, v123, v151
  v_cvt_pk_bf16_f32 v52, v52, v52
  v_and_b32 v52, 0xffff0000, v52
  v_mul_f32 v52, 0x3e3504f3, v52
  v_cvt_pk_bf16_f32 v52, v52, v52
  v_and_b32 v52, 0xffff0000, v52
  v_add_u32 v148, 16, v13
  v_cmp_gt_u32 vcc, 256, v148
  v_mov_b32 v149, 0xce6e6b28
  s_nop 0
  v_cndmask_b32 v52, v149, v52, vcc
  v_cvt_pk_bf16_f32 v53, v53, v53
  v_and_b32 v53, 0xffff0000, v53
  v_mul_f32 v53, 0x3e3504f3, v53
  v_cvt_pk_bf16_f32 v53, v53, v53
  v_and_b32 v53, 0xffff0000, v53
  v_add_u32 v148, 15, v13
  v_cmp_gt_u32 vcc, 256, v148
  v_mov_b32 v149, 0xce6e6b28
  s_nop 0
  v_cndmask_b32 v53, v149, v53, vcc
  v_cvt_pk_bf16_f32 v54, v54, v54
  v_and_b32 v54, 0xffff0000, v54
  v_mul_f32 v54, 0x3e3504f3, v54
  v_cvt_pk_bf16_f32 v54, v54, v54
  v_and_b32 v54, 0xffff0000, v54
  v_add_u32 v148, 14, v13
  v_cmp_gt_u32 vcc, 256, v148
  v_mov_b32 v149, 0xce6e6b28
  s_nop 0
  v_cndmask_b32 v54, v149, v54, vcc
  v_cvt_pk_bf16_f32 v55, v55, v55
  v_and_b32 v55, 0xffff0000, v55
  v_mul_f32 v55, 0x3e3504f3, v55
  v_cvt_pk_bf16_f32 v55, v55, v55
  v_and_b32 v55, 0xffff0000, v55
  v_add_u32 v148, 13, v13
  v_cmp_gt_u32 vcc, 256, v148
  v_mov_b32 v149, 0xce6e6b28
  s_nop 0
  v_cndmask_b32 v55, v149, v55, vcc
  v_cvt_pk_bf16_f32 v68, v68, v68
  v_and_b32 v68, 0xffff0000, v68
  v_mul_f32 v68, 0x3e3504f3, v68
  v_cvt_pk_bf16_f32 v68, v68, v68
  v_and_b32 v68, 0xffff0000, v68
  v_add_u32 v148, 0, v13
  v_cmp_gt_u32 vcc, 256, v148
  v_mov_b32 v149, 0xce6e6b28
  s_nop 0
  v_cndmask_b32 v68, v149, v68, vcc
  v_cvt_pk_bf16_f32 v69, v69, v69
  v_and_b32 v69, 0xffff0000, v69
  v_mul_f32 v69, 0x3e3504f3, v69
  v_cvt_pk_bf16_f32 v69, v69, v69
  v_and_b32 v69, 0xffff0000, v69
  v_add_u32 v148, 4294967295, v13
  v_cmp_gt_u32 vcc, 256, v148
  v_mov_b32 v149, 0xce6e6b28
  s_nop 0
  v_cndmask_b32 v69, v149, v69, vcc
  v_cvt_pk_bf16_f32 v70, v70, v70
  v_and_b32 v70, 0xffff0000, v70
  v_mul_f32 v70, 0x3e3504f3, v70
  v_cvt_pk_bf16_f32 v70, v70, v70
  v_and_b32 v70, 0xffff0000, v70
  v_add_u32 v148, 4294967294, v13
  v_cmp_gt_u32 vcc, 256, v148
  v_mov_b32 v149, 0xce6e6b28
  s_nop 0
  v_cndmask_b32 v70, v149, v70, vcc
  v_cvt_pk_bf16_f32 v71, v71, v71
  v_and_b32 v71, 0xffff0000, v71
  v_mul_f32 v71, 0x3e3504f3, v71
  v_cvt_pk_bf16_f32 v71, v71, v71
  v_and_b32 v71, 0xffff0000, v71
  v_add_u32 v148, 4294967293, v13
  v_cmp_gt_u32 vcc, 256, v148
  v_mov_b32 v149, 0xce6e6b28
  s_nop 0
  v_cndmask_b32 v71, v149, v71, vcc
  v_max_f32 v150, v52, v53
  v_max_f32 v150, v150, v54
  v_max_f32 v150, v150, v55
  v_max_f32 v150, v150, v68
  v_max_f32 v150, v150, v69
  v_max_f32 v150, v150, v70
  v_max_f32 v150, v150, v71
  v_mov_b32 v151, v150
  s_nop 1
  v_permlane32_swap_b32 v150, v151
  s_nop 1
  v_max_f32 v150, v150, v151
  v_mov_b32 v151, v150
  s_nop 1
  v_permlane16_swap_b32 v150, v151
  s_nop 1
  v_max_f32 v150, v150, v151
  v_max_f32 v150, v150, v137
  v_sub_f32 v151, v137, v150
  v_mul_f32 v151, 0x3fb8aa3b, v151
  v_exp_f32 v151, v151
  v_mov_b32 v137, v150
  v_mul_f32 v152, v141, v151
  v_sub_f32 v52, v52, v150
  v_mul_f32 v52, 0x3fb8aa3b, v52
  v_exp_f32 v52, v52
  s_nop 0
  v_add_f32 v152, v152, v52
  v_sub_f32 v53, v53, v150
  v_mul_f32 v53, 0x3fb8aa3b, v53
  v_exp_f32 v53, v53
  s_nop 0
  v_add_f32 v152, v152, v53
  v_sub_f32 v54, v54, v150
  v_mul_f32 v54, 0x3fb8aa3b, v54
  v_exp_f32 v54, v54
  s_nop 0
  v_add_f32 v152, v152, v54
  v_sub_f32 v55, v55, v150
  v_mul_f32 v55, 0x3fb8aa3b, v55
  v_exp_f32 v55, v55
  s_nop 0
  v_add_f32 v152, v152, v55
  v_sub_f32 v68, v68, v150
  v_mul_f32 v68, 0x3fb8aa3b, v68
  v_exp_f32 v68, v68
  s_nop 0
  v_add_f32 v152, v152, v68
  v_sub_f32 v69, v69, v150
  v_mul_f32 v69, 0x3fb8aa3b, v69
  v_exp_f32 v69, v69
  s_nop 0
  v_add_f32 v152, v152, v69
  v_sub_f32 v70, v70, v150
  v_mul_f32 v70, 0x3fb8aa3b, v70
  v_exp_f32 v70, v70
  s_nop 0
  v_add_f32 v152, v152, v70
  v_sub_f32 v71, v71, v150
  v_mul_f32 v71, 0x3fb8aa3b, v71
  v_exp_f32 v71, v71
  s_nop 0
  v_add_f32 v152, v152, v71
  v_mov_b32 v141, v152
  v_cvt_pk_bf16_f32 v84, v52, v53
  v_cvt_pk_bf16_f32 v85, v54, v55
  v_cvt_pk_bf16_f32 v86, v68, v69
  v_cvt_pk_bf16_f32 v87, v70, v71
  v_mul_f32 v108, v108, v151
  v_mul_f32 v109, v109, v151
  v_mul_f32 v110, v110, v151
  v_mul_f32 v111, v111, v151
  v_mul_f32 v124, v124, v151
  v_mul_f32 v125, v125, v151
  v_mul_f32 v126, v126, v151
  v_mul_f32 v127, v127, v151
  v_cvt_pk_bf16_f32 v56, v56, v56
  v_and_b32 v56, 0xffff0000, v56
  v_mul_f32 v56, 0x3e3504f3, v56
  v_cvt_pk_bf16_f32 v56, v56, v56
  v_and_b32 v56, 0xffff0000, v56
  v_add_u32 v148, 32, v13
  v_cmp_gt_u32 vcc, 256, v148
  v_mov_b32 v149, 0xce6e6b28
  s_nop 0
  v_cndmask_b32 v56, v149, v56, vcc
  v_cvt_pk_bf16_f32 v57, v57, v57
  v_and_b32 v57, 0xffff0000, v57
  v_mul_f32 v57, 0x3e3504f3, v57
  v_cvt_pk_bf16_f32 v57, v57, v57
  v_and_b32 v57, 0xffff0000, v57
  v_add_u32 v148, 31, v13
  v_cmp_gt_u32 vcc, 256, v148
  v_mov_b32 v149, 0xce6e6b28
  s_nop 0
  v_cndmask_b32 v57, v149, v57, vcc
  v_cvt_pk_bf16_f32 v58, v58, v58
  v_and_b32 v58, 0xffff0000, v58
  v_mul_f32 v58, 0x3e3504f3, v58
  v_cvt_pk_bf16_f32 v58, v58, v58
  v_and_b32 v58, 0xffff0000, v58
  v_add_u32 v148, 30, v13
  v_cmp_gt_u32 vcc, 256, v148
  v_mov_b32 v149, 0xce6e6b28
  s_nop 0
  v_cndmask_b32 v58, v149, v58, vcc
  v_cvt_pk_bf16_f32 v59, v59, v59
  v_and_b32 v59, 0xffff0000, v59
  v_mul_f32 v59, 0x3e3504f3, v59
  v_cvt_pk_bf16_f32 v59, v59, v59
  v_and_b32 v59, 0xffff0000, v59
  v_add_u32 v148, 29, v13
  v_cmp_gt_u32 vcc, 256, v148
  v_mov_b32 v149, 0xce6e6b28
  s_nop 0
  v_cndmask_b32 v59, v149, v59, vcc
  v_cvt_pk_bf16_f32 v72, v72, v72
  v_and_b32 v72, 0xffff0000, v72
  v_mul_f32 v72, 0x3e3504f3, v72
  v_cvt_pk_bf16_f32 v72, v72, v72
  v_and_b32 v72, 0xffff0000, v72
  v_add_u32 v148, 16, v13
  v_cmp_gt_u32 vcc, 256, v148
  v_mov_b32 v149, 0xce6e6b28
  s_nop 0
  v_cndmask_b32 v72, v149, v72, vcc
  v_cvt_pk_bf16_f32 v73, v73, v73
  v_and_b32 v73, 0xffff0000, v73
  v_mul_f32 v73, 0x3e3504f3, v73
  v_cvt_pk_bf16_f32 v73, v73, v73
  v_and_b32 v73, 0xffff0000, v73
  v_add_u32 v148, 15, v13
  v_cmp_gt_u32 vcc, 256, v148
  v_mov_b32 v149, 0xce6e6b28
  s_nop 0
  v_cndmask_b32 v73, v149, v73, vcc
  v_cvt_pk_bf16_f32 v74, v74, v74
  v_and_b32 v74, 0xffff0000, v74
  v_mul_f32 v74, 0x3e3504f3, v74
  v_cvt_pk_bf16_f32 v74, v74, v74
  v_and_b32 v74, 0xffff0000, v74
  v_add_u32 v148, 14, v13
  v_cmp_gt_u32 vcc, 256, v148
  v_mov_b32 v149, 0xce6e6b28
  s_nop 0
  v_cndmask_b32 v74, v149, v74, vcc
  v_cvt_pk_bf16_f32 v75, v75, v75
  v_and_b32 v75, 0xffff0000, v75
  v_mul_f32 v75, 0x3e3504f3, v75
  v_cvt_pk_bf16_f32 v75, v75, v75
  v_and_b32 v75, 0xffff0000, v75
  v_add_u32 v148, 13, v13
  v_cmp_gt_u32 vcc, 256, v148
  v_mov_b32 v149, 0xce6e6b28
  s_nop 0
  v_cndmask_b32 v75, v149, v75, vcc
  v_max_f32 v150, v56, v57
  v_max_f32 v150, v150, v58
  v_max_f32 v150, v150, v59
  v_max_f32 v150, v150, v72
  v_max_f32 v150, v150, v73
  v_max_f32 v150, v150, v74
  v_max_f32 v150, v150, v75
  v_mov_b32 v151, v150
  s_nop 1
  v_permlane32_swap_b32 v150, v151
  s_nop 1
  v_max_f32 v150, v150, v151
  v_mov_b32 v151, v150
  s_nop 1
  v_permlane16_swap_b32 v150, v151
  s_nop 1
  v_max_f32 v150, v150, v151
  v_max_f32 v150, v150, v138
  v_sub_f32 v151, v138, v150
  v_mul_f32 v151, 0x3fb8aa3b, v151
  v_exp_f32 v151, v151
  v_mov_b32 v138, v150
  v_mul_f32 v152, v142, v151
  v_sub_f32 v56, v56, v150
  v_mul_f32 v56, 0x3fb8aa3b, v56
  v_exp_f32 v56, v56
  s_nop 0
  v_add_f32 v152, v152, v56
  v_sub_f32 v57, v57, v150
  v_mul_f32 v57, 0x3fb8aa3b, v57
  v_exp_f32 v57, v57
  s_nop 0
  v_add_f32 v152, v152, v57
  v_sub_f32 v58, v58, v150
  v_mul_f32 v58, 0x3fb8aa3b, v58
  v_exp_f32 v58, v58
  s_nop 0
  v_add_f32 v152, v152, v58
  v_sub_f32 v59, v59, v150
  v_mul_f32 v59, 0x3fb8aa3b, v59
  v_exp_f32 v59, v59
  s_nop 0
  v_add_f32 v152, v152, v59
  v_sub_f32 v72, v72, v150
  v_mul_f32 v72, 0x3fb8aa3b, v72
  v_exp_f32 v72, v72
  s_nop 0
  v_add_f32 v152, v152, v72
  v_sub_f32 v73, v73, v150
  v_mul_f32 v73, 0x3fb8aa3b, v73
  v_exp_f32 v73, v73
  s_nop 0
  v_add_f32 v152, v152, v73
  v_sub_f32 v74, v74, v150
  v_mul_f32 v74, 0x3fb8aa3b, v74
  v_exp_f32 v74, v74
  s_nop 0
  v_add_f32 v152, v152, v74
  v_sub_f32 v75, v75, v150
  v_mul_f32 v75, 0x3fb8aa3b, v75
  v_exp_f32 v75, v75
  s_nop 0
  v_add_f32 v152, v152, v75
  v_mov_b32 v142, v152
  v_cvt_pk_bf16_f32 v88, v56, v57
  v_cvt_pk_bf16_f32 v89, v58, v59
  v_cvt_pk_bf16_f32 v90, v72, v73
  v_cvt_pk_bf16_f32 v91, v74, v75
  v_mul_f32 v112, v112, v151
  v_mul_f32 v113, v113, v151
  v_mul_f32 v114, v114, v151
  v_mul_f32 v115, v115, v151
  v_mul_f32 v128, v128, v151
  v_mul_f32 v129, v129, v151
  v_mul_f32 v130, v130, v151
  v_mul_f32 v131, v131, v151
  v_cvt_pk_bf16_f32 v60, v60, v60
  v_and_b32 v60, 0xffff0000, v60
  v_mul_f32 v60, 0x3e3504f3, v60
  v_cvt_pk_bf16_f32 v60, v60, v60
  v_and_b32 v60, 0xffff0000, v60
  v_add_u32 v148, 48, v13
  v_cmp_gt_u32 vcc, 256, v148
  v_mov_b32 v149, 0xce6e6b28
  s_nop 0
  v_cndmask_b32 v60, v149, v60, vcc
  v_cvt_pk_bf16_f32 v61, v61, v61
  v_and_b32 v61, 0xffff0000, v61
  v_mul_f32 v61, 0x3e3504f3, v61
  v_cvt_pk_bf16_f32 v61, v61, v61
  v_and_b32 v61, 0xffff0000, v61
  v_add_u32 v148, 47, v13
  v_cmp_gt_u32 vcc, 256, v148
  v_mov_b32 v149, 0xce6e6b28
  s_nop 0
  v_cndmask_b32 v61, v149, v61, vcc
  v_cvt_pk_bf16_f32 v62, v62, v62
  v_and_b32 v62, 0xffff0000, v62
  v_mul_f32 v62, 0x3e3504f3, v62
  v_cvt_pk_bf16_f32 v62, v62, v62
  v_and_b32 v62, 0xffff0000, v62
  v_add_u32 v148, 46, v13
  v_cmp_gt_u32 vcc, 256, v148
  v_mov_b32 v149, 0xce6e6b28
  s_nop 0
  v_cndmask_b32 v62, v149, v62, vcc
  v_cvt_pk_bf16_f32 v63, v63, v63
  v_and_b32 v63, 0xffff0000, v63
  v_mul_f32 v63, 0x3e3504f3, v63
  v_cvt_pk_bf16_f32 v63, v63, v63
  v_and_b32 v63, 0xffff0000, v63
  v_add_u32 v148, 45, v13
  v_cmp_gt_u32 vcc, 256, v148
  v_mov_b32 v149, 0xce6e6b28
  s_nop 0
  v_cndmask_b32 v63, v149, v63, vcc
  v_cvt_pk_bf16_f32 v76, v76, v76
  v_and_b32 v76, 0xffff0000, v76
  v_mul_f32 v76, 0x3e3504f3, v76
  v_cvt_pk_bf16_f32 v76, v76, v76
  v_and_b32 v76, 0xffff0000, v76
  v_add_u32 v148, 32, v13
  v_cmp_gt_u32 vcc, 256, v148
  v_mov_b32 v149, 0xce6e6b28
  s_nop 0
  v_cndmask_b32 v76, v149, v76, vcc
  v_cvt_pk_bf16_f32 v77, v77, v77
  v_and_b32 v77, 0xffff0000, v77
  v_mul_f32 v77, 0x3e3504f3, v77
  v_cvt_pk_bf16_f32 v77, v77, v77
  v_and_b32 v77, 0xffff0000, v77
  v_add_u32 v148, 31, v13
  v_cmp_gt_u32 vcc, 256, v148
  v_mov_b32 v149, 0xce6e6b28
  s_nop 0
  v_cndmask_b32 v77, v149, v77, vcc
  v_cvt_pk_bf16_f32 v78, v78, v78
  v_and_b32 v78, 0xffff0000, v78
  v_mul_f32 v78, 0x3e3504f3, v78
  v_cvt_pk_bf16_f32 v78, v78, v78
  v_and_b32 v78, 0xffff0000, v78
  v_add_u32 v148, 30, v13
  v_cmp_gt_u32 vcc, 256, v148
  v_mov_b32 v149, 0xce6e6b28
  s_nop 0
  v_cndmask_b32 v78, v149, v78, vcc
  v_cvt_pk_bf16_f32 v79, v79, v79
  v_and_b32 v79, 0xffff0000, v79
  v_mul_f32 v79, 0x3e3504f3, v79
  v_cvt_pk_bf16_f32 v79, v79, v79
  v_and_b32 v79, 0xffff0000, v79
  v_add_u32 v148, 29, v13
  v_cmp_gt_u32 vcc, 256, v148
  v_mov_b32 v149, 0xce6e6b28
  s_nop 0
  v_cndmask_b32 v79, v149, v79, vcc
  v_max_f32 v150, v60, v61
  v_max_f32 v150, v150, v62
  v_max_f32 v150, v150, v63
  v_max_f32 v150, v150, v76
  v_max_f32 v150, v150, v77
  v_max_f32 v150, v150, v78
  v_max_f32 v150, v150, v79
  v_mov_b32 v151, v150
  s_nop 1
  v_permlane32_swap_b32 v150, v151
  s_nop 1
  v_max_f32 v150, v150, v151
  v_mov_b32 v151, v150
  s_nop 1
  v_permlane16_swap_b32 v150, v151
  s_nop 1
  v_max_f32 v150, v150, v151
  v_max_f32 v150, v150, v139
  v_sub_f32 v151, v139, v150
  v_mul_f32 v151, 0x3fb8aa3b, v151
  v_exp_f32 v151, v151
  v_mov_b32 v139, v150
  v_mul_f32 v152, v143, v151
  v_sub_f32 v60, v60, v150
  v_mul_f32 v60, 0x3fb8aa3b, v60
  v_exp_f32 v60, v60
  s_nop 0
  v_add_f32 v152, v152, v60
  v_sub_f32 v61, v61, v150
  v_mul_f32 v61, 0x3fb8aa3b, v61
  v_exp_f32 v61, v61
  s_nop 0
  v_add_f32 v152, v152, v61
  v_sub_f32 v62, v62, v150
  v_mul_f32 v62, 0x3fb8aa3b, v62
  v_exp_f32 v62, v62
  s_nop 0
  v_add_f32 v152, v152, v62
  v_sub_f32 v63, v63, v150
  v_mul_f32 v63, 0x3fb8aa3b, v63
  v_exp_f32 v63, v63
  s_nop 0
  v_add_f32 v152, v152, v63
  v_sub_f32 v76, v76, v150
  v_mul_f32 v76, 0x3fb8aa3b, v76
  v_exp_f32 v76, v76
  s_nop 0
  v_add_f32 v152, v152, v76
  v_sub_f32 v77, v77, v150
  v_mul_f32 v77, 0x3fb8aa3b, v77
  v_exp_f32 v77, v77
  s_nop 0
  v_add_f32 v152, v152, v77
  v_sub_f32 v78, v78, v150
  v_mul_f32 v78, 0x3fb8aa3b, v78
  v_exp_f32 v78, v78
  s_nop 0
  v_add_f32 v152, v152, v78
  v_sub_f32 v79, v79, v150
  v_mul_f32 v79, 0x3fb8aa3b, v79
  v_exp_f32 v79, v79
  s_nop 0
  v_add_f32 v152, v152, v79
  v_mov_b32 v143, v152
  v_cvt_pk_bf16_f32 v92, v60, v61
  v_cvt_pk_bf16_f32 v93, v62, v63
  v_cvt_pk_bf16_f32 v94, v76, v77
  v_cvt_pk_bf16_f32 v95, v78, v79
  v_mul_f32 v116, v116, v151
  v_mul_f32 v117, v117, v151
  v_mul_f32 v118, v118, v151
  v_mul_f32 v119, v119, v151
  v_mul_f32 v132, v132, v151
  v_mul_f32 v133, v133, v151
  v_mul_f32 v134, v134, v151
  v_mul_f32 v135, v135, v151
  s_waitcnt lgkmcnt(0)
  s_nop 1
  v_mfma_f32_16x16x32_bf16 v[104:107], v[96:99], v[80:83], v[104:107]
  v_mfma_f32_16x16x32_bf16 v[120:123], v[100:103], v[80:83], v[120:123]
  v_mfma_f32_16x16x32_bf16 v[108:111], v[96:99], v[84:87], v[108:111]
  v_mfma_f32_16x16x32_bf16 v[124:127], v[100:103], v[84:87], v[124:127]
  v_mfma_f32_16x16x32_bf16 v[112:115], v[96:99], v[88:91], v[112:115]
  v_mfma_f32_16x16x32_bf16 v[128:131], v[100:103], v[88:91], v[128:131]
  v_mfma_f32_16x16x32_bf16 v[116:119], v[96:99], v[92:95], v[116:119]
  v_mfma_f32_16x16x32_bf16 v[132:135], v[100:103], v[92:95], v[132:135]
  s_add_u32 s42, s42, 32
  s_cmp_lt_u32 s42, s45
  s_nop 7
  s_cbranch_scc1 L_slide1_kernel_loop
  s_nop 7
  v_add_u32 v14, s41, v3
  v_lshlrev_b32 v14, 11, v14
  v_lshl_add_u32 v14, v4, 3, v14
  v_add_u32 v14, s43, v14
  v_mov_b32 v151, v140
  s_nop 1
  v_permlane32_swap_b32 v140, v151
  s_nop 1
  v_add_f32 v140, v140, v151
  v_mov_b32 v151, v140
  s_nop 1
  v_permlane16_swap_b32 v140, v151
  s_nop 1
  v_add_f32 v140, v140, v151
  v_rcp_f32 v152, v140
  s_nop 0
  v_mul_f32 v153, v104, v152
  v_fma_f32 v154, -v153, v140, v104
  v_fma_f32 v104, v154, v152, v153
  v_mul_f32 v153, v105, v152
  v_fma_f32 v154, -v153, v140, v105
  v_fma_f32 v105, v154, v152, v153
  v_mul_f32 v153, v106, v152
  v_fma_f32 v154, -v153, v140, v106
  v_fma_f32 v106, v154, v152, v153
  v_mul_f32 v153, v107, v152
  v_fma_f32 v154, -v153, v140, v107
  v_fma_f32 v107, v154, v152, v153
  v_cvt_pk_bf16_f32 v104, v104, v105
  v_cvt_pk_bf16_f32 v105, v106, v107
  buffer_store_dwordx2 v[104:105], v14, s[32:35], 0 offen offset:0
  v_mul_f32 v153, v120, v152
  v_fma_f32 v154, -v153, v140, v120
  v_fma_f32 v120, v154, v152, v153
  v_mul_f32 v153, v121, v152
  v_fma_f32 v154, -v153, v140, v121
  v_fma_f32 v121, v154, v152, v153
  v_mul_f32 v153, v122, v152
  v_fma_f32 v154, -v153, v140, v122
  v_fma_f32 v122, v154, v152, v153
  v_mul_f32 v153, v123, v152
  v_fma_f32 v154, -v153, v140, v123
  v_fma_f32 v123, v154, v152, v153
  v_cvt_pk_bf16_f32 v120, v120, v121
  v_cvt_pk_bf16_f32 v121, v122, v123
  buffer_store_dwordx2 v[120:121], v14, s[32:35], 0 offen offset:32
  v_add_u32 v14, 32768, v14
  v_mov_b32 v151, v141
  s_nop 1
  v_permlane32_swap_b32 v141, v151
  s_nop 1
  v_add_f32 v141, v141, v151
  v_mov_b32 v151, v141
  s_nop 1
  v_permlane16_swap_b32 v141, v151
  s_nop 1
  v_add_f32 v141, v141, v151
  v_rcp_f32 v152, v141
  s_nop 0
  v_mul_f32 v153, v108, v152
  v_fma_f32 v154, -v153, v141, v108
  v_fma_f32 v108, v154, v152, v153
  v_mul_f32 v153, v109, v152
  v_fma_f32 v154, -v153, v141, v109
  v_fma_f32 v109, v154, v152, v153
  v_mul_f32 v153, v110, v152
  v_fma_f32 v154, -v153, v141, v110
  v_fma_f32 v110, v154, v152, v153
  v_mul_f32 v153, v111, v152
  v_fma_f32 v154, -v153, v141, v111
  v_fma_f32 v111, v154, v152, v153
  v_cvt_pk_bf16_f32 v108, v108, v109
  v_cvt_pk_bf16_f32 v109, v110, v111
  buffer_store_dwordx2 v[108:109], v14, s[32:35], 0 offen offset:0
  v_mul_f32 v153, v124, v152
  v_fma_f32 v154, -v153, v141, v124
  v_fma_f32 v124, v154, v152, v153
  v_mul_f32 v153, v125, v152
  v_fma_f32 v154, -v153, v141, v125
  v_fma_f32 v125, v154, v152, v153
  v_mul_f32 v153, v126, v152
  v_fma_f32 v154, -v153, v141, v126
  v_fma_f32 v126, v154, v152, v153
  v_mul_f32 v153, v127, v152
  v_fma_f32 v154, -v153, v141, v127
  v_fma_f32 v127, v154, v152, v153
  v_cvt_pk_bf16_f32 v124, v124, v125
  v_cvt_pk_bf16_f32 v125, v126, v127
  buffer_store_dwordx2 v[124:125], v14, s[32:35], 0 offen offset:32
  v_add_u32 v14, 32768, v14
  v_mov_b32 v151, v142
  s_nop 1
  v_permlane32_swap_b32 v142, v151
  s_nop 1
  v_add_f32 v142, v142, v151
  v_mov_b32 v151, v142
  s_nop 1
  v_permlane16_swap_b32 v142, v151
  s_nop 1
  v_add_f32 v142, v142, v151
  v_rcp_f32 v152, v142
  s_nop 0
  v_mul_f32 v153, v112, v152
  v_fma_f32 v154, -v153, v142, v112
  v_fma_f32 v112, v154, v152, v153
  v_mul_f32 v153, v113, v152
  v_fma_f32 v154, -v153, v142, v113
  v_fma_f32 v113, v154, v152, v153
  v_mul_f32 v153, v114, v152
  v_fma_f32 v154, -v153, v142, v114
  v_fma_f32 v114, v154, v152, v153
  v_mul_f32 v153, v115, v152
  v_fma_f32 v154, -v153, v142, v115
  v_fma_f32 v115, v154, v152, v153
  v_cvt_pk_bf16_f32 v112, v112, v113
  v_cvt_pk_bf16_f32 v113, v114, v115
  buffer_store_dwordx2 v[112:113], v14, s[32:35], 0 offen offset:0
  v_mul_f32 v153, v128, v152
  v_fma_f32 v154, -v153, v142, v128
  v_fma_f32 v128, v154, v152, v153
  v_mul_f32 v153, v129, v152
  v_fma_f32 v154, -v153, v142, v129
  v_fma_f32 v129, v154, v152, v153
  v_mul_f32 v153, v130, v152
  v_fma_f32 v154, -v153, v142, v130
  v_fma_f32 v130, v154, v152, v153
  v_mul_f32 v153, v131, v152
  v_fma_f32 v154, -v153, v142, v131
  v_fma_f32 v131, v154, v152, v153
  v_cvt_pk_bf16_f32 v128, v128, v129
  v_cvt_pk_bf16_f32 v129, v130, v131
  buffer_store_dwordx2 v[128:129], v14, s[32:35], 0 offen offset:32
  v_add_u32 v14, 32768, v14
  v_mov_b32 v151, v143
  s_nop 1
  v_permlane32_swap_b32 v143, v151
  s_nop 1
  v_add_f32 v143, v143, v151
  v_mov_b32 v151, v143
  s_nop 1
  v_permlane16_swap_b32 v143, v151
  s_nop 1
  v_add_f32 v143, v143, v151
  v_rcp_f32 v152, v143
  s_nop 0
  v_mul_f32 v153, v116, v152
  v_fma_f32 v154, -v153, v143, v116
  v_fma_f32 v116, v154, v152, v153
  v_mul_f32 v153, v117, v152
  v_fma_f32 v154, -v153, v143, v117
  v_fma_f32 v117, v154, v152, v153
  v_mul_f32 v153, v118, v152
  v_fma_f32 v154, -v153, v143, v118
  v_fma_f32 v118, v154, v152, v153
  v_mul_f32 v153, v119, v152
  v_fma_f32 v154, -v153, v143, v119
  v_fma_f32 v119, v154, v152, v153
  v_cvt_pk_bf16_f32 v116, v116, v117
  v_cvt_pk_bf16_f32 v117, v118, v119
  buffer_store_dwordx2 v[116:117], v14, s[32:35], 0 offen offset:0
  v_mul_f32 v153, v132, v152
  v_fma_f32 v154, -v153, v143, v132
  v_fma_f32 v132, v154, v152, v153
  v_mul_f32 v153, v133, v152
  v_fma_f32 v154, -v153, v143, v133
  v_fma_f32 v133, v154, v152, v153
  v_mul_f32 v153, v134, v152
  v_fma_f32 v154, -v153, v143, v134
  v_fma_f32 v134, v154, v152, v153
  v_mul_f32 v153, v135, v152
  v_fma_f32 v154, -v153, v143, v135
  v_fma_f32 v135, v154, v152, v153
  v_cvt_pk_bf16_f32 v132, v132, v133
  v_cvt_pk_bf16_f32 v133, v134, v135
  buffer_store_dwordx2 v[132:133], v14, s[32:35], 0 offen offset:32
L_slide1_kernel_end:
  s_endpgm
.globl gemmo1_kernel
.p2align 8
.type gemmo1_kernel,@function
gemmo1_kernel:
  s_cmp_ge_u32 s2, 256
  s_cbranch_scc1 L_gemmo1_kernel_end
  s_load_dwordx16 s[4:19], s[0:1], 0
  s_load_dwordx2 s[20:21], s[0:1], 64
  s_waitcnt lgkmcnt(0)
  s_add_u32 s24, s20, 16777216
  s_addc_u32 s25, s21, 0
  s_and_b32 s25, s25, 0xffff
  s_mov_b32 s26, 4194304
  s_mov_b32 s27, 0x00020000
  s_mov_b32 s28, s14
  s_and_b32 s29, s15, 0xffff
  s_mov_b32 s30, 2097152
  s_mov_b32 s31, 0x00020000
  s_add_u32 s32, s20, 25165824
  s_addc_u32 s33, s21, 0
  s_and_b32 s33, s33, 0xffff
  s_mov_b32 s34, 4194304
  s_mov_b32 s35, 0x00020000
  s_add_u32 s36, s20, 20971520
  s_addc_u32 s37, s21, 0
  s_and_b32 s37, s37, 0xffff
  s_mov_b32 s38, 4194304
  s_mov_b32 s39, 0x00020000
  s_mov_b32 s3, 268435457
  s_mul_hi_u32 s40, s2, s3
  s_mul_i32 s3, s40, 16
  s_sub_u32 s41, s2, s3
  v_and_b32 v1, 63, v0
  v_lshrrev_b32 v2, 6, v0
  s_nop 0
  v_readfirstlane_b32 s42, v2
  v_lshrrev_b32 v14, 3, v1
  v_and_b32 v15, 7, v1
  v_xor_b32 v3, v14, v15
  v_lshlrev_b32 v4, 11, v14
  v_lshl_add_u32 v4, v3, 4, v4
  v_bfe_u32 v3, v1, 4, 1
  v_and_b32 v5, 1, v2
  v_lshl_add_u32 v3, v5, 1, v3
  v_lshrrev_b32 v5, 1, v15
  v_xor_b32 v3, v3, v5
  v_lshlrev_b32 v3, 1, v3
  v_and_b32 v5, 1, v15
  v_or_b32 v3, v3, v5
  v_lshl_add_u32 v5, v2, 3, v14
  v_mul_u32_u24 v5, 2048, v5
  v_lshl_add_u32 v5, v3, 4, v5
  s_mul_i32 s44, s40, 262144
  s_lshl_b32 s3, s42, 14
  s_add_u32 s44, s44, s3
  s_add_u32 s45, s44, 131072
  s_mul_i32 s46, s41, 128
  s_lshl_b32 s43, s42, 10
  v_and_b32 v6, 1, v2
  v_lshrrev_b32 v7, 1, v2
  v_and_b32 v14, 15, v1
  v_lshrrev_b32 v15, 4, v1
  v_mul_u32_u24 v8, 32, v7
  v_add_u32 v8, v8, v14
  v_lshlrev_b32 v8, 7, v8
  v_and_b32 v3, 7, v1
  v_xor_b32 v3, v3, v15
  v_lshl_add_u32 v9, v3, 4, v8
  v_xor_b32 v3, 4, v3
  v_lshl_add_u32 v8, v3, 4, v8
  v_mov_b32 v3, v9
  v_mov_b32 v9, v8
  v_mov_b32 v8, v3
  v_bfe_u32 v3, v1, 2, 2
  v_lshl_add_u32 v10, v15, 3, v3
  v_lshlrev_b32 v10, 7, v10
  v_and_b32 v11, 3, v1
  v_lshl_add_u32 v10, v11, 3, v10
  v_lshrrev_b32 v3, 1, v3
  v_and_b32 v11, 1, v15
  v_lshl_add_u32 v3, v11, 1, v3
  v_mul_u32_u24 v11, 2, v6
  v_add_u32 v120, 0, v11
  v_and_b32 v121, 3, v120
  v_xor_b32 v121, v121, v3
  v_lshlrev_b32 v121, 5, v121
  v_lshrrev_b32 v120, 2, v120
  v_lshl_add_u32 v121, v120, 13, v121
  v_add_u32 v122, v10, v121
  v_add_u32 v122, 16384, v122
  v_add_u32 v120, 1, v11
  v_and_b32 v121, 3, v120
  v_xor_b32 v121, v121, v3
  v_lshlrev_b32 v121, 5, v121
  v_lshrrev_b32 v120, 2, v120
  v_lshl_add_u32 v121, v120, 13, v121
  v_add_u32 v123, v10, v121
  v_add_u32 v123, 16384, v123
  v_add_u32 v128, 0, v8
  v_add_u32 v129, 0, v9
  v_add_u32 v134, 0, v122
  v_add_u32 v135, 0, v123
  v_add_u32 v130, 24576, v8
  v_add_u32 v131, 24576, v9
  v_add_u32 v136, 24576, v122
  v_add_u32 v137, 24576, v123
  v_add_u32 v132, 49152, v8
  v_add_u32 v133, 49152, v9
  v_add_u32 v138, 49152, v122
  v_add_u32 v139, 49152, v123
  s_mul_i32 s3, s40, 128
  v_mul_u32_u24 v13, 32, v7
  v_add_u32 v13, v13, v14
  v_add_u32 v13, s3, v13
  v_mul_u32_u24 v13, 2048, v13
  s_mul_i32 s3, s41, 128
  v_mul_u32_u24 v3, 64, v6
  v_add_u32 v13, v13, v3
  v_lshl_add_u32 v13, v15, 3, v13
  v_add_u32 v13, s3, v13
  v_mov_b32 v72, 0
  v_mov_b32 v73, 0
  v_mov_b32 v74, 0
  v_mov_b32 v75, 0
  v_mov_b32 v76, 0
  v_mov_b32 v77, 0
  v_mov_b32 v78, 0
  v_mov_b32 v79, 0
  v_mov_b32 v80, 0
  v_mov_b32 v81, 0
  v_mov_b32 v82, 0
  v_mov_b32 v83, 0
  v_mov_b32 v84, 0
  v_mov_b32 v85, 0
  v_mov_b32 v86, 0
  v_mov_b32 v87, 0
  s_add_u32 m0, s43, 0
  s_nop 0
  buffer_load_dwordx4 v4, s[24:27], s44 offen lds
  s_add_u32 s44, s44, 128
  s_add_u32 m0, s43, 8192
  s_nop 0
  buffer_load_dwordx4 v4, s[24:27], s45 offen lds
  s_add_u32 s45, s45, 128
  s_add_u32 m0, s43, 16384
  s_nop 0
  buffer_load_dwordx4 v5, s[28:31], s46 offen lds
  s_add_u32 s46, s46, 131072
  s_add_u32 m0, s43, 24576
  s_nop 0
  buffer_load_dwordx4 v4, s[24:27], s44 offen lds
  s_add_u32 s44, s44, 128
  s_add_u32 m0, s43, 32768
  s_nop 0
  buffer_load_dwordx4 v4, s[24:27], s45 offen lds
  s_add_u32 s45, s45, 128
  s_add_u32 m0, s43, 40960
  s_nop 0
  buffer_load_dwordx4 v5, s[28:31], s46 offen lds
  s_add_u32 s46, s46, 131072
  s_waitcnt vmcnt(3)
  s_barrier
  s_add_u32 m0, s43, 49152
  s_nop 0
  buffer_load_dwordx4 v4, s[24:27], s44 offen lds
  s_add_u32 s44, s44, 128
  s_add_u32 m0, s43, 57344
  s_nop 0
  buffer_load_dwordx4 v4, s[24:27], s45 offen lds
  s_add_u32 s45, s45, 128
  s_add_u32 m0, s43, 65536
  s_nop 0
  buffer_load_dwordx4 v5, s[28:31], s46 offen lds
  s_add_u32 s46, s46, 131072
  ds_read_b128 v[16:19], v128 offset:0
  ds_read_b128 v[20:23], v128 offset:2048
  ds_read_b64_tr_b16 v[48:49], v134 offset:0
  ds_read_b64_tr_b16 v[50:51], v134 offset:512
  ds_read_b64_tr_b16 v[52:53], v135 offset:0
  ds_read_b64_tr_b16 v[54:55], v135 offset:512
  ds_read_b128 v[32:35], v129 offset:0
  ds_read_b128 v[36:39], v129 offset:2048
  ds_read_b64_tr_b16 v[60:61], v134 offset:4096
  ds_read_b64_tr_b16 v[62:63], v134 offset:4608
  ds_read_b64_tr_b16 v[64:65], v135 offset:4096
  ds_read_b64_tr_b16 v[66:67], v135 offset:4608
  s_waitcnt lgkmcnt(6)
  v_mfma_f32_16x16x32_bf16 v[72:75], v[48:51], v[16:19], v[72:75]
  v_mfma_f32_16x16x32_bf16 v[76:79], v[52:55], v[16:19], v[76:79]
  v_mfma_f32_16x16x32_bf16 v[80:83], v[48:51], v[20:23], v[80:83]
  v_mfma_f32_16x16x32_bf16 v[84:87], v[52:55], v[20:23], v[84:87]
  s_waitcnt lgkmcnt(0)
  v_mfma_f32_16x16x32_bf16 v[72:75], v[60:63], v[32:35], v[72:75]
  v_mfma_f32_16x16x32_bf16 v[76:79], v[64:67], v[32:35], v[76:79]
  v_mfma_f32_16x16x32_bf16 v[80:83], v[60:63], v[36:39], v[80:83]
  v_mfma_f32_16x16x32_bf16 v[84:87], v[64:67], v[36:39], v[84:87]
  s_waitcnt vmcnt(3)
  s_barrier
  s_add_u32 m0, s43, 0
  s_nop 0
  buffer_load_dwordx4 v4, s[24:27], s44 offen lds
  s_add_u32 s44, s44, 128
  s_add_u32 m0, s43, 8192
  s_nop 0
  buffer_load_dwordx4 v4, s[24:27], s45 offen lds
  s_add_u32 s45, s45, 128
  s_add_u32 m0, s43, 16384
  s_nop 0
  buffer_load_dwordx4 v5, s[28:31], s46 offen lds
  s_add_u32 s46, s46, 131072
  ds_read_b128 v[16:19], v130 offset:0
  ds_read_b128 v[20:23], v130 offset:2048
  ds_read_b64_tr_b16 v[48:49], v136 offset:0
  ds_read_b64_tr_b16 v[50:51], v136 offset:512
  ds_read_b64_tr_b16 v[52:53], v137 offset:0
  ds_read_b64_tr_b16 v[54:55], v137 offset:512
  ds_read_b128 v[32:35], v131 offset:0
  ds_read_b128 v[36:39], v131 offset:2048
  ds_read_b64_tr_b16 v[60:61], v136 offset:4096
  ds_read_b64_tr_b16 v[62:63], v136 offset:4608
  ds_read_b64_tr_b16 v[64:65], v137 offset:4096
  ds_read_b64_tr_b16 v[66:67], v137 offset:4608
  s_waitcnt lgkmcnt(6)
  v_mfma_f32_16x16x32_bf16 v[72:75], v[48:51], v[16:19], v[72:75]
  v_mfma_f32_16x16x32_bf16 v[76:79], v[52:55], v[16:19], v[76:79]
  v_mfma_f32_16x16x32_bf16 v[80:83], v[48:51], v[20:23], v[80:83]
  v_mfma_f32_16x16x32_bf16 v[84:87], v[52:55], v[20:23], v[84:87]
  s_waitcnt lgkmcnt(0)
  v_mfma_f32_16x16x32_bf16 v[72:75], v[60:63], v[32:35], v[72:75]
  v_mfma_f32_16x16x32_bf16 v[76:79], v[64:67], v[32:35], v[76:79]
  v_mfma_f32_16x16x32_bf16 v[80:83], v[60:63], v[36:39], v[80:83]
  v_mfma_f32_16x16x32_bf16 v[84:87], v[64:67], v[36:39], v[84:87]
  s_waitcnt vmcnt(3)
  s_barrier
  s_add_u32 m0, s43, 24576
  s_nop 0
  buffer_load_dwordx4 v4, s[24:27], s44 offen lds
  s_add_u32 s44, s44, 128
  s_add_u32 m0, s43, 32768
  s_nop 0
  buffer_load_dwordx4 v4, s[24:27], s45 offen lds
  s_add_u32 s45, s45, 128
  s_add_u32 m0, s43, 40960
  s_nop 0
  buffer_load_dwordx4 v5, s[28:31], s46 offen lds
  s_add_u32 s46, s46, 131072
  ds_read_b128 v[16:19], v132 offset:0
  ds_read_b128 v[20:23], v132 offset:2048
  ds_read_b64_tr_b16 v[48:49], v138 offset:0
  ds_read_b64_tr_b16 v[50:51], v138 offset:512
  ds_read_b64_tr_b16 v[52:53], v139 offset:0
  ds_read_b64_tr_b16 v[54:55], v139 offset:512
  ds_read_b128 v[32:35], v133 offset:0
  ds_read_b128 v[36:39], v133 offset:2048
  ds_read_b64_tr_b16 v[60:61], v138 offset:4096
  ds_read_b64_tr_b16 v[62:63], v138 offset:4608
  ds_read_b64_tr_b16 v[64:65], v139 offset:4096
  ds_read_b64_tr_b16 v[66:67], v139 offset:4608
  s_waitcnt lgkmcnt(6)
  v_mfma_f32_16x16x32_bf16 v[72:75], v[48:51], v[16:19], v[72:75]
  v_mfma_f32_16x16x32_bf16 v[76:79], v[52:55], v[16:19], v[76:79]
  v_mfma_f32_16x16x32_bf16 v[80:83], v[48:51], v[20:23], v[80:83]
  v_mfma_f32_16x16x32_bf16 v[84:87], v[52:55], v[20:23], v[84:87]
  s_waitcnt lgkmcnt(0)
  v_mfma_f32_16x16x32_bf16 v[72:75], v[60:63], v[32:35], v[72:75]
  v_mfma_f32_16x16x32_bf16 v[76:79], v[64:67], v[32:35], v[76:79]
  v_mfma_f32_16x16x32_bf16 v[80:83], v[60:63], v[36:39], v[80:83]
  v_mfma_f32_16x16x32_bf16 v[84:87], v[64:67], v[36:39], v[84:87]
  s_waitcnt vmcnt(3)
  s_barrier
  s_add_u32 m0, s43, 49152
  s_nop 0
  buffer_load_dwordx4 v4, s[24:27], s44 offen lds
  s_add_u32 s44, s44, 128
  s_add_u32 m0, s43, 57344
  s_nop 0
  buffer_load_dwordx4 v4, s[24:27], s45 offen lds
  s_add_u32 s45, s45, 128
  s_add_u32 m0, s43, 65536
  s_nop 0
  buffer_load_dwordx4 v5, s[28:31], s46 offen lds
  s_add_u32 s46, s46, 131072
  ds_read_b128 v[16:19], v128 offset:0
  ds_read_b128 v[20:23], v128 offset:2048
  ds_read_b64_tr_b16 v[48:49], v134 offset:0
  ds_read_b64_tr_b16 v[50:51], v134 offset:512
  ds_read_b64_tr_b16 v[52:53], v135 offset:0
  ds_read_b64_tr_b16 v[54:55], v135 offset:512
  ds_read_b128 v[32:35], v129 offset:0
  ds_read_b128 v[36:39], v129 offset:2048
  ds_read_b64_tr_b16 v[60:61], v134 offset:4096
  ds_read_b64_tr_b16 v[62:63], v134 offset:4608
  ds_read_b64_tr_b16 v[64:65], v135 offset:4096
  ds_read_b64_tr_b16 v[66:67], v135 offset:4608
  s_waitcnt lgkmcnt(6)
  v_mfma_f32_16x16x32_bf16 v[72:75], v[48:51], v[16:19], v[72:75]
  v_mfma_f32_16x16x32_bf16 v[76:79], v[52:55], v[16:19], v[76:79]
  v_mfma_f32_16x16x32_bf16 v[80:83], v[48:51], v[20:23], v[80:83]
  v_mfma_f32_16x16x32_bf16 v[84:87], v[52:55], v[20:23], v[84:87]
  s_waitcnt lgkmcnt(0)
  v_mfma_f32_16x16x32_bf16 v[72:75], v[60:63], v[32:35], v[72:75]
  v_mfma_f32_16x16x32_bf16 v[76:79], v[64:67], v[32:35], v[76:79]
  v_mfma_f32_16x16x32_bf16 v[80:83], v[60:63], v[36:39], v[80:83]
  v_mfma_f32_16x16x32_bf16 v[84:87], v[64:67], v[36:39], v[84:87]
  s_waitcnt vmcnt(3)
  s_barrier
  s_add_u32 m0, s43, 0
  s_nop 0
  buffer_load_dwordx4 v4, s[24:27], s44 offen lds
  s_add_u32 s44, s44, 128
  s_add_u32 m0, s43, 8192
  s_nop 0
  buffer_load_dwordx4 v4, s[24:27], s45 offen lds
  s_add_u32 s45, s45, 128
  s_add_u32 m0, s43, 16384
  s_nop 0
  buffer_load_dwordx4 v5, s[28:31], s46 offen lds
  s_add_u32 s46, s46, 131072
  ds_read_b128 v[16:19], v130 offset:0
  ds_read_b128 v[20:23], v130 offset:2048
  ds_read_b64_tr_b16 v[48:49], v136 offset:0
  ds_read_b64_tr_b16 v[50:51], v136 offset:512
  ds_read_b64_tr_b16 v[52:53], v137 offset:0
  ds_read_b64_tr_b16 v[54:55], v137 offset:512
  ds_read_b128 v[32:35], v131 offset:0
  ds_read_b128 v[36:39], v131 offset:2048
  ds_read_b64_tr_b16 v[60:61], v136 offset:4096
  ds_read_b64_tr_b16 v[62:63], v136 offset:4608
  ds_read_b64_tr_b16 v[64:65], v137 offset:4096
  ds_read_b64_tr_b16 v[66:67], v137 offset:4608
  s_waitcnt lgkmcnt(6)
  v_mfma_f32_16x16x32_bf16 v[72:75], v[48:51], v[16:19], v[72:75]
  v_mfma_f32_16x16x32_bf16 v[76:79], v[52:55], v[16:19], v[76:79]
  v_mfma_f32_16x16x32_bf16 v[80:83], v[48:51], v[20:23], v[80:83]
  v_mfma_f32_16x16x32_bf16 v[84:87], v[52:55], v[20:23], v[84:87]
  s_waitcnt lgkmcnt(0)
  v_mfma_f32_16x16x32_bf16 v[72:75], v[60:63], v[32:35], v[72:75]
  v_mfma_f32_16x16x32_bf16 v[76:79], v[64:67], v[32:35], v[76:79]
  v_mfma_f32_16x16x32_bf16 v[80:83], v[60:63], v[36:39], v[80:83]
  v_mfma_f32_16x16x32_bf16 v[84:87], v[64:67], v[36:39], v[84:87]
  s_waitcnt vmcnt(3)
  s_barrier
  s_add_u32 m0, s43, 24576
  s_nop 0
  buffer_load_dwordx4 v4, s[24:27], s44 offen lds
  s_add_u32 s44, s44, 128
  s_add_u32 m0, s43, 32768
  s_nop 0
  buffer_load_dwordx4 v4, s[24:27], s45 offen lds
  s_add_u32 s45, s45, 128
  s_add_u32 m0, s43, 40960
  s_nop 0
  buffer_load_dwordx4 v5, s[28:31], s46 offen lds
  s_add_u32 s46, s46, 131072
  ds_read_b128 v[16:19], v132 offset:0
  ds_read_b128 v[20:23], v132 offset:2048
  ds_read_b64_tr_b16 v[48:49], v138 offset:0
  ds_read_b64_tr_b16 v[50:51], v138 offset:512
  ds_read_b64_tr_b16 v[52:53], v139 offset:0
  ds_read_b64_tr_b16 v[54:55], v139 offset:512
  ds_read_b128 v[32:35], v133 offset:0
  ds_read_b128 v[36:39], v133 offset:2048
  ds_read_b64_tr_b16 v[60:61], v138 offset:4096
  ds_read_b64_tr_b16 v[62:63], v138 offset:4608
  ds_read_b64_tr_b16 v[64:65], v139 offset:4096
  ds_read_b64_tr_b16 v[66:67], v139 offset:4608
  s_waitcnt lgkmcnt(6)
  v_mfma_f32_16x16x32_bf16 v[72:75], v[48:51], v[16:19], v[72:75]
  v_mfma_f32_16x16x32_bf16 v[76:79], v[52:55], v[16:19], v[76:79]
  v_mfma_f32_16x16x32_bf16 v[80:83], v[48:51], v[20:23], v[80:83]
  v_mfma_f32_16x16x32_bf16 v[84:87], v[52:55], v[20:23], v[84:87]
  s_waitcnt lgkmcnt(0)
  v_mfma_f32_16x16x32_bf16 v[72:75], v[60:63], v[32:35], v[72:75]
  v_mfma_f32_16x16x32_bf16 v[76:79], v[64:67], v[32:35], v[76:79]
  v_mfma_f32_16x16x32_bf16 v[80:83], v[60:63], v[36:39], v[80:83]
  v_mfma_f32_16x16x32_bf16 v[84:87], v[64:67], v[36:39], v[84:87]
  s_waitcnt vmcnt(3)
  s_barrier
  s_add_u32 m0, s43, 49152
  s_nop 0
  buffer_load_dwordx4 v4, s[24:27], s44 offen lds
  s_add_u32 s44, s44, 128
  s_add_u32 m0, s43, 57344
  s_nop 0
  buffer_load_dwordx4 v4, s[24:27], s45 offen lds
  s_add_u32 s45, s45, 128
  s_add_u32 m0, s43, 65536
  s_nop 0
  buffer_load_dwordx4 v5, s[28:31], s46 offen lds
  s_add_u32 s46, s46, 131072
  ds_read_b128 v[16:19], v128 offset:0
  ds_read_b128 v[20:23], v128 offset:2048
  ds_read_b64_tr_b16 v[48:49], v134 offset:0
  ds_read_b64_tr_b16 v[50:51], v134 offset:512
  ds_read_b64_tr_b16 v[52:53], v135 offset:0
  ds_read_b64_tr_b16 v[54:55], v135 offset:512
  ds_read_b128 v[32:35], v129 offset:0
  ds_read_b128 v[36:39], v129 offset:2048
  ds_read_b64_tr_b16 v[60:61], v134 offset:4096
  ds_read_b64_tr_b16 v[62:63], v134 offset:4608
  ds_read_b64_tr_b16 v[64:65], v135 offset:4096
  ds_read_b64_tr_b16 v[66:67], v135 offset:4608
  s_waitcnt lgkmcnt(6)
  v_mfma_f32_16x16x32_bf16 v[72:75], v[48:51], v[16:19], v[72:75]
  v_mfma_f32_16x16x32_bf16 v[76:79], v[52:55], v[16:19], v[76:79]
  v_mfma_f32_16x16x32_bf16 v[80:83], v[48:51], v[20:23], v[80:83]
  v_mfma_f32_16x16x32_bf16 v[84:87], v[52:55], v[20:23], v[84:87]
  s_waitcnt lgkmcnt(0)
  v_mfma_f32_16x16x32_bf16 v[72:75], v[60:63], v[32:35], v[72:75]
  v_mfma_f32_16x16x32_bf16 v[76:79], v[64:67], v[32:35], v[76:79]
  v_mfma_f32_16x16x32_bf16 v[80:83], v[60:63], v[36:39], v[80:83]
  v_mfma_f32_16x16x32_bf16 v[84:87], v[64:67], v[36:39], v[84:87]
  s_waitcnt vmcnt(3)
  s_barrier
  s_add_u32 m0, s43, 0
  s_nop 0
  buffer_load_dwordx4 v4, s[24:27], s44 offen lds
  s_add_u32 s44, s44, 128
  s_add_u32 m0, s43, 8192
  s_nop 0
  buffer_load_dwordx4 v4, s[24:27], s45 offen lds
  s_add_u32 s45, s45, 128
  s_add_u32 m0, s43, 16384
  s_nop 0
  buffer_load_dwordx4 v5, s[28:31], s46 offen lds
  s_add_u32 s46, s46, 131072
  ds_read_b128 v[16:19], v130 offset:0
  ds_read_b128 v[20:23], v130 offset:2048
  ds_read_b64_tr_b16 v[48:49], v136 offset:0
  ds_read_b64_tr_b16 v[50:51], v136 offset:512
  ds_read_b64_tr_b16 v[52:53], v137 offset:0
  ds_read_b64_tr_b16 v[54:55], v137 offset:512
  ds_read_b128 v[32:35], v131 offset:0
  ds_read_b128 v[36:39], v131 offset:2048
  ds_read_b64_tr_b16 v[60:61], v136 offset:4096
  ds_read_b64_tr_b16 v[62:63], v136 offset:4608
  ds_read_b64_tr_b16 v[64:65], v137 offset:4096
  ds_read_b64_tr_b16 v[66:67], v137 offset:4608
  s_waitcnt lgkmcnt(6)
  v_mfma_f32_16x16x32_bf16 v[72:75], v[48:51], v[16:19], v[72:75]
  v_mfma_f32_16x16x32_bf16 v[76:79], v[52:55], v[16:19], v[76:79]
  v_mfma_f32_16x16x32_bf16 v[80:83], v[48:51], v[20:23], v[80:83]
  v_mfma_f32_16x16x32_bf16 v[84:87], v[52:55], v[20:23], v[84:87]
  s_waitcnt lgkmcnt(0)
  v_mfma_f32_16x16x32_bf16 v[72:75], v[60:63], v[32:35], v[72:75]
  v_mfma_f32_16x16x32_bf16 v[76:79], v[64:67], v[32:35], v[76:79]
  v_mfma_f32_16x16x32_bf16 v[80:83], v[60:63], v[36:39], v[80:83]
  v_mfma_f32_16x16x32_bf16 v[84:87], v[64:67], v[36:39], v[84:87]
  s_waitcnt vmcnt(3)
  s_barrier
  s_add_u32 m0, s43, 24576
  s_nop 0
  buffer_load_dwordx4 v4, s[24:27], s44 offen lds
  s_add_u32 s44, s44, 128
  s_add_u32 m0, s43, 32768
  s_nop 0
  buffer_load_dwordx4 v4, s[24:27], s45 offen lds
  s_add_u32 s45, s45, 128
  s_add_u32 m0, s43, 40960
  s_nop 0
  buffer_load_dwordx4 v5, s[28:31], s46 offen lds
  s_add_u32 s46, s46, 131072
  ds_read_b128 v[16:19], v132 offset:0
  ds_read_b128 v[20:23], v132 offset:2048
  ds_read_b64_tr_b16 v[48:49], v138 offset:0
  ds_read_b64_tr_b16 v[50:51], v138 offset:512
  ds_read_b64_tr_b16 v[52:53], v139 offset:0
  ds_read_b64_tr_b16 v[54:55], v139 offset:512
  ds_read_b128 v[32:35], v133 offset:0
  ds_read_b128 v[36:39], v133 offset:2048
  ds_read_b64_tr_b16 v[60:61], v138 offset:4096
  ds_read_b64_tr_b16 v[62:63], v138 offset:4608
  ds_read_b64_tr_b16 v[64:65], v139 offset:4096
  ds_read_b64_tr_b16 v[66:67], v139 offset:4608
  s_waitcnt lgkmcnt(6)
  v_mfma_f32_16x16x32_bf16 v[72:75], v[48:51], v[16:19], v[72:75]
  v_mfma_f32_16x16x32_bf16 v[76:79], v[52:55], v[16:19], v[76:79]
  v_mfma_f32_16x16x32_bf16 v[80:83], v[48:51], v[20:23], v[80:83]
  v_mfma_f32_16x16x32_bf16 v[84:87], v[52:55], v[20:23], v[84:87]
  s_waitcnt lgkmcnt(0)
  v_mfma_f32_16x16x32_bf16 v[72:75], v[60:63], v[32:35], v[72:75]
  v_mfma_f32_16x16x32_bf16 v[76:79], v[64:67], v[32:35], v[76:79]
  v_mfma_f32_16x16x32_bf16 v[80:83], v[60:63], v[36:39], v[80:83]
  v_mfma_f32_16x16x32_bf16 v[84:87], v[64:67], v[36:39], v[84:87]
  s_waitcnt vmcnt(3)
  s_barrier
  s_add_u32 m0, s43, 49152
  s_nop 0
  buffer_load_dwordx4 v4, s[24:27], s44 offen lds
  s_add_u32 s44, s44, 128
  s_add_u32 m0, s43, 57344
  s_nop 0
  buffer_load_dwordx4 v4, s[24:27], s45 offen lds
  s_add_u32 s45, s45, 128
  s_add_u32 m0, s43, 65536
  s_nop 0
  buffer_load_dwordx4 v5, s[28:31], s46 offen lds
  s_add_u32 s46, s46, 131072
  ds_read_b128 v[16:19], v128 offset:0
  ds_read_b128 v[20:23], v128 offset:2048
  ds_read_b64_tr_b16 v[48:49], v134 offset:0
  ds_read_b64_tr_b16 v[50:51], v134 offset:512
  ds_read_b64_tr_b16 v[52:53], v135 offset:0
  ds_read_b64_tr_b16 v[54:55], v135 offset:512
  ds_read_b128 v[32:35], v129 offset:0
  ds_read_b128 v[36:39], v129 offset:2048
  ds_read_b64_tr_b16 v[60:61], v134 offset:4096
  ds_read_b64_tr_b16 v[62:63], v134 offset:4608
  ds_read_b64_tr_b16 v[64:65], v135 offset:4096
  ds_read_b64_tr_b16 v[66:67], v135 offset:4608
  s_waitcnt lgkmcnt(6)
  v_mfma_f32_16x16x32_bf16 v[72:75], v[48:51], v[16:19], v[72:75]
  v_mfma_f32_16x16x32_bf16 v[76:79], v[52:55], v[16:19], v[76:79]
  v_mfma_f32_16x16x32_bf16 v[80:83], v[48:51], v[20:23], v[80:83]
  v_mfma_f32_16x16x32_bf16 v[84:87], v[52:55], v[20:23], v[84:87]
  s_waitcnt lgkmcnt(0)
  v_mfma_f32_16x16x32_bf16 v[72:75], v[60:63], v[32:35], v[72:75]
  v_mfma_f32_16x16x32_bf16 v[76:79], v[64:67], v[32:35], v[76:79]
  v_mfma_f32_16x16x32_bf16 v[80:83], v[60:63], v[36:39], v[80:83]
  v_mfma_f32_16x16x32_bf16 v[84:87], v[64:67], v[36:39], v[84:87]
  s_waitcnt vmcnt(3)
  s_barrier
  s_add_u32 m0, s43, 0
  s_nop 0
  buffer_load_dwordx4 v4, s[24:27], s44 offen lds
  s_add_u32 s44, s44, 128
  s_add_u32 m0, s43, 8192
  s_nop 0
  buffer_load_dwordx4 v4, s[24:27], s45 offen lds
  s_add_u32 s45, s45, 128
  s_add_u32 m0, s43, 16384
  s_nop 0
  buffer_load_dwordx4 v5, s[28:31], s46 offen lds
  s_add_u32 s46, s46, 131072
  ds_read_b128 v[16:19], v130 offset:0
  ds_read_b128 v[20:23], v130 offset:2048
  ds_read_b64_tr_b16 v[48:49], v136 offset:0
  ds_read_b64_tr_b16 v[50:51], v136 offset:512
  ds_read_b64_tr_b16 v[52:53], v137 offset:0
  ds_read_b64_tr_b16 v[54:55], v137 offset:512
  ds_read_b128 v[32:35], v131 offset:0
  ds_read_b128 v[36:39], v131 offset:2048
  ds_read_b64_tr_b16 v[60:61], v136 offset:4096
  ds_read_b64_tr_b16 v[62:63], v136 offset:4608
  ds_read_b64_tr_b16 v[64:65], v137 offset:4096
  ds_read_b64_tr_b16 v[66:67], v137 offset:4608
  s_waitcnt lgkmcnt(6)
  v_mfma_f32_16x16x32_bf16 v[72:75], v[48:51], v[16:19], v[72:75]
  v_mfma_f32_16x16x32_bf16 v[76:79], v[52:55], v[16:19], v[76:79]
  v_mfma_f32_16x16x32_bf16 v[80:83], v[48:51], v[20:23], v[80:83]
  v_mfma_f32_16x16x32_bf16 v[84:87], v[52:55], v[20:23], v[84:87]
  s_waitcnt lgkmcnt(0)
  v_mfma_f32_16x16x32_bf16 v[72:75], v[60:63], v[32:35], v[72:75]
  v_mfma_f32_16x16x32_bf16 v[76:79], v[64:67], v[32:35], v[76:79]
  v_mfma_f32_16x16x32_bf16 v[80:83], v[60:63], v[36:39], v[80:83]
  v_mfma_f32_16x16x32_bf16 v[84:87], v[64:67], v[36:39], v[84:87]
  s_waitcnt vmcnt(3)
  s_barrier
  s_add_u32 m0, s43, 24576
  s_nop 0
  buffer_load_dwordx4 v4, s[24:27], s44 offen lds
  s_add_u32 s44, s44, 128
  s_add_u32 m0, s43, 32768
  s_nop 0
  buffer_load_dwordx4 v4, s[24:27], s45 offen lds
  s_add_u32 s45, s45, 128
  s_add_u32 m0, s43, 40960
  s_nop 0
  buffer_load_dwordx4 v5, s[28:31], s46 offen lds
  s_add_u32 s46, s46, 131072
  ds_read_b128 v[16:19], v132 offset:0
  ds_read_b128 v[20:23], v132 offset:2048
  ds_read_b64_tr_b16 v[48:49], v138 offset:0
  ds_read_b64_tr_b16 v[50:51], v138 offset:512
  ds_read_b64_tr_b16 v[52:53], v139 offset:0
  ds_read_b64_tr_b16 v[54:55], v139 offset:512
  ds_read_b128 v[32:35], v133 offset:0
  ds_read_b128 v[36:39], v133 offset:2048
  ds_read_b64_tr_b16 v[60:61], v138 offset:4096
  ds_read_b64_tr_b16 v[62:63], v138 offset:4608
  ds_read_b64_tr_b16 v[64:65], v139 offset:4096
  ds_read_b64_tr_b16 v[66:67], v139 offset:4608
  s_waitcnt lgkmcnt(6)
  v_mfma_f32_16x16x32_bf16 v[72:75], v[48:51], v[16:19], v[72:75]
  v_mfma_f32_16x16x32_bf16 v[76:79], v[52:55], v[16:19], v[76:79]
  v_mfma_f32_16x16x32_bf16 v[80:83], v[48:51], v[20:23], v[80:83]
  v_mfma_f32_16x16x32_bf16 v[84:87], v[52:55], v[20:23], v[84:87]
  s_waitcnt lgkmcnt(0)
  v_mfma_f32_16x16x32_bf16 v[72:75], v[60:63], v[32:35], v[72:75]
  v_mfma_f32_16x16x32_bf16 v[76:79], v[64:67], v[32:35], v[76:79]
  v_mfma_f32_16x16x32_bf16 v[80:83], v[60:63], v[36:39], v[80:83]
  v_mfma_f32_16x16x32_bf16 v[84:87], v[64:67], v[36:39], v[84:87]
  s_waitcnt vmcnt(3)
  s_barrier
  s_add_u32 m0, s43, 49152
  s_nop 0
  buffer_load_dwordx4 v4, s[24:27], s44 offen lds
  s_add_u32 s44, s44, 128
  s_add_u32 m0, s43, 57344
  s_nop 0
  buffer_load_dwordx4 v4, s[24:27], s45 offen lds
  s_add_u32 s45, s45, 128
  s_add_u32 m0, s43, 65536
  s_nop 0
  buffer_load_dwordx4 v5, s[28:31], s46 offen lds
  s_add_u32 s46, s46, 131072
  ds_read_b128 v[16:19], v128 offset:0
  ds_read_b128 v[20:23], v128 offset:2048
  ds_read_b64_tr_b16 v[48:49], v134 offset:0
  ds_read_b64_tr_b16 v[50:51], v134 offset:512
  ds_read_b64_tr_b16 v[52:53], v135 offset:0
  ds_read_b64_tr_b16 v[54:55], v135 offset:512
  ds_read_b128 v[32:35], v129 offset:0
  ds_read_b128 v[36:39], v129 offset:2048
  ds_read_b64_tr_b16 v[60:61], v134 offset:4096
  ds_read_b64_tr_b16 v[62:63], v134 offset:4608
  ds_read_b64_tr_b16 v[64:65], v135 offset:4096
  ds_read_b64_tr_b16 v[66:67], v135 offset:4608
  s_waitcnt lgkmcnt(6)
  v_mfma_f32_16x16x32_bf16 v[72:75], v[48:51], v[16:19], v[72:75]
  v_mfma_f32_16x16x32_bf16 v[76:79], v[52:55], v[16:19], v[76:79]
  v_mfma_f32_16x16x32_bf16 v[80:83], v[48:51], v[20:23], v[80:83]
  v_mfma_f32_16x16x32_bf16 v[84:87], v[52:55], v[20:23], v[84:87]
  s_waitcnt lgkmcnt(0)
  v_mfma_f32_16x16x32_bf16 v[72:75], v[60:63], v[32:35], v[72:75]
  v_mfma_f32_16x16x32_bf16 v[76:79], v[64:67], v[32:35], v[76:79]
  v_mfma_f32_16x16x32_bf16 v[80:83], v[60:63], v[36:39], v[80:83]
  v_mfma_f32_16x16x32_bf16 v[84:87], v[64:67], v[36:39], v[84:87]
  s_waitcnt vmcnt(3)
  s_barrier
  s_add_u32 m0, s43, 0
  s_nop 0
  buffer_load_dwordx4 v4, s[24:27], s44 offen lds
  s_add_u32 s44, s44, 128
  s_add_u32 m0, s43, 8192
  s_nop 0
  buffer_load_dwordx4 v4, s[24:27], s45 offen lds
  s_add_u32 s45, s45, 128
  s_add_u32 m0, s43, 16384
  s_nop 0
  buffer_load_dwordx4 v5, s[28:31], s46 offen lds
  s_add_u32 s46, s46, 131072
  ds_read_b128 v[16:19], v130 offset:0
  ds_read_b128 v[20:23], v130 offset:2048
  ds_read_b64_tr_b16 v[48:49], v136 offset:0
  ds_read_b64_tr_b16 v[50:51], v136 offset:512
  ds_read_b64_tr_b16 v[52:53], v137 offset:0
  ds_read_b64_tr_b16 v[54:55], v137 offset:512
  ds_read_b128 v[32:35], v131 offset:0
  ds_read_b128 v[36:39], v131 offset:2048
  ds_read_b64_tr_b16 v[60:61], v136 offset:4096
  ds_read_b64_tr_b16 v[62:63], v136 offset:4608
  ds_read_b64_tr_b16 v[64:65], v137 offset:4096
  ds_read_b64_tr_b16 v[66:67], v137 offset:4608
  s_waitcnt lgkmcnt(6)
  v_mfma_f32_16x16x32_bf16 v[72:75], v[48:51], v[16:19], v[72:75]
  v_mfma_f32_16x16x32_bf16 v[76:79], v[52:55], v[16:19], v[76:79]
  v_mfma_f32_16x16x32_bf16 v[80:83], v[48:51], v[20:23], v[80:83]
  v_mfma_f32_16x16x32_bf16 v[84:87], v[52:55], v[20:23], v[84:87]
  s_waitcnt lgkmcnt(0)
  v_mfma_f32_16x16x32_bf16 v[72:75], v[60:63], v[32:35], v[72:75]
  v_mfma_f32_16x16x32_bf16 v[76:79], v[64:67], v[32:35], v[76:79]
  v_mfma_f32_16x16x32_bf16 v[80:83], v[60:63], v[36:39], v[80:83]
  v_mfma_f32_16x16x32_bf16 v[84:87], v[64:67], v[36:39], v[84:87]
  s_waitcnt vmcnt(3)
  s_barrier
  ds_read_b128 v[16:19], v132 offset:0
  ds_read_b128 v[20:23], v132 offset:2048
  ds_read_b64_tr_b16 v[48:49], v138 offset:0
  ds_read_b64_tr_b16 v[50:51], v138 offset:512
  ds_read_b64_tr_b16 v[52:53], v139 offset:0
  ds_read_b64_tr_b16 v[54:55], v139 offset:512
  ds_read_b128 v[32:35], v133 offset:0
  ds_read_b128 v[36:39], v133 offset:2048
  ds_read_b64_tr_b16 v[60:61], v138 offset:4096
  ds_read_b64_tr_b16 v[62:63], v138 offset:4608
  ds_read_b64_tr_b16 v[64:65], v139 offset:4096
  ds_read_b64_tr_b16 v[66:67], v139 offset:4608
  s_waitcnt lgkmcnt(6)
  v_mfma_f32_16x16x32_bf16 v[72:75], v[48:51], v[16:19], v[72:75]
  v_mfma_f32_16x16x32_bf16 v[76:79], v[52:55], v[16:19], v[76:79]
  v_mfma_f32_16x16x32_bf16 v[80:83], v[48:51], v[20:23], v[80:83]
  v_mfma_f32_16x16x32_bf16 v[84:87], v[52:55], v[20:23], v[84:87]
  s_waitcnt lgkmcnt(0)
  v_mfma_f32_16x16x32_bf16 v[72:75], v[60:63], v[32:35], v[72:75]
  v_mfma_f32_16x16x32_bf16 v[76:79], v[64:67], v[32:35], v[76:79]
  v_mfma_f32_16x16x32_bf16 v[80:83], v[60:63], v[36:39], v[80:83]
  v_mfma_f32_16x16x32_bf16 v[84:87], v[64:67], v[36:39], v[84:87]
  s_waitcnt vmcnt(0)
  s_barrier
  ds_read_b128 v[16:19], v128 offset:0
  ds_read_b128 v[20:23], v128 offset:2048
  ds_read_b64_tr_b16 v[48:49], v134 offset:0
  ds_read_b64_tr_b16 v[50:51], v134 offset:512
  ds_read_b64_tr_b16 v[52:53], v135 offset:0
  ds_read_b64_tr_b16 v[54:55], v135 offset:512
  ds_read_b128 v[32:35], v129 offset:0
  ds_read_b128 v[36:39], v129 offset:2048
  ds_read_b64_tr_b16 v[60:61], v134 offset:4096
  ds_read_b64_tr_b16 v[62:63], v134 offset:4608
  ds_read_b64_tr_b16 v[64:65], v135 offset:4096
  ds_read_b64_tr_b16 v[66:67], v135 offset:4608
  s_waitcnt lgkmcnt(6)
  v_mfma_f32_16x16x32_bf16 v[72:75], v[48:51], v[16:19], v[72:75]
  v_mfma_f32_16x16x32_bf16 v[76:79], v[52:55], v[16:19], v[76:79]
  v_mfma_f32_16x16x32_bf16 v[80:83], v[48:51], v[20:23], v[80:83]
  v_mfma_f32_16x16x32_bf16 v[84:87], v[52:55], v[20:23], v[84:87]
  s_waitcnt lgkmcnt(0)
  v_mfma_f32_16x16x32_bf16 v[72:75], v[60:63], v[32:35], v[72:75]
  v_mfma_f32_16x16x32_bf16 v[76:79], v[64:67], v[32:35], v[76:79]
  v_mfma_f32_16x16x32_bf16 v[80:83], v[60:63], v[36:39], v[80:83]
  v_mfma_f32_16x16x32_bf16 v[84:87], v[64:67], v[36:39], v[84:87]
  s_nop 7
  s_nop 7
  buffer_load_dwordx2 v[16:17], v13, s[36:39], 0 offen offset:0
  buffer_load_dwordx2 v[18:19], v13, s[36:39], 0 offen offset:32
  s_waitcnt vmcnt(0)
  v_cvt_pk_bf16_f32 v72, v72, v73
  v_cvt_pk_bf16_f32 v73, v74, v75
  v_lshlrev_b32 v32, 16, v72
  v_and_b32 v33, 0xffff0000, v72
  v_lshlrev_b32 v34, 16, v16
  v_and_b32 v35, 0xffff0000, v16
  v_add_f32 v32, v32, v34
  v_add_f32 v33, v33, v35
  v_cvt_pk_bf16_f32 v72, v32, v33
  v_lshlrev_b32 v32, 16, v73
  v_and_b32 v33, 0xffff0000, v73
  v_lshlrev_b32 v34, 16, v17
  v_and_b32 v35, 0xffff0000, v17
  v_add_f32 v32, v32, v34
  v_add_f32 v33, v33, v35
  v_cvt_pk_bf16_f32 v73, v32, v33
  buffer_store_dwordx2 v[72:73], v13, s[32:35], 0 offen offset:0
  v_cvt_pk_bf16_f32 v76, v76, v77
  v_cvt_pk_bf16_f32 v77, v78, v79
  v_lshlrev_b32 v32, 16, v76
  v_and_b32 v33, 0xffff0000, v76
  v_lshlrev_b32 v34, 16, v18
  v_and_b32 v35, 0xffff0000, v18
  v_add_f32 v32, v32, v34
  v_add_f32 v33, v33, v35
  v_cvt_pk_bf16_f32 v76, v32, v33
  v_lshlrev_b32 v32, 16, v77
  v_and_b32 v33, 0xffff0000, v77
  v_lshlrev_b32 v34, 16, v19
  v_and_b32 v35, 0xffff0000, v19
  v_add_f32 v32, v32, v34
  v_add_f32 v33, v33, v35
  v_cvt_pk_bf16_f32 v77, v32, v33
  buffer_store_dwordx2 v[76:77], v13, s[32:35], 0 offen offset:32
  v_add_u32 v13, 32768, v13
  buffer_load_dwordx2 v[16:17], v13, s[36:39], 0 offen offset:0
  buffer_load_dwordx2 v[18:19], v13, s[36:39], 0 offen offset:32
  s_waitcnt vmcnt(0)
  v_cvt_pk_bf16_f32 v80, v80, v81
  v_cvt_pk_bf16_f32 v81, v82, v83
  v_lshlrev_b32 v32, 16, v80
  v_and_b32 v33, 0xffff0000, v80
  v_lshlrev_b32 v34, 16, v16
  v_and_b32 v35, 0xffff0000, v16
  v_add_f32 v32, v32, v34
  v_add_f32 v33, v33, v35
  v_cvt_pk_bf16_f32 v80, v32, v33
  v_lshlrev_b32 v32, 16, v81
  v_and_b32 v33, 0xffff0000, v81
  v_lshlrev_b32 v34, 16, v17
  v_and_b32 v35, 0xffff0000, v17
  v_add_f32 v32, v32, v34
  v_add_f32 v33, v33, v35
  v_cvt_pk_bf16_f32 v81, v32, v33
  buffer_store_dwordx2 v[80:81], v13, s[32:35], 0 offen offset:0
  v_cvt_pk_bf16_f32 v84, v84, v85
  v_cvt_pk_bf16_f32 v85, v86, v87
  v_lshlrev_b32 v32, 16, v84
  v_and_b32 v33, 0xffff0000, v84
  v_lshlrev_b32 v34, 16, v18
  v_and_b32 v35, 0xffff0000, v18
  v_add_f32 v32, v32, v34
  v_add_f32 v33, v33, v35
  v_cvt_pk_bf16_f32 v84, v32, v33
  v_lshlrev_b32 v32, 16, v85
  v_and_b32 v33, 0xffff0000, v85
  v_lshlrev_b32 v34, 16, v19
  v_and_b32 v35, 0xffff0000, v19
  v_add_f32 v32, v32, v34
  v_add_f32 v33, v33, v35
  v_cvt_pk_bf16_f32 v85, v32, v33
  buffer_store_dwordx2 v[84:85], v13, s[32:35], 0 offen offset:32
L_gemmo1_kernel_end:
  s_endpgm
.globl ln2_kernel
.p2align 8
.type ln2_kernel,@function
ln2_kernel:
  s_cmp_ge_u32 s2, 512
  s_cbranch_scc1 L_ln2_kernel_end
  s_load_dwordx16 s[4:19], s[0:1], 0
  s_load_dwordx2 s[20:21], s[0:1], 64
  s_waitcnt lgkmcnt(0)
  s_add_u32 s24, s20, 25165824
  s_addc_u32 s25, s21, 0
  s_and_b32 s25, s25, 0xffff
  s_mov_b32 s26, 4194304
  s_mov_b32 s27, 0x00020000
  s_mov_b32 s28, s20
  s_and_b32 s29, s21, 0xffff
  s_mov_b32 s30, 4194304
  s_mov_b32 s31, 0x00020000
  v_lshrrev_b32 v1, 6, v0
  v_and_b32 v2, 63, v0
  s_lshl_b32 s3, s2, 2
  v_add_u32 v3, s3, v1
  v_lshlrev_b32 v4, 11, v3
  v_lshl_add_u32 v4, v2, 4, v4
  buffer_load_dwordx4 v[8:11], v4, s[24:27], 0 offen
  buffer_load_dwordx4 v[12:15], v4, s[24:27], 0 offen offset:1024
  s_waitcnt vmcnt(0)
  v_lshlrev_b32 v16, 16, v8
  v_and_b32 v17, 0xffff0000, v8
  v_lshlrev_b32 v18, 16, v9
  v_and_b32 v19, 0xffff0000, v9
  v_lshlrev_b32 v20, 16, v10
  v_and_b32 v21, 0xffff0000, v10
  v_lshlrev_b32 v22, 16, v11
  v_and_b32 v23, 0xffff0000, v11
  v_lshlrev_b32 v24, 16, v12
  v_and_b32 v25, 0xffff0000, v12
  v_lshlrev_b32 v26, 16, v13
  v_and_b32 v27, 0xffff0000, v13
  v_lshlrev_b32 v28, 16, v14
  v_and_b32 v29, 0xffff0000, v14
  v_lshlrev_b32 v30, 16, v15
  v_and_b32 v31, 0xffff0000, v15
  v_add_f32 v32, v16, v17
  v_add_f32 v32, v32, v18
  v_add_f32 v32, v32, v19
  v_add_f32 v32, v32, v20
  v_add_f32 v32, v32, v21
  v_add_f32 v32, v32, v22
  v_add_f32 v32, v32, v23
  v_add_f32 v32, v32, v24
  v_add_f32 v32, v32, v25
  v_add_f32 v32, v32, v26
  v_add_f32 v32, v32, v27
  v_add_f32 v32, v32, v28
  v_add_f32 v32, v32, v29
  v_add_f32 v32, v32, v30
  v_add_f32 v32, v32, v31
  v_xor_b32 v41, 1, v2
  v_lshlrev_b32 v41, 2, v41
  ds_bpermute_b32 v40, v41, v32
  s_waitcnt lgkmcnt(0)
  v_add_f32 v32, v32, v40
  v_xor_b32 v41, 2, v2
  v_lshlrev_b32 v41, 2, v41
  ds_bpermute_b32 v40, v41, v32
  s_waitcnt lgkmcnt(0)
  v_add_f32 v32, v32, v40
  v_xor_b32 v41, 4, v2
  v_lshlrev_b32 v41, 2, v41
  ds_bpermute_b32 v40, v41, v32
  s_waitcnt lgkmcnt(0)
  v_add_f32 v32, v32, v40
  v_xor_b32 v41, 8, v2
  v_lshlrev_b32 v41, 2, v41
  ds_bpermute_b32 v40, v41, v32
  s_waitcnt lgkmcnt(0)
  v_add_f32 v32, v32, v40
  v_xor_b32 v41, 16, v2
  v_lshlrev_b32 v41, 2, v41
  ds_bpermute_b32 v40, v41, v32
  s_waitcnt lgkmcnt(0)
  v_add_f32 v32, v32, v40
  v_xor_b32 v41, 32, v2
  v_lshlrev_b32 v41, 2, v41
  ds_bpermute_b32 v40, v41, v32
  s_waitcnt lgkmcnt(0)
  v_add_f32 v32, v32, v40
  v_mul_f32 v32, 0x3a800000, v32
  v_sub_f32 v34, v16, v32
  v_mul_f32 v33, v34, v34
  v_sub_f32 v34, v17, v32
  v_fma_f32 v33, v34, v34, v33
  v_sub_f32 v34, v18, v32
  v_fma_f32 v33, v34, v34, v33
  v_sub_f32 v34, v19, v32
  v_fma_f32 v33, v34, v34, v33
  v_sub_f32 v34, v20, v32
  v_fma_f32 v33, v34, v34, v33
  v_sub_f32 v34, v21, v32
  v_fma_f32 v33, v34, v34, v33
  v_sub_f32 v34, v22, v32
  v_fma_f32 v33, v34, v34, v33
  v_sub_f32 v34, v23, v32
  v_fma_f32 v33, v34, v34, v33
  v_sub_f32 v34, v24, v32
  v_fma_f32 v33, v34, v34, v33
  v_sub_f32 v34, v25, v32
  v_fma_f32 v33, v34, v34, v33
  v_sub_f32 v34, v26, v32
  v_fma_f32 v33, v34, v34, v33
  v_sub_f32 v34, v27, v32
  v_fma_f32 v33, v34, v34, v33
  v_sub_f32 v34, v28, v32
  v_fma_f32 v33, v34, v34, v33
  v_sub_f32 v34, v29, v32
  v_fma_f32 v33, v34, v34, v33
  v_sub_f32 v34, v30, v32
  v_fma_f32 v33, v34, v34, v33
  v_sub_f32 v34, v31, v32
  v_fma_f32 v33, v34, v34, v33
  v_xor_b32 v41, 1, v2
  v_lshlrev_b32 v41, 2, v41
  ds_bpermute_b32 v40, v41, v33
  s_waitcnt lgkmcnt(0)
  v_add_f32 v33, v33, v40
  v_xor_b32 v41, 2, v2
  v_lshlrev_b32 v41, 2, v41
  ds_bpermute_b32 v40, v41, v33
  s_waitcnt lgkmcnt(0)
  v_add_f32 v33, v33, v40
  v_xor_b32 v41, 4, v2
  v_lshlrev_b32 v41, 2, v41
  ds_bpermute_b32 v40, v41, v33
  s_waitcnt lgkmcnt(0)
  v_add_f32 v33, v33, v40
  v_xor_b32 v41, 8, v2
  v_lshlrev_b32 v41, 2, v41
  ds_bpermute_b32 v40, v41, v33
  s_waitcnt lgkmcnt(0)
  v_add_f32 v33, v33, v40
  v_xor_b32 v41, 16, v2
  v_lshlrev_b32 v41, 2, v41
  ds_bpermute_b32 v40, v41, v33
  s_waitcnt lgkmcnt(0)
  v_add_f32 v33, v33, v40
  v_xor_b32 v41, 32, v2
  v_lshlrev_b32 v41, 2, v41
  ds_bpermute_b32 v40, v41, v33
  s_waitcnt lgkmcnt(0)
  v_add_f32 v33, v33, v40
  v_mul_f32 v33, 0x3a800000, v33
  v_cvt_pk_bf16_f32 v32, v32, v32
  v_and_b32 v32, 0xffff0000, v32
  v_cvt_pk_bf16_f32 v33, v33, v33
  v_and_b32 v33, 0xffff0000, v33
  v_add_f32 v33, 0x3727c5ac, v33
  v_cvt_pk_bf16_f32 v33, v33, v33
  v_and_b32 v33, 0xffff0000, v33
  v_sqrt_f32 v33, v33
  s_nop 0
  v_cvt_pk_bf16_f32 v33, v33, v33
  v_and_b32 v33, 0xffff0000, v33
  v_rcp_f32 v35, v33
  s_nop 0
  v_sub_f32 v16, v16, v32
  v_cvt_pk_bf16_f32 v16, v16, v16
  v_and_b32 v16, 0xffff0000, v16
  v_mul_f32 v36, v16, v35
  v_fma_f32 v37, -v36, v33, v16
  v_fma_f32 v16, v37, v35, v36
  v_sub_f32 v17, v17, v32
  v_cvt_pk_bf16_f32 v17, v17, v17
  v_and_b32 v17, 0xffff0000, v17
  v_mul_f32 v36, v17, v35
  v_fma_f32 v37, -v36, v33, v17
  v_fma_f32 v17, v37, v35, v36
  v_sub_f32 v18, v18, v32
  v_cvt_pk_bf16_f32 v18, v18, v18
  v_and_b32 v18, 0xffff0000, v18
  v_mul_f32 v36, v18, v35
  v_fma_f32 v37, -v36, v33, v18
  v_fma_f32 v18, v37, v35, v36
  v_sub_f32 v19, v19, v32
  v_cvt_pk_bf16_f32 v19, v19, v19
  v_and_b32 v19, 0xffff0000, v19
  v_mul_f32 v36, v19, v35
  v_fma_f32 v37, -v36, v33, v19
  v_fma_f32 v19, v37, v35, v36
  v_sub_f32 v20, v20, v32
  v_cvt_pk_bf16_f32 v20, v20, v20
  v_and_b32 v20, 0xffff0000, v20
  v_mul_f32 v36, v20, v35
  v_fma_f32 v37, -v36, v33, v20
  v_fma_f32 v20, v37, v35, v36
  v_sub_f32 v21, v21, v32
  v_cvt_pk_bf16_f32 v21, v21, v21
  v_and_b32 v21, 0xffff0000, v21
  v_mul_f32 v36, v21, v35
  v_fma_f32 v37, -v36, v33, v21
  v_fma_f32 v21, v37, v35, v36
  v_sub_f32 v22, v22, v32
  v_cvt_pk_bf16_f32 v22, v22, v22
  v_and_b32 v22, 0xffff0000, v22
  v_mul_f32 v36, v22, v35
  v_fma_f32 v37, -v36, v33, v22
  v_fma_f32 v22, v37, v35, v36
  v_sub_f32 v23, v23, v32
  v_cvt_pk_bf16_f32 v23, v23, v23
  v_and_b32 v23, 0xffff0000, v23
  v_mul_f32 v36, v23, v35
  v_fma_f32 v37, -v36, v33, v23
  v_fma_f32 v23, v37, v35, v36
  v_sub_f32 v24, v24, v32
  v_cvt_pk_bf16_f32 v24, v24, v24
  v_and_b32 v24, 0xffff0000, v24
  v_mul_f32 v36, v24, v35
  v_fma_f32 v37, -v36, v33, v24
  v_fma_f32 v24, v37, v35, v36
  v_sub_f32 v25, v25, v32
  v_cvt_pk_bf16_f32 v25, v25, v25
  v_and_b32 v25, 0xffff0000, v25
  v_mul_f32 v36, v25, v35
  v_fma_f32 v37, -v36, v33, v25
  v_fma_f32 v25, v37, v35, v36
  v_sub_f32 v26, v26, v32
  v_cvt_pk_bf16_f32 v26, v26, v26
  v_and_b32 v26, 0xffff0000, v26
  v_mul_f32 v36, v26, v35
  v_fma_f32 v37, -v36, v33, v26
  v_fma_f32 v26, v37, v35, v36
  v_sub_f32 v27, v27, v32
  v_cvt_pk_bf16_f32 v27, v27, v27
  v_and_b32 v27, 0xffff0000, v27
  v_mul_f32 v36, v27, v35
  v_fma_f32 v37, -v36, v33, v27
  v_fma_f32 v27, v37, v35, v36
  v_sub_f32 v28, v28, v32
  v_cvt_pk_bf16_f32 v28, v28, v28
  v_and_b32 v28, 0xffff0000, v28
  v_mul_f32 v36, v28, v35
  v_fma_f32 v37, -v36, v33, v28
  v_fma_f32 v28, v37, v35, v36
  v_sub_f32 v29, v29, v32
  v_cvt_pk_bf16_f32 v29, v29, v29
  v_and_b32 v29, 0xffff0000, v29
  v_mul_f32 v36, v29, v35
  v_fma_f32 v37, -v36, v33, v29
  v_fma_f32 v29, v37, v35, v36
  v_sub_f32 v30, v30, v32
  v_cvt_pk_bf16_f32 v30, v30, v30
  v_and_b32 v30, 0xffff0000, v30
  v_mul_f32 v36, v30, v35
  v_fma_f32 v37, -v36, v33, v30
  v_fma_f32 v30, v37, v35, v36
  v_sub_f32 v31, v31, v32
  v_cvt_pk_bf16_f32 v31, v31, v31
  v_and_b32 v31, 0xffff0000, v31
  v_mul_f32 v36, v31, v35
  v_fma_f32 v37, -v36, v33, v31
  v_fma_f32 v31, v37, v35, v36
  v_cvt_pk_bf16_f32 v8, v16, v17
  v_cvt_pk_bf16_f32 v9, v18, v19
  v_cvt_pk_bf16_f32 v10, v20, v21
  v_cvt_pk_bf16_f32 v11, v22, v23
  v_cvt_pk_bf16_f32 v12, v24, v25
  v_cvt_pk_bf16_f32 v13, v26, v27
  v_cvt_pk_bf16_f32 v14, v28, v29
  v_cvt_pk_bf16_f32 v15, v30, v31
  buffer_store_dwordx4 v[8:11], v4, s[28:31], 0 offen
  buffer_store_dwordx4 v[12:15], v4, s[28:31], 0 offen offset:1024
L_ln2_kernel_end:
  s_endpgm
.globl gemmq2_kernel
.p2align 8
.type gemmq2_kernel,@function
gemmq2_kernel:
  s_cmp_ge_u32 s2, 256
  s_cbranch_scc1 L_gemmq2_kernel_end
  s_load_dwordx16 s[4:19], s[0:1], 0
  s_load_dwordx2 s[20:21], s[0:1], 64
  s_waitcnt lgkmcnt(0)
  s_mov_b32 s24, s20
  s_and_b32 s25, s21, 0xffff
  s_mov_b32 s26, 4194304
  s_mov_b32 s27, 0x00020000
  s_mov_b32 s28, s6
  s_and_b32 s29, s7, 0xffff
  s_mov_b32 s30, 6291456
  s_mov_b32 s31, 0x00020000
  s_add_u32 s32, s20, 4194304
  s_addc_u32 s33, s21, 0
  s_and_b32 s33, s33, 0xffff
  s_mov_b32 s34, 12582912
  s_mov_b32 s35, 0x00020000
  s_mov_b32 s3, 268435457
  s_mul_hi_u32 s40, s2, s3
  s_mul_i32 s3, s40, 16
  s_sub_u32 s41, s2, s3
  v_and_b32 v1, 63, v0
  v_lshrrev_b32 v2, 6, v0
  s_nop 0
  v_readfirstlane_b32 s42, v2
  v_lshrrev_b32 v14, 3, v1
  v_and_b32 v15, 7, v1
  v_xor_b32 v3, v14, v15
  v_lshlrev_b32 v4, 11, v14
  v_lshl_add_u32 v4, v3, 4, v4
  v_bfe_u32 v3, v1, 4, 1
  v_and_b32 v5, 1, v2
  v_lshl_add_u32 v3, v5, 1, v3
  v_lshrrev_b32 v5, 1, v15
  v_xor_b32 v3, v3, v5
  v_lshlrev_b32 v3, 1, v3
  v_and_b32 v5, 1, v15
  v_or_b32 v3, v3, v5
  v_lshl_add_u32 v5, v2, 3, v14
  v_mul_u32_u24 v5, 6144, v5
  v_lshl_add_u32 v5, v3, 4, v5
  s_mul_i32 s44, s40, 262144
  s_lshl_b32 s3, s42, 14
  s_add_u32 s44, s44, s3
  s_add_u32 s45, s44, 131072
  s_mul_i32 s46, s41, 384
  s_add_u32 s47, s46, 128
  s_add_u32 s48, s46, 256
  s_lshl_b32 s43, s42, 10
  v_and_b32 v6, 3, v2
  v_lshrrev_b32 v7, 2, v2
  v_and_b32 v14, 15, v1
  v_lshrrev_b32 v15, 4, v1
  v_mul_u32_u24 v8, 64, v7
  v_add_u32 v8, v8, v14
  v_lshlrev_b32 v8, 7, v8
  v_and_b32 v3, 7, v1
  v_xor_b32 v3, v3, v15
  v_lshl_add_u32 v9, v3, 4, v8
  v_xor_b32 v3, 4, v3
  v_lshl_add_u32 v8, v3, 4, v8
  v_mov_b32 v3, v9
  v_mov_b32 v9, v8
  v_mov_b32 v8, v3
  v_bfe_u32 v3, v1, 2, 2
  v_lshl_add_u32 v10, v15, 3, v3
  v_lshlrev_b32 v10, 7, v10
  v_and_b32 v11, 3, v1
  v_lshl_add_u32 v10, v11, 3, v10
  v_lshrrev_b32 v3, 1, v3
  v_and_b32 v11, 1, v15
  v_lshl_add_u32 v3, v11, 1, v3
  v_mul_u32_u24 v11, 3, v6
  v_add_u32 v120, 0, v11
  v_and_b32 v121, 3, v120
  v_xor_b32 v121, v121, v3
  v_lshlrev_b32 v121, 5, v121
  v_lshrrev_b32 v120, 2, v120
  v_lshl_add_u32 v121, v120, 13, v121
  v_add_u32 v122, v10, v121
  v_add_u32 v122, 16384, v122
  v_add_u32 v120, 1, v11
  v_and_b32 v121, 3, v120
  v_xor_b32 v121, v121, v3
  v_lshlrev_b32 v121, 5, v121
  v_lshrrev_b32 v120, 2, v120
  v_lshl_add_u32 v121, v120, 13, v121
  v_add_u32 v123, v10, v121
  v_add_u32 v123, 16384, v123
  v_add_u32 v120, 2, v11
  v_and_b32 v121, 3, v120
  v_xor_b32 v121, v121, v3
  v_lshlrev_b32 v121, 5, v121
  v_lshrrev_b32 v120, 2, v120
  v_lshl_add_u32 v121, v120, 13, v121
  v_add_u32 v124, v10, v121
  v_add_u32 v124, 16384, v124
  v_add_u32 v128, 0, v8
  v_add_u32 v129, 0, v9
  v_add_u32 v134, 0, v122
  v_add_u32 v135, 0, v123
  v_add_u32 v136, 0, v124
  v_add_u32 v130, 40960, v8
  v_add_u32 v131, 40960, v9
  v_add_u32 v137, 40960, v122
  v_add_u32 v138, 40960, v123
  v_add_u32 v139, 40960, v124
  v_add_u32 v132, 81920, v8
  v_add_u32 v133, 81920, v9
  v_add_u32 v140, 81920, v122
  v_add_u32 v141, 81920, v123
  v_add_u32 v142, 81920, v124
  s_mul_i32 s3, s40, 128
  v_mul_u32_u24 v13, 64, v7
  v_add_u32 v13, v13, v14
  v_add_u32 v13, s3, v13
  v_mul_u32_u24 v13, 6144, v13
  s_mul_i32 s3, s41, 384
  v_mul_u32_u24 v3, 96, v6
  v_add_u32 v13, v13, v3
  v_lshl_add_u32 v13, v15, 3, v13
  v_add_u32 v13, s3, v13
  v_mov_b32 v72, 0
  v_mov_b32 v73, 0
  v_mov_b32 v74, 0
  v_mov_b32 v75, 0
  v_mov_b32 v76, 0
  v_mov_b32 v77, 0
  v_mov_b32 v78, 0
  v_mov_b32 v79, 0
  v_mov_b32 v80, 0
  v_mov_b32 v81, 0
  v_mov_b32 v82, 0
  v_mov_b32 v83, 0
  v_mov_b32 v84, 0
  v_mov_b32 v85, 0
  v_mov_b32 v86, 0
  v_mov_b32 v87, 0
  v_mov_b32 v88, 0
  v_mov_b32 v89, 0
  v_mov_b32 v90, 0
  v_mov_b32 v91, 0
  v_mov_b32 v92, 0
  v_mov_b32 v93, 0
  v_mov_b32 v94, 0
  v_mov_b32 v95, 0
  v_mov_b32 v96, 0
  v_mov_b32 v97, 0
  v_mov_b32 v98, 0
  v_mov_b32 v99, 0
  v_mov_b32 v100, 0
  v_mov_b32 v101, 0
  v_mov_b32 v102, 0
  v_mov_b32 v103, 0
  v_mov_b32 v104, 0
  v_mov_b32 v105, 0
  v_mov_b32 v106, 0
  v_mov_b32 v107, 0
  v_mov_b32 v108, 0
  v_mov_b32 v109, 0
  v_mov_b32 v110, 0
  v_mov_b32 v111, 0
  v_mov_b32 v112, 0
  v_mov_b32 v113, 0
  v_mov_b32 v114, 0
  v_mov_b32 v115, 0
  v_mov_b32 v116, 0
  v_mov_b32 v117, 0
  v_mov_b32 v118, 0
  v_mov_b32 v119, 0
  s_add_u32 m0, s43, 0
  s_nop 0
  buffer_load_dwordx4 v4, s[24:27], s44 offen lds
  s_add_u32 s44, s44, 128
  s_add_u32 m0, s43, 8192
  s_nop 0
  buffer_load_dwordx4 v4, s[24:27], s45 offen lds
  s_add_u32 s45, s45, 128
  s_add_u32 m0, s43, 16384
  s_nop 0
  buffer_load_dwordx4 v5, s[28:31], s46 offen lds
  s_add_u32 s46, s46, 393216
  s_add_u32 m0, s43, 24576
  s_nop 0
  buffer_load_dwordx4 v5, s[28:31], s47 offen lds
  s_add_u32 s47, s47, 393216
  s_add_u32 m0, s43, 32768
  s_nop 0
  buffer_load_dwordx4 v5, s[28:31], s48 offen lds
  s_add_u32 s48, s48, 393216
  s_add_u32 m0, s43, 40960
  s_nop 0
  buffer_load_dwordx4 v4, s[24:27], s44 offen lds
  s_add_u32 s44, s44, 128
  s_add_u32 m0, s43, 49152
  s_nop 0
  buffer_load_dwordx4 v4, s[24:27], s45 offen lds
  s_add_u32 s45, s45, 128
  s_add_u32 m0, s43, 57344
  s_nop 0
  buffer_load_dwordx4 v5, s[28:31], s46 offen lds
  s_add_u32 s46, s46, 393216
  s_add_u32 m0, s43, 65536
  s_nop 0
  buffer_load_dwordx4 v5, s[28:31], s47 offen lds
  s_add_u32 s47, s47, 393216
  s_add_u32 m0, s43, 73728
  s_nop 0
  buffer_load_dwordx4 v5, s[28:31], s48 offen lds
  s_add_u32 s48, s48, 393216
  s_waitcnt vmcnt(5)
  s_barrier
  s_add_u32 m0, s43, 81920
  s_nop 0
  buffer_load_dwordx4 v4, s[24:27], s44 offen lds
  s_add_u32 s44, s44, 128
  s_add_u32 m0, s43, 90112
  s_nop 0
  buffer_load_dwordx4 v4, s[24:27], s45 offen lds
  s_add_u32 s45, s45, 128
  s_add_u32 m0, s43, 98304
  s_nop 0
  buffer_load_dwordx4 v5, s[28:31], s46 offen lds
  s_add_u32 s46, s46, 393216
  s_add_u32 m0, s43, 106496
  s_nop 0
  buffer_load_dwordx4 v5, s[28:31], s47 offen lds
  s_add_u32 s47, s47, 393216
  s_add_u32 m0, s43, 114688
  s_nop 0
  buffer_load_dwordx4 v5, s[28:31], s48 offen lds
  s_add_u32 s48, s48, 393216
  ds_read_b128 v[16:19], v128 offset:0
  ds_read_b128 v[20:23], v128 offset:2048
  ds_read_b128 v[24:27], v128 offset:4096
  ds_read_b128 v[28:31], v128 offset:6144
  ds_read_b64_tr_b16 v[48:49], v134 offset:0
  ds_read_b64_tr_b16 v[50:51], v134 offset:512
  ds_read_b64_tr_b16 v[52:53], v135 offset:0
  ds_read_b64_tr_b16 v[54:55], v135 offset:512
  ds_read_b64_tr_b16 v[56:57], v136 offset:0
  ds_read_b64_tr_b16 v[58:59], v136 offset:512
  ds_read_b128 v[32:35], v129 offset:0
  ds_read_b128 v[36:39], v129 offset:2048
  ds_read_b128 v[40:43], v129 offset:4096
  ds_read_b128 v[44:47], v129 offset:6144
  ds_read_b64_tr_b16 v[60:61], v134 offset:4096
  ds_read_b64_tr_b16 v[62:63], v134 offset:4608
  ds_read_b64_tr_b16 v[64:65], v135 offset:4096
  ds_read_b64_tr_b16 v[66:67], v135 offset:4608
  ds_read_b64_tr_b16 v[68:69], v136 offset:4096
  ds_read_b64_tr_b16 v[70:71], v136 offset:4608
  s_waitcnt lgkmcnt(10)
  v_mfma_f32_16x16x32_bf16 v[72:75], v[48:51], v[16:19], v[72:75]
  v_mfma_f32_16x16x32_bf16 v[76:79], v[52:55], v[16:19], v[76:79]
  v_mfma_f32_16x16x32_bf16 v[80:83], v[56:59], v[16:19], v[80:83]
  v_mfma_f32_16x16x32_bf16 v[84:87], v[48:51], v[20:23], v[84:87]
  v_mfma_f32_16x16x32_bf16 v[88:91], v[52:55], v[20:23], v[88:91]
  v_mfma_f32_16x16x32_bf16 v[92:95], v[56:59], v[20:23], v[92:95]
  v_mfma_f32_16x16x32_bf16 v[96:99], v[48:51], v[24:27], v[96:99]
  v_mfma_f32_16x16x32_bf16 v[100:103], v[52:55], v[24:27], v[100:103]
  v_mfma_f32_16x16x32_bf16 v[104:107], v[56:59], v[24:27], v[104:107]
  v_mfma_f32_16x16x32_bf16 v[108:111], v[48:51], v[28:31], v[108:111]
  v_mfma_f32_16x16x32_bf16 v[112:115], v[52:55], v[28:31], v[112:115]
  v_mfma_f32_16x16x32_bf16 v[116:119], v[56:59], v[28:31], v[116:119]
  s_waitcnt lgkmcnt(0)
  v_mfma_f32_16x16x32_bf16 v[72:75], v[60:63], v[32:35], v[72:75]
  v_mfma_f32_16x16x32_bf16 v[76:79], v[64:67], v[32:35], v[76:79]
  v_mfma_f32_16x16x32_bf16 v[80:83], v[68:71], v[32:35], v[80:83]
  v_mfma_f32_16x16x32_bf16 v[84:87], v[60:63], v[36:39], v[84:87]
  v_mfma_f32_16x16x32_bf16 v[88:91], v[64:67], v[36:39], v[88:91]
  v_mfma_f32_16x16x32_bf16 v[92:95], v[68:71], v[36:39], v[92:95]
  v_mfma_f32_16x16x32_bf16 v[96:99], v[60:63], v[40:43], v[96:99]
  v_mfma_f32_16x16x32_bf16 v[100:103], v[64:67], v[40:43], v[100:103]
  v_mfma_f32_16x16x32_bf16 v[104:107], v[68:71], v[40:43], v[104:107]
  v_mfma_f32_16x16x32_bf16 v[108:111], v[60:63], v[44:47], v[108:111]
  v_mfma_f32_16x16x32_bf16 v[112:115], v[64:67], v[44:47], v[112:115]
  v_mfma_f32_16x16x32_bf16 v[116:119], v[68:71], v[44:47], v[116:119]
  s_waitcnt vmcnt(5)
  s_barrier
  s_add_u32 m0, s43, 0
  s_nop 0
  buffer_load_dwordx4 v4, s[24:27], s44 offen lds
  s_add_u32 s44, s44, 128
  s_add_u32 m0, s43, 8192
  s_nop 0
  buffer_load_dwordx4 v4, s[24:27], s45 offen lds
  s_add_u32 s45, s45, 128
  s_add_u32 m0, s43, 16384
  s_nop 0
  buffer_load_dwordx4 v5, s[28:31], s46 offen lds
  s_add_u32 s46, s46, 393216
  s_add_u32 m0, s43, 24576
  s_nop 0
  buffer_load_dwordx4 v5, s[28:31], s47 offen lds
  s_add_u32 s47, s47, 393216
  s_add_u32 m0, s43, 32768
  s_nop 0
  buffer_load_dwordx4 v5, s[28:31], s48 offen lds
  s_add_u32 s48, s48, 393216
  ds_read_b128 v[16:19], v130 offset:0
  ds_read_b128 v[20:23], v130 offset:2048
  ds_read_b128 v[24:27], v130 offset:4096
  ds_read_b128 v[28:31], v130 offset:6144
  ds_read_b64_tr_b16 v[48:49], v137 offset:0
  ds_read_b64_tr_b16 v[50:51], v137 offset:512
  ds_read_b64_tr_b16 v[52:53], v138 offset:0
  ds_read_b64_tr_b16 v[54:55], v138 offset:512
  ds_read_b64_tr_b16 v[56:57], v139 offset:0
  ds_read_b64_tr_b16 v[58:59], v139 offset:512
  ds_read_b128 v[32:35], v131 offset:0
  ds_read_b128 v[36:39], v131 offset:2048
  ds_read_b128 v[40:43], v131 offset:4096
  ds_read_b128 v[44:47], v131 offset:6144
  ds_read_b64_tr_b16 v[60:61], v137 offset:4096
  ds_read_b64_tr_b16 v[62:63], v137 offset:4608
  ds_read_b64_tr_b16 v[64:65], v138 offset:4096
  ds_read_b64_tr_b16 v[66:67], v138 offset:4608
  ds_read_b64_tr_b16 v[68:69], v139 offset:4096
  ds_read_b64_tr_b16 v[70:71], v139 offset:4608
  s_waitcnt lgkmcnt(10)
  v_mfma_f32_16x16x32_bf16 v[72:75], v[48:51], v[16:19], v[72:75]
  v_mfma_f32_16x16x32_bf16 v[76:79], v[52:55], v[16:19], v[76:79]
  v_mfma_f32_16x16x32_bf16 v[80:83], v[56:59], v[16:19], v[80:83]
  v_mfma_f32_16x16x32_bf16 v[84:87], v[48:51], v[20:23], v[84:87]
  v_mfma_f32_16x16x32_bf16 v[88:91], v[52:55], v[20:23], v[88:91]
  v_mfma_f32_16x16x32_bf16 v[92:95], v[56:59], v[20:23], v[92:95]
  v_mfma_f32_16x16x32_bf16 v[96:99], v[48:51], v[24:27], v[96:99]
  v_mfma_f32_16x16x32_bf16 v[100:103], v[52:55], v[24:27], v[100:103]
  v_mfma_f32_16x16x32_bf16 v[104:107], v[56:59], v[24:27], v[104:107]
  v_mfma_f32_16x16x32_bf16 v[108:111], v[48:51], v[28:31], v[108:111]
  v_mfma_f32_16x16x32_bf16 v[112:115], v[52:55], v[28:31], v[112:115]
  v_mfma_f32_16x16x32_bf16 v[116:119], v[56:59], v[28:31], v[116:119]
  s_waitcnt lgkmcnt(0)
  v_mfma_f32_16x16x32_bf16 v[72:75], v[60:63], v[32:35], v[72:75]
  v_mfma_f32_16x16x32_bf16 v[76:79], v[64:67], v[32:35], v[76:79]
  v_mfma_f32_16x16x32_bf16 v[80:83], v[68:71], v[32:35], v[80:83]
  v_mfma_f32_16x16x32_bf16 v[84:87], v[60:63], v[36:39], v[84:87]
  v_mfma_f32_16x16x32_bf16 v[88:91], v[64:67], v[36:39], v[88:91]
  v_mfma_f32_16x16x32_bf16 v[92:95], v[68:71], v[36:39], v[92:95]
  v_mfma_f32_16x16x32_bf16 v[96:99], v[60:63], v[40:43], v[96:99]
  v_mfma_f32_16x16x32_bf16 v[100:103], v[64:67], v[40:43], v[100:103]
  v_mfma_f32_16x16x32_bf16 v[104:107], v[68:71], v[40:43], v[104:107]
  v_mfma_f32_16x16x32_bf16 v[108:111], v[60:63], v[44:47], v[108:111]
  v_mfma_f32_16x16x32_bf16 v[112:115], v[64:67], v[44:47], v[112:115]
  v_mfma_f32_16x16x32_bf16 v[116:119], v[68:71], v[44:47], v[116:119]
  s_waitcnt vmcnt(5)
  s_barrier
  s_add_u32 m0, s43, 40960
  s_nop 0
  buffer_load_dwordx4 v4, s[24:27], s44 offen lds
  s_add_u32 s44, s44, 128
  s_add_u32 m0, s43, 49152
  s_nop 0
  buffer_load_dwordx4 v4, s[24:27], s45 offen lds
  s_add_u32 s45, s45, 128
  s_add_u32 m0, s43, 57344
  s_nop 0
  buffer_load_dwordx4 v5, s[28:31], s46 offen lds
  s_add_u32 s46, s46, 393216
  s_add_u32 m0, s43, 65536
  s_nop 0
  buffer_load_dwordx4 v5, s[28:31], s47 offen lds
  s_add_u32 s47, s47, 393216
  s_add_u32 m0, s43, 73728
  s_nop 0
  buffer_load_dwordx4 v5, s[28:31], s48 offen lds
  s_add_u32 s48, s48, 393216
  ds_read_b128 v[16:19], v132 offset:0
  ds_read_b128 v[20:23], v132 offset:2048
  ds_read_b128 v[24:27], v132 offset:4096
  ds_read_b128 v[28:31], v132 offset:6144
  ds_read_b64_tr_b16 v[48:49], v140 offset:0
  ds_read_b64_tr_b16 v[50:51], v140 offset:512
  ds_read_b64_tr_b16 v[52:53], v141 offset:0
  ds_read_b64_tr_b16 v[54:55], v141 offset:512
  ds_read_b64_tr_b16 v[56:57], v142 offset:0
  ds_read_b64_tr_b16 v[58:59], v142 offset:512
  ds_read_b128 v[32:35], v133 offset:0
  ds_read_b128 v[36:39], v133 offset:2048
  ds_read_b128 v[40:43], v133 offset:4096
  ds_read_b128 v[44:47], v133 offset:6144
  ds_read_b64_tr_b16 v[60:61], v140 offset:4096
  ds_read_b64_tr_b16 v[62:63], v140 offset:4608
  ds_read_b64_tr_b16 v[64:65], v141 offset:4096
  ds_read_b64_tr_b16 v[66:67], v141 offset:4608
  ds_read_b64_tr_b16 v[68:69], v142 offset:4096
  ds_read_b64_tr_b16 v[70:71], v142 offset:4608
  s_waitcnt lgkmcnt(10)
  v_mfma_f32_16x16x32_bf16 v[72:75], v[48:51], v[16:19], v[72:75]
  v_mfma_f32_16x16x32_bf16 v[76:79], v[52:55], v[16:19], v[76:79]
  v_mfma_f32_16x16x32_bf16 v[80:83], v[56:59], v[16:19], v[80:83]
  v_mfma_f32_16x16x32_bf16 v[84:87], v[48:51], v[20:23], v[84:87]
  v_mfma_f32_16x16x32_bf16 v[88:91], v[52:55], v[20:23], v[88:91]
  v_mfma_f32_16x16x32_bf16 v[92:95], v[56:59], v[20:23], v[92:95]
  v_mfma_f32_16x16x32_bf16 v[96:99], v[48:51], v[24:27], v[96:99]
  v_mfma_f32_16x16x32_bf16 v[100:103], v[52:55], v[24:27], v[100:103]
  v_mfma_f32_16x16x32_bf16 v[104:107], v[56:59], v[24:27], v[104:107]
  v_mfma_f32_16x16x32_bf16 v[108:111], v[48:51], v[28:31], v[108:111]
  v_mfma_f32_16x16x32_bf16 v[112:115], v[52:55], v[28:31], v[112:115]
  v_mfma_f32_16x16x32_bf16 v[116:119], v[56:59], v[28:31], v[116:119]
  s_waitcnt lgkmcnt(0)
  v_mfma_f32_16x16x32_bf16 v[72:75], v[60:63], v[32:35], v[72:75]
  v_mfma_f32_16x16x32_bf16 v[76:79], v[64:67], v[32:35], v[76:79]
  v_mfma_f32_16x16x32_bf16 v[80:83], v[68:71], v[32:35], v[80:83]
  v_mfma_f32_16x16x32_bf16 v[84:87], v[60:63], v[36:39], v[84:87]
  v_mfma_f32_16x16x32_bf16 v[88:91], v[64:67], v[36:39], v[88:91]
  v_mfma_f32_16x16x32_bf16 v[92:95], v[68:71], v[36:39], v[92:95]
  v_mfma_f32_16x16x32_bf16 v[96:99], v[60:63], v[40:43], v[96:99]
  v_mfma_f32_16x16x32_bf16 v[100:103], v[64:67], v[40:43], v[100:103]
  v_mfma_f32_16x16x32_bf16 v[104:107], v[68:71], v[40:43], v[104:107]
  v_mfma_f32_16x16x32_bf16 v[108:111], v[60:63], v[44:47], v[108:111]
  v_mfma_f32_16x16x32_bf16 v[112:115], v[64:67], v[44:47], v[112:115]
  v_mfma_f32_16x16x32_bf16 v[116:119], v[68:71], v[44:47], v[116:119]
  s_waitcnt vmcnt(5)
  s_barrier
  s_add_u32 m0, s43, 81920
  s_nop 0
  buffer_load_dwordx4 v4, s[24:27], s44 offen lds
  s_add_u32 s44, s44, 128
  s_add_u32 m0, s43, 90112
  s_nop 0
  buffer_load_dwordx4 v4, s[24:27], s45 offen lds
  s_add_u32 s45, s45, 128
  s_add_u32 m0, s43, 98304
  s_nop 0
  buffer_load_dwordx4 v5, s[28:31], s46 offen lds
  s_add_u32 s46, s46, 393216
  s_add_u32 m0, s43, 106496
  s_nop 0
  buffer_load_dwordx4 v5, s[28:31], s47 offen lds
  s_add_u32 s47, s47, 393216
  s_add_u32 m0, s43, 114688
  s_nop 0
  buffer_load_dwordx4 v5, s[28:31], s48 offen lds
  s_add_u32 s48, s48, 393216
  ds_read_b128 v[16:19], v128 offset:0
  ds_read_b128 v[20:23], v128 offset:2048
  ds_read_b128 v[24:27], v128 offset:4096
  ds_read_b128 v[28:31], v128 offset:6144
  ds_read_b64_tr_b16 v[48:49], v134 offset:0
  ds_read_b64_tr_b16 v[50:51], v134 offset:512
  ds_read_b64_tr_b16 v[52:53], v135 offset:0
  ds_read_b64_tr_b16 v[54:55], v135 offset:512
  ds_read_b64_tr_b16 v[56:57], v136 offset:0
  ds_read_b64_tr_b16 v[58:59], v136 offset:512
  ds_read_b128 v[32:35], v129 offset:0
  ds_read_b128 v[36:39], v129 offset:2048
  ds_read_b128 v[40:43], v129 offset:4096
  ds_read_b128 v[44:47], v129 offset:6144
  ds_read_b64_tr_b16 v[60:61], v134 offset:4096
  ds_read_b64_tr_b16 v[62:63], v134 offset:4608
  ds_read_b64_tr_b16 v[64:65], v135 offset:4096
  ds_read_b64_tr_b16 v[66:67], v135 offset:4608
  ds_read_b64_tr_b16 v[68:69], v136 offset:4096
  ds_read_b64_tr_b16 v[70:71], v136 offset:4608
  s_waitcnt lgkmcnt(10)
  v_mfma_f32_16x16x32_bf16 v[72:75], v[48:51], v[16:19], v[72:75]
  v_mfma_f32_16x16x32_bf16 v[76:79], v[52:55], v[16:19], v[76:79]
  v_mfma_f32_16x16x32_bf16 v[80:83], v[56:59], v[16:19], v[80:83]
  v_mfma_f32_16x16x32_bf16 v[84:87], v[48:51], v[20:23], v[84:87]
  v_mfma_f32_16x16x32_bf16 v[88:91], v[52:55], v[20:23], v[88:91]
  v_mfma_f32_16x16x32_bf16 v[92:95], v[56:59], v[20:23], v[92:95]
  v_mfma_f32_16x16x32_bf16 v[96:99], v[48:51], v[24:27], v[96:99]
  v_mfma_f32_16x16x32_bf16 v[100:103], v[52:55], v[24:27], v[100:103]
  v_mfma_f32_16x16x32_bf16 v[104:107], v[56:59], v[24:27], v[104:107]
  v_mfma_f32_16x16x32_bf16 v[108:111], v[48:51], v[28:31], v[108:111]
  v_mfma_f32_16x16x32_bf16 v[112:115], v[52:55], v[28:31], v[112:115]
  v_mfma_f32_16x16x32_bf16 v[116:119], v[56:59], v[28:31], v[116:119]
  s_waitcnt lgkmcnt(0)
  v_mfma_f32_16x16x32_bf16 v[72:75], v[60:63], v[32:35], v[72:75]
  v_mfma_f32_16x16x32_bf16 v[76:79], v[64:67], v[32:35], v[76:79]
  v_mfma_f32_16x16x32_bf16 v[80:83], v[68:71], v[32:35], v[80:83]
  v_mfma_f32_16x16x32_bf16 v[84:87], v[60:63], v[36:39], v[84:87]
  v_mfma_f32_16x16x32_bf16 v[88:91], v[64:67], v[36:39], v[88:91]
  v_mfma_f32_16x16x32_bf16 v[92:95], v[68:71], v[36:39], v[92:95]
  v_mfma_f32_16x16x32_bf16 v[96:99], v[60:63], v[40:43], v[96:99]
  v_mfma_f32_16x16x32_bf16 v[100:103], v[64:67], v[40:43], v[100:103]
  v_mfma_f32_16x16x32_bf16 v[104:107], v[68:71], v[40:43], v[104:107]
  v_mfma_f32_16x16x32_bf16 v[108:111], v[60:63], v[44:47], v[108:111]
  v_mfma_f32_16x16x32_bf16 v[112:115], v[64:67], v[44:47], v[112:115]
  v_mfma_f32_16x16x32_bf16 v[116:119], v[68:71], v[44:47], v[116:119]
  s_waitcnt vmcnt(5)
  s_barrier
  s_add_u32 m0, s43, 0
  s_nop 0
  buffer_load_dwordx4 v4, s[24:27], s44 offen lds
  s_add_u32 s44, s44, 128
  s_add_u32 m0, s43, 8192
  s_nop 0
  buffer_load_dwordx4 v4, s[24:27], s45 offen lds
  s_add_u32 s45, s45, 128
  s_add_u32 m0, s43, 16384
  s_nop 0
  buffer_load_dwordx4 v5, s[28:31], s46 offen lds
  s_add_u32 s46, s46, 393216
  s_add_u32 m0, s43, 24576
  s_nop 0
  buffer_load_dwordx4 v5, s[28:31], s47 offen lds
  s_add_u32 s47, s47, 393216
  s_add_u32 m0, s43, 32768
  s_nop 0
  buffer_load_dwordx4 v5, s[28:31], s48 offen lds
  s_add_u32 s48, s48, 393216
  ds_read_b128 v[16:19], v130 offset:0
  ds_read_b128 v[20:23], v130 offset:2048
  ds_read_b128 v[24:27], v130 offset:4096
  ds_read_b128 v[28:31], v130 offset:6144
  ds_read_b64_tr_b16 v[48:49], v137 offset:0
  ds_read_b64_tr_b16 v[50:51], v137 offset:512
  ds_read_b64_tr_b16 v[52:53], v138 offset:0
  ds_read_b64_tr_b16 v[54:55], v138 offset:512
  ds_read_b64_tr_b16 v[56:57], v139 offset:0
  ds_read_b64_tr_b16 v[58:59], v139 offset:512
  ds_read_b128 v[32:35], v131 offset:0
  ds_read_b128 v[36:39], v131 offset:2048
  ds_read_b128 v[40:43], v131 offset:4096
  ds_read_b128 v[44:47], v131 offset:6144
  ds_read_b64_tr_b16 v[60:61], v137 offset:4096
  ds_read_b64_tr_b16 v[62:63], v137 offset:4608
  ds_read_b64_tr_b16 v[64:65], v138 offset:4096
  ds_read_b64_tr_b16 v[66:67], v138 offset:4608
  ds_read_b64_tr_b16 v[68:69], v139 offset:4096
  ds_read_b64_tr_b16 v[70:71], v139 offset:4608
  s_waitcnt lgkmcnt(10)
  v_mfma_f32_16x16x32_bf16 v[72:75], v[48:51], v[16:19], v[72:75]
  v_mfma_f32_16x16x32_bf16 v[76:79], v[52:55], v[16:19], v[76:79]
  v_mfma_f32_16x16x32_bf16 v[80:83], v[56:59], v[16:19], v[80:83]
  v_mfma_f32_16x16x32_bf16 v[84:87], v[48:51], v[20:23], v[84:87]
  v_mfma_f32_16x16x32_bf16 v[88:91], v[52:55], v[20:23], v[88:91]
  v_mfma_f32_16x16x32_bf16 v[92:95], v[56:59], v[20:23], v[92:95]
  v_mfma_f32_16x16x32_bf16 v[96:99], v[48:51], v[24:27], v[96:99]
  v_mfma_f32_16x16x32_bf16 v[100:103], v[52:55], v[24:27], v[100:103]
  v_mfma_f32_16x16x32_bf16 v[104:107], v[56:59], v[24:27], v[104:107]
  v_mfma_f32_16x16x32_bf16 v[108:111], v[48:51], v[28:31], v[108:111]
  v_mfma_f32_16x16x32_bf16 v[112:115], v[52:55], v[28:31], v[112:115]
  v_mfma_f32_16x16x32_bf16 v[116:119], v[56:59], v[28:31], v[116:119]
  s_waitcnt lgkmcnt(0)
  v_mfma_f32_16x16x32_bf16 v[72:75], v[60:63], v[32:35], v[72:75]
  v_mfma_f32_16x16x32_bf16 v[76:79], v[64:67], v[32:35], v[76:79]
  v_mfma_f32_16x16x32_bf16 v[80:83], v[68:71], v[32:35], v[80:83]
  v_mfma_f32_16x16x32_bf16 v[84:87], v[60:63], v[36:39], v[84:87]
  v_mfma_f32_16x16x32_bf16 v[88:91], v[64:67], v[36:39], v[88:91]
  v_mfma_f32_16x16x32_bf16 v[92:95], v[68:71], v[36:39], v[92:95]
  v_mfma_f32_16x16x32_bf16 v[96:99], v[60:63], v[40:43], v[96:99]
  v_mfma_f32_16x16x32_bf16 v[100:103], v[64:67], v[40:43], v[100:103]
  v_mfma_f32_16x16x32_bf16 v[104:107], v[68:71], v[40:43], v[104:107]
  v_mfma_f32_16x16x32_bf16 v[108:111], v[60:63], v[44:47], v[108:111]
  v_mfma_f32_16x16x32_bf16 v[112:115], v[64:67], v[44:47], v[112:115]
  v_mfma_f32_16x16x32_bf16 v[116:119], v[68:71], v[44:47], v[116:119]
  s_waitcnt vmcnt(5)
  s_barrier
  s_add_u32 m0, s43, 40960
  s_nop 0
  buffer_load_dwordx4 v4, s[24:27], s44 offen lds
  s_add_u32 s44, s44, 128
  s_add_u32 m0, s43, 49152
  s_nop 0
  buffer_load_dwordx4 v4, s[24:27], s45 offen lds
  s_add_u32 s45, s45, 128
  s_add_u32 m0, s43, 57344
  s_nop 0
  buffer_load_dwordx4 v5, s[28:31], s46 offen lds
  s_add_u32 s46, s46, 393216
  s_add_u32 m0, s43, 65536
  s_nop 0
  buffer_load_dwordx4 v5, s[28:31], s47 offen lds
  s_add_u32 s47, s47, 393216
  s_add_u32 m0, s43, 73728
  s_nop 0
  buffer_load_dwordx4 v5, s[28:31], s48 offen lds
  s_add_u32 s48, s48, 393216
  ds_read_b128 v[16:19], v132 offset:0
  ds_read_b128 v[20:23], v132 offset:2048
  ds_read_b128 v[24:27], v132 offset:4096
  ds_read_b128 v[28:31], v132 offset:6144
  ds_read_b64_tr_b16 v[48:49], v140 offset:0
  ds_read_b64_tr_b16 v[50:51], v140 offset:512
  ds_read_b64_tr_b16 v[52:53], v141 offset:0
  ds_read_b64_tr_b16 v[54:55], v141 offset:512
  ds_read_b64_tr_b16 v[56:57], v142 offset:0
  ds_read_b64_tr_b16 v[58:59], v142 offset:512
  ds_read_b128 v[32:35], v133 offset:0
  ds_read_b128 v[36:39], v133 offset:2048
  ds_read_b128 v[40:43], v133 offset:4096
  ds_read_b128 v[44:47], v133 offset:6144
  ds_read_b64_tr_b16 v[60:61], v140 offset:4096
  ds_read_b64_tr_b16 v[62:63], v140 offset:4608
  ds_read_b64_tr_b16 v[64:65], v141 offset:4096
  ds_read_b64_tr_b16 v[66:67], v141 offset:4608
  ds_read_b64_tr_b16 v[68:69], v142 offset:4096
  ds_read_b64_tr_b16 v[70:71], v142 offset:4608
  s_waitcnt lgkmcnt(10)
  v_mfma_f32_16x16x32_bf16 v[72:75], v[48:51], v[16:19], v[72:75]
  v_mfma_f32_16x16x32_bf16 v[76:79], v[52:55], v[16:19], v[76:79]
  v_mfma_f32_16x16x32_bf16 v[80:83], v[56:59], v[16:19], v[80:83]
  v_mfma_f32_16x16x32_bf16 v[84:87], v[48:51], v[20:23], v[84:87]
  v_mfma_f32_16x16x32_bf16 v[88:91], v[52:55], v[20:23], v[88:91]
  v_mfma_f32_16x16x32_bf16 v[92:95], v[56:59], v[20:23], v[92:95]
  v_mfma_f32_16x16x32_bf16 v[96:99], v[48:51], v[24:27], v[96:99]
  v_mfma_f32_16x16x32_bf16 v[100:103], v[52:55], v[24:27], v[100:103]
  v_mfma_f32_16x16x32_bf16 v[104:107], v[56:59], v[24:27], v[104:107]
  v_mfma_f32_16x16x32_bf16 v[108:111], v[48:51], v[28:31], v[108:111]
  v_mfma_f32_16x16x32_bf16 v[112:115], v[52:55], v[28:31], v[112:115]
  v_mfma_f32_16x16x32_bf16 v[116:119], v[56:59], v[28:31], v[116:119]
  s_waitcnt lgkmcnt(0)
  v_mfma_f32_16x16x32_bf16 v[72:75], v[60:63], v[32:35], v[72:75]
  v_mfma_f32_16x16x32_bf16 v[76:79], v[64:67], v[32:35], v[76:79]
  v_mfma_f32_16x16x32_bf16 v[80:83], v[68:71], v[32:35], v[80:83]
  v_mfma_f32_16x16x32_bf16 v[84:87], v[60:63], v[36:39], v[84:87]
  v_mfma_f32_16x16x32_bf16 v[88:91], v[64:67], v[36:39], v[88:91]
  v_mfma_f32_16x16x32_bf16 v[92:95], v[68:71], v[36:39], v[92:95]
  v_mfma_f32_16x16x32_bf16 v[96:99], v[60:63], v[40:43], v[96:99]
  v_mfma_f32_16x16x32_bf16 v[100:103], v[64:67], v[40:43], v[100:103]
  v_mfma_f32_16x16x32_bf16 v[104:107], v[68:71], v[40:43], v[104:107]
  v_mfma_f32_16x16x32_bf16 v[108:111], v[60:63], v[44:47], v[108:111]
  v_mfma_f32_16x16x32_bf16 v[112:115], v[64:67], v[44:47], v[112:115]
  v_mfma_f32_16x16x32_bf16 v[116:119], v[68:71], v[44:47], v[116:119]
  s_waitcnt vmcnt(5)
  s_barrier
  s_add_u32 m0, s43, 81920
  s_nop 0
  buffer_load_dwordx4 v4, s[24:27], s44 offen lds
  s_add_u32 s44, s44, 128
  s_add_u32 m0, s43, 90112
  s_nop 0
  buffer_load_dwordx4 v4, s[24:27], s45 offen lds
  s_add_u32 s45, s45, 128
  s_add_u32 m0, s43, 98304
  s_nop 0
  buffer_load_dwordx4 v5, s[28:31], s46 offen lds
  s_add_u32 s46, s46, 393216
  s_add_u32 m0, s43, 106496
  s_nop 0
  buffer_load_dwordx4 v5, s[28:31], s47 offen lds
  s_add_u32 s47, s47, 393216
  s_add_u32 m0, s43, 114688
  s_nop 0
  buffer_load_dwordx4 v5, s[28:31], s48 offen lds
  s_add_u32 s48, s48, 393216
  ds_read_b128 v[16:19], v128 offset:0
  ds_read_b128 v[20:23], v128 offset:2048
  ds_read_b128 v[24:27], v128 offset:4096
  ds_read_b128 v[28:31], v128 offset:6144
  ds_read_b64_tr_b16 v[48:49], v134 offset:0
  ds_read_b64_tr_b16 v[50:51], v134 offset:512
  ds_read_b64_tr_b16 v[52:53], v135 offset:0
  ds_read_b64_tr_b16 v[54:55], v135 offset:512
  ds_read_b64_tr_b16 v[56:57], v136 offset:0
  ds_read_b64_tr_b16 v[58:59], v136 offset:512
  ds_read_b128 v[32:35], v129 offset:0
  ds_read_b128 v[36:39], v129 offset:2048
  ds_read_b128 v[40:43], v129 offset:4096
  ds_read_b128 v[44:47], v129 offset:6144
  ds_read_b64_tr_b16 v[60:61], v134 offset:4096
  ds_read_b64_tr_b16 v[62:63], v134 offset:4608
  ds_read_b64_tr_b16 v[64:65], v135 offset:4096
  ds_read_b64_tr_b16 v[66:67], v135 offset:4608
  ds_read_b64_tr_b16 v[68:69], v136 offset:4096
  ds_read_b64_tr_b16 v[70:71], v136 offset:4608
  s_waitcnt lgkmcnt(10)
  v_mfma_f32_16x16x32_bf16 v[72:75], v[48:51], v[16:19], v[72:75]
  v_mfma_f32_16x16x32_bf16 v[76:79], v[52:55], v[16:19], v[76:79]
  v_mfma_f32_16x16x32_bf16 v[80:83], v[56:59], v[16:19], v[80:83]
  v_mfma_f32_16x16x32_bf16 v[84:87], v[48:51], v[20:23], v[84:87]
  v_mfma_f32_16x16x32_bf16 v[88:91], v[52:55], v[20:23], v[88:91]
  v_mfma_f32_16x16x32_bf16 v[92:95], v[56:59], v[20:23], v[92:95]
  v_mfma_f32_16x16x32_bf16 v[96:99], v[48:51], v[24:27], v[96:99]
  v_mfma_f32_16x16x32_bf16 v[100:103], v[52:55], v[24:27], v[100:103]
  v_mfma_f32_16x16x32_bf16 v[104:107], v[56:59], v[24:27], v[104:107]
  v_mfma_f32_16x16x32_bf16 v[108:111], v[48:51], v[28:31], v[108:111]
  v_mfma_f32_16x16x32_bf16 v[112:115], v[52:55], v[28:31], v[112:115]
  v_mfma_f32_16x16x32_bf16 v[116:119], v[56:59], v[28:31], v[116:119]
  s_waitcnt lgkmcnt(0)
  v_mfma_f32_16x16x32_bf16 v[72:75], v[60:63], v[32:35], v[72:75]
  v_mfma_f32_16x16x32_bf16 v[76:79], v[64:67], v[32:35], v[76:79]
  v_mfma_f32_16x16x32_bf16 v[80:83], v[68:71], v[32:35], v[80:83]
  v_mfma_f32_16x16x32_bf16 v[84:87], v[60:63], v[36:39], v[84:87]
  v_mfma_f32_16x16x32_bf16 v[88:91], v[64:67], v[36:39], v[88:91]
  v_mfma_f32_16x16x32_bf16 v[92:95], v[68:71], v[36:39], v[92:95]
  v_mfma_f32_16x16x32_bf16 v[96:99], v[60:63], v[40:43], v[96:99]
  v_mfma_f32_16x16x32_bf16 v[100:103], v[64:67], v[40:43], v[100:103]
  v_mfma_f32_16x16x32_bf16 v[104:107], v[68:71], v[40:43], v[104:107]
  v_mfma_f32_16x16x32_bf16 v[108:111], v[60:63], v[44:47], v[108:111]
  v_mfma_f32_16x16x32_bf16 v[112:115], v[64:67], v[44:47], v[112:115]
  v_mfma_f32_16x16x32_bf16 v[116:119], v[68:71], v[44:47], v[116:119]
  s_waitcnt vmcnt(5)
  s_barrier
  s_add_u32 m0, s43, 0
  s_nop 0
  buffer_load_dwordx4 v4, s[24:27], s44 offen lds
  s_add_u32 s44, s44, 128
  s_add_u32 m0, s43, 8192
  s_nop 0
  buffer_load_dwordx4 v4, s[24:27], s45 offen lds
  s_add_u32 s45, s45, 128
  s_add_u32 m0, s43, 16384
  s_nop 0
  buffer_load_dwordx4 v5, s[28:31], s46 offen lds
  s_add_u32 s46, s46, 393216
  s_add_u32 m0, s43, 24576
  s_nop 0
  buffer_load_dwordx4 v5, s[28:31], s47 offen lds
  s_add_u32 s47, s47, 393216
  s_add_u32 m0, s43, 32768
  s_nop 0
  buffer_load_dwordx4 v5, s[28:31], s48 offen lds
  s_add_u32 s48, s48, 393216
  ds_read_b128 v[16:19], v130 offset:0
  ds_read_b128 v[20:23], v130 offset:2048
  ds_read_b128 v[24:27], v130 offset:4096
  ds_read_b128 v[28:31], v130 offset:6144
  ds_read_b64_tr_b16 v[48:49], v137 offset:0
  ds_read_b64_tr_b16 v[50:51], v137 offset:512
  ds_read_b64_tr_b16 v[52:53], v138 offset:0
  ds_read_b64_tr_b16 v[54:55], v138 offset:512
  ds_read_b64_tr_b16 v[56:57], v139 offset:0
  ds_read_b64_tr_b16 v[58:59], v139 offset:512
  ds_read_b128 v[32:35], v131 offset:0
  ds_read_b128 v[36:39], v131 offset:2048
  ds_read_b128 v[40:43], v131 offset:4096
  ds_read_b128 v[44:47], v131 offset:6144
  ds_read_b64_tr_b16 v[60:61], v137 offset:4096
  ds_read_b64_tr_b16 v[62:63], v137 offset:4608
  ds_read_b64_tr_b16 v[64:65], v138 offset:4096
  ds_read_b64_tr_b16 v[66:67], v138 offset:4608
  ds_read_b64_tr_b16 v[68:69], v139 offset:4096
  ds_read_b64_tr_b16 v[70:71], v139 offset:4608
  s_waitcnt lgkmcnt(10)
  v_mfma_f32_16x16x32_bf16 v[72:75], v[48:51], v[16:19], v[72:75]
  v_mfma_f32_16x16x32_bf16 v[76:79], v[52:55], v[16:19], v[76:79]
  v_mfma_f32_16x16x32_bf16 v[80:83], v[56:59], v[16:19], v[80:83]
  v_mfma_f32_16x16x32_bf16 v[84:87], v[48:51], v[20:23], v[84:87]
  v_mfma_f32_16x16x32_bf16 v[88:91], v[52:55], v[20:23], v[88:91]
  v_mfma_f32_16x16x32_bf16 v[92:95], v[56:59], v[20:23], v[92:95]
  v_mfma_f32_16x16x32_bf16 v[96:99], v[48:51], v[24:27], v[96:99]
  v_mfma_f32_16x16x32_bf16 v[100:103], v[52:55], v[24:27], v[100:103]
  v_mfma_f32_16x16x32_bf16 v[104:107], v[56:59], v[24:27], v[104:107]
  v_mfma_f32_16x16x32_bf16 v[108:111], v[48:51], v[28:31], v[108:111]
  v_mfma_f32_16x16x32_bf16 v[112:115], v[52:55], v[28:31], v[112:115]
  v_mfma_f32_16x16x32_bf16 v[116:119], v[56:59], v[28:31], v[116:119]
  s_waitcnt lgkmcnt(0)
  v_mfma_f32_16x16x32_bf16 v[72:75], v[60:63], v[32:35], v[72:75]
  v_mfma_f32_16x16x32_bf16 v[76:79], v[64:67], v[32:35], v[76:79]
  v_mfma_f32_16x16x32_bf16 v[80:83], v[68:71], v[32:35], v[80:83]
  v_mfma_f32_16x16x32_bf16 v[84:87], v[60:63], v[36:39], v[84:87]
  v_mfma_f32_16x16x32_bf16 v[88:91], v[64:67], v[36:39], v[88:91]
  v_mfma_f32_16x16x32_bf16 v[92:95], v[68:71], v[36:39], v[92:95]
  v_mfma_f32_16x16x32_bf16 v[96:99], v[60:63], v[40:43], v[96:99]
  v_mfma_f32_16x16x32_bf16 v[100:103], v[64:67], v[40:43], v[100:103]
  v_mfma_f32_16x16x32_bf16 v[104:107], v[68:71], v[40:43], v[104:107]
  v_mfma_f32_16x16x32_bf16 v[108:111], v[60:63], v[44:47], v[108:111]
  v_mfma_f32_16x16x32_bf16 v[112:115], v[64:67], v[44:47], v[112:115]
  v_mfma_f32_16x16x32_bf16 v[116:119], v[68:71], v[44:47], v[116:119]
  s_waitcnt vmcnt(5)
  s_barrier
  s_add_u32 m0, s43, 40960
  s_nop 0
  buffer_load_dwordx4 v4, s[24:27], s44 offen lds
  s_add_u32 s44, s44, 128
  s_add_u32 m0, s43, 49152
  s_nop 0
  buffer_load_dwordx4 v4, s[24:27], s45 offen lds
  s_add_u32 s45, s45, 128
  s_add_u32 m0, s43, 57344
  s_nop 0
  buffer_load_dwordx4 v5, s[28:31], s46 offen lds
  s_add_u32 s46, s46, 393216
  s_add_u32 m0, s43, 65536
  s_nop 0
  buffer_load_dwordx4 v5, s[28:31], s47 offen lds
  s_add_u32 s47, s47, 393216
  s_add_u32 m0, s43, 73728
  s_nop 0
  buffer_load_dwordx4 v5, s[28:31], s48 offen lds
  s_add_u32 s48, s48, 393216
  ds_read_b128 v[16:19], v132 offset:0
  ds_read_b128 v[20:23], v132 offset:2048
  ds_read_b128 v[24:27], v132 offset:4096
  ds_read_b128 v[28:31], v132 offset:6144
  ds_read_b64_tr_b16 v[48:49], v140 offset:0
  ds_read_b64_tr_b16 v[50:51], v140 offset:512
  ds_read_b64_tr_b16 v[52:53], v141 offset:0
  ds_read_b64_tr_b16 v[54:55], v141 offset:512
  ds_read_b64_tr_b16 v[56:57], v142 offset:0
  ds_read_b64_tr_b16 v[58:59], v142 offset:512
  ds_read_b128 v[32:35], v133 offset:0
  ds_read_b128 v[36:39], v133 offset:2048
  ds_read_b128 v[40:43], v133 offset:4096
  ds_read_b128 v[44:47], v133 offset:6144
  ds_read_b64_tr_b16 v[60:61], v140 offset:4096
  ds_read_b64_tr_b16 v[62:63], v140 offset:4608
  ds_read_b64_tr_b16 v[64:65], v141 offset:4096
  ds_read_b64_tr_b16 v[66:67], v141 offset:4608
  ds_read_b64_tr_b16 v[68:69], v142 offset:4096
  ds_read_b64_tr_b16 v[70:71], v142 offset:4608
  s_waitcnt lgkmcnt(10)
  v_mfma_f32_16x16x32_bf16 v[72:75], v[48:51], v[16:19], v[72:75]
  v_mfma_f32_16x16x32_bf16 v[76:79], v[52:55], v[16:19], v[76:79]
  v_mfma_f32_16x16x32_bf16 v[80:83], v[56:59], v[16:19], v[80:83]
  v_mfma_f32_16x16x32_bf16 v[84:87], v[48:51], v[20:23], v[84:87]
  v_mfma_f32_16x16x32_bf16 v[88:91], v[52:55], v[20:23], v[88:91]
  v_mfma_f32_16x16x32_bf16 v[92:95], v[56:59], v[20:23], v[92:95]
  v_mfma_f32_16x16x32_bf16 v[96:99], v[48:51], v[24:27], v[96:99]
  v_mfma_f32_16x16x32_bf16 v[100:103], v[52:55], v[24:27], v[100:103]
  v_mfma_f32_16x16x32_bf16 v[104:107], v[56:59], v[24:27], v[104:107]
  v_mfma_f32_16x16x32_bf16 v[108:111], v[48:51], v[28:31], v[108:111]
  v_mfma_f32_16x16x32_bf16 v[112:115], v[52:55], v[28:31], v[112:115]
  v_mfma_f32_16x16x32_bf16 v[116:119], v[56:59], v[28:31], v[116:119]
  s_waitcnt lgkmcnt(0)
  v_mfma_f32_16x16x32_bf16 v[72:75], v[60:63], v[32:35], v[72:75]
  v_mfma_f32_16x16x32_bf16 v[76:79], v[64:67], v[32:35], v[76:79]
  v_mfma_f32_16x16x32_bf16 v[80:83], v[68:71], v[32:35], v[80:83]
  v_mfma_f32_16x16x32_bf16 v[84:87], v[60:63], v[36:39], v[84:87]
  v_mfma_f32_16x16x32_bf16 v[88:91], v[64:67], v[36:39], v[88:91]
  v_mfma_f32_16x16x32_bf16 v[92:95], v[68:71], v[36:39], v[92:95]
  v_mfma_f32_16x16x32_bf16 v[96:99], v[60:63], v[40:43], v[96:99]
  v_mfma_f32_16x16x32_bf16 v[100:103], v[64:67], v[40:43], v[100:103]
  v_mfma_f32_16x16x32_bf16 v[104:107], v[68:71], v[40:43], v[104:107]
  v_mfma_f32_16x16x32_bf16 v[108:111], v[60:63], v[44:47], v[108:111]
  v_mfma_f32_16x16x32_bf16 v[112:115], v[64:67], v[44:47], v[112:115]
  v_mfma_f32_16x16x32_bf16 v[116:119], v[68:71], v[44:47], v[116:119]
  s_waitcnt vmcnt(5)
  s_barrier
  s_add_u32 m0, s43, 81920
  s_nop 0
  buffer_load_dwordx4 v4, s[24:27], s44 offen lds
  s_add_u32 s44, s44, 128
  s_add_u32 m0, s43, 90112
  s_nop 0
  buffer_load_dwordx4 v4, s[24:27], s45 offen lds
  s_add_u32 s45, s45, 128
  s_add_u32 m0, s43, 98304
  s_nop 0
  buffer_load_dwordx4 v5, s[28:31], s46 offen lds
  s_add_u32 s46, s46, 393216
  s_add_u32 m0, s43, 106496
  s_nop 0
  buffer_load_dwordx4 v5, s[28:31], s47 offen lds
  s_add_u32 s47, s47, 393216
  s_add_u32 m0, s43, 114688
  s_nop 0
  buffer_load_dwordx4 v5, s[28:31], s48 offen lds
  s_add_u32 s48, s48, 393216
  ds_read_b128 v[16:19], v128 offset:0
  ds_read_b128 v[20:23], v128 offset:2048
  ds_read_b128 v[24:27], v128 offset:4096
  ds_read_b128 v[28:31], v128 offset:6144
  ds_read_b64_tr_b16 v[48:49], v134 offset:0
  ds_read_b64_tr_b16 v[50:51], v134 offset:512
  ds_read_b64_tr_b16 v[52:53], v135 offset:0
  ds_read_b64_tr_b16 v[54:55], v135 offset:512
  ds_read_b64_tr_b16 v[56:57], v136 offset:0
  ds_read_b64_tr_b16 v[58:59], v136 offset:512
  ds_read_b128 v[32:35], v129 offset:0
  ds_read_b128 v[36:39], v129 offset:2048
  ds_read_b128 v[40:43], v129 offset:4096
  ds_read_b128 v[44:47], v129 offset:6144
  ds_read_b64_tr_b16 v[60:61], v134 offset:4096
  ds_read_b64_tr_b16 v[62:63], v134 offset:4608
  ds_read_b64_tr_b16 v[64:65], v135 offset:4096
  ds_read_b64_tr_b16 v[66:67], v135 offset:4608
  ds_read_b64_tr_b16 v[68:69], v136 offset:4096
  ds_read_b64_tr_b16 v[70:71], v136 offset:4608
  s_waitcnt lgkmcnt(10)
  v_mfma_f32_16x16x32_bf16 v[72:75], v[48:51], v[16:19], v[72:75]
  v_mfma_f32_16x16x32_bf16 v[76:79], v[52:55], v[16:19], v[76:79]
  v_mfma_f32_16x16x32_bf16 v[80:83], v[56:59], v[16:19], v[80:83]
  v_mfma_f32_16x16x32_bf16 v[84:87], v[48:51], v[20:23], v[84:87]
  v_mfma_f32_16x16x32_bf16 v[88:91], v[52:55], v[20:23], v[88:91]
  v_mfma_f32_16x16x32_bf16 v[92:95], v[56:59], v[20:23], v[92:95]
  v_mfma_f32_16x16x32_bf16 v[96:99], v[48:51], v[24:27], v[96:99]
  v_mfma_f32_16x16x32_bf16 v[100:103], v[52:55], v[24:27], v[100:103]
  v_mfma_f32_16x16x32_bf16 v[104:107], v[56:59], v[24:27], v[104:107]
  v_mfma_f32_16x16x32_bf16 v[108:111], v[48:51], v[28:31], v[108:111]
  v_mfma_f32_16x16x32_bf16 v[112:115], v[52:55], v[28:31], v[112:115]
  v_mfma_f32_16x16x32_bf16 v[116:119], v[56:59], v[28:31], v[116:119]
  s_waitcnt lgkmcnt(0)
  v_mfma_f32_16x16x32_bf16 v[72:75], v[60:63], v[32:35], v[72:75]
  v_mfma_f32_16x16x32_bf16 v[76:79], v[64:67], v[32:35], v[76:79]
  v_mfma_f32_16x16x32_bf16 v[80:83], v[68:71], v[32:35], v[80:83]
  v_mfma_f32_16x16x32_bf16 v[84:87], v[60:63], v[36:39], v[84:87]
  v_mfma_f32_16x16x32_bf16 v[88:91], v[64:67], v[36:39], v[88:91]
  v_mfma_f32_16x16x32_bf16 v[92:95], v[68:71], v[36:39], v[92:95]
  v_mfma_f32_16x16x32_bf16 v[96:99], v[60:63], v[40:43], v[96:99]
  v_mfma_f32_16x16x32_bf16 v[100:103], v[64:67], v[40:43], v[100:103]
  v_mfma_f32_16x16x32_bf16 v[104:107], v[68:71], v[40:43], v[104:107]
  v_mfma_f32_16x16x32_bf16 v[108:111], v[60:63], v[44:47], v[108:111]
  v_mfma_f32_16x16x32_bf16 v[112:115], v[64:67], v[44:47], v[112:115]
  v_mfma_f32_16x16x32_bf16 v[116:119], v[68:71], v[44:47], v[116:119]
  s_waitcnt vmcnt(5)
  s_barrier
  s_add_u32 m0, s43, 0
  s_nop 0
  buffer_load_dwordx4 v4, s[24:27], s44 offen lds
  s_add_u32 s44, s44, 128
  s_add_u32 m0, s43, 8192
  s_nop 0
  buffer_load_dwordx4 v4, s[24:27], s45 offen lds
  s_add_u32 s45, s45, 128
  s_add_u32 m0, s43, 16384
  s_nop 0
  buffer_load_dwordx4 v5, s[28:31], s46 offen lds
  s_add_u32 s46, s46, 393216
  s_add_u32 m0, s43, 24576
  s_nop 0
  buffer_load_dwordx4 v5, s[28:31], s47 offen lds
  s_add_u32 s47, s47, 393216
  s_add_u32 m0, s43, 32768
  s_nop 0
  buffer_load_dwordx4 v5, s[28:31], s48 offen lds
  s_add_u32 s48, s48, 393216
  ds_read_b128 v[16:19], v130 offset:0
  ds_read_b128 v[20:23], v130 offset:2048
  ds_read_b128 v[24:27], v130 offset:4096
  ds_read_b128 v[28:31], v130 offset:6144
  ds_read_b64_tr_b16 v[48:49], v137 offset:0
  ds_read_b64_tr_b16 v[50:51], v137 offset:512
  ds_read_b64_tr_b16 v[52:53], v138 offset:0
  ds_read_b64_tr_b16 v[54:55], v138 offset:512
  ds_read_b64_tr_b16 v[56:57], v139 offset:0
  ds_read_b64_tr_b16 v[58:59], v139 offset:512
  ds_read_b128 v[32:35], v131 offset:0
  ds_read_b128 v[36:39], v131 offset:2048
  ds_read_b128 v[40:43], v131 offset:4096
  ds_read_b128 v[44:47], v131 offset:6144
  ds_read_b64_tr_b16 v[60:61], v137 offset:4096
  ds_read_b64_tr_b16 v[62:63], v137 offset:4608
  ds_read_b64_tr_b16 v[64:65], v138 offset:4096
  ds_read_b64_tr_b16 v[66:67], v138 offset:4608
  ds_read_b64_tr_b16 v[68:69], v139 offset:4096
  ds_read_b64_tr_b16 v[70:71], v139 offset:4608
  s_waitcnt lgkmcnt(10)
  v_mfma_f32_16x16x32_bf16 v[72:75], v[48:51], v[16:19], v[72:75]
  v_mfma_f32_16x16x32_bf16 v[76:79], v[52:55], v[16:19], v[76:79]
  v_mfma_f32_16x16x32_bf16 v[80:83], v[56:59], v[16:19], v[80:83]
  v_mfma_f32_16x16x32_bf16 v[84:87], v[48:51], v[20:23], v[84:87]
  v_mfma_f32_16x16x32_bf16 v[88:91], v[52:55], v[20:23], v[88:91]
  v_mfma_f32_16x16x32_bf16 v[92:95], v[56:59], v[20:23], v[92:95]
  v_mfma_f32_16x16x32_bf16 v[96:99], v[48:51], v[24:27], v[96:99]
  v_mfma_f32_16x16x32_bf16 v[100:103], v[52:55], v[24:27], v[100:103]
  v_mfma_f32_16x16x32_bf16 v[104:107], v[56:59], v[24:27], v[104:107]
  v_mfma_f32_16x16x32_bf16 v[108:111], v[48:51], v[28:31], v[108:111]
  v_mfma_f32_16x16x32_bf16 v[112:115], v[52:55], v[28:31], v[112:115]
  v_mfma_f32_16x16x32_bf16 v[116:119], v[56:59], v[28:31], v[116:119]
  s_waitcnt lgkmcnt(0)
  v_mfma_f32_16x16x32_bf16 v[72:75], v[60:63], v[32:35], v[72:75]
  v_mfma_f32_16x16x32_bf16 v[76:79], v[64:67], v[32:35], v[76:79]
  v_mfma_f32_16x16x32_bf16 v[80:83], v[68:71], v[32:35], v[80:83]
  v_mfma_f32_16x16x32_bf16 v[84:87], v[60:63], v[36:39], v[84:87]
  v_mfma_f32_16x16x32_bf16 v[88:91], v[64:67], v[36:39], v[88:91]
  v_mfma_f32_16x16x32_bf16 v[92:95], v[68:71], v[36:39], v[92:95]
  v_mfma_f32_16x16x32_bf16 v[96:99], v[60:63], v[40:43], v[96:99]
  v_mfma_f32_16x16x32_bf16 v[100:103], v[64:67], v[40:43], v[100:103]
  v_mfma_f32_16x16x32_bf16 v[104:107], v[68:71], v[40:43], v[104:107]
  v_mfma_f32_16x16x32_bf16 v[108:111], v[60:63], v[44:47], v[108:111]
  v_mfma_f32_16x16x32_bf16 v[112:115], v[64:67], v[44:47], v[112:115]
  v_mfma_f32_16x16x32_bf16 v[116:119], v[68:71], v[44:47], v[116:119]
  s_waitcnt vmcnt(5)
  s_barrier
  s_add_u32 m0, s43, 40960
  s_nop 0
  buffer_load_dwordx4 v4, s[24:27], s44 offen lds
  s_add_u32 s44, s44, 128
  s_add_u32 m0, s43, 49152
  s_nop 0
  buffer_load_dwordx4 v4, s[24:27], s45 offen lds
  s_add_u32 s45, s45, 128
  s_add_u32 m0, s43, 57344
  s_nop 0
  buffer_load_dwordx4 v5, s[28:31], s46 offen lds
  s_add_u32 s46, s46, 393216
  s_add_u32 m0, s43, 65536
  s_nop 0
  buffer_load_dwordx4 v5, s[28:31], s47 offen lds
  s_add_u32 s47, s47, 393216
  s_add_u32 m0, s43, 73728
  s_nop 0
  buffer_load_dwordx4 v5, s[28:31], s48 offen lds
  s_add_u32 s48, s48, 393216
  ds_read_b128 v[16:19], v132 offset:0
  ds_read_b128 v[20:23], v132 offset:2048
  ds_read_b128 v[24:27], v132 offset:4096
  ds_read_b128 v[28:31], v132 offset:6144
  ds_read_b64_tr_b16 v[48:49], v140 offset:0
  ds_read_b64_tr_b16 v[50:51], v140 offset:512
  ds_read_b64_tr_b16 v[52:53], v141 offset:0
  ds_read_b64_tr_b16 v[54:55], v141 offset:512
  ds_read_b64_tr_b16 v[56:57], v142 offset:0
  ds_read_b64_tr_b16 v[58:59], v142 offset:512
  ds_read_b128 v[32:35], v133 offset:0
  ds_read_b128 v[36:39], v133 offset:2048
  ds_read_b128 v[40:43], v133 offset:4096
  ds_read_b128 v[44:47], v133 offset:6144
  ds_read_b64_tr_b16 v[60:61], v140 offset:4096
  ds_read_b64_tr_b16 v[62:63], v140 offset:4608
  ds_read_b64_tr_b16 v[64:65], v141 offset:4096
  ds_read_b64_tr_b16 v[66:67], v141 offset:4608
  ds_read_b64_tr_b16 v[68:69], v142 offset:4096
  ds_read_b64_tr_b16 v[70:71], v142 offset:4608
  s_waitcnt lgkmcnt(10)
  v_mfma_f32_16x16x32_bf16 v[72:75], v[48:51], v[16:19], v[72:75]
  v_mfma_f32_16x16x32_bf16 v[76:79], v[52:55], v[16:19], v[76:79]
  v_mfma_f32_16x16x32_bf16 v[80:83], v[56:59], v[16:19], v[80:83]
  v_mfma_f32_16x16x32_bf16 v[84:87], v[48:51], v[20:23], v[84:87]
  v_mfma_f32_16x16x32_bf16 v[88:91], v[52:55], v[20:23], v[88:91]
  v_mfma_f32_16x16x32_bf16 v[92:95], v[56:59], v[20:23], v[92:95]
  v_mfma_f32_16x16x32_bf16 v[96:99], v[48:51], v[24:27], v[96:99]
  v_mfma_f32_16x16x32_bf16 v[100:103], v[52:55], v[24:27], v[100:103]
  v_mfma_f32_16x16x32_bf16 v[104:107], v[56:59], v[24:27], v[104:107]
  v_mfma_f32_16x16x32_bf16 v[108:111], v[48:51], v[28:31], v[108:111]
  v_mfma_f32_16x16x32_bf16 v[112:115], v[52:55], v[28:31], v[112:115]
  v_mfma_f32_16x16x32_bf16 v[116:119], v[56:59], v[28:31], v[116:119]
  s_waitcnt lgkmcnt(0)
  v_mfma_f32_16x16x32_bf16 v[72:75], v[60:63], v[32:35], v[72:75]
  v_mfma_f32_16x16x32_bf16 v[76:79], v[64:67], v[32:35], v[76:79]
  v_mfma_f32_16x16x32_bf16 v[80:83], v[68:71], v[32:35], v[80:83]
  v_mfma_f32_16x16x32_bf16 v[84:87], v[60:63], v[36:39], v[84:87]
  v_mfma_f32_16x16x32_bf16 v[88:91], v[64:67], v[36:39], v[88:91]
  v_mfma_f32_16x16x32_bf16 v[92:95], v[68:71], v[36:39], v[92:95]
  v_mfma_f32_16x16x32_bf16 v[96:99], v[60:63], v[40:43], v[96:99]
  v_mfma_f32_16x16x32_bf16 v[100:103], v[64:67], v[40:43], v[100:103]
  v_mfma_f32_16x16x32_bf16 v[104:107], v[68:71], v[40:43], v[104:107]
  v_mfma_f32_16x16x32_bf16 v[108:111], v[60:63], v[44:47], v[108:111]
  v_mfma_f32_16x16x32_bf16 v[112:115], v[64:67], v[44:47], v[112:115]
  v_mfma_f32_16x16x32_bf16 v[116:119], v[68:71], v[44:47], v[116:119]
  s_waitcnt vmcnt(5)
  s_barrier
  s_add_u32 m0, s43, 81920
  s_nop 0
  buffer_load_dwordx4 v4, s[24:27], s44 offen lds
  s_add_u32 s44, s44, 128
  s_add_u32 m0, s43, 90112
  s_nop 0
  buffer_load_dwordx4 v4, s[24:27], s45 offen lds
  s_add_u32 s45, s45, 128
  s_add_u32 m0, s43, 98304
  s_nop 0
  buffer_load_dwordx4 v5, s[28:31], s46 offen lds
  s_add_u32 s46, s46, 393216
  s_add_u32 m0, s43, 106496
  s_nop 0
  buffer_load_dwordx4 v5, s[28:31], s47 offen lds
  s_add_u32 s47, s47, 393216
  s_add_u32 m0, s43, 114688
  s_nop 0
  buffer_load_dwordx4 v5, s[28:31], s48 offen lds
  s_add_u32 s48, s48, 393216
  ds_read_b128 v[16:19], v128 offset:0
  ds_read_b128 v[20:23], v128 offset:2048
  ds_read_b128 v[24:27], v128 offset:4096
  ds_read_b128 v[28:31], v128 offset:6144
  ds_read_b64_tr_b16 v[48:49], v134 offset:0
  ds_read_b64_tr_b16 v[50:51], v134 offset:512
  ds_read_b64_tr_b16 v[52:53], v135 offset:0
  ds_read_b64_tr_b16 v[54:55], v135 offset:512
  ds_read_b64_tr_b16 v[56:57], v136 offset:0
  ds_read_b64_tr_b16 v[58:59], v136 offset:512
  ds_read_b128 v[32:35], v129 offset:0
  ds_read_b128 v[36:39], v129 offset:2048
  ds_read_b128 v[40:43], v129 offset:4096
  ds_read_b128 v[44:47], v129 offset:6144
  ds_read_b64_tr_b16 v[60:61], v134 offset:4096
  ds_read_b64_tr_b16 v[62:63], v134 offset:4608
  ds_read_b64_tr_b16 v[64:65], v135 offset:4096
  ds_read_b64_tr_b16 v[66:67], v135 offset:4608
  ds_read_b64_tr_b16 v[68:69], v136 offset:4096
  ds_read_b64_tr_b16 v[70:71], v136 offset:4608
  s_waitcnt lgkmcnt(10)
  v_mfma_f32_16x16x32_bf16 v[72:75], v[48:51], v[16:19], v[72:75]
  v_mfma_f32_16x16x32_bf16 v[76:79], v[52:55], v[16:19], v[76:79]
  v_mfma_f32_16x16x32_bf16 v[80:83], v[56:59], v[16:19], v[80:83]
  v_mfma_f32_16x16x32_bf16 v[84:87], v[48:51], v[20:23], v[84:87]
  v_mfma_f32_16x16x32_bf16 v[88:91], v[52:55], v[20:23], v[88:91]
  v_mfma_f32_16x16x32_bf16 v[92:95], v[56:59], v[20:23], v[92:95]
  v_mfma_f32_16x16x32_bf16 v[96:99], v[48:51], v[24:27], v[96:99]
  v_mfma_f32_16x16x32_bf16 v[100:103], v[52:55], v[24:27], v[100:103]
  v_mfma_f32_16x16x32_bf16 v[104:107], v[56:59], v[24:27], v[104:107]
  v_mfma_f32_16x16x32_bf16 v[108:111], v[48:51], v[28:31], v[108:111]
  v_mfma_f32_16x16x32_bf16 v[112:115], v[52:55], v[28:31], v[112:115]
  v_mfma_f32_16x16x32_bf16 v[116:119], v[56:59], v[28:31], v[116:119]
  s_waitcnt lgkmcnt(0)
  v_mfma_f32_16x16x32_bf16 v[72:75], v[60:63], v[32:35], v[72:75]
  v_mfma_f32_16x16x32_bf16 v[76:79], v[64:67], v[32:35], v[76:79]
  v_mfma_f32_16x16x32_bf16 v[80:83], v[68:71], v[32:35], v[80:83]
  v_mfma_f32_16x16x32_bf16 v[84:87], v[60:63], v[36:39], v[84:87]
  v_mfma_f32_16x16x32_bf16 v[88:91], v[64:67], v[36:39], v[88:91]
  v_mfma_f32_16x16x32_bf16 v[92:95], v[68:71], v[36:39], v[92:95]
  v_mfma_f32_16x16x32_bf16 v[96:99], v[60:63], v[40:43], v[96:99]
  v_mfma_f32_16x16x32_bf16 v[100:103], v[64:67], v[40:43], v[100:103]
  v_mfma_f32_16x16x32_bf16 v[104:107], v[68:71], v[40:43], v[104:107]
  v_mfma_f32_16x16x32_bf16 v[108:111], v[60:63], v[44:47], v[108:111]
  v_mfma_f32_16x16x32_bf16 v[112:115], v[64:67], v[44:47], v[112:115]
  v_mfma_f32_16x16x32_bf16 v[116:119], v[68:71], v[44:47], v[116:119]
  s_waitcnt vmcnt(5)
  s_barrier
  s_add_u32 m0, s43, 0
  s_nop 0
  buffer_load_dwordx4 v4, s[24:27], s44 offen lds
  s_add_u32 s44, s44, 128
  s_add_u32 m0, s43, 8192
  s_nop 0
  buffer_load_dwordx4 v4, s[24:27], s45 offen lds
  s_add_u32 s45, s45, 128
  s_add_u32 m0, s43, 16384
  s_nop 0
  buffer_load_dwordx4 v5, s[28:31], s46 offen lds
  s_add_u32 s46, s46, 393216
  s_add_u32 m0, s43, 24576
  s_nop 0
  buffer_load_dwordx4 v5, s[28:31], s47 offen lds
  s_add_u32 s47, s47, 393216
  s_add_u32 m0, s43, 32768
  s_nop 0
  buffer_load_dwordx4 v5, s[28:31], s48 offen lds
  s_add_u32 s48, s48, 393216
  ds_read_b128 v[16:19], v130 offset:0
  ds_read_b128 v[20:23], v130 offset:2048
  ds_read_b128 v[24:27], v130 offset:4096
  ds_read_b128 v[28:31], v130 offset:6144
  ds_read_b64_tr_b16 v[48:49], v137 offset:0
  ds_read_b64_tr_b16 v[50:51], v137 offset:512
  ds_read_b64_tr_b16 v[52:53], v138 offset:0
  ds_read_b64_tr_b16 v[54:55], v138 offset:512
  ds_read_b64_tr_b16 v[56:57], v139 offset:0
  ds_read_b64_tr_b16 v[58:59], v139 offset:512
  ds_read_b128 v[32:35], v131 offset:0
  ds_read_b128 v[36:39], v131 offset:2048
  ds_read_b128 v[40:43], v131 offset:4096
  ds_read_b128 v[44:47], v131 offset:6144
  ds_read_b64_tr_b16 v[60:61], v137 offset:4096
  ds_read_b64_tr_b16 v[62:63], v137 offset:4608
  ds_read_b64_tr_b16 v[64:65], v138 offset:4096
  ds_read_b64_tr_b16 v[66:67], v138 offset:4608
  ds_read_b64_tr_b16 v[68:69], v139 offset:4096
  ds_read_b64_tr_b16 v[70:71], v139 offset:4608
  s_waitcnt lgkmcnt(10)
  v_mfma_f32_16x16x32_bf16 v[72:75], v[48:51], v[16:19], v[72:75]
  v_mfma_f32_16x16x32_bf16 v[76:79], v[52:55], v[16:19], v[76:79]
  v_mfma_f32_16x16x32_bf16 v[80:83], v[56:59], v[16:19], v[80:83]
  v_mfma_f32_16x16x32_bf16 v[84:87], v[48:51], v[20:23], v[84:87]
  v_mfma_f32_16x16x32_bf16 v[88:91], v[52:55], v[20:23], v[88:91]
  v_mfma_f32_16x16x32_bf16 v[92:95], v[56:59], v[20:23], v[92:95]
  v_mfma_f32_16x16x32_bf16 v[96:99], v[48:51], v[24:27], v[96:99]
  v_mfma_f32_16x16x32_bf16 v[100:103], v[52:55], v[24:27], v[100:103]
  v_mfma_f32_16x16x32_bf16 v[104:107], v[56:59], v[24:27], v[104:107]
  v_mfma_f32_16x16x32_bf16 v[108:111], v[48:51], v[28:31], v[108:111]
  v_mfma_f32_16x16x32_bf16 v[112:115], v[52:55], v[28:31], v[112:115]
  v_mfma_f32_16x16x32_bf16 v[116:119], v[56:59], v[28:31], v[116:119]
  s_waitcnt lgkmcnt(0)
  v_mfma_f32_16x16x32_bf16 v[72:75], v[60:63], v[32:35], v[72:75]
  v_mfma_f32_16x16x32_bf16 v[76:79], v[64:67], v[32:35], v[76:79]
  v_mfma_f32_16x16x32_bf16 v[80:83], v[68:71], v[32:35], v[80:83]
  v_mfma_f32_16x16x32_bf16 v[84:87], v[60:63], v[36:39], v[84:87]
  v_mfma_f32_16x16x32_bf16 v[88:91], v[64:67], v[36:39], v[88:91]
  v_mfma_f32_16x16x32_bf16 v[92:95], v[68:71], v[36:39], v[92:95]
  v_mfma_f32_16x16x32_bf16 v[96:99], v[60:63], v[40:43], v[96:99]
  v_mfma_f32_16x16x32_bf16 v[100:103], v[64:67], v[40:43], v[100:103]
  v_mfma_f32_16x16x32_bf16 v[104:107], v[68:71], v[40:43], v[104:107]
  v_mfma_f32_16x16x32_bf16 v[108:111], v[60:63], v[44:47], v[108:111]
  v_mfma_f32_16x16x32_bf16 v[112:115], v[64:67], v[44:47], v[112:115]
  v_mfma_f32_16x16x32_bf16 v[116:119], v[68:71], v[44:47], v[116:119]
  s_waitcnt vmcnt(5)
  s_barrier
  ds_read_b128 v[16:19], v132 offset:0
  ds_read_b128 v[20:23], v132 offset:2048
  ds_read_b128 v[24:27], v132 offset:4096
  ds_read_b128 v[28:31], v132 offset:6144
  ds_read_b64_tr_b16 v[48:49], v140 offset:0
  ds_read_b64_tr_b16 v[50:51], v140 offset:512
  ds_read_b64_tr_b16 v[52:53], v141 offset:0
  ds_read_b64_tr_b16 v[54:55], v141 offset:512
  ds_read_b64_tr_b16 v[56:57], v142 offset:0
  ds_read_b64_tr_b16 v[58:59], v142 offset:512
  ds_read_b128 v[32:35], v133 offset:0
  ds_read_b128 v[36:39], v133 offset:2048
  ds_read_b128 v[40:43], v133 offset:4096
  ds_read_b128 v[44:47], v133 offset:6144
  ds_read_b64_tr_b16 v[60:61], v140 offset:4096
  ds_read_b64_tr_b16 v[62:63], v140 offset:4608
  ds_read_b64_tr_b16 v[64:65], v141 offset:4096
  ds_read_b64_tr_b16 v[66:67], v141 offset:4608
  ds_read_b64_tr_b16 v[68:69], v142 offset:4096
  ds_read_b64_tr_b16 v[70:71], v142 offset:4608
  s_waitcnt lgkmcnt(10)
  v_mfma_f32_16x16x32_bf16 v[72:75], v[48:51], v[16:19], v[72:75]
  v_mfma_f32_16x16x32_bf16 v[76:79], v[52:55], v[16:19], v[76:79]
  v_mfma_f32_16x16x32_bf16 v[80:83], v[56:59], v[16:19], v[80:83]
  v_mfma_f32_16x16x32_bf16 v[84:87], v[48:51], v[20:23], v[84:87]
  v_mfma_f32_16x16x32_bf16 v[88:91], v[52:55], v[20:23], v[88:91]
  v_mfma_f32_16x16x32_bf16 v[92:95], v[56:59], v[20:23], v[92:95]
  v_mfma_f32_16x16x32_bf16 v[96:99], v[48:51], v[24:27], v[96:99]
  v_mfma_f32_16x16x32_bf16 v[100:103], v[52:55], v[24:27], v[100:103]
  v_mfma_f32_16x16x32_bf16 v[104:107], v[56:59], v[24:27], v[104:107]
  v_mfma_f32_16x16x32_bf16 v[108:111], v[48:51], v[28:31], v[108:111]
  v_mfma_f32_16x16x32_bf16 v[112:115], v[52:55], v[28:31], v[112:115]
  v_mfma_f32_16x16x32_bf16 v[116:119], v[56:59], v[28:31], v[116:119]
  s_waitcnt lgkmcnt(0)
  v_mfma_f32_16x16x32_bf16 v[72:75], v[60:63], v[32:35], v[72:75]
  v_mfma_f32_16x16x32_bf16 v[76:79], v[64:67], v[32:35], v[76:79]
  v_mfma_f32_16x16x32_bf16 v[80:83], v[68:71], v[32:35], v[80:83]
  v_mfma_f32_16x16x32_bf16 v[84:87], v[60:63], v[36:39], v[84:87]
  v_mfma_f32_16x16x32_bf16 v[88:91], v[64:67], v[36:39], v[88:91]
  v_mfma_f32_16x16x32_bf16 v[92:95], v[68:71], v[36:39], v[92:95]
  v_mfma_f32_16x16x32_bf16 v[96:99], v[60:63], v[40:43], v[96:99]
  v_mfma_f32_16x16x32_bf16 v[100:103], v[64:67], v[40:43], v[100:103]
  v_mfma_f32_16x16x32_bf16 v[104:107], v[68:71], v[40:43], v[104:107]
  v_mfma_f32_16x16x32_bf16 v[108:111], v[60:63], v[44:47], v[108:111]
  v_mfma_f32_16x16x32_bf16 v[112:115], v[64:67], v[44:47], v[112:115]
  v_mfma_f32_16x16x32_bf16 v[116:119], v[68:71], v[44:47], v[116:119]
  s_waitcnt vmcnt(0)
  s_barrier
  ds_read_b128 v[16:19], v128 offset:0
  ds_read_b128 v[20:23], v128 offset:2048
  ds_read_b128 v[24:27], v128 offset:4096
  ds_read_b128 v[28:31], v128 offset:6144
  ds_read_b64_tr_b16 v[48:49], v134 offset:0
  ds_read_b64_tr_b16 v[50:51], v134 offset:512
  ds_read_b64_tr_b16 v[52:53], v135 offset:0
  ds_read_b64_tr_b16 v[54:55], v135 offset:512
  ds_read_b64_tr_b16 v[56:57], v136 offset:0
  ds_read_b64_tr_b16 v[58:59], v136 offset:512
  ds_read_b128 v[32:35], v129 offset:0
  ds_read_b128 v[36:39], v129 offset:2048
  ds_read_b128 v[40:43], v129 offset:4096
  ds_read_b128 v[44:47], v129 offset:6144
  ds_read_b64_tr_b16 v[60:61], v134 offset:4096
  ds_read_b64_tr_b16 v[62:63], v134 offset:4608
  ds_read_b64_tr_b16 v[64:65], v135 offset:4096
  ds_read_b64_tr_b16 v[66:67], v135 offset:4608
  ds_read_b64_tr_b16 v[68:69], v136 offset:4096
  ds_read_b64_tr_b16 v[70:71], v136 offset:4608
  s_waitcnt lgkmcnt(10)
  v_mfma_f32_16x16x32_bf16 v[72:75], v[48:51], v[16:19], v[72:75]
  v_mfma_f32_16x16x32_bf16 v[76:79], v[52:55], v[16:19], v[76:79]
  v_mfma_f32_16x16x32_bf16 v[80:83], v[56:59], v[16:19], v[80:83]
  v_mfma_f32_16x16x32_bf16 v[84:87], v[48:51], v[20:23], v[84:87]
  v_mfma_f32_16x16x32_bf16 v[88:91], v[52:55], v[20:23], v[88:91]
  v_mfma_f32_16x16x32_bf16 v[92:95], v[56:59], v[20:23], v[92:95]
  v_mfma_f32_16x16x32_bf16 v[96:99], v[48:51], v[24:27], v[96:99]
  v_mfma_f32_16x16x32_bf16 v[100:103], v[52:55], v[24:27], v[100:103]
  v_mfma_f32_16x16x32_bf16 v[104:107], v[56:59], v[24:27], v[104:107]
  v_mfma_f32_16x16x32_bf16 v[108:111], v[48:51], v[28:31], v[108:111]
  v_mfma_f32_16x16x32_bf16 v[112:115], v[52:55], v[28:31], v[112:115]
  v_mfma_f32_16x16x32_bf16 v[116:119], v[56:59], v[28:31], v[116:119]
  s_waitcnt lgkmcnt(0)
  v_mfma_f32_16x16x32_bf16 v[72:75], v[60:63], v[32:35], v[72:75]
  v_mfma_f32_16x16x32_bf16 v[76:79], v[64:67], v[32:35], v[76:79]
  v_mfma_f32_16x16x32_bf16 v[80:83], v[68:71], v[32:35], v[80:83]
  v_mfma_f32_16x16x32_bf16 v[84:87], v[60:63], v[36:39], v[84:87]
  v_mfma_f32_16x16x32_bf16 v[88:91], v[64:67], v[36:39], v[88:91]
  v_mfma_f32_16x16x32_bf16 v[92:95], v[68:71], v[36:39], v[92:95]
  v_mfma_f32_16x16x32_bf16 v[96:99], v[60:63], v[40:43], v[96:99]
  v_mfma_f32_16x16x32_bf16 v[100:103], v[64:67], v[40:43], v[100:103]
  v_mfma_f32_16x16x32_bf16 v[104:107], v[68:71], v[40:43], v[104:107]
  v_mfma_f32_16x16x32_bf16 v[108:111], v[60:63], v[44:47], v[108:111]
  v_mfma_f32_16x16x32_bf16 v[112:115], v[64:67], v[44:47], v[112:115]
  v_mfma_f32_16x16x32_bf16 v[116:119], v[68:71], v[44:47], v[116:119]
  s_nop 7
  s_nop 7
  v_cvt_pk_bf16_f32 v72, v72, v73
  v_cvt_pk_bf16_f32 v73, v74, v75
  buffer_store_dwordx2 v[72:73], v13, s[32:35], 0 offen offset:0
  v_cvt_pk_bf16_f32 v76, v76, v77
  v_cvt_pk_bf16_f32 v77, v78, v79
  buffer_store_dwordx2 v[76:77], v13, s[32:35], 0 offen offset:32
  v_cvt_pk_bf16_f32 v80, v80, v81
  v_cvt_pk_bf16_f32 v81, v82, v83
  buffer_store_dwordx2 v[80:81], v13, s[32:35], 0 offen offset:64
  v_add_u32 v13, 98304, v13
  v_cvt_pk_bf16_f32 v84, v84, v85
  v_cvt_pk_bf16_f32 v85, v86, v87
  buffer_store_dwordx2 v[84:85], v13, s[32:35], 0 offen offset:0
  v_cvt_pk_bf16_f32 v88, v88, v89
  v_cvt_pk_bf16_f32 v89, v90, v91
  buffer_store_dwordx2 v[88:89], v13, s[32:35], 0 offen offset:32
  v_cvt_pk_bf16_f32 v92, v92, v93
  v_cvt_pk_bf16_f32 v93, v94, v95
  buffer_store_dwordx2 v[92:93], v13, s[32:35], 0 offen offset:64
  v_add_u32 v13, 98304, v13
  v_cvt_pk_bf16_f32 v96, v96, v97
  v_cvt_pk_bf16_f32 v97, v98, v99
  buffer_store_dwordx2 v[96:97], v13, s[32:35], 0 offen offset:0
  v_cvt_pk_bf16_f32 v100, v100, v101
  v_cvt_pk_bf16_f32 v101, v102, v103
  buffer_store_dwordx2 v[100:101], v13, s[32:35], 0 offen offset:32
  v_cvt_pk_bf16_f32 v104, v104, v105
  v_cvt_pk_bf16_f32 v105, v106, v107
  buffer_store_dwordx2 v[104:105], v13, s[32:35], 0 offen offset:64
  v_add_u32 v13, 98304, v13
  v_cvt_pk_bf16_f32 v108, v108, v109
  v_cvt_pk_bf16_f32 v109, v110, v111
  buffer_store_dwordx2 v[108:109], v13, s[32:35], 0 offen offset:0
  v_cvt_pk_bf16_f32 v112, v112, v113
  v_cvt_pk_bf16_f32 v113, v114, v115
  buffer_store_dwordx2 v[112:113], v13, s[32:35], 0 offen offset:32
  v_cvt_pk_bf16_f32 v116, v116, v117
  v_cvt_pk_bf16_f32 v117, v118, v119
  buffer_store_dwordx2 v[116:117], v13, s[32:35], 0 offen offset:64
L_gemmq2_kernel_end:
  s_endpgm
.globl kvpart2_kernel
.p2align 8
.type kvpart2_kernel,@function
kvpart2_kernel:
  s_cmp_ge_u32 s2, 256
  s_cbranch_scc1 L_kvpart2_kernel_end
  s_load_dwordx16 s[4:19], s[0:1], 0
  s_load_dwordx2 s[20:21], s[0:1], 64
  s_waitcnt lgkmcnt(0)
  s_add_u32 s24, s20, 4194304
  s_addc_u32 s25, s21, 0
  s_and_b32 s25, s25, 0xffff
  s_mov_b32 s26, 12582912
  s_mov_b32 s27, 0x00020000
  s_add_u32 s28, s20, 33554432
  s_addc_u32 s29, s21, 0
  s_and_b32 s29, s29, 0xffff
  s_mov_b32 s30, 1081344
  s_mov_b32 s31, 0x00020000
  s_lshr_b32 s40, s2, 3
  s_and_b32 s41, s2, 7
  v_and_b32 v1, 63, v0
  v_lshrrev_b32 v2, 6, v0
  v_lshrrev_b32 v3, 2, v1
  v_lshl_add_u32 v3, v2, 6, v3
  s_lshl_b32 s3, s41, 8
  v_add_u32 v3, s3, v3
  v_mul_u32_u24 v4, 6144, v3
  v_and_b32 v5, 3, v1
  v_lshl_add_u32 v4, v5, 4, v4
  s_lshl_b32 s42, s40, 6
  s_add_u32 s43, s42, 4096
  s_add_u32 s42, s42, 2048
  s_add_u32 s44, s42, 0
  buffer_load_dwordx4 v[16:19], v4, s[24:27], s44 offen
  s_add_u32 s44, s43, 0
  buffer_load_dwordx4 v[32:35], v4, s[24:27], s44 offen
  s_add_u32 s44, s42, 98304
  buffer_load_dwordx4 v[20:23], v4, s[24:27], s44 offen
  s_add_u32 s44, s43, 98304
  buffer_load_dwordx4 v[36:39], v4, s[24:27], s44 offen
  s_add_u32 s44, s42, 196608
  buffer_load_dwordx4 v[24:27], v4, s[24:27], s44 offen
  s_add_u32 s44, s43, 196608
  buffer_load_dwordx4 v[40:43], v4, s[24:27], s44 offen
  s_add_u32 s44, s42, 294912
  buffer_load_dwordx4 v[28:31], v4, s[24:27], s44 offen
  s_add_u32 s44, s43, 294912
  buffer_load_dwordx4 v[44:47], v4, s[24:27], s44 offen
  v_lshrrev_b32 v6, 2, v1
  v_lshlrev_b32 v6, 6, v6
  v_lshl_add_u32 v6, v5, 4, v6
  v_lshl_add_u32 v6, v2, 13, v6
  s_waitcnt vmcnt(0)
  v_lshlrev_b32 v60, 16, v16
  v_and_b32 v61, 0xffff0000, v16
  v_mul_f32 v62, 0x3fb8aa3b, v60
  v_exp_f32 v62, v62
  v_add_f32 v63, 1.0, v60
  v_cmp_lt_f32 vcc, 0, v60
  s_nop 1
  v_cndmask_b32 v60, v62, v63, vcc
  v_mul_f32 v62, 0x3fb8aa3b, v61
  v_exp_f32 v62, v62
  v_add_f32 v63, 1.0, v61
  v_cmp_lt_f32 vcc, 0, v61
  s_nop 1
  v_cndmask_b32 v61, v62, v63, vcc
  v_cvt_pk_bf16_f32 v62, v60, v61
  v_lshlrev_b32 v60, 16, v62
  v_and_b32 v61, 0xffff0000, v62
  v_add_f32 v60, 0x358637bd, v60
  v_add_f32 v61, 0x358637bd, v61
  v_cvt_pk_bf16_f32 v16, v60, v61
  v_lshlrev_b32 v60, 16, v17
  v_and_b32 v61, 0xffff0000, v17
  v_mul_f32 v62, 0x3fb8aa3b, v60
  v_exp_f32 v62, v62
  v_add_f32 v63, 1.0, v60
  v_cmp_lt_f32 vcc, 0, v60
  s_nop 1
  v_cndmask_b32 v60, v62, v63, vcc
  v_mul_f32 v62, 0x3fb8aa3b, v61
  v_exp_f32 v62, v62
  v_add_f32 v63, 1.0, v61
  v_cmp_lt_f32 vcc, 0, v61
  s_nop 1
  v_cndmask_b32 v61, v62, v63, vcc
  v_cvt_pk_bf16_f32 v62, v60, v61
  v_lshlrev_b32 v60, 16, v62
  v_and_b32 v61, 0xffff0000, v62
  v_add_f32 v60, 0x358637bd, v60
  v_add_f32 v61, 0x358637bd, v61
  v_cvt_pk_bf16_f32 v17, v60, v61
  v_lshlrev_b32 v60, 16, v18
  v_and_b32 v61, 0xffff0000, v18
  v_mul_f32 v62, 0x3fb8aa3b, v60
  v_exp_f32 v62, v62
  v_add_f32 v63, 1.0, v60
  v_cmp_lt_f32 vcc, 0, v60
  s_nop 1
  v_cndmask_b32 v60, v62, v63, vcc
  v_mul_f32 v62, 0x3fb8aa3b, v61
  v_exp_f32 v62, v62
  v_add_f32 v63, 1.0, v61
  v_cmp_lt_f32 vcc, 0, v61
  s_nop 1
  v_cndmask_b32 v61, v62, v63, vcc
  v_cvt_pk_bf16_f32 v62, v60, v61
  v_lshlrev_b32 v60, 16, v62
  v_and_b32 v61, 0xffff0000, v62
  v_add_f32 v60, 0x358637bd, v60
  v_add_f32 v61, 0x358637bd, v61
  v_cvt_pk_bf16_f32 v18, v60, v61
  v_lshlrev_b32 v60, 16, v19
  v_and_b32 v61, 0xffff0000, v19
  v_mul_f32 v62, 0x3fb8aa3b, v60
  v_exp_f32 v62, v62
  v_add_f32 v63, 1.0, v60
  v_cmp_lt_f32 vcc, 0, v60
  s_nop 1
  v_cndmask_b32 v60, v62, v63, vcc
  v_mul_f32 v62, 0x3fb8aa3b, v61
  v_exp_f32 v62, v62
  v_add_f32 v63, 1.0, v61
  v_cmp_lt_f32 vcc, 0, v61
  s_nop 1
  v_cndmask_b32 v61, v62, v63, vcc
  v_cvt_pk_bf16_f32 v62, v60, v61
  v_lshlrev_b32 v60, 16, v62
  v_and_b32 v61, 0xffff0000, v62
  v_add_f32 v60, 0x358637bd, v60
  v_add_f32 v61, 0x358637bd, v61
  v_cvt_pk_bf16_f32 v19, v60, v61
  v_lshlrev_b32 v60, 16, v20
  v_and_b32 v61, 0xffff0000, v20
  v_mul_f32 v62, 0x3fb8aa3b, v60
  v_exp_f32 v62, v62
  v_add_f32 v63, 1.0, v60
  v_cmp_lt_f32 vcc, 0, v60
  s_nop 1
  v_cndmask_b32 v60, v62, v63, vcc
  v_mul_f32 v62, 0x3fb8aa3b, v61
  v_exp_f32 v62, v62
  v_add_f32 v63, 1.0, v61
  v_cmp_lt_f32 vcc, 0, v61
  s_nop 1
  v_cndmask_b32 v61, v62, v63, vcc
  v_cvt_pk_bf16_f32 v62, v60, v61
  v_lshlrev_b32 v60, 16, v62
  v_and_b32 v61, 0xffff0000, v62
  v_add_f32 v60, 0x358637bd, v60
  v_add_f32 v61, 0x358637bd, v61
  v_cvt_pk_bf16_f32 v20, v60, v61
  v_lshlrev_b32 v60, 16, v21
  v_and_b32 v61, 0xffff0000, v21
  v_mul_f32 v62, 0x3fb8aa3b, v60
  v_exp_f32 v62, v62
  v_add_f32 v63, 1.0, v60
  v_cmp_lt_f32 vcc, 0, v60
  s_nop 1
  v_cndmask_b32 v60, v62, v63, vcc
  v_mul_f32 v62, 0x3fb8aa3b, v61
  v_exp_f32 v62, v62
  v_add_f32 v63, 1.0, v61
  v_cmp_lt_f32 vcc, 0, v61
  s_nop 1
  v_cndmask_b32 v61, v62, v63, vcc
  v_cvt_pk_bf16_f32 v62, v60, v61
  v_lshlrev_b32 v60, 16, v62
  v_and_b32 v61, 0xffff0000, v62
  v_add_f32 v60, 0x358637bd, v60
  v_add_f32 v61, 0x358637bd, v61
  v_cvt_pk_bf16_f32 v21, v60, v61
  v_lshlrev_b32 v60, 16, v22
  v_and_b32 v61, 0xffff0000, v22
  v_mul_f32 v62, 0x3fb8aa3b, v60
  v_exp_f32 v62, v62
  v_add_f32 v63, 1.0, v60
  v_cmp_lt_f32 vcc, 0, v60
  s_nop 1
  v_cndmask_b32 v60, v62, v63, vcc
  v_mul_f32 v62, 0x3fb8aa3b, v61
  v_exp_f32 v62, v62
  v_add_f32 v63, 1.0, v61
  v_cmp_lt_f32 vcc, 0, v61
  s_nop 1
  v_cndmask_b32 v61, v62, v63, vcc
  v_cvt_pk_bf16_f32 v62, v60, v61
  v_lshlrev_b32 v60, 16, v62
  v_and_b32 v61, 0xffff0000, v62
  v_add_f32 v60, 0x358637bd, v60
  v_add_f32 v61, 0x358637bd, v61
  v_cvt_pk_bf16_f32 v22, v60, v61
  v_lshlrev_b32 v60, 16, v23
  v_and_b32 v61, 0xffff0000, v23
  v_mul_f32 v62, 0x3fb8aa3b, v60
  v_exp_f32 v62, v62
  v_add_f32 v63, 1.0, v60
  v_cmp_lt_f32 vcc, 0, v60
  s_nop 1
  v_cndmask_b32 v60, v62, v63, vcc
  v_mul_f32 v62, 0x3fb8aa3b, v61
  v_exp_f32 v62, v62
  v_add_f32 v63, 1.0, v61
  v_cmp_lt_f32 vcc, 0, v61
  s_nop 1
  v_cndmask_b32 v61, v62, v63, vcc
  v_cvt_pk_bf16_f32 v62, v60, v61
  v_lshlrev_b32 v60, 16, v62
  v_and_b32 v61, 0xffff0000, v62
  v_add_f32 v60, 0x358637bd, v60
  v_add_f32 v61, 0x358637bd, v61
  v_cvt_pk_bf16_f32 v23, v60, v61
  v_lshlrev_b32 v60, 16, v24
  v_and_b32 v61, 0xffff0000, v24
  v_mul_f32 v62, 0x3fb8aa3b, v60
  v_exp_f32 v62, v62
  v_add_f32 v63, 1.0, v60
  v_cmp_lt_f32 vcc, 0, v60
  s_nop 1
  v_cndmask_b32 v60, v62, v63, vcc
  v_mul_f32 v62, 0x3fb8aa3b, v61
  v_exp_f32 v62, v62
  v_add_f32 v63, 1.0, v61
  v_cmp_lt_f32 vcc, 0, v61
  s_nop 1
  v_cndmask_b32 v61, v62, v63, vcc
  v_cvt_pk_bf16_f32 v62, v60, v61
  v_lshlrev_b32 v60, 16, v62
  v_and_b32 v61, 0xffff0000, v62
  v_add_f32 v60, 0x358637bd, v60
  v_add_f32 v61, 0x358637bd, v61
  v_cvt_pk_bf16_f32 v24, v60, v61
  v_lshlrev_b32 v60, 16, v25
  v_and_b32 v61, 0xffff0000, v25
  v_mul_f32 v62, 0x3fb8aa3b, v60
  v_exp_f32 v62, v62
  v_add_f32 v63, 1.0, v60
  v_cmp_lt_f32 vcc, 0, v60
  s_nop 1
  v_cndmask_b32 v60, v62, v63, vcc
  v_mul_f32 v62, 0x3fb8aa3b, v61
  v_exp_f32 v62, v62
  v_add_f32 v63, 1.0, v61
  v_cmp_lt_f32 vcc, 0, v61
  s_nop 1
  v_cndmask_b32 v61, v62, v63, vcc
  v_cvt_pk_bf16_f32 v62, v60, v61
  v_lshlrev_b32 v60, 16, v62
  v_and_b32 v61, 0xffff0000, v62
  v_add_f32 v60, 0x358637bd, v60
  v_add_f32 v61, 0x358637bd, v61
  v_cvt_pk_bf16_f32 v25, v60, v61
  v_lshlrev_b32 v60, 16, v26
  v_and_b32 v61, 0xffff0000, v26
  v_mul_f32 v62, 0x3fb8aa3b, v60
  v_exp_f32 v62, v62
  v_add_f32 v63, 1.0, v60
  v_cmp_lt_f32 vcc, 0, v60
  s_nop 1
  v_cndmask_b32 v60, v62, v63, vcc
  v_mul_f32 v62, 0x3fb8aa3b, v61
  v_exp_f32 v62, v62
  v_add_f32 v63, 1.0, v61
  v_cmp_lt_f32 vcc, 0, v61
  s_nop 1
  v_cndmask_b32 v61, v62, v63, vcc
  v_cvt_pk_bf16_f32 v62, v60, v61
  v_lshlrev_b32 v60, 16, v62
  v_and_b32 v61, 0xffff0000, v62
  v_add_f32 v60, 0x358637bd, v60
  v_add_f32 v61, 0x358637bd, v61
  v_cvt_pk_bf16_f32 v26, v60, v61
  v_lshlrev_b32 v60, 16, v27
  v_and_b32 v61, 0xffff0000, v27
  v_mul_f32 v62, 0x3fb8aa3b, v60
  v_exp_f32 v62, v62
  v_add_f32 v63, 1.0, v60
  v_cmp_lt_f32 vcc, 0, v60
  s_nop 1
  v_cndmask_b32 v60, v62, v63, vcc
  v_mul_f32 v62, 0x3fb8aa3b, v61
  v_exp_f32 v62, v62
  v_add_f32 v63, 1.0, v61
  v_cmp_lt_f32 vcc, 0, v61
  s_nop 1
  v_cndmask_b32 v61, v62, v63, vcc
  v_cvt_pk_bf16_f32 v62, v60, v61
  v_lshlrev_b32 v60, 16, v62
  v_and_b32 v61, 0xffff0000, v62
  v_add_f32 v60, 0x358637bd, v60
  v_add_f32 v61, 0x358637bd, v61
  v_cvt_pk_bf16_f32 v27, v60, v61
  v_lshlrev_b32 v60, 16, v28
  v_and_b32 v61, 0xffff0000, v28
  v_mul_f32 v62, 0x3fb8aa3b, v60
  v_exp_f32 v62, v62
  v_add_f32 v63, 1.0, v60
  v_cmp_lt_f32 vcc, 0, v60
  s_nop 1
  v_cndmask_b32 v60, v62, v63, vcc
  v_mul_f32 v62, 0x3fb8aa3b, v61
  v_exp_f32 v62, v62
  v_add_f32 v63, 1.0, v61
  v_cmp_lt_f32 vcc, 0, v61
  s_nop 1
  v_cndmask_b32 v61, v62, v63, vcc
  v_cvt_pk_bf16_f32 v62, v60, v61
  v_lshlrev_b32 v60, 16, v62
  v_and_b32 v61, 0xffff0000, v62
  v_add_f32 v60, 0x358637bd, v60
  v_add_f32 v61, 0x358637bd, v61
  v_cvt_pk_bf16_f32 v28, v60, v61
  v_lshlrev_b32 v60, 16, v29
  v_and_b32 v61, 0xffff0000, v29
  v_mul_f32 v62, 0x3fb8aa3b, v60
  v_exp_f32 v62, v62
  v_add_f32 v63, 1.0, v60
  v_cmp_lt_f32 vcc, 0, v60
  s_nop 1
  v_cndmask_b32 v60, v62, v63, vcc
  v_mul_f32 v62, 0x3fb8aa3b, v61
  v_exp_f32 v62, v62
  v_add_f32 v63, 1.0, v61
  v_cmp_lt_f32 vcc, 0, v61
  s_nop 1
  v_cndmask_b32 v61, v62, v63, vcc
  v_cvt_pk_bf16_f32 v62, v60, v61
  v_lshlrev_b32 v60, 16, v62
  v_and_b32 v61, 0xffff0000, v62
  v_add_f32 v60, 0x358637bd, v60
  v_add_f32 v61, 0x358637bd, v61
  v_cvt_pk_bf16_f32 v29, v60, v61
  v_lshlrev_b32 v60, 16, v30
  v_and_b32 v61, 0xffff0000, v30
  v_mul_f32 v62, 0x3fb8aa3b, v60
  v_exp_f32 v62, v62
  v_add_f32 v63, 1.0, v60
  v_cmp_lt_f32 vcc, 0, v60
  s_nop 1
  v_cndmask_b32 v60, v62, v63, vcc
  v_mul_f32 v62, 0x3fb8aa3b, v61
  v_exp_f32 v62, v62
  v_add_f32 v63, 1.0, v61
  v_cmp_lt_f32 vcc, 0, v61
  s_nop 1
  v_cndmask_b32 v61, v62, v63, vcc
  v_cvt_pk_bf16_f32 v62, v60, v61
  v_lshlrev_b32 v60, 16, v62
  v_and_b32 v61, 0xffff0000, v62
  v_add_f32 v60, 0x358637bd, v60
  v_add_f32 v61, 0x358637bd, v61
  v_cvt_pk_bf16_f32 v30, v60, v61
  v_lshlrev_b32 v60, 16, v31
  v_and_b32 v61, 0xffff0000, v31
  v_mul_f32 v62, 0x3fb8aa3b, v60
  v_exp_f32 v62, v62
  v_add_f32 v63, 1.0, v60
  v_cmp_lt_f32 vcc, 0, v60
  s_nop 1
  v_cndmask_b32 v60, v62, v63, vcc
  v_mul_f32 v62, 0x3fb8aa3b, v61
  v_exp_f32 v62, v62
  v_add_f32 v63, 1.0, v61
  v_cmp_lt_f32 vcc, 0, v61
  s_nop 1
  v_cndmask_b32 v61, v62, v63, vcc
  v_cvt_pk_bf16_f32 v62, v60, v61
  v_lshlrev_b32 v60, 16, v62
  v_and_b32 v61, 0xffff0000, v62
  v_add_f32 v60, 0x358637bd, v60
  v_add_f32 v61, 0x358637bd, v61
  v_cvt_pk_bf16_f32 v31, v60, v61
  ds_write_b128 v6, v[16:19] offset:0
  ds_write_b128 v6, v[32:35] offset:4096
  ds_write_b128 v6, v[20:23] offset:1024
  ds_write_b128 v6, v[36:39] offset:5120
  ds_write_b128 v6, v[24:27] offset:2048
  ds_write_b128 v6, v[40:43] offset:6144
  ds_write_b128 v6, v[28:31] offset:3072
  ds_write_b128 v6, v[44:47] offset:7168
  v_lshrrev_b32 v7, 4, v1
  v_lshlrev_b32 v7, 3, v7
  v_bfe_u32 v8, v1, 2, 2
  v_add_u32 v7, v7, v8
  v_lshlrev_b32 v7, 6, v7
  v_lshl_add_u32 v7, v5, 3, v7
  v_lshl_add_u32 v7, v2, 13, v7
  v_mov_b32 v100, 0
  v_mov_b32 v101, 0
  v_mov_b32 v102, 0
  v_mov_b32 v103, 0
  v_mov_b32 v104, 0
  v_mov_b32 v105, 0
  v_mov_b32 v106, 0
  v_mov_b32 v107, 0
  v_mov_b32 v108, 0
  v_mov_b32 v109, 0
  v_mov_b32 v110, 0
  v_mov_b32 v111, 0
  v_mov_b32 v112, 0
  v_mov_b32 v113, 0
  v_mov_b32 v114, 0
  v_mov_b32 v115, 0
  v_mov_b32 v116, 0
  v_mov_b32 v117, 0
  v_mov_b32 v118, 0
  v_mov_b32 v119, 0
  v_mov_b32 v120, 0
  v_mov_b32 v121, 0
  v_mov_b32 v122, 0
  v_mov_b32 v123, 0
  v_mov_b32 v96, 0x3f803f80
  v_mov_b32 v97, 0x3f803f80
  v_mov_b32 v98, 0x3f803f80
  v_mov_b32 v99, 0x3f803f80
  s_waitcnt lgkmcnt(0)
  ds_read_b64_tr_b16 v[64:65], v7 offset:0
  ds_read_b64_tr_b16 v[72:73], v7 offset:4096
  ds_read_b64_tr_b16 v[66:67], v7 offset:256
  ds_read_b64_tr_b16 v[74:75], v7 offset:4352
  ds_read_b64_tr_b16 v[68:69], v7 offset:32
  ds_read_b64_tr_b16 v[76:77], v7 offset:4128
  ds_read_b64_tr_b16 v[70:71], v7 offset:288
  ds_read_b64_tr_b16 v[78:79], v7 offset:4384
  s_waitcnt lgkmcnt(0)
  v_mfma_f32_16x16x32_bf16 v[100:103], v[64:67], v[72:75], v[100:103]
  v_mfma_f32_16x16x32_bf16 v[104:107], v[64:67], v[76:79], v[104:107]
  v_mfma_f32_16x16x32_bf16 v[116:119], v[64:67], v[96:99], v[116:119]
  v_mfma_f32_16x16x32_bf16 v[108:111], v[68:71], v[72:75], v[108:111]
  v_mfma_f32_16x16x32_bf16 v[112:115], v[68:71], v[76:79], v[112:115]
  v_mfma_f32_16x16x32_bf16 v[120:123], v[68:71], v[96:99], v[120:123]
  ds_read_b64_tr_b16 v[64:65], v7 offset:2048
  ds_read_b64_tr_b16 v[72:73], v7 offset:6144
  ds_read_b64_tr_b16 v[66:67], v7 offset:2304
  ds_read_b64_tr_b16 v[74:75], v7 offset:6400
  ds_read_b64_tr_b16 v[68:69], v7 offset:2080
  ds_read_b64_tr_b16 v[76:77], v7 offset:6176
  ds_read_b64_tr_b16 v[70:71], v7 offset:2336
  ds_read_b64_tr_b16 v[78:79], v7 offset:6432
  s_waitcnt lgkmcnt(0)
  v_mfma_f32_16x16x32_bf16 v[100:103], v[64:67], v[72:75], v[100:103]
  v_mfma_f32_16x16x32_bf16 v[104:107], v[64:67], v[76:79], v[104:107]
  v_mfma_f32_16x16x32_bf16 v[116:119], v[64:67], v[96:99], v[116:119]
  v_mfma_f32_16x16x32_bf16 v[108:111], v[68:71], v[72:75], v[108:111]
  v_mfma_f32_16x16x32_bf16 v[112:115], v[68:71], v[76:79], v[112:115]
  v_mfma_f32_16x16x32_bf16 v[120:123], v[68:71], v[96:99], v[120:123]
  s_nop 7
  s_nop 7
  s_barrier
  v_lshrrev_b32 v9, 4, v1
  v_lshlrev_b32 v9, 9, v9
  v_and_b32 v10, 15, v1
  v_lshl_add_u32 v9, v10, 2, v9
  v_mul_u32_u24 v11, 4352, v2
  v_add_u32 v9, v9, v11
  ds_write_b32 v9, v100 offset:0
  ds_write_b32 v9, v101 offset:128
  ds_write_b32 v9, v102 offset:256
  ds_write_b32 v9, v103 offset:384
  ds_write_b32 v9, v104 offset:64
  ds_write_b32 v9, v105 offset:192
  ds_write_b32 v9, v106 offset:320
  ds_write_b32 v9, v107 offset:448
  ds_write_b32 v9, v108 offset:2048
  ds_write_b32 v9, v109 offset:2176
  ds_write_b32 v9, v110 offset:2304
  ds_write_b32 v9, v111 offset:2432
  ds_write_b32 v9, v112 offset:2112
  ds_write_b32 v9, v113 offset:2240
  ds_write_b32 v9, v114 offset:2368
  ds_write_b32 v9, v115 offset:2496
  v_lshrrev_b32 v12, 4, v1
  v_lshlrev_b32 v12, 4, v12
  v_add_u32 v12, v12, v11
  v_cmp_eq_u32 vcc, 0, v10
  s_and_saveexec_b64 s[50:51], vcc
  ds_write_b32 v12, v116 offset:4096
  ds_write_b32 v12, v117 offset:4100
  ds_write_b32 v12, v118 offset:4104
  ds_write_b32 v12, v119 offset:4108
  ds_write_b32 v12, v120 offset:4160
  ds_write_b32 v12, v121 offset:4164
  ds_write_b32 v12, v122 offset:4168
  ds_write_b32 v12, v123 offset:4172
  s_mov_b64 exec, s[50:51]
  s_waitcnt lgkmcnt(0)
  s_barrier
  v_lshlrev_b32 v13, 2, v0
  s_mul_i32 s3, s2, 4224
  ds_read_b32 v20, v13 offset:0
  ds_read_b32 v21, v13 offset:4352
  ds_read_b32 v22, v13 offset:8704
  ds_read_b32 v23, v13 offset:13056
  s_waitcnt lgkmcnt(0)
  v_add_f32 v20, v20, v21
  v_add_f32 v22, v22, v23
  v_add_f32 v20, v20, v22
  s_add_u32 s52, s3, 0
  buffer_store_dword v20, v13, s[28:31], s52 offen
  ds_read_b32 v20, v13 offset:1024
  ds_read_b32 v21, v13 offset:5376
  ds_read_b32 v22, v13 offset:9728
  ds_read_b32 v23, v13 offset:14080
  s_waitcnt lgkmcnt(0)
  v_add_f32 v20, v20, v21
  v_add_f32 v22, v22, v23
  v_add_f32 v20, v20, v22
  s_add_u32 s52, s3, 1024
  buffer_store_dword v20, v13, s[28:31], s52 offen
  ds_read_b32 v20, v13 offset:2048
  ds_read_b32 v21, v13 offset:6400
  ds_read_b32 v22, v13 offset:10752
  ds_read_b32 v23, v13 offset:15104
  s_waitcnt lgkmcnt(0)
  v_add_f32 v20, v20, v21
  v_add_f32 v22, v22, v23
  v_add_f32 v20, v20, v22
  s_add_u32 s52, s3, 2048
  buffer_store_dword v20, v13, s[28:31], s52 offen
  ds_read_b32 v20, v13 offset:3072
  ds_read_b32 v21, v13 offset:7424
  ds_read_b32 v22, v13 offset:11776
  ds_read_b32 v23, v13 offset:16128
  s_waitcnt lgkmcnt(0)
  v_add_f32 v20, v20, v21
  v_add_f32 v22, v22, v23
  v_add_f32 v20, v20, v22
  s_add_u32 s52, s3, 3072
  buffer_store_dword v20, v13, s[28:31], s52 offen
  v_cmp_gt_u32 vcc, 32, v0
  s_and_saveexec_b64 s[50:51], vcc
  ds_read_b32 v20, v13 offset:4096
  ds_read_b32 v21, v13 offset:8448
  ds_read_b32 v22, v13 offset:12800
  ds_read_b32 v23, v13 offset:17152
  s_waitcnt lgkmcnt(0)
  v_add_f32 v20, v20, v21
  v_add_f32 v22, v22, v23
  v_add_f32 v20, v20, v22
  s_add_u32 s52, s3, 4096
  buffer_store_dword v20, v13, s[28:31], s52 offen
  s_mov_b64 exec, s[50:51]
L_kvpart2_kernel_end:
  s_endpgm
.globl linapply2_kernel
.p2align 8
.type linapply2_kernel,@function
linapply2_kernel:
  s_cmp_ge_u32 s2, 256
  s_cbranch_scc1 L_linapply2_kernel_end
  s_load_dwordx16 s[4:19], s[0:1], 0
  s_load_dwordx2 s[20:21], s[0:1], 64
  s_waitcnt lgkmcnt(0)
  s_add_u32 s24, s20, 4194304
  s_addc_u32 s25, s21, 0
  s_and_b32 s25, s25, 0xffff
  s_mov_b32 s26, 12582912
  s_mov_b32 s27, 0x00020000
  s_add_u32 s28, s20, 33554432
  s_addc_u32 s29, s21, 0
  s_and_b32 s29, s29, 0xffff
  s_mov_b32 s30, 1081344
  s_mov_b32 s31, 0x00020000
  s_add_u32 s32, s20, 16777216
  s_addc_u32 s33, s21, 0
  s_and_b32 s33, s33, 0xffff
  s_mov_b32 s34, 4194304
  s_mov_b32 s35, 0x00020000
  s_lshr_b32 s40, s2, 3
  s_and_b32 s41, s2, 7
  v_and_b32 v1, 63, v0
  v_lshrrev_b32 v2, 6, v0
  v_lshlrev_b32 v13, 2, v0
  s_mul_i32 s42, s40, 33792
  v_and_b32 v14, 31, v0
  v_lshlrev_b32 v14, 6, v14
  v_lshrrev_b32 v15, 5, v0
  v_lshl_add_u32 v14, v15, 1, v14
  s_add_u32 s3, s42, 0
  buffer_load_dword v20, v13, s[28:31], s3 offen
  s_add_u32 s3, s42, 4224
  buffer_load_dword v21, v13, s[28:31], s3 offen
  s_add_u32 s3, s42, 8448
  buffer_load_dword v22, v13, s[28:31], s3 offen
  s_add_u32 s3, s42, 12672
  buffer_load_dword v23, v13, s[28:31], s3 offen
  s_add_u32 s3, s42, 16896
  buffer_load_dword v24, v13, s[28:31], s3 offen
  s_add_u32 s3, s42, 21120
  buffer_load_dword v25, v13, s[28:31], s3 offen
  s_add_u32 s3, s42, 25344
  buffer_load_dword v26, v13, s[28:31], s3 offen
  s_add_u32 s3, s42, 29568
  buffer_load_dword v27, v13, s[28:31], s3 offen
  s_waitcnt vmcnt(0)
  v_add_f32 v20, v20, v21
  v_add_f32 v20, v20, v22
  v_add_f32 v20, v20, v23
  v_add_f32 v20, v20, v24
  v_add_f32 v20, v20, v25
  v_add_f32 v20, v20, v26
  v_add_f32 v20, v20, v27
  v_cvt_pk_bf16_f32 v20, v20, v20
  ds_write_b16 v14, v20 offset:0
  s_add_u32 s3, s42, 1024
  buffer_load_dword v20, v13, s[28:31], s3 offen
  s_add_u32 s3, s42, 5248
  buffer_load_dword v21, v13, s[28:31], s3 offen
  s_add_u32 s3, s42, 9472
  buffer_load_dword v22, v13, s[28:31], s3 offen
  s_add_u32 s3, s42, 13696
  buffer_load_dword v23, v13, s[28:31], s3 offen
  s_add_u32 s3, s42, 17920
  buffer_load_dword v24, v13, s[28:31], s3 offen
  s_add_u32 s3, s42, 22144
  buffer_load_dword v25, v13, s[28:31], s3 offen
  s_add_u32 s3, s42, 26368
  buffer_load_dword v26, v13, s[28:31], s3 offen
  s_add_u32 s3, s42, 30592
  buffer_load_dword v27, v13, s[28:31], s3 offen
  s_waitcnt vmcnt(0)
  v_add_f32 v20, v20, v21
  v_add_f32 v20, v20, v22
  v_add_f32 v20, v20, v23
  v_add_f32 v20, v20, v24
  v_add_f32 v20, v20, v25
  v_add_f32 v20, v20, v26
  v_add_f32 v20, v20, v27
  v_cvt_pk_bf16_f32 v20, v20, v20
  ds_write_b16 v14, v20 offset:16
  s_add_u32 s3, s42, 2048
  buffer_load_dword v20, v13, s[28:31], s3 offen
  s_add_u32 s3, s42, 6272
  buffer_load_dword v21, v13, s[28:31], s3 offen
  s_add_u32 s3, s42, 10496
  buffer_load_dword v22, v13, s[28:31], s3 offen
  s_add_u32 s3, s42, 14720
  buffer_load_dword v23, v13, s[28:31], s3 offen
  s_add_u32 s3, s42, 18944
  buffer_load_dword v24, v13, s[28:31], s3 offen
  s_add_u32 s3, s42, 23168
  buffer_load_dword v25, v13, s[28:31], s3 offen
  s_add_u32 s3, s42, 27392
  buffer_load_dword v26, v13, s[28:31], s3 offen
  s_add_u32 s3, s42, 31616
  buffer_load_dword v27, v13, s[28:31], s3 offen
  s_waitcnt vmcnt(0)
  v_add_f32 v20, v20, v21
  v_add_f32 v20, v20, v22
  v_add_f32 v20, v20, v23
  v_add_f32 v20, v20, v24
  v_add_f32 v20, v20, v25
  v_add_f32 v20, v20, v26
  v_add_f32 v20, v20, v27
  v_cvt_pk_bf16_f32 v20, v20, v20
  ds_write_b16 v14, v20 offset:32
  s_add_u32 s3, s42, 3072
  buffer_load_dword v20, v13, s[28:31], s3 offen
  s_add_u32 s3, s42, 7296
  buffer_load_dword v21, v13, s[28:31], s3 offen
  s_add_u32 s3, s42, 11520
  buffer_load_dword v22, v13, s[28:31], s3 offen
  s_add_u32 s3, s42, 15744
  buffer_load_dword v23, v13, s[28:31], s3 offen
  s_add_u32 s3, s42, 19968
  buffer_load_dword v24, v13, s[28:31], s3 offen
  s_add_u32 s3, s42, 24192
  buffer_load_dword v25, v13, s[28:31], s3 offen
  s_add_u32 s3, s42, 28416
  buffer_load_dword v26, v13, s[28:31], s3 offen
  s_add_u32 s3, s42, 32640
  buffer_load_dword v27, v13, s[28:31], s3 offen
  s_waitcnt vmcnt(0)
  v_add_f32 v20, v20, v21
  v_add_f32 v20, v20, v22
  v_add_f32 v20, v20, v23
  v_add_f32 v20, v20, v24
  v_add_f32 v20, v20, v25
  v_add_f32 v20, v20, v26
  v_add_f32 v20, v20, v27
  v_cvt_pk_bf16_f32 v20, v20, v20
  ds_write_b16 v14, v20 offset:48
  v_cmp_gt_u32 vcc, 32, v0
  s_and_saveexec_b64 s[50:51], vcc
  v_lshlrev_b32 v14, 1, v0
  v_add_u32 v14, 2048, v14
  s_add_u32 s3, s42, 4096
  buffer_load_dword v20, v13, s[28:31], s3 offen
  s_add_u32 s3, s42, 8320
  buffer_load_dword v21, v13, s[28:31], s3 offen
  s_add_u32 s3, s42, 12544
  buffer_load_dword v22, v13, s[28:31], s3 offen
  s_add_u32 s3, s42, 16768
  buffer_load_dword v23, v13, s[28:31], s3 offen
  s_add_u32 s3, s42, 20992
  buffer_load_dword v24, v13, s[28:31], s3 offen
  s_add_u32 s3, s42, 25216
  buffer_load_dword v25, v13, s[28:31], s3 offen
  s_add_u32 s3, s42, 29440
  buffer_load_dword v26, v13, s[28:31], s3 offen
  s_add_u32 s3, s42, 33664
  buffer_load_dword v27, v13, s[28:31], s3 offen
  s_waitcnt vmcnt(0)
  v_add_f32 v20, v20, v21
  v_add_f32 v20, v20, v22
  v_add_f32 v20, v20, v23
  v_add_f32 v20, v20, v24
  v_add_f32 v20, v20, v25
  v_add_f32 v20, v20, v26
  v_add_f32 v20, v20, v27
  v_cvt_pk_bf16_f32 v20, v20, v20
  ds_write_b16 v14, v20 offset:0
  s_mov_b64 exec, s[50:51]
  s_waitcnt lgkmcnt(0)
  s_barrier
  v_and_b32 v3, 15, v1
  v_lshrrev_b32 v4, 4, v1
  v_lshlrev_b32 v5, 6, v3
  v_lshl_add_u32 v5, v4, 4, v5
  v_lshlrev_b32 v6, 4, v4
  ds_read_b128 v[64:67], v5
  ds_read_b128 v[68:71], v5 offset:1024
  ds_read_b128 v[72:75], v6 offset:2048
  s_lshl_b32 s3, s41, 8
  v_lshl_add_u32 v7, v2, 6, v3
  v_add_u32 v7, s3, v7
  v_mul_u32_u24 v8, 6144, v7
  v_lshl_add_u32 v8, v4, 4, v8
  s_lshl_b32 s43, s40, 6
  s_add_u32 s44, s43, 0
  buffer_load_dwordx4 v[16:19], v8, s[24:27], s44 offen
  s_add_u32 s44, s43, 98304
  buffer_load_dwordx4 v[20:23], v8, s[24:27], s44 offen
  s_add_u32 s44, s43, 196608
  buffer_load_dwordx4 v[24:27], v8, s[24:27], s44 offen
  s_add_u32 s44, s43, 294912
  buffer_load_dwordx4 v[28:31], v8, s[24:27], s44 offen
  v_lshlrev_b32 v9, 11, v7
  v_lshl_add_u32 v9, v4, 3, v9
  v_add_u32 v9, s43, v9
  s_waitcnt vmcnt(0) lgkmcnt(0)
  v_lshlrev_b32 v60, 16, v16
  v_and_b32 v61, 0xffff0000, v16
  v_mul_f32 v62, 0x3fb8aa3b, v60
  v_exp_f32 v62, v62
  v_add_f32 v63, 1.0, v60
  v_cmp_lt_f32 vcc, 0, v60
  s_nop 1
  v_cndmask_b32 v60, v62, v63, vcc
  v_mul_f32 v62, 0x3fb8aa3b, v61
  v_exp_f32 v62, v62
  v_add_f32 v63, 1.0, v61
  v_cmp_lt_f32 vcc, 0, v61
  s_nop 1
  v_cndmask_b32 v61, v62, v63, vcc
  v_cvt_pk_bf16_f32 v62, v60, v61
  v_lshlrev_b32 v60, 16, v62
  v_and_b32 v61, 0xffff0000, v62
  v_add_f32 v60, 0x358637bd, v60
  v_add_f32 v61, 0x358637bd, v61
  v_cvt_pk_bf16_f32 v16, v60, v61
  v_lshlrev_b32 v60, 16, v17
  v_and_b32 v61, 0xffff0000, v17
  v_mul_f32 v62, 0x3fb8aa3b, v60
  v_exp_f32 v62, v62
  v_add_f32 v63, 1.0, v60
  v_cmp_lt_f32 vcc, 0, v60
  s_nop 1
  v_cndmask_b32 v60, v62, v63, vcc
  v_mul_f32 v62, 0x3fb8aa3b, v61
  v_exp_f32 v62, v62
  v_add_f32 v63, 1.0, v61
  v_cmp_lt_f32 vcc, 0, v61
  s_nop 1
  v_cndmask_b32 v61, v62, v63, vcc
  v_cvt_pk_bf16_f32 v62, v60, v61
  v_lshlrev_b32 v60, 16, v62
  v_and_b32 v61, 0xffff0000, v62
  v_add_f32 v60, 0x358637bd, v60
  v_add_f32 v61, 0x358637bd, v61
  v_cvt_pk_bf16_f32 v17, v60, v61
  v_lshlrev_b32 v60, 16, v18
  v_and_b32 v61, 0xffff0000, v18
  v_mul_f32 v62, 0x3fb8aa3b, v60
  v_exp_f32 v62, v62
  v_add_f32 v63, 1.0, v60
  v_cmp_lt_f32 vcc, 0, v60
  s_nop 1
  v_cndmask_b32 v60, v62, v63, vcc
  v_mul_f32 v62, 0x3fb8aa3b, v61
  v_exp_f32 v62, v62
  v_add_f32 v63, 1.0, v61
  v_cmp_lt_f32 vcc, 0, v61
  s_nop 1
  v_cndmask_b32 v61, v62, v63, vcc
  v_cvt_pk_bf16_f32 v62, v60, v61
  v_lshlrev_b32 v60, 16, v62
  v_and_b32 v61, 0xffff0000, v62
  v_add_f32 v60, 0x358637bd, v60
  v_add_f32 v61, 0x358637bd, v61
  v_cvt_pk_bf16_f32 v18, v60, v61
  v_lshlrev_b32 v60, 16, v19
  v_and_b32 v61, 0xffff0000, v19
  v_mul_f32 v62, 0x3fb8aa3b, v60
  v_exp_f32 v62, v62
  v_add_f32 v63, 1.0, v60
  v_cmp_lt_f32 vcc, 0, v60
  s_nop 1
  v_cndmask_b32 v60, v62, v63, vcc
  v_mul_f32 v62, 0x3fb8aa3b, v61
  v_exp_f32 v62, v62
  v_add_f32 v63, 1.0, v61
  v_cmp_lt_f32 vcc, 0, v61
  s_nop 1
  v_cndmask_b32 v61, v62, v63, vcc
  v_cvt_pk_bf16_f32 v62, v60, v61
  v_lshlrev_b32 v60, 16, v62
  v_and_b32 v61, 0xffff0000, v62
  v_add_f32 v60, 0x358637bd, v60
  v_add_f32 v61, 0x358637bd, v61
  v_cvt_pk_bf16_f32 v19, v60, v61
  v_lshlrev_b32 v60, 16, v20
  v_and_b32 v61, 0xffff0000, v20
  v_mul_f32 v62, 0x3fb8aa3b, v60
  v_exp_f32 v62, v62
  v_add_f32 v63, 1.0, v60
  v_cmp_lt_f32 vcc, 0, v60
  s_nop 1
  v_cndmask_b32 v60, v62, v63, vcc
  v_mul_f32 v62, 0x3fb8aa3b, v61
  v_exp_f32 v62, v62
  v_add_f32 v63, 1.0, v61
  v_cmp_lt_f32 vcc, 0, v61
  s_nop 1
  v_cndmask_b32 v61, v62, v63, vcc
  v_cvt_pk_bf16_f32 v62, v60, v61
  v_lshlrev_b32 v60, 16, v62
  v_and_b32 v61, 0xffff0000, v62
  v_add_f32 v60, 0x358637bd, v60
  v_add_f32 v61, 0x358637bd, v61
  v_cvt_pk_bf16_f32 v20, v60, v61
  v_lshlrev_b32 v60, 16, v21
  v_and_b32 v61, 0xffff0000, v21
  v_mul_f32 v62, 0x3fb8aa3b, v60
  v_exp_f32 v62, v62
  v_add_f32 v63, 1.0, v60
  v_cmp_lt_f32 vcc, 0, v60
  s_nop 1
  v_cndmask_b32 v60, v62, v63, vcc
  v_mul_f32 v62, 0x3fb8aa3b, v61
  v_exp_f32 v62, v62
  v_add_f32 v63, 1.0, v61
  v_cmp_lt_f32 vcc, 0, v61
  s_nop 1
  v_cndmask_b32 v61, v62, v63, vcc
  v_cvt_pk_bf16_f32 v62, v60, v61
  v_lshlrev_b32 v60, 16, v62
  v_and_b32 v61, 0xffff0000, v62
  v_add_f32 v60, 0x358637bd, v60
  v_add_f32 v61, 0x358637bd, v61
  v_cvt_pk_bf16_f32 v21, v60, v61
  v_lshlrev_b32 v60, 16, v22
  v_and_b32 v61, 0xffff0000, v22
  v_mul_f32 v62, 0x3fb8aa3b, v60
  v_exp_f32 v62, v62
  v_add_f32 v63, 1.0, v60
  v_cmp_lt_f32 vcc, 0, v60
  s_nop 1
  v_cndmask_b32 v60, v62, v63, vcc
  v_mul_f32 v62, 0x3fb8aa3b, v61
  v_exp_f32 v62, v62
  v_add_f32 v63, 1.0, v61
  v_cmp_lt_f32 vcc, 0, v61
  s_nop 1
  v_cndmask_b32 v61, v62, v63, vcc
  v_cvt_pk_bf16_f32 v62, v60, v61
  v_lshlrev_b32 v60, 16, v62
  v_and_b32 v61, 0xffff0000, v62
  v_add_f32 v60, 0x358637bd, v60
  v_add_f32 v61, 0x358637bd, v61
  v_cvt_pk_bf16_f32 v22, v60, v61
  v_lshlrev_b32 v60, 16, v23
  v_and_b32 v61, 0xffff0000, v23
  v_mul_f32 v62, 0x3fb8aa3b, v60
  v_exp_f32 v62, v62
  v_add_f32 v63, 1.0, v60
  v_cmp_lt_f32 vcc, 0, v60
  s_nop 1
  v_cndmask_b32 v60, v62, v63, vcc
  v_mul_f32 v62, 0x3fb8aa3b, v61
  v_exp_f32 v62, v62
  v_add_f32 v63, 1.0, v61
  v_cmp_lt_f32 vcc, 0, v61
  s_nop 1
  v_cndmask_b32 v61, v62, v63, vcc
  v_cvt_pk_bf16_f32 v62, v60, v61
  v_lshlrev_b32 v60, 16, v62
  v_and_b32 v61, 0xffff0000, v62
  v_add_f32 v60, 0x358637bd, v60
  v_add_f32 v61, 0x358637bd, v61
  v_cvt_pk_bf16_f32 v23, v60, v61
  v_lshlrev_b32 v60, 16, v24
  v_and_b32 v61, 0xffff0000, v24
  v_mul_f32 v62, 0x3fb8aa3b, v60
  v_exp_f32 v62, v62
  v_add_f32 v63, 1.0, v60
  v_cmp_lt_f32 vcc, 0, v60
  s_nop 1
  v_cndmask_b32 v60, v62, v63, vcc
  v_mul_f32 v62, 0x3fb8aa3b, v61
  v_exp_f32 v62, v62
  v_add_f32 v63, 1.0, v61
  v_cmp_lt_f32 vcc, 0, v61
  s_nop 1
  v_cndmask_b32 v61, v62, v63, vcc
  v_cvt_pk_bf16_f32 v62, v60, v61
  v_lshlrev_b32 v60, 16, v62
  v_and_b32 v61, 0xffff0000, v62
  v_add_f32 v60, 0x358637bd, v60
  v_add_f32 v61, 0x358637bd, v61
  v_cvt_pk_bf16_f32 v24, v60, v61
  v_lshlrev_b32 v60, 16, v25
  v_and_b32 v61, 0xffff0000, v25
  v_mul_f32 v62, 0x3fb8aa3b, v60
  v_exp_f32 v62, v62
  v_add_f32 v63, 1.0, v60
  v_cmp_lt_f32 vcc, 0, v60
  s_nop 1
  v_cndmask_b32 v60, v62, v63, vcc
  v_mul_f32 v62, 0x3fb8aa3b, v61
  v_exp_f32 v62, v62
  v_add_f32 v63, 1.0, v61
  v_cmp_lt_f32 vcc, 0, v61
  s_nop 1
  v_cndmask_b32 v61, v62, v63, vcc
  v_cvt_pk_bf16_f32 v62, v60, v61
  v_lshlrev_b32 v60, 16, v62
  v_and_b32 v61, 0xffff0000, v62
  v_add_f32 v60, 0x358637bd, v60
  v_add_f32 v61, 0x358637bd, v61
  v_cvt_pk_bf16_f32 v25, v60, v61
  v_lshlrev_b32 v60, 16, v26
  v_and_b32 v61, 0xffff0000, v26
  v_mul_f32 v62, 0x3fb8aa3b, v60
  v_exp_f32 v62, v62
  v_add_f32 v63, 1.0, v60
  v_cmp_lt_f32 vcc, 0, v60
  s_nop 1
  v_cndmask_b32 v60, v62, v63, vcc
  v_mul_f32 v62, 0x3fb8aa3b, v61
  v_exp_f32 v62, v62
  v_add_f32 v63, 1.0, v61
  v_cmp_lt_f32 vcc, 0, v61
  s_nop 1
  v_cndmask_b32 v61, v62, v63, vcc
  v_cvt_pk_bf16_f32 v62, v60, v61
  v_lshlrev_b32 v60, 16, v62
  v_and_b32 v61, 0xffff0000, v62
  v_add_f32 v60, 0x358637bd, v60
  v_add_f32 v61, 0x358637bd, v61
  v_cvt_pk_bf16_f32 v26, v60, v61
  v_lshlrev_b32 v60, 16, v27
  v_and_b32 v61, 0xffff0000, v27
  v_mul_f32 v62, 0x3fb8aa3b, v60
  v_exp_f32 v62, v62
  v_add_f32 v63, 1.0, v60
  v_cmp_lt_f32 vcc, 0, v60
  s_nop 1
  v_cndmask_b32 v60, v62, v63, vcc
  v_mul_f32 v62, 0x3fb8aa3b, v61
  v_exp_f32 v62, v62
  v_add_f32 v63, 1.0, v61
  v_cmp_lt_f32 vcc, 0, v61
  s_nop 1
  v_cndmask_b32 v61, v62, v63, vcc
  v_cvt_pk_bf16_f32 v62, v60, v61
  v_lshlrev_b32 v60, 16, v62
  v_and_b32 v61, 0xffff0000, v62
  v_add_f32 v60, 0x358637bd, v60
  v_add_f32 v61, 0x358637bd, v61
  v_cvt_pk_bf16_f32 v27, v60, v61
  v_lshlrev_b32 v60, 16, v28
  v_and_b32 v61, 0xffff0000, v28
  v_mul_f32 v62, 0x3fb8aa3b, v60
  v_exp_f32 v62, v62
  v_add_f32 v63, 1.0, v60
  v_cmp_lt_f32 vcc, 0, v60
  s_nop 1
  v_cndmask_b32 v60, v62, v63, vcc
  v_mul_f32 v62, 0x3fb8aa3b, v61
  v_exp_f32 v62, v62
  v_add_f32 v63, 1.0, v61
  v_cmp_lt_f32 vcc, 0, v61
  s_nop 1
  v_cndmask_b32 v61, v62, v63, vcc
  v_cvt_pk_bf16_f32 v62, v60, v61
  v_lshlrev_b32 v60, 16, v62
  v_and_b32 v61, 0xffff0000, v62
  v_add_f32 v60, 0x358637bd, v60
  v_add_f32 v61, 0x358637bd, v61
  v_cvt_pk_bf16_f32 v28, v60, v61
  v_lshlrev_b32 v60, 16, v29
  v_and_b32 v61, 0xffff0000, v29
  v_mul_f32 v62, 0x3fb8aa3b, v60
  v_exp_f32 v62, v62
  v_add_f32 v63, 1.0, v60
  v_cmp_lt_f32 vcc, 0, v60
  s_nop 1
  v_cndmask_b32 v60, v62, v63, vcc
  v_mul_f32 v62, 0x3fb8aa3b, v61
  v_exp_f32 v62, v62
  v_add_f32 v63, 1.0, v61
  v_cmp_lt_f32 vcc, 0, v61
  s_nop 1
  v_cndmask_b32 v61, v62, v63, vcc
  v_cvt_pk_bf16_f32 v62, v60, v61
  v_lshlrev_b32 v60, 16, v62
  v_and_b32 v61, 0xffff0000, v62
  v_add_f32 v60, 0x358637bd, v60
  v_add_f32 v61, 0x358637bd, v61
  v_cvt_pk_bf16_f32 v29, v60, v61
  v_lshlrev_b32 v60, 16, v30
  v_and_b32 v61, 0xffff0000, v30
  v_mul_f32 v62, 0x3fb8aa3b, v60
  v_exp_f32 v62, v62
  v_add_f32 v63, 1.0, v60
  v_cmp_lt_f32 vcc, 0, v60
  s_nop 1
  v_cndmask_b32 v60, v62, v63, vcc
  v_mul_f32 v62, 0x3fb8aa3b, v61
  v_exp_f32 v62, v62
  v_add_f32 v63, 1.0, v61
  v_cmp_lt_f32 vcc, 0, v61
  s_nop 1
  v_cndmask_b32 v61, v62, v63, vcc
  v_cvt_pk_bf16_f32 v62, v60, v61
  v_lshlrev_b32 v60, 16, v62
  v_and_b32 v61, 0xffff0000, v62
  v_add_f32 v60, 0x358637bd, v60
  v_add_f32 v61, 0x358637bd, v61
  v_cvt_pk_bf16_f32 v30, v60, v61
  v_lshlrev_b32 v60, 16, v31
  v_and_b32 v61, 0xffff0000, v31
  v_mul_f32 v62, 0x3fb8aa3b, v60
  v_exp_f32 v62, v62
  v_add_f32 v63, 1.0, v60
  v_cmp_lt_f32 vcc, 0, v60
  s_nop 1
  v_cndmask_b32 v60, v62, v63, vcc
  v_mul_f32 v62, 0x3fb8aa3b, v61
  v_exp_f32 v62, v62
  v_add_f32 v63, 1.0, v61
  v_cmp_lt_f32 vcc, 0, v61
  s_nop 1
  v_cndmask_b32 v61, v62, v63, vcc
  v_cvt_pk_bf16_f32 v62, v60, v61
  v_lshlrev_b32 v60, 16, v62
  v_and_b32 v61, 0xffff0000, v62
  v_add_f32 v60, 0x358637bd, v60
  v_add_f32 v61, 0x358637bd, v61
  v_cvt_pk_bf16_f32 v31, v60, v61
  s_nop 1
  v_mov_b32 v80, 0
  v_mov_b32 v81, 0
  v_mov_b32 v82, 0
  v_mov_b32 v83, 0
  v_mov_b32 v84, 0
  v_mov_b32 v85, 0
  v_mov_b32 v86, 0
  v_mov_b32 v87, 0
  v_mov_b32 v88, 0
  v_mov_b32 v89, 0
  v_mov_b32 v90, 0
  v_mov_b32 v91, 0
  s_nop 1
  v_mfma_f32_16x16x32_bf16 v[80:83], v[64:67], v[16:19], v[80:83]
  v_mfma_f32_16x16x32_bf16 v[84:87], v[68:71], v[16:19], v[84:87]
  v_mfma_f32_16x16x32_bf16 v[88:91], v[72:75], v[16:19], v[88:91]
  s_nop 7
  s_nop 7
  v_cvt_pk_bf16_f32 v88, v88, v88
  v_and_b32 v88, 0xffff0000, v88
  v_add_f32 v88, 0x358637bd, v88
  v_cvt_pk_bf16_f32 v88, v88, v88
  v_and_b32 v88, 0xffff0000, v88
  v_rcp_f32 v89, v88
  s_nop 0
  v_cvt_pk_bf16_f32 v80, v80, v80
  v_and_b32 v80, 0xffff0000, v80
  v_mul_f32 v90, v80, v89
  v_fma_f32 v91, -v90, v88, v80
  v_fma_f32 v80, v91, v89, v90
  v_cvt_pk_bf16_f32 v81, v81, v81
  v_and_b32 v81, 0xffff0000, v81
  v_mul_f32 v90, v81, v89
  v_fma_f32 v91, -v90, v88, v81
  v_fma_f32 v81, v91, v89, v90
  v_cvt_pk_bf16_f32 v82, v82, v82
  v_and_b32 v82, 0xffff0000, v82
  v_mul_f32 v90, v82, v89
  v_fma_f32 v91, -v90, v88, v82
  v_fma_f32 v82, v91, v89, v90
  v_cvt_pk_bf16_f32 v83, v83, v83
  v_and_b32 v83, 0xffff0000, v83
  v_mul_f32 v90, v83, v89
  v_fma_f32 v91, -v90, v88, v83
  v_fma_f32 v83, v91, v89, v90
  v_cvt_pk_bf16_f32 v84, v84, v84
  v_and_b32 v84, 0xffff0000, v84
  v_mul_f32 v90, v84, v89
  v_fma_f32 v91, -v90, v88, v84
  v_fma_f32 v84, v91, v89, v90
  v_cvt_pk_bf16_f32 v85, v85, v85
  v_and_b32 v85, 0xffff0000, v85
  v_mul_f32 v90, v85, v89
  v_fma_f32 v91, -v90, v88, v85
  v_fma_f32 v85, v91, v89, v90
  v_cvt_pk_bf16_f32 v86, v86, v86
  v_and_b32 v86, 0xffff0000, v86
  v_mul_f32 v90, v86, v89
  v_fma_f32 v91, -v90, v88, v86
  v_fma_f32 v86, v91, v89, v90
  v_cvt_pk_bf16_f32 v87, v87, v87
  v_and_b32 v87, 0xffff0000, v87
  v_mul_f32 v90, v87, v89
  v_fma_f32 v91, -v90, v88, v87
  v_fma_f32 v87, v91, v89, v90
  v_cvt_pk_bf16_f32 v80, v80, v81
  v_cvt_pk_bf16_f32 v81, v82, v83
  buffer_store_dwordx2 v[80:81], v9, s[32:35], 0 offen offset:0
  v_cvt_pk_bf16_f32 v84, v84, v85
  v_cvt_pk_bf16_f32 v85, v86, v87
  buffer_store_dwordx2 v[84:85], v9, s[32:35], 0 offen offset:32
  v_add_u32 v9, 32768, v9
  v_mov_b32 v80, 0
  v_mov_b32 v81, 0
  v_mov_b32 v82, 0
  v_mov_b32 v83, 0
  v_mov_b32 v84, 0
  v_mov_b32 v85, 0
  v_mov_b32 v86, 0
  v_mov_b32 v87, 0
  v_mov_b32 v88, 0
  v_mov_b32 v89, 0
  v_mov_b32 v90, 0
  v_mov_b32 v91, 0
  s_nop 1
  v_mfma_f32_16x16x32_bf16 v[80:83], v[64:67], v[20:23], v[80:83]
  v_mfma_f32_16x16x32_bf16 v[84:87], v[68:71], v[20:23], v[84:87]
  v_mfma_f32_16x16x32_bf16 v[88:91], v[72:75], v[20:23], v[88:91]
  s_nop 7
  s_nop 7
  v_cvt_pk_bf16_f32 v88, v88, v88
  v_and_b32 v88, 0xffff0000, v88
  v_add_f32 v88, 0x358637bd, v88
  v_cvt_pk_bf16_f32 v88, v88, v88
  v_and_b32 v88, 0xffff0000, v88
  v_rcp_f32 v89, v88
  s_nop 0
  v_cvt_pk_bf16_f32 v80, v80, v80
  v_and_b32 v80, 0xffff0000, v80
  v_mul_f32 v90, v80, v89
  v_fma_f32 v91, -v90, v88, v80
  v_fma_f32 v80, v91, v89, v90
  v_cvt_pk_bf16_f32 v81, v81, v81
  v_and_b32 v81, 0xffff0000, v81
  v_mul_f32 v90, v81, v89
  v_fma_f32 v91, -v90, v88, v81
  v_fma_f32 v81, v91, v89, v90
  v_cvt_pk_bf16_f32 v82, v82, v82
  v_and_b32 v82, 0xffff0000, v82
  v_mul_f32 v90, v82, v89
  v_fma_f32 v91, -v90, v88, v82
  v_fma_f32 v82, v91, v89, v90
  v_cvt_pk_bf16_f32 v83, v83, v83
  v_and_b32 v83, 0xffff0000, v83
  v_mul_f32 v90, v83, v89
  v_fma_f32 v91, -v90, v88, v83
  v_fma_f32 v83, v91, v89, v90
  v_cvt_pk_bf16_f32 v84, v84, v84
  v_and_b32 v84, 0xffff0000, v84
  v_mul_f32 v90, v84, v89
  v_fma_f32 v91, -v90, v88, v84
  v_fma_f32 v84, v91, v89, v90
  v_cvt_pk_bf16_f32 v85, v85, v85
  v_and_b32 v85, 0xffff0000, v85
  v_mul_f32 v90, v85, v89
  v_fma_f32 v91, -v90, v88, v85
  v_fma_f32 v85, v91, v89, v90
  v_cvt_pk_bf16_f32 v86, v86, v86
  v_and_b32 v86, 0xffff0000, v86
  v_mul_f32 v90, v86, v89
  v_fma_f32 v91, -v90, v88, v86
  v_fma_f32 v86, v91, v89, v90
  v_cvt_pk_bf16_f32 v87, v87, v87
  v_and_b32 v87, 0xffff0000, v87
  v_mul_f32 v90, v87, v89
  v_fma_f32 v91, -v90, v88, v87
  v_fma_f32 v87, v91, v89, v90
  v_cvt_pk_bf16_f32 v80, v80, v81
  v_cvt_pk_bf16_f32 v81, v82, v83
  buffer_store_dwordx2 v[80:81], v9, s[32:35], 0 offen offset:0
  v_cvt_pk_bf16_f32 v84, v84, v85
  v_cvt_pk_bf16_f32 v85, v86, v87
  buffer_store_dwordx2 v[84:85], v9, s[32:35], 0 offen offset:32
  v_add_u32 v9, 32768, v9
  v_mov_b32 v80, 0
  v_mov_b32 v81, 0
  v_mov_b32 v82, 0
  v_mov_b32 v83, 0
  v_mov_b32 v84, 0
  v_mov_b32 v85, 0
  v_mov_b32 v86, 0
  v_mov_b32 v87, 0
  v_mov_b32 v88, 0
  v_mov_b32 v89, 0
  v_mov_b32 v90, 0
  v_mov_b32 v91, 0
  s_nop 1
  v_mfma_f32_16x16x32_bf16 v[80:83], v[64:67], v[24:27], v[80:83]
  v_mfma_f32_16x16x32_bf16 v[84:87], v[68:71], v[24:27], v[84:87]
  v_mfma_f32_16x16x32_bf16 v[88:91], v[72:75], v[24:27], v[88:91]
  s_nop 7
  s_nop 7
  v_cvt_pk_bf16_f32 v88, v88, v88
  v_and_b32 v88, 0xffff0000, v88
  v_add_f32 v88, 0x358637bd, v88
  v_cvt_pk_bf16_f32 v88, v88, v88
  v_and_b32 v88, 0xffff0000, v88
  v_rcp_f32 v89, v88
  s_nop 0
  v_cvt_pk_bf16_f32 v80, v80, v80
  v_and_b32 v80, 0xffff0000, v80
  v_mul_f32 v90, v80, v89
  v_fma_f32 v91, -v90, v88, v80
  v_fma_f32 v80, v91, v89, v90
  v_cvt_pk_bf16_f32 v81, v81, v81
  v_and_b32 v81, 0xffff0000, v81
  v_mul_f32 v90, v81, v89
  v_fma_f32 v91, -v90, v88, v81
  v_fma_f32 v81, v91, v89, v90
  v_cvt_pk_bf16_f32 v82, v82, v82
  v_and_b32 v82, 0xffff0000, v82
  v_mul_f32 v90, v82, v89
  v_fma_f32 v91, -v90, v88, v82
  v_fma_f32 v82, v91, v89, v90
  v_cvt_pk_bf16_f32 v83, v83, v83
  v_and_b32 v83, 0xffff0000, v83
  v_mul_f32 v90, v83, v89
  v_fma_f32 v91, -v90, v88, v83
  v_fma_f32 v83, v91, v89, v90
  v_cvt_pk_bf16_f32 v84, v84, v84
  v_and_b32 v84, 0xffff0000, v84
  v_mul_f32 v90, v84, v89
  v_fma_f32 v91, -v90, v88, v84
  v_fma_f32 v84, v91, v89, v90
  v_cvt_pk_bf16_f32 v85, v85, v85
  v_and_b32 v85, 0xffff0000, v85
  v_mul_f32 v90, v85, v89
  v_fma_f32 v91, -v90, v88, v85
  v_fma_f32 v85, v91, v89, v90
  v_cvt_pk_bf16_f32 v86, v86, v86
  v_and_b32 v86, 0xffff0000, v86
  v_mul_f32 v90, v86, v89
  v_fma_f32 v91, -v90, v88, v86
  v_fma_f32 v86, v91, v89, v90
  v_cvt_pk_bf16_f32 v87, v87, v87
  v_and_b32 v87, 0xffff0000, v87
  v_mul_f32 v90, v87, v89
  v_fma_f32 v91, -v90, v88, v87
  v_fma_f32 v87, v91, v89, v90
  v_cvt_pk_bf16_f32 v80, v80, v81
  v_cvt_pk_bf16_f32 v81, v82, v83
  buffer_store_dwordx2 v[80:81], v9, s[32:35], 0 offen offset:0
  v_cvt_pk_bf16_f32 v84, v84, v85
  v_cvt_pk_bf16_f32 v85, v86, v87
  buffer_store_dwordx2 v[84:85], v9, s[32:35], 0 offen offset:32
  v_add_u32 v9, 32768, v9
  v_mov_b32 v80, 0
  v_mov_b32 v81, 0
  v_mov_b32 v82, 0
  v_mov_b32 v83, 0
  v_mov_b32 v84, 0
  v_mov_b32 v85, 0
  v_mov_b32 v86, 0
  v_mov_b32 v87, 0
  v_mov_b32 v88, 0
  v_mov_b32 v89, 0
  v_mov_b32 v90, 0
  v_mov_b32 v91, 0
  s_nop 1
  v_mfma_f32_16x16x32_bf16 v[80:83], v[64:67], v[28:31], v[80:83]
  v_mfma_f32_16x16x32_bf16 v[84:87], v[68:71], v[28:31], v[84:87]
  v_mfma_f32_16x16x32_bf16 v[88:91], v[72:75], v[28:31], v[88:91]
  s_nop 7
  s_nop 7
  v_cvt_pk_bf16_f32 v88, v88, v88
  v_and_b32 v88, 0xffff0000, v88
  v_add_f32 v88, 0x358637bd, v88
  v_cvt_pk_bf16_f32 v88, v88, v88
  v_and_b32 v88, 0xffff0000, v88
  v_rcp_f32 v89, v88
  s_nop 0
  v_cvt_pk_bf16_f32 v80, v80, v80
  v_and_b32 v80, 0xffff0000, v80
  v_mul_f32 v90, v80, v89
  v_fma_f32 v91, -v90, v88, v80
  v_fma_f32 v80, v91, v89, v90
  v_cvt_pk_bf16_f32 v81, v81, v81
  v_and_b32 v81, 0xffff0000, v81
  v_mul_f32 v90, v81, v89
  v_fma_f32 v91, -v90, v88, v81
  v_fma_f32 v81, v91, v89, v90
  v_cvt_pk_bf16_f32 v82, v82, v82
  v_and_b32 v82, 0xffff0000, v82
  v_mul_f32 v90, v82, v89
  v_fma_f32 v91, -v90, v88, v82
  v_fma_f32 v82, v91, v89, v90
  v_cvt_pk_bf16_f32 v83, v83, v83
  v_and_b32 v83, 0xffff0000, v83
  v_mul_f32 v90, v83, v89
  v_fma_f32 v91, -v90, v88, v83
  v_fma_f32 v83, v91, v89, v90
  v_cvt_pk_bf16_f32 v84, v84, v84
  v_and_b32 v84, 0xffff0000, v84
  v_mul_f32 v90, v84, v89
  v_fma_f32 v91, -v90, v88, v84
  v_fma_f32 v84, v91, v89, v90
  v_cvt_pk_bf16_f32 v85, v85, v85
  v_and_b32 v85, 0xffff0000, v85
  v_mul_f32 v90, v85, v89
  v_fma_f32 v91, -v90, v88, v85
  v_fma_f32 v85, v91, v89, v90
  v_cvt_pk_bf16_f32 v86, v86, v86
  v_and_b32 v86, 0xffff0000, v86
  v_mul_f32 v90, v86, v89
  v_fma_f32 v91, -v90, v88, v86
  v_fma_f32 v86, v91, v89, v90
  v_cvt_pk_bf16_f32 v87, v87, v87
  v_and_b32 v87, 0xffff0000, v87
  v_mul_f32 v90, v87, v89
  v_fma_f32 v91, -v90, v88, v87
  v_fma_f32 v87, v91, v89, v90
  v_cvt_pk_bf16_f32 v80, v80, v81
  v_cvt_pk_bf16_f32 v81, v82, v83
  buffer_store_dwordx2 v[80:81], v9, s[32:35], 0 offen offset:0
  v_cvt_pk_bf16_f32 v84, v84, v85
  v_cvt_pk_bf16_f32 v85, v86, v87
  buffer_store_dwordx2 v[84:85], v9, s[32:35], 0 offen offset:32
L_linapply2_kernel_end:
  s_endpgm
.globl gemmo2_kernel
.p2align 8
.type gemmo2_kernel,@function
gemmo2_kernel:
  s_cmp_ge_u32 s2, 256
  s_cbranch_scc1 L_gemmo2_kernel_end
  s_load_dwordx16 s[4:19], s[0:1], 0
  s_load_dwordx2 s[20:21], s[0:1], 64
  s_waitcnt lgkmcnt(0)
  s_add_u32 s24, s20, 16777216
  s_addc_u32 s25, s21, 0
  s_and_b32 s25, s25, 0xffff
  s_mov_b32 s26, 4194304
  s_mov_b32 s27, 0x00020000
  s_mov_b32 s28, s8
  s_and_b32 s29, s9, 0xffff
  s_mov_b32 s30, 2097152
  s_mov_b32 s31, 0x00020000
  s_add_u32 s32, s20, 29360128
  s_addc_u32 s33, s21, 0
  s_and_b32 s33, s33, 0xffff
  s_mov_b32 s34, 4194304
  s_mov_b32 s35, 0x00020000
  s_add_u32 s36, s20, 25165824
  s_addc_u32 s37, s21, 0
  s_and_b32 s37, s37, 0xffff
  s_mov_b32 s38, 4194304
  s_mov_b32 s39, 0x00020000
  s_mov_b32 s3, 268435457
  s_mul_hi_u32 s40, s2, s3
  s_mul_i32 s3, s40, 16
  s_sub_u32 s41, s2, s3
  v_and_b32 v1, 63, v0
  v_lshrrev_b32 v2, 6, v0
  s_nop 0
  v_readfirstlane_b32 s42, v2
  v_lshrrev_b32 v14, 3, v1
  v_and_b32 v15, 7, v1
  v_xor_b32 v3, v14, v15
  v_lshlrev_b32 v4, 11, v14
  v_lshl_add_u32 v4, v3, 4, v4
  v_bfe_u32 v3, v1, 4, 1
  v_and_b32 v5, 1, v2
  v_lshl_add_u32 v3, v5, 1, v3
  v_lshrrev_b32 v5, 1, v15
  v_xor_b32 v3, v3, v5
  v_lshlrev_b32 v3, 1, v3
  v_and_b32 v5, 1, v15
  v_or_b32 v3, v3, v5
  v_lshl_add_u32 v5, v2, 3, v14
  v_mul_u32_u24 v5, 2048, v5
  v_lshl_add_u32 v5, v3, 4, v5
  s_mul_i32 s44, s40, 262144
  s_lshl_b32 s3, s42, 14
  s_add_u32 s44, s44, s3
  s_add_u32 s45, s44, 131072
  s_mul_i32 s46, s41, 128
  s_lshl_b32 s43, s42, 10
  v_and_b32 v6, 1, v2
  v_lshrrev_b32 v7, 1, v2
  v_and_b32 v14, 15, v1
  v_lshrrev_b32 v15, 4, v1
  v_mul_u32_u24 v8, 32, v7
  v_add_u32 v8, v8, v14
  v_lshlrev_b32 v8, 7, v8
  v_and_b32 v3, 7, v1
  v_xor_b32 v3, v3, v15
  v_lshl_add_u32 v9, v3, 4, v8
  v_xor_b32 v3, 4, v3
  v_lshl_add_u32 v8, v3, 4, v8
  v_mov_b32 v3, v9
  v_mov_b32 v9, v8
  v_mov_b32 v8, v3
  v_bfe_u32 v3, v1, 2, 2
  v_lshl_add_u32 v10, v15, 3, v3
  v_lshlrev_b32 v10, 7, v10
  v_and_b32 v11, 3, v1
  v_lshl_add_u32 v10, v11, 3, v10
  v_lshrrev_b32 v3, 1, v3
  v_and_b32 v11, 1, v15
  v_lshl_add_u32 v3, v11, 1, v3
  v_mul_u32_u24 v11, 2, v6
  v_add_u32 v120, 0, v11
  v_and_b32 v121, 3, v120
  v_xor_b32 v121, v121, v3
  v_lshlrev_b32 v121, 5, v121
  v_lshrrev_b32 v120, 2, v120
  v_lshl_add_u32 v121, v120, 13, v121
  v_add_u32 v122, v10, v121
  v_add_u32 v122, 16384, v122
  v_add_u32 v120, 1, v11
  v_and_b32 v121, 3, v120
  v_xor_b32 v121, v121, v3
  v_lshlrev_b32 v121, 5, v121
  v_lshrrev_b32 v120, 2, v120
  v_lshl_add_u32 v121, v120, 13, v121
  v_add_u32 v123, v10, v121
  v_add_u32 v123, 16384, v123
  v_add_u32 v128, 0, v8
  v_add_u32 v129, 0, v9
  v_add_u32 v134, 0, v122
  v_add_u32 v135, 0, v123
  v_add_u32 v130, 24576, v8
  v_add_u32 v131, 24576, v9
  v_add_u32 v136, 24576, v122
  v_add_u32 v137, 24576, v123
  v_add_u32 v132, 49152, v8
  v_add_u32 v133, 49152, v9
  v_add_u32 v138, 49152, v122
  v_add_u32 v139, 49152, v123
  s_mul_i32 s3, s40, 128
  v_mul_u32_u24 v13, 32, v7
  v_add_u32 v13, v13, v14
  v_add_u32 v13, s3, v13
  v_mul_u32_u24 v13, 2048, v13
  s_mul_i32 s3, s41, 128
  v_mul_u32_u24 v3, 64, v6
  v_add_u32 v13, v13, v3
  v_lshl_add_u32 v13, v15, 3, v13
  v_add_u32 v13, s3, v13
  v_mov_b32 v72, 0
  v_mov_b32 v73, 0
  v_mov_b32 v74, 0
  v_mov_b32 v75, 0
  v_mov_b32 v76, 0
  v_mov_b32 v77, 0
  v_mov_b32 v78, 0
  v_mov_b32 v79, 0
  v_mov_b32 v80, 0
  v_mov_b32 v81, 0
  v_mov_b32 v82, 0
  v_mov_b32 v83, 0
  v_mov_b32 v84, 0
  v_mov_b32 v85, 0
  v_mov_b32 v86, 0
  v_mov_b32 v87, 0
  s_add_u32 m0, s43, 0
  s_nop 0
  buffer_load_dwordx4 v4, s[24:27], s44 offen lds
  s_add_u32 s44, s44, 128
  s_add_u32 m0, s43, 8192
  s_nop 0
  buffer_load_dwordx4 v4, s[24:27], s45 offen lds
  s_add_u32 s45, s45, 128
  s_add_u32 m0, s43, 16384
  s_nop 0
  buffer_load_dwordx4 v5, s[28:31], s46 offen lds
  s_add_u32 s46, s46, 131072
  s_add_u32 m0, s43, 24576
  s_nop 0
  buffer_load_dwordx4 v4, s[24:27], s44 offen lds
  s_add_u32 s44, s44, 128
  s_add_u32 m0, s43, 32768
  s_nop 0
  buffer_load_dwordx4 v4, s[24:27], s45 offen lds
  s_add_u32 s45, s45, 128
  s_add_u32 m0, s43, 40960
  s_nop 0
  buffer_load_dwordx4 v5, s[28:31], s46 offen lds
  s_add_u32 s46, s46, 131072
  s_waitcnt vmcnt(3)
  s_barrier
  s_add_u32 m0, s43, 49152
  s_nop 0
  buffer_load_dwordx4 v4, s[24:27], s44 offen lds
  s_add_u32 s44, s44, 128
  s_add_u32 m0, s43, 57344
  s_nop 0
  buffer_load_dwordx4 v4, s[24:27], s45 offen lds
  s_add_u32 s45, s45, 128
  s_add_u32 m0, s43, 65536
  s_nop 0
  buffer_load_dwordx4 v5, s[28:31], s46 offen lds
  s_add_u32 s46, s46, 131072
  ds_read_b128 v[16:19], v128 offset:0
  ds_read_b128 v[20:23], v128 offset:2048
  ds_read_b64_tr_b16 v[48:49], v134 offset:0
  ds_read_b64_tr_b16 v[50:51], v134 offset:512
  ds_read_b64_tr_b16 v[52:53], v135 offset:0
  ds_read_b64_tr_b16 v[54:55], v135 offset:512
  ds_read_b128 v[32:35], v129 offset:0
  ds_read_b128 v[36:39], v129 offset:2048
  ds_read_b64_tr_b16 v[60:61], v134 offset:4096
  ds_read_b64_tr_b16 v[62:63], v134 offset:4608
  ds_read_b64_tr_b16 v[64:65], v135 offset:4096
  ds_read_b64_tr_b16 v[66:67], v135 offset:4608
  s_waitcnt lgkmcnt(6)
  v_mfma_f32_16x16x32_bf16 v[72:75], v[48:51], v[16:19], v[72:75]
  v_mfma_f32_16x16x32_bf16 v[76:79], v[52:55], v[16:19], v[76:79]
  v_mfma_f32_16x16x32_bf16 v[80:83], v[48:51], v[20:23], v[80:83]
  v_mfma_f32_16x16x32_bf16 v[84:87], v[52:55], v[20:23], v[84:87]
  s_waitcnt lgkmcnt(0)
  v_mfma_f32_16x16x32_bf16 v[72:75], v[60:63], v[32:35], v[72:75]
  v_mfma_f32_16x16x32_bf16 v[76:79], v[64:67], v[32:35], v[76:79]
  v_mfma_f32_16x16x32_bf16 v[80:83], v[60:63], v[36:39], v[80:83]
  v_mfma_f32_16x16x32_bf16 v[84:87], v[64:67], v[36:39], v[84:87]
  s_waitcnt vmcnt(3)
  s_barrier
  s_add_u32 m0, s43, 0
  s_nop 0
  buffer_load_dwordx4 v4, s[24:27], s44 offen lds
  s_add_u32 s44, s44, 128
  s_add_u32 m0, s43, 8192
  s_nop 0
  buffer_load_dwordx4 v4, s[24:27], s45 offen lds
  s_add_u32 s45, s45, 128
  s_add_u32 m0, s43, 16384
  s_nop 0
  buffer_load_dwordx4 v5, s[28:31], s46 offen lds
  s_add_u32 s46, s46, 131072
  ds_read_b128 v[16:19], v130 offset:0
  ds_read_b128 v[20:23], v130 offset:2048
  ds_read_b64_tr_b16 v[48:49], v136 offset:0
  ds_read_b64_tr_b16 v[50:51], v136 offset:512
  ds_read_b64_tr_b16 v[52:53], v137 offset:0
  ds_read_b64_tr_b16 v[54:55], v137 offset:512
  ds_read_b128 v[32:35], v131 offset:0
  ds_read_b128 v[36:39], v131 offset:2048
  ds_read_b64_tr_b16 v[60:61], v136 offset:4096
  ds_read_b64_tr_b16 v[62:63], v136 offset:4608
  ds_read_b64_tr_b16 v[64:65], v137 offset:4096
  ds_read_b64_tr_b16 v[66:67], v137 offset:4608
  s_waitcnt lgkmcnt(6)
  v_mfma_f32_16x16x32_bf16 v[72:75], v[48:51], v[16:19], v[72:75]
  v_mfma_f32_16x16x32_bf16 v[76:79], v[52:55], v[16:19], v[76:79]
  v_mfma_f32_16x16x32_bf16 v[80:83], v[48:51], v[20:23], v[80:83]
  v_mfma_f32_16x16x32_bf16 v[84:87], v[52:55], v[20:23], v[84:87]
  s_waitcnt lgkmcnt(0)
  v_mfma_f32_16x16x32_bf16 v[72:75], v[60:63], v[32:35], v[72:75]
  v_mfma_f32_16x16x32_bf16 v[76:79], v[64:67], v[32:35], v[76:79]
  v_mfma_f32_16x16x32_bf16 v[80:83], v[60:63], v[36:39], v[80:83]
  v_mfma_f32_16x16x32_bf16 v[84:87], v[64:67], v[36:39], v[84:87]
  s_waitcnt vmcnt(3)
  s_barrier
  s_add_u32 m0, s43, 24576
  s_nop 0
  buffer_load_dwordx4 v4, s[24:27], s44 offen lds
  s_add_u32 s44, s44, 128
  s_add_u32 m0, s43, 32768
  s_nop 0
  buffer_load_dwordx4 v4, s[24:27], s45 offen lds
  s_add_u32 s45, s45, 128
  s_add_u32 m0, s43, 40960
  s_nop 0
  buffer_load_dwordx4 v5, s[28:31], s46 offen lds
  s_add_u32 s46, s46, 131072
  ds_read_b128 v[16:19], v132 offset:0
  ds_read_b128 v[20:23], v132 offset:2048
  ds_read_b64_tr_b16 v[48:49], v138 offset:0
  ds_read_b64_tr_b16 v[50:51], v138 offset:512
  ds_read_b64_tr_b16 v[52:53], v139 offset:0
  ds_read_b64_tr_b16 v[54:55], v139 offset:512
  ds_read_b128 v[32:35], v133 offset:0
  ds_read_b128 v[36:39], v133 offset:2048
  ds_read_b64_tr_b16 v[60:61], v138 offset:4096
  ds_read_b64_tr_b16 v[62:63], v138 offset:4608
  ds_read_b64_tr_b16 v[64:65], v139 offset:4096
  ds_read_b64_tr_b16 v[66:67], v139 offset:4608
  s_waitcnt lgkmcnt(6)
  v_mfma_f32_16x16x32_bf16 v[72:75], v[48:51], v[16:19], v[72:75]
  v_mfma_f32_16x16x32_bf16 v[76:79], v[52:55], v[16:19], v[76:79]
  v_mfma_f32_16x16x32_bf16 v[80:83], v[48:51], v[20:23], v[80:83]
  v_mfma_f32_16x16x32_bf16 v[84:87], v[52:55], v[20:23], v[84:87]
  s_waitcnt lgkmcnt(0)
  v_mfma_f32_16x16x32_bf16 v[72:75], v[60:63], v[32:35], v[72:75]
  v_mfma_f32_16x16x32_bf16 v[76:79], v[64:67], v[32:35], v[76:79]
  v_mfma_f32_16x16x32_bf16 v[80:83], v[60:63], v[36:39], v[80:83]
  v_mfma_f32_16x16x32_bf16 v[84:87], v[64:67], v[36:39], v[84:87]
  s_waitcnt vmcnt(3)
  s_barrier
  s_add_u32 m0, s43, 49152
  s_nop 0
  buffer_load_dwordx4 v4, s[24:27], s44 offen lds
  s_add_u32 s44, s44, 128
  s_add_u32 m0, s43, 57344
  s_nop 0
  buffer_load_dwordx4 v4, s[24:27], s45 offen lds
  s_add_u32 s45, s45, 128
  s_add_u32 m0, s43, 65536
  s_nop 0
  buffer_load_dwordx4 v5, s[28:31], s46 offen lds
  s_add_u32 s46, s46, 131072
  ds_read_b128 v[16:19], v128 offset:0
  ds_read_b128 v[20:23], v128 offset:2048
  ds_read_b64_tr_b16 v[48:49], v134 offset:0
  ds_read_b64_tr_b16 v[50:51], v134 offset:512
  ds_read_b64_tr_b16 v[52:53], v135 offset:0
  ds_read_b64_tr_b16 v[54:55], v135 offset:512
  ds_read_b128 v[32:35], v129 offset:0
  ds_read_b128 v[36:39], v129 offset:2048
  ds_read_b64_tr_b16 v[60:61], v134 offset:4096
  ds_read_b64_tr_b16 v[62:63], v134 offset:4608
  ds_read_b64_tr_b16 v[64:65], v135 offset:4096
  ds_read_b64_tr_b16 v[66:67], v135 offset:4608
  s_waitcnt lgkmcnt(6)
  v_mfma_f32_16x16x32_bf16 v[72:75], v[48:51], v[16:19], v[72:75]
  v_mfma_f32_16x16x32_bf16 v[76:79], v[52:55], v[16:19], v[76:79]
  v_mfma_f32_16x16x32_bf16 v[80:83], v[48:51], v[20:23], v[80:83]
  v_mfma_f32_16x16x32_bf16 v[84:87], v[52:55], v[20:23], v[84:87]
  s_waitcnt lgkmcnt(0)
  v_mfma_f32_16x16x32_bf16 v[72:75], v[60:63], v[32:35], v[72:75]
  v_mfma_f32_16x16x32_bf16 v[76:79], v[64:67], v[32:35], v[76:79]
  v_mfma_f32_16x16x32_bf16 v[80:83], v[60:63], v[36:39], v[80:83]
  v_mfma_f32_16x16x32_bf16 v[84:87], v[64:67], v[36:39], v[84:87]
  s_waitcnt vmcnt(3)
  s_barrier
  s_add_u32 m0, s43, 0
  s_nop 0
  buffer_load_dwordx4 v4, s[24:27], s44 offen lds
  s_add_u32 s44, s44, 128
  s_add_u32 m0, s43, 8192
  s_nop 0
  buffer_load_dwordx4 v4, s[24:27], s45 offen lds
  s_add_u32 s45, s45, 128
  s_add_u32 m0, s43, 16384
  s_nop 0
  buffer_load_dwordx4 v5, s[28:31], s46 offen lds
  s_add_u32 s46, s46, 131072
  ds_read_b128 v[16:19], v130 offset:0
  ds_read_b128 v[20:23], v130 offset:2048
  ds_read_b64_tr_b16 v[48:49], v136 offset:0
  ds_read_b64_tr_b16 v[50:51], v136 offset:512
  ds_read_b64_tr_b16 v[52:53], v137 offset:0
  ds_read_b64_tr_b16 v[54:55], v137 offset:512
  ds_read_b128 v[32:35], v131 offset:0
  ds_read_b128 v[36:39], v131 offset:2048
  ds_read_b64_tr_b16 v[60:61], v136 offset:4096
  ds_read_b64_tr_b16 v[62:63], v136 offset:4608
  ds_read_b64_tr_b16 v[64:65], v137 offset:4096
  ds_read_b64_tr_b16 v[66:67], v137 offset:4608
  s_waitcnt lgkmcnt(6)
  v_mfma_f32_16x16x32_bf16 v[72:75], v[48:51], v[16:19], v[72:75]
  v_mfma_f32_16x16x32_bf16 v[76:79], v[52:55], v[16:19], v[76:79]
  v_mfma_f32_16x16x32_bf16 v[80:83], v[48:51], v[20:23], v[80:83]
  v_mfma_f32_16x16x32_bf16 v[84:87], v[52:55], v[20:23], v[84:87]
  s_waitcnt lgkmcnt(0)
  v_mfma_f32_16x16x32_bf16 v[72:75], v[60:63], v[32:35], v[72:75]
  v_mfma_f32_16x16x32_bf16 v[76:79], v[64:67], v[32:35], v[76:79]
  v_mfma_f32_16x16x32_bf16 v[80:83], v[60:63], v[36:39], v[80:83]
  v_mfma_f32_16x16x32_bf16 v[84:87], v[64:67], v[36:39], v[84:87]
  s_waitcnt vmcnt(3)
  s_barrier
  s_add_u32 m0, s43, 24576
  s_nop 0
  buffer_load_dwordx4 v4, s[24:27], s44 offen lds
  s_add_u32 s44, s44, 128
  s_add_u32 m0, s43, 32768
  s_nop 0
  buffer_load_dwordx4 v4, s[24:27], s45 offen lds
  s_add_u32 s45, s45, 128
  s_add_u32 m0, s43, 40960
  s_nop 0
  buffer_load_dwordx4 v5, s[28:31], s46 offen lds
  s_add_u32 s46, s46, 131072
  ds_read_b128 v[16:19], v132 offset:0
  ds_read_b128 v[20:23], v132 offset:2048
  ds_read_b64_tr_b16 v[48:49], v138 offset:0
  ds_read_b64_tr_b16 v[50:51], v138 offset:512
  ds_read_b64_tr_b16 v[52:53], v139 offset:0
  ds_read_b64_tr_b16 v[54:55], v139 offset:512
  ds_read_b128 v[32:35], v133 offset:0
  ds_read_b128 v[36:39], v133 offset:2048
  ds_read_b64_tr_b16 v[60:61], v138 offset:4096
  ds_read_b64_tr_b16 v[62:63], v138 offset:4608
  ds_read_b64_tr_b16 v[64:65], v139 offset:4096
  ds_read_b64_tr_b16 v[66:67], v139 offset:4608
  s_waitcnt lgkmcnt(6)
  v_mfma_f32_16x16x32_bf16 v[72:75], v[48:51], v[16:19], v[72:75]
  v_mfma_f32_16x16x32_bf16 v[76:79], v[52:55], v[16:19], v[76:79]
  v_mfma_f32_16x16x32_bf16 v[80:83], v[48:51], v[20:23], v[80:83]
  v_mfma_f32_16x16x32_bf16 v[84:87], v[52:55], v[20:23], v[84:87]
  s_waitcnt lgkmcnt(0)
  v_mfma_f32_16x16x32_bf16 v[72:75], v[60:63], v[32:35], v[72:75]
  v_mfma_f32_16x16x32_bf16 v[76:79], v[64:67], v[32:35], v[76:79]
  v_mfma_f32_16x16x32_bf16 v[80:83], v[60:63], v[36:39], v[80:83]
  v_mfma_f32_16x16x32_bf16 v[84:87], v[64:67], v[36:39], v[84:87]
  s_waitcnt vmcnt(3)
  s_barrier
  s_add_u32 m0, s43, 49152
  s_nop 0
  buffer_load_dwordx4 v4, s[24:27], s44 offen lds
  s_add_u32 s44, s44, 128
  s_add_u32 m0, s43, 57344
  s_nop 0
  buffer_load_dwordx4 v4, s[24:27], s45 offen lds
  s_add_u32 s45, s45, 128
  s_add_u32 m0, s43, 65536
  s_nop 0
  buffer_load_dwordx4 v5, s[28:31], s46 offen lds
  s_add_u32 s46, s46, 131072
  ds_read_b128 v[16:19], v128 offset:0
  ds_read_b128 v[20:23], v128 offset:2048
  ds_read_b64_tr_b16 v[48:49], v134 offset:0
  ds_read_b64_tr_b16 v[50:51], v134 offset:512
  ds_read_b64_tr_b16 v[52:53], v135 offset:0
  ds_read_b64_tr_b16 v[54:55], v135 offset:512
  ds_read_b128 v[32:35], v129 offset:0
  ds_read_b128 v[36:39], v129 offset:2048
  ds_read_b64_tr_b16 v[60:61], v134 offset:4096
  ds_read_b64_tr_b16 v[62:63], v134 offset:4608
  ds_read_b64_tr_b16 v[64:65], v135 offset:4096
  ds_read_b64_tr_b16 v[66:67], v135 offset:4608
  s_waitcnt lgkmcnt(6)
  v_mfma_f32_16x16x32_bf16 v[72:75], v[48:51], v[16:19], v[72:75]
  v_mfma_f32_16x16x32_bf16 v[76:79], v[52:55], v[16:19], v[76:79]
  v_mfma_f32_16x16x32_bf16 v[80:83], v[48:51], v[20:23], v[80:83]
  v_mfma_f32_16x16x32_bf16 v[84:87], v[52:55], v[20:23], v[84:87]
  s_waitcnt lgkmcnt(0)
  v_mfma_f32_16x16x32_bf16 v[72:75], v[60:63], v[32:35], v[72:75]
  v_mfma_f32_16x16x32_bf16 v[76:79], v[64:67], v[32:35], v[76:79]
  v_mfma_f32_16x16x32_bf16 v[80:83], v[60:63], v[36:39], v[80:83]
  v_mfma_f32_16x16x32_bf16 v[84:87], v[64:67], v[36:39], v[84:87]
  s_waitcnt vmcnt(3)
  s_barrier
  s_add_u32 m0, s43, 0
  s_nop 0
  buffer_load_dwordx4 v4, s[24:27], s44 offen lds
  s_add_u32 s44, s44, 128
  s_add_u32 m0, s43, 8192
  s_nop 0
  buffer_load_dwordx4 v4, s[24:27], s45 offen lds
  s_add_u32 s45, s45, 128
  s_add_u32 m0, s43, 16384
  s_nop 0
  buffer_load_dwordx4 v5, s[28:31], s46 offen lds
  s_add_u32 s46, s46, 131072
  ds_read_b128 v[16:19], v130 offset:0
  ds_read_b128 v[20:23], v130 offset:2048
  ds_read_b64_tr_b16 v[48:49], v136 offset:0
  ds_read_b64_tr_b16 v[50:51], v136 offset:512
  ds_read_b64_tr_b16 v[52:53], v137 offset:0
  ds_read_b64_tr_b16 v[54:55], v137 offset:512
  ds_read_b128 v[32:35], v131 offset:0
  ds_read_b128 v[36:39], v131 offset:2048
  ds_read_b64_tr_b16 v[60:61], v136 offset:4096
  ds_read_b64_tr_b16 v[62:63], v136 offset:4608
  ds_read_b64_tr_b16 v[64:65], v137 offset:4096
  ds_read_b64_tr_b16 v[66:67], v137 offset:4608
  s_waitcnt lgkmcnt(6)
  v_mfma_f32_16x16x32_bf16 v[72:75], v[48:51], v[16:19], v[72:75]
  v_mfma_f32_16x16x32_bf16 v[76:79], v[52:55], v[16:19], v[76:79]
  v_mfma_f32_16x16x32_bf16 v[80:83], v[48:51], v[20:23], v[80:83]
  v_mfma_f32_16x16x32_bf16 v[84:87], v[52:55], v[20:23], v[84:87]
  s_waitcnt lgkmcnt(0)
  v_mfma_f32_16x16x32_bf16 v[72:75], v[60:63], v[32:35], v[72:75]
  v_mfma_f32_16x16x32_bf16 v[76:79], v[64:67], v[32:35], v[76:79]
  v_mfma_f32_16x16x32_bf16 v[80:83], v[60:63], v[36:39], v[80:83]
  v_mfma_f32_16x16x32_bf16 v[84:87], v[64:67], v[36:39], v[84:87]
  s_waitcnt vmcnt(3)
  s_barrier
  s_add_u32 m0, s43, 24576
  s_nop 0
  buffer_load_dwordx4 v4, s[24:27], s44 offen lds
  s_add_u32 s44, s44, 128
  s_add_u32 m0, s43, 32768
  s_nop 0
  buffer_load_dwordx4 v4, s[24:27], s45 offen lds
  s_add_u32 s45, s45, 128
  s_add_u32 m0, s43, 40960
  s_nop 0
  buffer_load_dwordx4 v5, s[28:31], s46 offen lds
  s_add_u32 s46, s46, 131072
  ds_read_b128 v[16:19], v132 offset:0
  ds_read_b128 v[20:23], v132 offset:2048
  ds_read_b64_tr_b16 v[48:49], v138 offset:0
  ds_read_b64_tr_b16 v[50:51], v138 offset:512
  ds_read_b64_tr_b16 v[52:53], v139 offset:0
  ds_read_b64_tr_b16 v[54:55], v139 offset:512
  ds_read_b128 v[32:35], v133 offset:0
  ds_read_b128 v[36:39], v133 offset:2048
  ds_read_b64_tr_b16 v[60:61], v138 offset:4096
  ds_read_b64_tr_b16 v[62:63], v138 offset:4608
  ds_read_b64_tr_b16 v[64:65], v139 offset:4096
  ds_read_b64_tr_b16 v[66:67], v139 offset:4608
  s_waitcnt lgkmcnt(6)
  v_mfma_f32_16x16x32_bf16 v[72:75], v[48:51], v[16:19], v[72:75]
  v_mfma_f32_16x16x32_bf16 v[76:79], v[52:55], v[16:19], v[76:79]
  v_mfma_f32_16x16x32_bf16 v[80:83], v[48:51], v[20:23], v[80:83]
  v_mfma_f32_16x16x32_bf16 v[84:87], v[52:55], v[20:23], v[84:87]
  s_waitcnt lgkmcnt(0)
  v_mfma_f32_16x16x32_bf16 v[72:75], v[60:63], v[32:35], v[72:75]
  v_mfma_f32_16x16x32_bf16 v[76:79], v[64:67], v[32:35], v[76:79]
  v_mfma_f32_16x16x32_bf16 v[80:83], v[60:63], v[36:39], v[80:83]
  v_mfma_f32_16x16x32_bf16 v[84:87], v[64:67], v[36:39], v[84:87]
  s_waitcnt vmcnt(3)
  s_barrier
  s_add_u32 m0, s43, 49152
  s_nop 0
  buffer_load_dwordx4 v4, s[24:27], s44 offen lds
  s_add_u32 s44, s44, 128
  s_add_u32 m0, s43, 57344
  s_nop 0
  buffer_load_dwordx4 v4, s[24:27], s45 offen lds
  s_add_u32 s45, s45, 128
  s_add_u32 m0, s43, 65536
  s_nop 0
  buffer_load_dwordx4 v5, s[28:31], s46 offen lds
  s_add_u32 s46, s46, 131072
  ds_read_b128 v[16:19], v128 offset:0
  ds_read_b128 v[20:23], v128 offset:2048
  ds_read_b64_tr_b16 v[48:49], v134 offset:0
  ds_read_b64_tr_b16 v[50:51], v134 offset:512
  ds_read_b64_tr_b16 v[52:53], v135 offset:0
  ds_read_b64_tr_b16 v[54:55], v135 offset:512
  ds_read_b128 v[32:35], v129 offset:0
  ds_read_b128 v[36:39], v129 offset:2048
  ds_read_b64_tr_b16 v[60:61], v134 offset:4096
  ds_read_b64_tr_b16 v[62:63], v134 offset:4608
  ds_read_b64_tr_b16 v[64:65], v135 offset:4096
  ds_read_b64_tr_b16 v[66:67], v135 offset:4608
  s_waitcnt lgkmcnt(6)
  v_mfma_f32_16x16x32_bf16 v[72:75], v[48:51], v[16:19], v[72:75]
  v_mfma_f32_16x16x32_bf16 v[76:79], v[52:55], v[16:19], v[76:79]
  v_mfma_f32_16x16x32_bf16 v[80:83], v[48:51], v[20:23], v[80:83]
  v_mfma_f32_16x16x32_bf16 v[84:87], v[52:55], v[20:23], v[84:87]
  s_waitcnt lgkmcnt(0)
  v_mfma_f32_16x16x32_bf16 v[72:75], v[60:63], v[32:35], v[72:75]
  v_mfma_f32_16x16x32_bf16 v[76:79], v[64:67], v[32:35], v[76:79]
  v_mfma_f32_16x16x32_bf16 v[80:83], v[60:63], v[36:39], v[80:83]
  v_mfma_f32_16x16x32_bf16 v[84:87], v[64:67], v[36:39], v[84:87]
  s_waitcnt vmcnt(3)
  s_barrier
  s_add_u32 m0, s43, 0
  s_nop 0
  buffer_load_dwordx4 v4, s[24:27], s44 offen lds
  s_add_u32 s44, s44, 128
  s_add_u32 m0, s43, 8192
  s_nop 0
  buffer_load_dwordx4 v4, s[24:27], s45 offen lds
  s_add_u32 s45, s45, 128
  s_add_u32 m0, s43, 16384
  s_nop 0
  buffer_load_dwordx4 v5, s[28:31], s46 offen lds
  s_add_u32 s46, s46, 131072
  ds_read_b128 v[16:19], v130 offset:0
  ds_read_b128 v[20:23], v130 offset:2048
  ds_read_b64_tr_b16 v[48:49], v136 offset:0
  ds_read_b64_tr_b16 v[50:51], v136 offset:512
  ds_read_b64_tr_b16 v[52:53], v137 offset:0
  ds_read_b64_tr_b16 v[54:55], v137 offset:512
  ds_read_b128 v[32:35], v131 offset:0
  ds_read_b128 v[36:39], v131 offset:2048
  ds_read_b64_tr_b16 v[60:61], v136 offset:4096
  ds_read_b64_tr_b16 v[62:63], v136 offset:4608
  ds_read_b64_tr_b16 v[64:65], v137 offset:4096
  ds_read_b64_tr_b16 v[66:67], v137 offset:4608
  s_waitcnt lgkmcnt(6)
  v_mfma_f32_16x16x32_bf16 v[72:75], v[48:51], v[16:19], v[72:75]
  v_mfma_f32_16x16x32_bf16 v[76:79], v[52:55], v[16:19], v[76:79]
  v_mfma_f32_16x16x32_bf16 v[80:83], v[48:51], v[20:23], v[80:83]
  v_mfma_f32_16x16x32_bf16 v[84:87], v[52:55], v[20:23], v[84:87]
  s_waitcnt lgkmcnt(0)
  v_mfma_f32_16x16x32_bf16 v[72:75], v[60:63], v[32:35], v[72:75]
  v_mfma_f32_16x16x32_bf16 v[76:79], v[64:67], v[32:35], v[76:79]
  v_mfma_f32_16x16x32_bf16 v[80:83], v[60:63], v[36:39], v[80:83]
  v_mfma_f32_16x16x32_bf16 v[84:87], v[64:67], v[36:39], v[84:87]
  s_waitcnt vmcnt(3)
  s_barrier
  s_add_u32 m0, s43, 24576
  s_nop 0
  buffer_load_dwordx4 v4, s[24:27], s44 offen lds
  s_add_u32 s44, s44, 128
  s_add_u32 m0, s43, 32768
  s_nop 0
  buffer_load_dwordx4 v4, s[24:27], s45 offen lds
  s_add_u32 s45, s45, 128
  s_add_u32 m0, s43, 40960
  s_nop 0
  buffer_load_dwordx4 v5, s[28:31], s46 offen lds
  s_add_u32 s46, s46, 131072
  ds_read_b128 v[16:19], v132 offset:0
  ds_read_b128 v[20:23], v132 offset:2048
  ds_read_b64_tr_b16 v[48:49], v138 offset:0
  ds_read_b64_tr_b16 v[50:51], v138 offset:512
  ds_read_b64_tr_b16 v[52:53], v139 offset:0
  ds_read_b64_tr_b16 v[54:55], v139 offset:512
  ds_read_b128 v[32:35], v133 offset:0
  ds_read_b128 v[36:39], v133 offset:2048
  ds_read_b64_tr_b16 v[60:61], v138 offset:4096
  ds_read_b64_tr_b16 v[62:63], v138 offset:4608
  ds_read_b64_tr_b16 v[64:65], v139 offset:4096
  ds_read_b64_tr_b16 v[66:67], v139 offset:4608
  s_waitcnt lgkmcnt(6)
  v_mfma_f32_16x16x32_bf16 v[72:75], v[48:51], v[16:19], v[72:75]
  v_mfma_f32_16x16x32_bf16 v[76:79], v[52:55], v[16:19], v[76:79]
  v_mfma_f32_16x16x32_bf16 v[80:83], v[48:51], v[20:23], v[80:83]
  v_mfma_f32_16x16x32_bf16 v[84:87], v[52:55], v[20:23], v[84:87]
  s_waitcnt lgkmcnt(0)
  v_mfma_f32_16x16x32_bf16 v[72:75], v[60:63], v[32:35], v[72:75]
  v_mfma_f32_16x16x32_bf16 v[76:79], v[64:67], v[32:35], v[76:79]
  v_mfma_f32_16x16x32_bf16 v[80:83], v[60:63], v[36:39], v[80:83]
  v_mfma_f32_16x16x32_bf16 v[84:87], v[64:67], v[36:39], v[84:87]
  s_waitcnt vmcnt(3)
  s_barrier
  s_add_u32 m0, s43, 49152
  s_nop 0
  buffer_load_dwordx4 v4, s[24:27], s44 offen lds
  s_add_u32 s44, s44, 128
  s_add_u32 m0, s43, 57344
  s_nop 0
  buffer_load_dwordx4 v4, s[24:27], s45 offen lds
  s_add_u32 s45, s45, 128
  s_add_u32 m0, s43, 65536
  s_nop 0
  buffer_load_dwordx4 v5, s[28:31], s46 offen lds
  s_add_u32 s46, s46, 131072
  ds_read_b128 v[16:19], v128 offset:0
  ds_read_b128 v[20:23], v128 offset:2048
  ds_read_b64_tr_b16 v[48:49], v134 offset:0
  ds_read_b64_tr_b16 v[50:51], v134 offset:512
  ds_read_b64_tr_b16 v[52:53], v135 offset:0
  ds_read_b64_tr_b16 v[54:55], v135 offset:512
  ds_read_b128 v[32:35], v129 offset:0
  ds_read_b128 v[36:39], v129 offset:2048
  ds_read_b64_tr_b16 v[60:61], v134 offset:4096
  ds_read_b64_tr_b16 v[62:63], v134 offset:4608
  ds_read_b64_tr_b16 v[64:65], v135 offset:4096
  ds_read_b64_tr_b16 v[66:67], v135 offset:4608
  s_waitcnt lgkmcnt(6)
  v_mfma_f32_16x16x32_bf16 v[72:75], v[48:51], v[16:19], v[72:75]
  v_mfma_f32_16x16x32_bf16 v[76:79], v[52:55], v[16:19], v[76:79]
  v_mfma_f32_16x16x32_bf16 v[80:83], v[48:51], v[20:23], v[80:83]
  v_mfma_f32_16x16x32_bf16 v[84:87], v[52:55], v[20:23], v[84:87]
  s_waitcnt lgkmcnt(0)
  v_mfma_f32_16x16x32_bf16 v[72:75], v[60:63], v[32:35], v[72:75]
  v_mfma_f32_16x16x32_bf16 v[76:79], v[64:67], v[32:35], v[76:79]
  v_mfma_f32_16x16x32_bf16 v[80:83], v[60:63], v[36:39], v[80:83]
  v_mfma_f32_16x16x32_bf16 v[84:87], v[64:67], v[36:39], v[84:87]
  s_waitcnt vmcnt(3)
  s_barrier
  s_add_u32 m0, s43, 0
  s_nop 0
  buffer_load_dwordx4 v4, s[24:27], s44 offen lds
  s_add_u32 s44, s44, 128
  s_add_u32 m0, s43, 8192
  s_nop 0
  buffer_load_dwordx4 v4, s[24:27], s45 offen lds
  s_add_u32 s45, s45, 128
  s_add_u32 m0, s43, 16384
  s_nop 0
  buffer_load_dwordx4 v5, s[28:31], s46 offen lds
  s_add_u32 s46, s46, 131072
  ds_read_b128 v[16:19], v130 offset:0
  ds_read_b128 v[20:23], v130 offset:2048
  ds_read_b64_tr_b16 v[48:49], v136 offset:0
  ds_read_b64_tr_b16 v[50:51], v136 offset:512
  ds_read_b64_tr_b16 v[52:53], v137 offset:0
  ds_read_b64_tr_b16 v[54:55], v137 offset:512
  ds_read_b128 v[32:35], v131 offset:0
  ds_read_b128 v[36:39], v131 offset:2048
  ds_read_b64_tr_b16 v[60:61], v136 offset:4096
  ds_read_b64_tr_b16 v[62:63], v136 offset:4608
  ds_read_b64_tr_b16 v[64:65], v137 offset:4096
  ds_read_b64_tr_b16 v[66:67], v137 offset:4608
  s_waitcnt lgkmcnt(6)
  v_mfma_f32_16x16x32_bf16 v[72:75], v[48:51], v[16:19], v[72:75]
  v_mfma_f32_16x16x32_bf16 v[76:79], v[52:55], v[16:19], v[76:79]
  v_mfma_f32_16x16x32_bf16 v[80:83], v[48:51], v[20:23], v[80:83]
  v_mfma_f32_16x16x32_bf16 v[84:87], v[52:55], v[20:23], v[84:87]
  s_waitcnt lgkmcnt(0)
  v_mfma_f32_16x16x32_bf16 v[72:75], v[60:63], v[32:35], v[72:75]
  v_mfma_f32_16x16x32_bf16 v[76:79], v[64:67], v[32:35], v[76:79]
  v_mfma_f32_16x16x32_bf16 v[80:83], v[60:63], v[36:39], v[80:83]
  v_mfma_f32_16x16x32_bf16 v[84:87], v[64:67], v[36:39], v[84:87]
  s_waitcnt vmcnt(3)
  s_barrier
  ds_read_b128 v[16:19], v132 offset:0
  ds_read_b128 v[20:23], v132 offset:2048
  ds_read_b64_tr_b16 v[48:49], v138 offset:0
  ds_read_b64_tr_b16 v[50:51], v138 offset:512
  ds_read_b64_tr_b16 v[52:53], v139 offset:0
  ds_read_b64_tr_b16 v[54:55], v139 offset:512
  ds_read_b128 v[32:35], v133 offset:0
  ds_read_b128 v[36:39], v133 offset:2048
  ds_read_b64_tr_b16 v[60:61], v138 offset:4096
  ds_read_b64_tr_b16 v[62:63], v138 offset:4608
  ds_read_b64_tr_b16 v[64:65], v139 offset:4096
  ds_read_b64_tr_b16 v[66:67], v139 offset:4608
  s_waitcnt lgkmcnt(6)
  v_mfma_f32_16x16x32_bf16 v[72:75], v[48:51], v[16:19], v[72:75]
  v_mfma_f32_16x16x32_bf16 v[76:79], v[52:55], v[16:19], v[76:79]
  v_mfma_f32_16x16x32_bf16 v[80:83], v[48:51], v[20:23], v[80:83]
  v_mfma_f32_16x16x32_bf16 v[84:87], v[52:55], v[20:23], v[84:87]
  s_waitcnt lgkmcnt(0)
  v_mfma_f32_16x16x32_bf16 v[72:75], v[60:63], v[32:35], v[72:75]
  v_mfma_f32_16x16x32_bf16 v[76:79], v[64:67], v[32:35], v[76:79]
  v_mfma_f32_16x16x32_bf16 v[80:83], v[60:63], v[36:39], v[80:83]
  v_mfma_f32_16x16x32_bf16 v[84:87], v[64:67], v[36:39], v[84:87]
  s_waitcnt vmcnt(0)
  s_barrier
  ds_read_b128 v[16:19], v128 offset:0
  ds_read_b128 v[20:23], v128 offset:2048
  ds_read_b64_tr_b16 v[48:49], v134 offset:0
  ds_read_b64_tr_b16 v[50:51], v134 offset:512
  ds_read_b64_tr_b16 v[52:53], v135 offset:0
  ds_read_b64_tr_b16 v[54:55], v135 offset:512
  ds_read_b128 v[32:35], v129 offset:0
  ds_read_b128 v[36:39], v129 offset:2048
  ds_read_b64_tr_b16 v[60:61], v134 offset:4096
  ds_read_b64_tr_b16 v[62:63], v134 offset:4608
  ds_read_b64_tr_b16 v[64:65], v135 offset:4096
  ds_read_b64_tr_b16 v[66:67], v135 offset:4608
  s_waitcnt lgkmcnt(6)
  v_mfma_f32_16x16x32_bf16 v[72:75], v[48:51], v[16:19], v[72:75]
  v_mfma_f32_16x16x32_bf16 v[76:79], v[52:55], v[16:19], v[76:79]
  v_mfma_f32_16x16x32_bf16 v[80:83], v[48:51], v[20:23], v[80:83]
  v_mfma_f32_16x16x32_bf16 v[84:87], v[52:55], v[20:23], v[84:87]
  s_waitcnt lgkmcnt(0)
  v_mfma_f32_16x16x32_bf16 v[72:75], v[60:63], v[32:35], v[72:75]
  v_mfma_f32_16x16x32_bf16 v[76:79], v[64:67], v[32:35], v[76:79]
  v_mfma_f32_16x16x32_bf16 v[80:83], v[60:63], v[36:39], v[80:83]
  v_mfma_f32_16x16x32_bf16 v[84:87], v[64:67], v[36:39], v[84:87]
  s_nop 7
  s_nop 7
  buffer_load_dwordx2 v[16:17], v13, s[36:39], 0 offen offset:0
  buffer_load_dwordx2 v[18:19], v13, s[36:39], 0 offen offset:32
  s_waitcnt vmcnt(0)
  v_cvt_pk_bf16_f32 v72, v72, v73
  v_cvt_pk_bf16_f32 v73, v74, v75
  v_lshlrev_b32 v32, 16, v72
  v_and_b32 v33, 0xffff0000, v72
  v_lshlrev_b32 v34, 16, v16
  v_and_b32 v35, 0xffff0000, v16
  v_add_f32 v32, v32, v34
  v_add_f32 v33, v33, v35
  v_cvt_pk_bf16_f32 v72, v32, v33
  v_lshlrev_b32 v32, 16, v73
  v_and_b32 v33, 0xffff0000, v73
  v_lshlrev_b32 v34, 16, v17
  v_and_b32 v35, 0xffff0000, v17
  v_add_f32 v32, v32, v34
  v_add_f32 v33, v33, v35
  v_cvt_pk_bf16_f32 v73, v32, v33
  buffer_store_dwordx2 v[72:73], v13, s[32:35], 0 offen offset:0
  v_cvt_pk_bf16_f32 v76, v76, v77
  v_cvt_pk_bf16_f32 v77, v78, v79
  v_lshlrev_b32 v32, 16, v76
  v_and_b32 v33, 0xffff0000, v76
  v_lshlrev_b32 v34, 16, v18
  v_and_b32 v35, 0xffff0000, v18
  v_add_f32 v32, v32, v34
  v_add_f32 v33, v33, v35
  v_cvt_pk_bf16_f32 v76, v32, v33
  v_lshlrev_b32 v32, 16, v77
  v_and_b32 v33, 0xffff0000, v77
  v_lshlrev_b32 v34, 16, v19
  v_and_b32 v35, 0xffff0000, v19
  v_add_f32 v32, v32, v34
  v_add_f32 v33, v33, v35
  v_cvt_pk_bf16_f32 v77, v32, v33
  buffer_store_dwordx2 v[76:77], v13, s[32:35], 0 offen offset:32
  v_add_u32 v13, 32768, v13
  buffer_load_dwordx2 v[16:17], v13, s[36:39], 0 offen offset:0
  buffer_load_dwordx2 v[18:19], v13, s[36:39], 0 offen offset:32
  s_waitcnt vmcnt(0)
  v_cvt_pk_bf16_f32 v80, v80, v81
  v_cvt_pk_bf16_f32 v81, v82, v83
  v_lshlrev_b32 v32, 16, v80
  v_and_b32 v33, 0xffff0000, v80
  v_lshlrev_b32 v34, 16, v16
  v_and_b32 v35, 0xffff0000, v16
  v_add_f32 v32, v32, v34
  v_add_f32 v33, v33, v35
  v_cvt_pk_bf16_f32 v80, v32, v33
  v_lshlrev_b32 v32, 16, v81
  v_and_b32 v33, 0xffff0000, v81
  v_lshlrev_b32 v34, 16, v17
  v_and_b32 v35, 0xffff0000, v17
  v_add_f32 v32, v32, v34
  v_add_f32 v33, v33, v35
  v_cvt_pk_bf16_f32 v81, v32, v33
  buffer_store_dwordx2 v[80:81], v13, s[32:35], 0 offen offset:0
  v_cvt_pk_bf16_f32 v84, v84, v85
  v_cvt_pk_bf16_f32 v85, v86, v87
  v_lshlrev_b32 v32, 16, v84
  v_and_b32 v33, 0xffff0000, v84
  v_lshlrev_b32 v34, 16, v18
  v_and_b32 v35, 0xffff0000, v18
  v_add_f32 v32, v32, v34
  v_add_f32 v33, v33, v35
  v_cvt_pk_bf16_f32 v84, v32, v33
  v_lshlrev_b32 v32, 16, v85
  v_and_b32 v33, 0xffff0000, v85
  v_lshlrev_b32 v34, 16, v19
  v_and_b32 v35, 0xffff0000, v19
  v_add_f32 v32, v32, v34
  v_add_f32 v33, v33, v35
  v_cvt_pk_bf16_f32 v85, v32, v33
  buffer_store_dwordx2 v[84:85], v13, s[32:35], 0 offen offset:32
L_gemmo2_kernel_end:
  s_endpgm
.globl ln3_kernel
.p2align 8
.type ln3_kernel,@function
ln3_kernel:
  s_cmp_ge_u32 s2, 512
  s_cbranch_scc1 L_ln3_kernel_end
  s_load_dwordx16 s[4:19], s[0:1], 0
  s_load_dwordx2 s[20:21], s[0:1], 64
  s_waitcnt lgkmcnt(0)
  s_add_u32 s24, s20, 29360128
  s_addc_u32 s25, s21, 0
  s_and_b32 s25, s25, 0xffff
  s_mov_b32 s26, 4194304
  s_mov_b32 s27, 0x00020000
  s_mov_b32 s28, s20
  s_and_b32 s29, s21, 0xffff
  s_mov_b32 s30, 4194304
  s_mov_b32 s31, 0x00020000
  v_lshrrev_b32 v1, 6, v0
  v_and_b32 v2, 63, v0
  s_lshl_b32 s3, s2, 2
  v_add_u32 v3, s3, v1
  v_lshlrev_b32 v4, 11, v3
  v_lshl_add_u32 v4, v2, 4, v4
  buffer_load_dwordx4 v[8:11], v4, s[24:27], 0 offen
  buffer_load_dwordx4 v[12:15], v4, s[24:27], 0 offen offset:1024
  s_waitcnt vmcnt(0)
  v_lshlrev_b32 v16, 16, v8
  v_and_b32 v17, 0xffff0000, v8
  v_lshlrev_b32 v18, 16, v9
  v_and_b32 v19, 0xffff0000, v9
  v_lshlrev_b32 v20, 16, v10
  v_and_b32 v21, 0xffff0000, v10
  v_lshlrev_b32 v22, 16, v11
  v_and_b32 v23, 0xffff0000, v11
  v_lshlrev_b32 v24, 16, v12
  v_and_b32 v25, 0xffff0000, v12
  v_lshlrev_b32 v26, 16, v13
  v_and_b32 v27, 0xffff0000, v13
  v_lshlrev_b32 v28, 16, v14
  v_and_b32 v29, 0xffff0000, v14
  v_lshlrev_b32 v30, 16, v15
  v_and_b32 v31, 0xffff0000, v15
  v_add_f32 v32, v16, v17
  v_add_f32 v32, v32, v18
  v_add_f32 v32, v32, v19
  v_add_f32 v32, v32, v20
  v_add_f32 v32, v32, v21
  v_add_f32 v32, v32, v22
  v_add_f32 v32, v32, v23
  v_add_f32 v32, v32, v24
  v_add_f32 v32, v32, v25
  v_add_f32 v32, v32, v26
  v_add_f32 v32, v32, v27
  v_add_f32 v32, v32, v28
  v_add_f32 v32, v32, v29
  v_add_f32 v32, v32, v30
  v_add_f32 v32, v32, v31
  v_xor_b32 v41, 1, v2
  v_lshlrev_b32 v41, 2, v41
  ds_bpermute_b32 v40, v41, v32
  s_waitcnt lgkmcnt(0)
  v_add_f32 v32, v32, v40
  v_xor_b32 v41, 2, v2
  v_lshlrev_b32 v41, 2, v41
  ds_bpermute_b32 v40, v41, v32
  s_waitcnt lgkmcnt(0)
  v_add_f32 v32, v32, v40
  v_xor_b32 v41, 4, v2
  v_lshlrev_b32 v41, 2, v41
  ds_bpermute_b32 v40, v41, v32
  s_waitcnt lgkmcnt(0)
  v_add_f32 v32, v32, v40
  v_xor_b32 v41, 8, v2
  v_lshlrev_b32 v41, 2, v41
  ds_bpermute_b32 v40, v41, v32
  s_waitcnt lgkmcnt(0)
  v_add_f32 v32, v32, v40
  v_xor_b32 v41, 16, v2
  v_lshlrev_b32 v41, 2, v41
  ds_bpermute_b32 v40, v41, v32
  s_waitcnt lgkmcnt(0)
  v_add_f32 v32, v32, v40
  v_xor_b32 v41, 32, v2
  v_lshlrev_b32 v41, 2, v41
  ds_bpermute_b32 v40, v41, v32
  s_waitcnt lgkmcnt(0)
  v_add_f32 v32, v32, v40
  v_mul_f32 v32, 0x3a800000, v32
  v_sub_f32 v34, v16, v32
  v_mul_f32 v33, v34, v34
  v_sub_f32 v34, v17, v32
  v_fma_f32 v33, v34, v34, v33
  v_sub_f32 v34, v18, v32
  v_fma_f32 v33, v34, v34, v33
  v_sub_f32 v34, v19, v32
  v_fma_f32 v33, v34, v34, v33
  v_sub_f32 v34, v20, v32
  v_fma_f32 v33, v34, v34, v33
  v_sub_f32 v34, v21, v32
  v_fma_f32 v33, v34, v34, v33
  v_sub_f32 v34, v22, v32
  v_fma_f32 v33, v34, v34, v33
  v_sub_f32 v34, v23, v32
  v_fma_f32 v33, v34, v34, v33
  v_sub_f32 v34, v24, v32
  v_fma_f32 v33, v34, v34, v33
  v_sub_f32 v34, v25, v32
  v_fma_f32 v33, v34, v34, v33
  v_sub_f32 v34, v26, v32
  v_fma_f32 v33, v34, v34, v33
  v_sub_f32 v34, v27, v32
  v_fma_f32 v33, v34, v34, v33
  v_sub_f32 v34, v28, v32
  v_fma_f32 v33, v34, v34, v33
  v_sub_f32 v34, v29, v32
  v_fma_f32 v33, v34, v34, v33
  v_sub_f32 v34, v30, v32
  v_fma_f32 v33, v34, v34, v33
  v_sub_f32 v34, v31, v32
  v_fma_f32 v33, v34, v34, v33
  v_xor_b32 v41, 1, v2
  v_lshlrev_b32 v41, 2, v41
  ds_bpermute_b32 v40, v41, v33
  s_waitcnt lgkmcnt(0)
  v_add_f32 v33, v33, v40
  v_xor_b32 v41, 2, v2
  v_lshlrev_b32 v41, 2, v41
  ds_bpermute_b32 v40, v41, v33
  s_waitcnt lgkmcnt(0)
  v_add_f32 v33, v33, v40
  v_xor_b32 v41, 4, v2
  v_lshlrev_b32 v41, 2, v41
  ds_bpermute_b32 v40, v41, v33
  s_waitcnt lgkmcnt(0)
  v_add_f32 v33, v33, v40
  v_xor_b32 v41, 8, v2
  v_lshlrev_b32 v41, 2, v41
  ds_bpermute_b32 v40, v41, v33
  s_waitcnt lgkmcnt(0)
  v_add_f32 v33, v33, v40
  v_xor_b32 v41, 16, v2
  v_lshlrev_b32 v41, 2, v41
  ds_bpermute_b32 v40, v41, v33
  s_waitcnt lgkmcnt(0)
  v_add_f32 v33, v33, v40
  v_xor_b32 v41, 32, v2
  v_lshlrev_b32 v41, 2, v41
  ds_bpermute_b32 v40, v41, v33
  s_waitcnt lgkmcnt(0)
  v_add_f32 v33, v33, v40
  v_mul_f32 v33, 0x3a800000, v33
  v_cvt_pk_bf16_f32 v32, v32, v32
  v_and_b32 v32, 0xffff0000, v32
  v_cvt_pk_bf16_f32 v33, v33, v33
  v_and_b32 v33, 0xffff0000, v33
  v_add_f32 v33, 0x3727c5ac, v33
  v_cvt_pk_bf16_f32 v33, v33, v33
  v_and_b32 v33, 0xffff0000, v33
  v_sqrt_f32 v33, v33
  s_nop 0
  v_cvt_pk_bf16_f32 v33, v33, v33
  v_and_b32 v33, 0xffff0000, v33
  v_rcp_f32 v35, v33
  s_nop 0
  v_sub_f32 v16, v16, v32
  v_cvt_pk_bf16_f32 v16, v16, v16
  v_and_b32 v16, 0xffff0000, v16
  v_mul_f32 v36, v16, v35
  v_fma_f32 v37, -v36, v33, v16
  v_fma_f32 v16, v37, v35, v36
  v_sub_f32 v17, v17, v32
  v_cvt_pk_bf16_f32 v17, v17, v17
  v_and_b32 v17, 0xffff0000, v17
  v_mul_f32 v36, v17, v35
  v_fma_f32 v37, -v36, v33, v17
  v_fma_f32 v17, v37, v35, v36
  v_sub_f32 v18, v18, v32
  v_cvt_pk_bf16_f32 v18, v18, v18
  v_and_b32 v18, 0xffff0000, v18
  v_mul_f32 v36, v18, v35
  v_fma_f32 v37, -v36, v33, v18
  v_fma_f32 v18, v37, v35, v36
  v_sub_f32 v19, v19, v32
  v_cvt_pk_bf16_f32 v19, v19, v19
  v_and_b32 v19, 0xffff0000, v19
  v_mul_f32 v36, v19, v35
  v_fma_f32 v37, -v36, v33, v19
  v_fma_f32 v19, v37, v35, v36
  v_sub_f32 v20, v20, v32
  v_cvt_pk_bf16_f32 v20, v20, v20
  v_and_b32 v20, 0xffff0000, v20
  v_mul_f32 v36, v20, v35
  v_fma_f32 v37, -v36, v33, v20
  v_fma_f32 v20, v37, v35, v36
  v_sub_f32 v21, v21, v32
  v_cvt_pk_bf16_f32 v21, v21, v21
  v_and_b32 v21, 0xffff0000, v21
  v_mul_f32 v36, v21, v35
  v_fma_f32 v37, -v36, v33, v21
  v_fma_f32 v21, v37, v35, v36
  v_sub_f32 v22, v22, v32
  v_cvt_pk_bf16_f32 v22, v22, v22
  v_and_b32 v22, 0xffff0000, v22
  v_mul_f32 v36, v22, v35
  v_fma_f32 v37, -v36, v33, v22
  v_fma_f32 v22, v37, v35, v36
  v_sub_f32 v23, v23, v32
  v_cvt_pk_bf16_f32 v23, v23, v23
  v_and_b32 v23, 0xffff0000, v23
  v_mul_f32 v36, v23, v35
  v_fma_f32 v37, -v36, v33, v23
  v_fma_f32 v23, v37, v35, v36
  v_sub_f32 v24, v24, v32
  v_cvt_pk_bf16_f32 v24, v24, v24
  v_and_b32 v24, 0xffff0000, v24
  v_mul_f32 v36, v24, v35
  v_fma_f32 v37, -v36, v33, v24
  v_fma_f32 v24, v37, v35, v36
  v_sub_f32 v25, v25, v32
  v_cvt_pk_bf16_f32 v25, v25, v25
  v_and_b32 v25, 0xffff0000, v25
  v_mul_f32 v36, v25, v35
  v_fma_f32 v37, -v36, v33, v25
  v_fma_f32 v25, v37, v35, v36
  v_sub_f32 v26, v26, v32
  v_cvt_pk_bf16_f32 v26, v26, v26
  v_and_b32 v26, 0xffff0000, v26
  v_mul_f32 v36, v26, v35
  v_fma_f32 v37, -v36, v33, v26
  v_fma_f32 v26, v37, v35, v36
  v_sub_f32 v27, v27, v32
  v_cvt_pk_bf16_f32 v27, v27, v27
  v_and_b32 v27, 0xffff0000, v27
  v_mul_f32 v36, v27, v35
  v_fma_f32 v37, -v36, v33, v27
  v_fma_f32 v27, v37, v35, v36
  v_sub_f32 v28, v28, v32
  v_cvt_pk_bf16_f32 v28, v28, v28
  v_and_b32 v28, 0xffff0000, v28
  v_mul_f32 v36, v28, v35
  v_fma_f32 v37, -v36, v33, v28
  v_fma_f32 v28, v37, v35, v36
  v_sub_f32 v29, v29, v32
  v_cvt_pk_bf16_f32 v29, v29, v29
  v_and_b32 v29, 0xffff0000, v29
  v_mul_f32 v36, v29, v35
  v_fma_f32 v37, -v36, v33, v29
  v_fma_f32 v29, v37, v35, v36
  v_sub_f32 v30, v30, v32
  v_cvt_pk_bf16_f32 v30, v30, v30
  v_and_b32 v30, 0xffff0000, v30
  v_mul_f32 v36, v30, v35
  v_fma_f32 v37, -v36, v33, v30
  v_fma_f32 v30, v37, v35, v36
  v_sub_f32 v31, v31, v32
  v_cvt_pk_bf16_f32 v31, v31, v31
  v_and_b32 v31, 0xffff0000, v31
  v_mul_f32 v36, v31, v35
  v_fma_f32 v37, -v36, v33, v31
  v_fma_f32 v31, v37, v35, v36
  v_cvt_pk_bf16_f32 v8, v16, v17
  v_cvt_pk_bf16_f32 v9, v18, v19
  v_cvt_pk_bf16_f32 v10, v20, v21
  v_cvt_pk_bf16_f32 v11, v22, v23
  v_cvt_pk_bf16_f32 v12, v24, v25
  v_cvt_pk_bf16_f32 v13, v26, v27
  v_cvt_pk_bf16_f32 v14, v28, v29
  v_cvt_pk_bf16_f32 v15, v30, v31
  buffer_store_dwordx4 v[8:11], v4, s[28:31], 0 offen
  buffer_store_dwordx4 v[12:15], v4, s[28:31], 0 offen offset:1024
L_ln3_kernel_end:
  s_endpgm
.globl gemmq3_kernel
.p2align 8
.type gemmq3_kernel,@function
gemmq3_kernel:
  s_cmp_ge_u32 s2, 256
  s_cbranch_scc1 L_gemmq3_kernel_end
  s_load_dwordx16 s[4:19], s[0:1], 0
  s_load_dwordx2 s[20:21], s[0:1], 64
  s_waitcnt lgkmcnt(0)
  s_mov_b32 s24, s20
  s_and_b32 s25, s21, 0xffff
  s_mov_b32 s26, 4194304
  s_mov_b32 s27, 0x00020000
  s_mov_b32 s28, s12
  s_and_b32 s29, s13, 0xffff
  s_mov_b32 s30, 6291456
  s_mov_b32 s31, 0x00020000
  s_add_u32 s32, s20, 4194304
  s_addc_u32 s33, s21, 0
  s_and_b32 s33, s33, 0xffff
  s_mov_b32 s34, 12582912
  s_mov_b32 s35, 0x00020000
  s_mov_b32 s3, 268435457
  s_mul_hi_u32 s40, s2, s3
  s_mul_i32 s3, s40, 16
  s_sub_u32 s41, s2, s3
  v_and_b32 v1, 63, v0
  v_lshrrev_b32 v2, 6, v0
  s_nop 0
  v_readfirstlane_b32 s42, v2
  v_lshrrev_b32 v14, 3, v1
  v_and_b32 v15, 7, v1
  v_xor_b32 v3, v14, v15
  v_lshlrev_b32 v4, 11, v14
  v_lshl_add_u32 v4, v3, 4, v4
  v_bfe_u32 v3, v1, 4, 1
  v_and_b32 v5, 1, v2
  v_lshl_add_u32 v3, v5, 1, v3
  v_lshrrev_b32 v5, 1, v15
  v_xor_b32 v3, v3, v5
  v_lshlrev_b32 v3, 1, v3
  v_and_b32 v5, 1, v15
  v_or_b32 v3, v3, v5
  v_lshl_add_u32 v5, v2, 3, v14
  v_mul_u32_u24 v5, 6144, v5
  v_lshl_add_u32 v5, v3, 4, v5
  s_mul_i32 s44, s40, 262144
  s_lshl_b32 s3, s42, 14
  s_add_u32 s44, s44, s3
  s_add_u32 s45, s44, 131072
  s_mul_i32 s46, s41, 384
  s_add_u32 s47, s46, 128
  s_add_u32 s48, s46, 256
  s_lshl_b32 s43, s42, 10
  v_and_b32 v6, 3, v2
  v_lshrrev_b32 v7, 2, v2
  v_and_b32 v14, 15, v1
  v_lshrrev_b32 v15, 4, v1
  v_mul_u32_u24 v8, 64, v7
  v_add_u32 v8, v8, v14
  v_lshlrev_b32 v8, 7, v8
  v_and_b32 v3, 7, v1
  v_xor_b32 v3, v3, v15
  v_lshl_add_u32 v9, v3, 4, v8
  v_xor_b32 v3, 4, v3
  v_lshl_add_u32 v8, v3, 4, v8
  v_mov_b32 v3, v9
  v_mov_b32 v9, v8
  v_mov_b32 v8, v3
  v_bfe_u32 v3, v1, 2, 2
  v_lshl_add_u32 v10, v15, 3, v3
  v_lshlrev_b32 v10, 7, v10
  v_and_b32 v11, 3, v1
  v_lshl_add_u32 v10, v11, 3, v10
  v_lshrrev_b32 v3, 1, v3
  v_and_b32 v11, 1, v15
  v_lshl_add_u32 v3, v11, 1, v3
  v_mul_u32_u24 v11, 3, v6
  v_add_u32 v120, 0, v11
  v_and_b32 v121, 3, v120
  v_xor_b32 v121, v121, v3
  v_lshlrev_b32 v121, 5, v121
  v_lshrrev_b32 v120, 2, v120
  v_lshl_add_u32 v121, v120, 13, v121
  v_add_u32 v122, v10, v121
  v_add_u32 v122, 16384, v122
  v_add_u32 v120, 1, v11
  v_and_b32 v121, 3, v120
  v_xor_b32 v121, v121, v3
  v_lshlrev_b32 v121, 5, v121
  v_lshrrev_b32 v120, 2, v120
  v_lshl_add_u32 v121, v120, 13, v121
  v_add_u32 v123, v10, v121
  v_add_u32 v123, 16384, v123
  v_add_u32 v120, 2, v11
  v_and_b32 v121, 3, v120
  v_xor_b32 v121, v121, v3
  v_lshlrev_b32 v121, 5, v121
  v_lshrrev_b32 v120, 2, v120
  v_lshl_add_u32 v121, v120, 13, v121
  v_add_u32 v124, v10, v121
  v_add_u32 v124, 16384, v124
  v_add_u32 v128, 0, v8
  v_add_u32 v129, 0, v9
  v_add_u32 v134, 0, v122
  v_add_u32 v135, 0, v123
  v_add_u32 v136, 0, v124
  v_add_u32 v130, 40960, v8
  v_add_u32 v131, 40960, v9
  v_add_u32 v137, 40960, v122
  v_add_u32 v138, 40960, v123
  v_add_u32 v139, 40960, v124
  v_add_u32 v132, 81920, v8
  v_add_u32 v133, 81920, v9
  v_add_u32 v140, 81920, v122
  v_add_u32 v141, 81920, v123
  v_add_u32 v142, 81920, v124
  s_mul_i32 s3, s40, 128
  v_mul_u32_u24 v13, 64, v7
  v_add_u32 v13, v13, v14
  v_add_u32 v13, s3, v13
  v_mul_u32_u24 v13, 6144, v13
  s_mul_i32 s3, s41, 384
  v_mul_u32_u24 v3, 96, v6
  v_add_u32 v13, v13, v3
  v_lshl_add_u32 v13, v15, 3, v13
  v_add_u32 v13, s3, v13
  v_mov_b32 v72, 0
  v_mov_b32 v73, 0
  v_mov_b32 v74, 0
  v_mov_b32 v75, 0
  v_mov_b32 v76, 0
  v_mov_b32 v77, 0
  v_mov_b32 v78, 0
  v_mov_b32 v79, 0
  v_mov_b32 v80, 0
  v_mov_b32 v81, 0
  v_mov_b32 v82, 0
  v_mov_b32 v83, 0
  v_mov_b32 v84, 0
  v_mov_b32 v85, 0
  v_mov_b32 v86, 0
  v_mov_b32 v87, 0
  v_mov_b32 v88, 0
  v_mov_b32 v89, 0
  v_mov_b32 v90, 0
  v_mov_b32 v91, 0
  v_mov_b32 v92, 0
  v_mov_b32 v93, 0
  v_mov_b32 v94, 0
  v_mov_b32 v95, 0
  v_mov_b32 v96, 0
  v_mov_b32 v97, 0
  v_mov_b32 v98, 0
  v_mov_b32 v99, 0
  v_mov_b32 v100, 0
  v_mov_b32 v101, 0
  v_mov_b32 v102, 0
  v_mov_b32 v103, 0
  v_mov_b32 v104, 0
  v_mov_b32 v105, 0
  v_mov_b32 v106, 0
  v_mov_b32 v107, 0
  v_mov_b32 v108, 0
  v_mov_b32 v109, 0
  v_mov_b32 v110, 0
  v_mov_b32 v111, 0
  v_mov_b32 v112, 0
  v_mov_b32 v113, 0
  v_mov_b32 v114, 0
  v_mov_b32 v115, 0
  v_mov_b32 v116, 0
  v_mov_b32 v117, 0
  v_mov_b32 v118, 0
  v_mov_b32 v119, 0
  s_add_u32 m0, s43, 0
  s_nop 0
  buffer_load_dwordx4 v4, s[24:27], s44 offen lds
  s_add_u32 s44, s44, 128
  s_add_u32 m0, s43, 8192
  s_nop 0
  buffer_load_dwordx4 v4, s[24:27], s45 offen lds
  s_add_u32 s45, s45, 128
  s_add_u32 m0, s43, 16384
  s_nop 0
  buffer_load_dwordx4 v5, s[28:31], s46 offen lds
  s_add_u32 s46, s46, 393216
  s_add_u32 m0, s43, 24576
  s_nop 0
  buffer_load_dwordx4 v5, s[28:31], s47 offen lds
  s_add_u32 s47, s47, 393216
  s_add_u32 m0, s43, 32768
  s_nop 0
  buffer_load_dwordx4 v5, s[28:31], s48 offen lds
  s_add_u32 s48, s48, 393216
  s_add_u32 m0, s43, 40960
  s_nop 0
  buffer_load_dwordx4 v4, s[24:27], s44 offen lds
  s_add_u32 s44, s44, 128
  s_add_u32 m0, s43, 49152
  s_nop 0
  buffer_load_dwordx4 v4, s[24:27], s45 offen lds
  s_add_u32 s45, s45, 128
  s_add_u32 m0, s43, 57344
  s_nop 0
  buffer_load_dwordx4 v5, s[28:31], s46 offen lds
  s_add_u32 s46, s46, 393216
  s_add_u32 m0, s43, 65536
  s_nop 0
  buffer_load_dwordx4 v5, s[28:31], s47 offen lds
  s_add_u32 s47, s47, 393216
  s_add_u32 m0, s43, 73728
  s_nop 0
  buffer_load_dwordx4 v5, s[28:31], s48 offen lds
  s_add_u32 s48, s48, 393216
  s_waitcnt vmcnt(5)
  s_barrier
  s_add_u32 m0, s43, 81920
  s_nop 0
  buffer_load_dwordx4 v4, s[24:27], s44 offen lds
  s_add_u32 s44, s44, 128
  s_add_u32 m0, s43, 90112
  s_nop 0
  buffer_load_dwordx4 v4, s[24:27], s45 offen lds
  s_add_u32 s45, s45, 128
  s_add_u32 m0, s43, 98304
  s_nop 0
  buffer_load_dwordx4 v5, s[28:31], s46 offen lds
  s_add_u32 s46, s46, 393216
  s_add_u32 m0, s43, 106496
  s_nop 0
  buffer_load_dwordx4 v5, s[28:31], s47 offen lds
  s_add_u32 s47, s47, 393216
  s_add_u32 m0, s43, 114688
  s_nop 0
  buffer_load_dwordx4 v5, s[28:31], s48 offen lds
  s_add_u32 s48, s48, 393216
  ds_read_b128 v[16:19], v128 offset:0
  ds_read_b128 v[20:23], v128 offset:2048
  ds_read_b128 v[24:27], v128 offset:4096
  ds_read_b128 v[28:31], v128 offset:6144
  ds_read_b64_tr_b16 v[48:49], v134 offset:0
  ds_read_b64_tr_b16 v[50:51], v134 offset:512
  ds_read_b64_tr_b16 v[52:53], v135 offset:0
  ds_read_b64_tr_b16 v[54:55], v135 offset:512
  ds_read_b64_tr_b16 v[56:57], v136 offset:0
  ds_read_b64_tr_b16 v[58:59], v136 offset:512
  ds_read_b128 v[32:35], v129 offset:0
  ds_read_b128 v[36:39], v129 offset:2048
  ds_read_b128 v[40:43], v129 offset:4096
  ds_read_b128 v[44:47], v129 offset:6144
  ds_read_b64_tr_b16 v[60:61], v134 offset:4096
  ds_read_b64_tr_b16 v[62:63], v134 offset:4608
  ds_read_b64_tr_b16 v[64:65], v135 offset:4096
  ds_read_b64_tr_b16 v[66:67], v135 offset:4608
  ds_read_b64_tr_b16 v[68:69], v136 offset:4096
  ds_read_b64_tr_b16 v[70:71], v136 offset:4608
  s_waitcnt lgkmcnt(10)
  v_mfma_f32_16x16x32_bf16 v[72:75], v[48:51], v[16:19], v[72:75]
  v_mfma_f32_16x16x32_bf16 v[76:79], v[52:55], v[16:19], v[76:79]
  v_mfma_f32_16x16x32_bf16 v[80:83], v[56:59], v[16:19], v[80:83]
  v_mfma_f32_16x16x32_bf16 v[84:87], v[48:51], v[20:23], v[84:87]
  v_mfma_f32_16x16x32_bf16 v[88:91], v[52:55], v[20:23], v[88:91]
  v_mfma_f32_16x16x32_bf16 v[92:95], v[56:59], v[20:23], v[92:95]
  v_mfma_f32_16x16x32_bf16 v[96:99], v[48:51], v[24:27], v[96:99]
  v_mfma_f32_16x16x32_bf16 v[100:103], v[52:55], v[24:27], v[100:103]
  v_mfma_f32_16x16x32_bf16 v[104:107], v[56:59], v[24:27], v[104:107]
  v_mfma_f32_16x16x32_bf16 v[108:111], v[48:51], v[28:31], v[108:111]
  v_mfma_f32_16x16x32_bf16 v[112:115], v[52:55], v[28:31], v[112:115]
  v_mfma_f32_16x16x32_bf16 v[116:119], v[56:59], v[28:31], v[116:119]
  s_waitcnt lgkmcnt(0)
  v_mfma_f32_16x16x32_bf16 v[72:75], v[60:63], v[32:35], v[72:75]
  v_mfma_f32_16x16x32_bf16 v[76:79], v[64:67], v[32:35], v[76:79]
  v_mfma_f32_16x16x32_bf16 v[80:83], v[68:71], v[32:35], v[80:83]
  v_mfma_f32_16x16x32_bf16 v[84:87], v[60:63], v[36:39], v[84:87]
  v_mfma_f32_16x16x32_bf16 v[88:91], v[64:67], v[36:39], v[88:91]
  v_mfma_f32_16x16x32_bf16 v[92:95], v[68:71], v[36:39], v[92:95]
  v_mfma_f32_16x16x32_bf16 v[96:99], v[60:63], v[40:43], v[96:99]
  v_mfma_f32_16x16x32_bf16 v[100:103], v[64:67], v[40:43], v[100:103]
  v_mfma_f32_16x16x32_bf16 v[104:107], v[68:71], v[40:43], v[104:107]
  v_mfma_f32_16x16x32_bf16 v[108:111], v[60:63], v[44:47], v[108:111]
  v_mfma_f32_16x16x32_bf16 v[112:115], v[64:67], v[44:47], v[112:115]
  v_mfma_f32_16x16x32_bf16 v[116:119], v[68:71], v[44:47], v[116:119]
  s_waitcnt vmcnt(5)
  s_barrier
  s_add_u32 m0, s43, 0
  s_nop 0
  buffer_load_dwordx4 v4, s[24:27], s44 offen lds
  s_add_u32 s44, s44, 128
  s_add_u32 m0, s43, 8192
  s_nop 0
  buffer_load_dwordx4 v4, s[24:27], s45 offen lds
  s_add_u32 s45, s45, 128
  s_add_u32 m0, s43, 16384
  s_nop 0
  buffer_load_dwordx4 v5, s[28:31], s46 offen lds
  s_add_u32 s46, s46, 393216
  s_add_u32 m0, s43, 24576
  s_nop 0
  buffer_load_dwordx4 v5, s[28:31], s47 offen lds
  s_add_u32 s47, s47, 393216
  s_add_u32 m0, s43, 32768
  s_nop 0
  buffer_load_dwordx4 v5, s[28:31], s48 offen lds
  s_add_u32 s48, s48, 393216
  ds_read_b128 v[16:19], v130 offset:0
  ds_read_b128 v[20:23], v130 offset:2048
  ds_read_b128 v[24:27], v130 offset:4096
  ds_read_b128 v[28:31], v130 offset:6144
  ds_read_b64_tr_b16 v[48:49], v137 offset:0
  ds_read_b64_tr_b16 v[50:51], v137 offset:512
  ds_read_b64_tr_b16 v[52:53], v138 offset:0
  ds_read_b64_tr_b16 v[54:55], v138 offset:512
  ds_read_b64_tr_b16 v[56:57], v139 offset:0
  ds_read_b64_tr_b16 v[58:59], v139 offset:512
  ds_read_b128 v[32:35], v131 offset:0
  ds_read_b128 v[36:39], v131 offset:2048
  ds_read_b128 v[40:43], v131 offset:4096
  ds_read_b128 v[44:47], v131 offset:6144
  ds_read_b64_tr_b16 v[60:61], v137 offset:4096
  ds_read_b64_tr_b16 v[62:63], v137 offset:4608
  ds_read_b64_tr_b16 v[64:65], v138 offset:4096
  ds_read_b64_tr_b16 v[66:67], v138 offset:4608
  ds_read_b64_tr_b16 v[68:69], v139 offset:4096
  ds_read_b64_tr_b16 v[70:71], v139 offset:4608
  s_waitcnt lgkmcnt(10)
  v_mfma_f32_16x16x32_bf16 v[72:75], v[48:51], v[16:19], v[72:75]
  v_mfma_f32_16x16x32_bf16 v[76:79], v[52:55], v[16:19], v[76:79]
  v_mfma_f32_16x16x32_bf16 v[80:83], v[56:59], v[16:19], v[80:83]
  v_mfma_f32_16x16x32_bf16 v[84:87], v[48:51], v[20:23], v[84:87]
  v_mfma_f32_16x16x32_bf16 v[88:91], v[52:55], v[20:23], v[88:91]
  v_mfma_f32_16x16x32_bf16 v[92:95], v[56:59], v[20:23], v[92:95]
  v_mfma_f32_16x16x32_bf16 v[96:99], v[48:51], v[24:27], v[96:99]
  v_mfma_f32_16x16x32_bf16 v[100:103], v[52:55], v[24:27], v[100:103]
  v_mfma_f32_16x16x32_bf16 v[104:107], v[56:59], v[24:27], v[104:107]
  v_mfma_f32_16x16x32_bf16 v[108:111], v[48:51], v[28:31], v[108:111]
  v_mfma_f32_16x16x32_bf16 v[112:115], v[52:55], v[28:31], v[112:115]
  v_mfma_f32_16x16x32_bf16 v[116:119], v[56:59], v[28:31], v[116:119]
  s_waitcnt lgkmcnt(0)
  v_mfma_f32_16x16x32_bf16 v[72:75], v[60:63], v[32:35], v[72:75]
  v_mfma_f32_16x16x32_bf16 v[76:79], v[64:67], v[32:35], v[76:79]
  v_mfma_f32_16x16x32_bf16 v[80:83], v[68:71], v[32:35], v[80:83]
  v_mfma_f32_16x16x32_bf16 v[84:87], v[60:63], v[36:39], v[84:87]
  v_mfma_f32_16x16x32_bf16 v[88:91], v[64:67], v[36:39], v[88:91]
  v_mfma_f32_16x16x32_bf16 v[92:95], v[68:71], v[36:39], v[92:95]
  v_mfma_f32_16x16x32_bf16 v[96:99], v[60:63], v[40:43], v[96:99]
  v_mfma_f32_16x16x32_bf16 v[100:103], v[64:67], v[40:43], v[100:103]
  v_mfma_f32_16x16x32_bf16 v[104:107], v[68:71], v[40:43], v[104:107]
  v_mfma_f32_16x16x32_bf16 v[108:111], v[60:63], v[44:47], v[108:111]
  v_mfma_f32_16x16x32_bf16 v[112:115], v[64:67], v[44:47], v[112:115]
  v_mfma_f32_16x16x32_bf16 v[116:119], v[68:71], v[44:47], v[116:119]
  s_waitcnt vmcnt(5)
  s_barrier
  s_add_u32 m0, s43, 40960
  s_nop 0
  buffer_load_dwordx4 v4, s[24:27], s44 offen lds
  s_add_u32 s44, s44, 128
  s_add_u32 m0, s43, 49152
  s_nop 0
  buffer_load_dwordx4 v4, s[24:27], s45 offen lds
  s_add_u32 s45, s45, 128
  s_add_u32 m0, s43, 57344
  s_nop 0
  buffer_load_dwordx4 v5, s[28:31], s46 offen lds
  s_add_u32 s46, s46, 393216
  s_add_u32 m0, s43, 65536
  s_nop 0
  buffer_load_dwordx4 v5, s[28:31], s47 offen lds
  s_add_u32 s47, s47, 393216
  s_add_u32 m0, s43, 73728
  s_nop 0
  buffer_load_dwordx4 v5, s[28:31], s48 offen lds
  s_add_u32 s48, s48, 393216
  ds_read_b128 v[16:19], v132 offset:0
  ds_read_b128 v[20:23], v132 offset:2048
  ds_read_b128 v[24:27], v132 offset:4096
  ds_read_b128 v[28:31], v132 offset:6144
  ds_read_b64_tr_b16 v[48:49], v140 offset:0
  ds_read_b64_tr_b16 v[50:51], v140 offset:512
  ds_read_b64_tr_b16 v[52:53], v141 offset:0
  ds_read_b64_tr_b16 v[54:55], v141 offset:512
  ds_read_b64_tr_b16 v[56:57], v142 offset:0
  ds_read_b64_tr_b16 v[58:59], v142 offset:512
  ds_read_b128 v[32:35], v133 offset:0
  ds_read_b128 v[36:39], v133 offset:2048
  ds_read_b128 v[40:43], v133 offset:4096
  ds_read_b128 v[44:47], v133 offset:6144
  ds_read_b64_tr_b16 v[60:61], v140 offset:4096
  ds_read_b64_tr_b16 v[62:63], v140 offset:4608
  ds_read_b64_tr_b16 v[64:65], v141 offset:4096
  ds_read_b64_tr_b16 v[66:67], v141 offset:4608
  ds_read_b64_tr_b16 v[68:69], v142 offset:4096
  ds_read_b64_tr_b16 v[70:71], v142 offset:4608
  s_waitcnt lgkmcnt(10)
  v_mfma_f32_16x16x32_bf16 v[72:75], v[48:51], v[16:19], v[72:75]
  v_mfma_f32_16x16x32_bf16 v[76:79], v[52:55], v[16:19], v[76:79]
  v_mfma_f32_16x16x32_bf16 v[80:83], v[56:59], v[16:19], v[80:83]
  v_mfma_f32_16x16x32_bf16 v[84:87], v[48:51], v[20:23], v[84:87]
  v_mfma_f32_16x16x32_bf16 v[88:91], v[52:55], v[20:23], v[88:91]
  v_mfma_f32_16x16x32_bf16 v[92:95], v[56:59], v[20:23], v[92:95]
  v_mfma_f32_16x16x32_bf16 v[96:99], v[48:51], v[24:27], v[96:99]
  v_mfma_f32_16x16x32_bf16 v[100:103], v[52:55], v[24:27], v[100:103]
  v_mfma_f32_16x16x32_bf16 v[104:107], v[56:59], v[24:27], v[104:107]
  v_mfma_f32_16x16x32_bf16 v[108:111], v[48:51], v[28:31], v[108:111]
  v_mfma_f32_16x16x32_bf16 v[112:115], v[52:55], v[28:31], v[112:115]
  v_mfma_f32_16x16x32_bf16 v[116:119], v[56:59], v[28:31], v[116:119]
  s_waitcnt lgkmcnt(0)
  v_mfma_f32_16x16x32_bf16 v[72:75], v[60:63], v[32:35], v[72:75]
  v_mfma_f32_16x16x32_bf16 v[76:79], v[64:67], v[32:35], v[76:79]
  v_mfma_f32_16x16x32_bf16 v[80:83], v[68:71], v[32:35], v[80:83]
  v_mfma_f32_16x16x32_bf16 v[84:87], v[60:63], v[36:39], v[84:87]
  v_mfma_f32_16x16x32_bf16 v[88:91], v[64:67], v[36:39], v[88:91]
  v_mfma_f32_16x16x32_bf16 v[92:95], v[68:71], v[36:39], v[92:95]
  v_mfma_f32_16x16x32_bf16 v[96:99], v[60:63], v[40:43], v[96:99]
  v_mfma_f32_16x16x32_bf16 v[100:103], v[64:67], v[40:43], v[100:103]
  v_mfma_f32_16x16x32_bf16 v[104:107], v[68:71], v[40:43], v[104:107]
  v_mfma_f32_16x16x32_bf16 v[108:111], v[60:63], v[44:47], v[108:111]
  v_mfma_f32_16x16x32_bf16 v[112:115], v[64:67], v[44:47], v[112:115]
  v_mfma_f32_16x16x32_bf16 v[116:119], v[68:71], v[44:47], v[116:119]
  s_waitcnt vmcnt(5)
  s_barrier
  s_add_u32 m0, s43, 81920
  s_nop 0
  buffer_load_dwordx4 v4, s[24:27], s44 offen lds
  s_add_u32 s44, s44, 128
  s_add_u32 m0, s43, 90112
  s_nop 0
  buffer_load_dwordx4 v4, s[24:27], s45 offen lds
  s_add_u32 s45, s45, 128
  s_add_u32 m0, s43, 98304
  s_nop 0
  buffer_load_dwordx4 v5, s[28:31], s46 offen lds
  s_add_u32 s46, s46, 393216
  s_add_u32 m0, s43, 106496
  s_nop 0
  buffer_load_dwordx4 v5, s[28:31], s47 offen lds
  s_add_u32 s47, s47, 393216
  s_add_u32 m0, s43, 114688
  s_nop 0
  buffer_load_dwordx4 v5, s[28:31], s48 offen lds
  s_add_u32 s48, s48, 393216
  ds_read_b128 v[16:19], v128 offset:0
  ds_read_b128 v[20:23], v128 offset:2048
  ds_read_b128 v[24:27], v128 offset:4096
  ds_read_b128 v[28:31], v128 offset:6144
  ds_read_b64_tr_b16 v[48:49], v134 offset:0
  ds_read_b64_tr_b16 v[50:51], v134 offset:512
  ds_read_b64_tr_b16 v[52:53], v135 offset:0
  ds_read_b64_tr_b16 v[54:55], v135 offset:512
  ds_read_b64_tr_b16 v[56:57], v136 offset:0
  ds_read_b64_tr_b16 v[58:59], v136 offset:512
  ds_read_b128 v[32:35], v129 offset:0
  ds_read_b128 v[36:39], v129 offset:2048
  ds_read_b128 v[40:43], v129 offset:4096
  ds_read_b128 v[44:47], v129 offset:6144
  ds_read_b64_tr_b16 v[60:61], v134 offset:4096
  ds_read_b64_tr_b16 v[62:63], v134 offset:4608
  ds_read_b64_tr_b16 v[64:65], v135 offset:4096
  ds_read_b64_tr_b16 v[66:67], v135 offset:4608
  ds_read_b64_tr_b16 v[68:69], v136 offset:4096
  ds_read_b64_tr_b16 v[70:71], v136 offset:4608
  s_waitcnt lgkmcnt(10)
  v_mfma_f32_16x16x32_bf16 v[72:75], v[48:51], v[16:19], v[72:75]
  v_mfma_f32_16x16x32_bf16 v[76:79], v[52:55], v[16:19], v[76:79]
  v_mfma_f32_16x16x32_bf16 v[80:83], v[56:59], v[16:19], v[80:83]
  v_mfma_f32_16x16x32_bf16 v[84:87], v[48:51], v[20:23], v[84:87]
  v_mfma_f32_16x16x32_bf16 v[88:91], v[52:55], v[20:23], v[88:91]
  v_mfma_f32_16x16x32_bf16 v[92:95], v[56:59], v[20:23], v[92:95]
  v_mfma_f32_16x16x32_bf16 v[96:99], v[48:51], v[24:27], v[96:99]
  v_mfma_f32_16x16x32_bf16 v[100:103], v[52:55], v[24:27], v[100:103]
  v_mfma_f32_16x16x32_bf16 v[104:107], v[56:59], v[24:27], v[104:107]
  v_mfma_f32_16x16x32_bf16 v[108:111], v[48:51], v[28:31], v[108:111]
  v_mfma_f32_16x16x32_bf16 v[112:115], v[52:55], v[28:31], v[112:115]
  v_mfma_f32_16x16x32_bf16 v[116:119], v[56:59], v[28:31], v[116:119]
  s_waitcnt lgkmcnt(0)
  v_mfma_f32_16x16x32_bf16 v[72:75], v[60:63], v[32:35], v[72:75]
  v_mfma_f32_16x16x32_bf16 v[76:79], v[64:67], v[32:35], v[76:79]
  v_mfma_f32_16x16x32_bf16 v[80:83], v[68:71], v[32:35], v[80:83]
  v_mfma_f32_16x16x32_bf16 v[84:87], v[60:63], v[36:39], v[84:87]
  v_mfma_f32_16x16x32_bf16 v[88:91], v[64:67], v[36:39], v[88:91]
  v_mfma_f32_16x16x32_bf16 v[92:95], v[68:71], v[36:39], v[92:95]
  v_mfma_f32_16x16x32_bf16 v[96:99], v[60:63], v[40:43], v[96:99]
  v_mfma_f32_16x16x32_bf16 v[100:103], v[64:67], v[40:43], v[100:103]
  v_mfma_f32_16x16x32_bf16 v[104:107], v[68:71], v[40:43], v[104:107]
  v_mfma_f32_16x16x32_bf16 v[108:111], v[60:63], v[44:47], v[108:111]
  v_mfma_f32_16x16x32_bf16 v[112:115], v[64:67], v[44:47], v[112:115]
  v_mfma_f32_16x16x32_bf16 v[116:119], v[68:71], v[44:47], v[116:119]
  s_waitcnt vmcnt(5)
  s_barrier
  s_add_u32 m0, s43, 0
  s_nop 0
  buffer_load_dwordx4 v4, s[24:27], s44 offen lds
  s_add_u32 s44, s44, 128
  s_add_u32 m0, s43, 8192
  s_nop 0
  buffer_load_dwordx4 v4, s[24:27], s45 offen lds
  s_add_u32 s45, s45, 128
  s_add_u32 m0, s43, 16384
  s_nop 0
  buffer_load_dwordx4 v5, s[28:31], s46 offen lds
  s_add_u32 s46, s46, 393216
  s_add_u32 m0, s43, 24576
  s_nop 0
  buffer_load_dwordx4 v5, s[28:31], s47 offen lds
  s_add_u32 s47, s47, 393216
  s_add_u32 m0, s43, 32768
  s_nop 0
  buffer_load_dwordx4 v5, s[28:31], s48 offen lds
  s_add_u32 s48, s48, 393216
  ds_read_b128 v[16:19], v130 offset:0
  ds_read_b128 v[20:23], v130 offset:2048
  ds_read_b128 v[24:27], v130 offset:4096
  ds_read_b128 v[28:31], v130 offset:6144
  ds_read_b64_tr_b16 v[48:49], v137 offset:0
  ds_read_b64_tr_b16 v[50:51], v137 offset:512
  ds_read_b64_tr_b16 v[52:53], v138 offset:0
  ds_read_b64_tr_b16 v[54:55], v138 offset:512
  ds_read_b64_tr_b16 v[56:57], v139 offset:0
  ds_read_b64_tr_b16 v[58:59], v139 offset:512
  ds_read_b128 v[32:35], v131 offset:0
  ds_read_b128 v[36:39], v131 offset:2048
  ds_read_b128 v[40:43], v131 offset:4096
  ds_read_b128 v[44:47], v131 offset:6144
  ds_read_b64_tr_b16 v[60:61], v137 offset:4096
  ds_read_b64_tr_b16 v[62:63], v137 offset:4608
  ds_read_b64_tr_b16 v[64:65], v138 offset:4096
  ds_read_b64_tr_b16 v[66:67], v138 offset:4608
  ds_read_b64_tr_b16 v[68:69], v139 offset:4096
  ds_read_b64_tr_b16 v[70:71], v139 offset:4608
  s_waitcnt lgkmcnt(10)
  v_mfma_f32_16x16x32_bf16 v[72:75], v[48:51], v[16:19], v[72:75]
  v_mfma_f32_16x16x32_bf16 v[76:79], v[52:55], v[16:19], v[76:79]
  v_mfma_f32_16x16x32_bf16 v[80:83], v[56:59], v[16:19], v[80:83]
  v_mfma_f32_16x16x32_bf16 v[84:87], v[48:51], v[20:23], v[84:87]
  v_mfma_f32_16x16x32_bf16 v[88:91], v[52:55], v[20:23], v[88:91]
  v_mfma_f32_16x16x32_bf16 v[92:95], v[56:59], v[20:23], v[92:95]
  v_mfma_f32_16x16x32_bf16 v[96:99], v[48:51], v[24:27], v[96:99]
  v_mfma_f32_16x16x32_bf16 v[100:103], v[52:55], v[24:27], v[100:103]
  v_mfma_f32_16x16x32_bf16 v[104:107], v[56:59], v[24:27], v[104:107]
  v_mfma_f32_16x16x32_bf16 v[108:111], v[48:51], v[28:31], v[108:111]
  v_mfma_f32_16x16x32_bf16 v[112:115], v[52:55], v[28:31], v[112:115]
  v_mfma_f32_16x16x32_bf16 v[116:119], v[56:59], v[28:31], v[116:119]
  s_waitcnt lgkmcnt(0)
  v_mfma_f32_16x16x32_bf16 v[72:75], v[60:63], v[32:35], v[72:75]
  v_mfma_f32_16x16x32_bf16 v[76:79], v[64:67], v[32:35], v[76:79]
  v_mfma_f32_16x16x32_bf16 v[80:83], v[68:71], v[32:35], v[80:83]
  v_mfma_f32_16x16x32_bf16 v[84:87], v[60:63], v[36:39], v[84:87]
  v_mfma_f32_16x16x32_bf16 v[88:91], v[64:67], v[36:39], v[88:91]
  v_mfma_f32_16x16x32_bf16 v[92:95], v[68:71], v[36:39], v[92:95]
  v_mfma_f32_16x16x32_bf16 v[96:99], v[60:63], v[40:43], v[96:99]
  v_mfma_f32_16x16x32_bf16 v[100:103], v[64:67], v[40:43], v[100:103]
  v_mfma_f32_16x16x32_bf16 v[104:107], v[68:71], v[40:43], v[104:107]
  v_mfma_f32_16x16x32_bf16 v[108:111], v[60:63], v[44:47], v[108:111]
  v_mfma_f32_16x16x32_bf16 v[112:115], v[64:67], v[44:47], v[112:115]
  v_mfma_f32_16x16x32_bf16 v[116:119], v[68:71], v[44:47], v[116:119]
  s_waitcnt vmcnt(5)
  s_barrier
  s_add_u32 m0, s43, 40960
  s_nop 0
  buffer_load_dwordx4 v4, s[24:27], s44 offen lds
  s_add_u32 s44, s44, 128
  s_add_u32 m0, s43, 49152
  s_nop 0
  buffer_load_dwordx4 v4, s[24:27], s45 offen lds
  s_add_u32 s45, s45, 128
  s_add_u32 m0, s43, 57344
  s_nop 0
  buffer_load_dwordx4 v5, s[28:31], s46 offen lds
  s_add_u32 s46, s46, 393216
  s_add_u32 m0, s43, 65536
  s_nop 0
  buffer_load_dwordx4 v5, s[28:31], s47 offen lds
  s_add_u32 s47, s47, 393216
  s_add_u32 m0, s43, 73728
  s_nop 0
  buffer_load_dwordx4 v5, s[28:31], s48 offen lds
  s_add_u32 s48, s48, 393216
  ds_read_b128 v[16:19], v132 offset:0
  ds_read_b128 v[20:23], v132 offset:2048
  ds_read_b128 v[24:27], v132 offset:4096
  ds_read_b128 v[28:31], v132 offset:6144
  ds_read_b64_tr_b16 v[48:49], v140 offset:0
  ds_read_b64_tr_b16 v[50:51], v140 offset:512
  ds_read_b64_tr_b16 v[52:53], v141 offset:0
  ds_read_b64_tr_b16 v[54:55], v141 offset:512
  ds_read_b64_tr_b16 v[56:57], v142 offset:0
  ds_read_b64_tr_b16 v[58:59], v142 offset:512
  ds_read_b128 v[32:35], v133 offset:0
  ds_read_b128 v[36:39], v133 offset:2048
  ds_read_b128 v[40:43], v133 offset:4096
  ds_read_b128 v[44:47], v133 offset:6144
  ds_read_b64_tr_b16 v[60:61], v140 offset:4096
  ds_read_b64_tr_b16 v[62:63], v140 offset:4608
  ds_read_b64_tr_b16 v[64:65], v141 offset:4096
  ds_read_b64_tr_b16 v[66:67], v141 offset:4608
  ds_read_b64_tr_b16 v[68:69], v142 offset:4096
  ds_read_b64_tr_b16 v[70:71], v142 offset:4608
  s_waitcnt lgkmcnt(10)
  v_mfma_f32_16x16x32_bf16 v[72:75], v[48:51], v[16:19], v[72:75]
  v_mfma_f32_16x16x32_bf16 v[76:79], v[52:55], v[16:19], v[76:79]
  v_mfma_f32_16x16x32_bf16 v[80:83], v[56:59], v[16:19], v[80:83]
  v_mfma_f32_16x16x32_bf16 v[84:87], v[48:51], v[20:23], v[84:87]
  v_mfma_f32_16x16x32_bf16 v[88:91], v[52:55], v[20:23], v[88:91]
  v_mfma_f32_16x16x32_bf16 v[92:95], v[56:59], v[20:23], v[92:95]
  v_mfma_f32_16x16x32_bf16 v[96:99], v[48:51], v[24:27], v[96:99]
  v_mfma_f32_16x16x32_bf16 v[100:103], v[52:55], v[24:27], v[100:103]
  v_mfma_f32_16x16x32_bf16 v[104:107], v[56:59], v[24:27], v[104:107]
  v_mfma_f32_16x16x32_bf16 v[108:111], v[48:51], v[28:31], v[108:111]
  v_mfma_f32_16x16x32_bf16 v[112:115], v[52:55], v[28:31], v[112:115]
  v_mfma_f32_16x16x32_bf16 v[116:119], v[56:59], v[28:31], v[116:119]
  s_waitcnt lgkmcnt(0)
  v_mfma_f32_16x16x32_bf16 v[72:75], v[60:63], v[32:35], v[72:75]
  v_mfma_f32_16x16x32_bf16 v[76:79], v[64:67], v[32:35], v[76:79]
  v_mfma_f32_16x16x32_bf16 v[80:83], v[68:71], v[32:35], v[80:83]
  v_mfma_f32_16x16x32_bf16 v[84:87], v[60:63], v[36:39], v[84:87]
  v_mfma_f32_16x16x32_bf16 v[88:91], v[64:67], v[36:39], v[88:91]
  v_mfma_f32_16x16x32_bf16 v[92:95], v[68:71], v[36:39], v[92:95]
  v_mfma_f32_16x16x32_bf16 v[96:99], v[60:63], v[40:43], v[96:99]
  v_mfma_f32_16x16x32_bf16 v[100:103], v[64:67], v[40:43], v[100:103]
  v_mfma_f32_16x16x32_bf16 v[104:107], v[68:71], v[40:43], v[104:107]
  v_mfma_f32_16x16x32_bf16 v[108:111], v[60:63], v[44:47], v[108:111]
  v_mfma_f32_16x16x32_bf16 v[112:115], v[64:67], v[44:47], v[112:115]
  v_mfma_f32_16x16x32_bf16 v[116:119], v[68:71], v[44:47], v[116:119]
  s_waitcnt vmcnt(5)
  s_barrier
  s_add_u32 m0, s43, 81920
  s_nop 0
  buffer_load_dwordx4 v4, s[24:27], s44 offen lds
  s_add_u32 s44, s44, 128
  s_add_u32 m0, s43, 90112
  s_nop 0
  buffer_load_dwordx4 v4, s[24:27], s45 offen lds
  s_add_u32 s45, s45, 128
  s_add_u32 m0, s43, 98304
  s_nop 0
  buffer_load_dwordx4 v5, s[28:31], s46 offen lds
  s_add_u32 s46, s46, 393216
  s_add_u32 m0, s43, 106496
  s_nop 0
  buffer_load_dwordx4 v5, s[28:31], s47 offen lds
  s_add_u32 s47, s47, 393216
  s_add_u32 m0, s43, 114688
  s_nop 0
  buffer_load_dwordx4 v5, s[28:31], s48 offen lds
  s_add_u32 s48, s48, 393216
  ds_read_b128 v[16:19], v128 offset:0
  ds_read_b128 v[20:23], v128 offset:2048
  ds_read_b128 v[24:27], v128 offset:4096
  ds_read_b128 v[28:31], v128 offset:6144
  ds_read_b64_tr_b16 v[48:49], v134 offset:0
  ds_read_b64_tr_b16 v[50:51], v134 offset:512
  ds_read_b64_tr_b16 v[52:53], v135 offset:0
  ds_read_b64_tr_b16 v[54:55], v135 offset:512
  ds_read_b64_tr_b16 v[56:57], v136 offset:0
  ds_read_b64_tr_b16 v[58:59], v136 offset:512
  ds_read_b128 v[32:35], v129 offset:0
  ds_read_b128 v[36:39], v129 offset:2048
  ds_read_b128 v[40:43], v129 offset:4096
  ds_read_b128 v[44:47], v129 offset:6144
  ds_read_b64_tr_b16 v[60:61], v134 offset:4096
  ds_read_b64_tr_b16 v[62:63], v134 offset:4608
  ds_read_b64_tr_b16 v[64:65], v135 offset:4096
  ds_read_b64_tr_b16 v[66:67], v135 offset:4608
  ds_read_b64_tr_b16 v[68:69], v136 offset:4096
  ds_read_b64_tr_b16 v[70:71], v136 offset:4608
  s_waitcnt lgkmcnt(10)
  v_mfma_f32_16x16x32_bf16 v[72:75], v[48:51], v[16:19], v[72:75]
  v_mfma_f32_16x16x32_bf16 v[76:79], v[52:55], v[16:19], v[76:79]
  v_mfma_f32_16x16x32_bf16 v[80:83], v[56:59], v[16:19], v[80:83]
  v_mfma_f32_16x16x32_bf16 v[84:87], v[48:51], v[20:23], v[84:87]
  v_mfma_f32_16x16x32_bf16 v[88:91], v[52:55], v[20:23], v[88:91]
  v_mfma_f32_16x16x32_bf16 v[92:95], v[56:59], v[20:23], v[92:95]
  v_mfma_f32_16x16x32_bf16 v[96:99], v[48:51], v[24:27], v[96:99]
  v_mfma_f32_16x16x32_bf16 v[100:103], v[52:55], v[24:27], v[100:103]
  v_mfma_f32_16x16x32_bf16 v[104:107], v[56:59], v[24:27], v[104:107]
  v_mfma_f32_16x16x32_bf16 v[108:111], v[48:51], v[28:31], v[108:111]
  v_mfma_f32_16x16x32_bf16 v[112:115], v[52:55], v[28:31], v[112:115]
  v_mfma_f32_16x16x32_bf16 v[116:119], v[56:59], v[28:31], v[116:119]
  s_waitcnt lgkmcnt(0)
  v_mfma_f32_16x16x32_bf16 v[72:75], v[60:63], v[32:35], v[72:75]
  v_mfma_f32_16x16x32_bf16 v[76:79], v[64:67], v[32:35], v[76:79]
  v_mfma_f32_16x16x32_bf16 v[80:83], v[68:71], v[32:35], v[80:83]
  v_mfma_f32_16x16x32_bf16 v[84:87], v[60:63], v[36:39], v[84:87]
  v_mfma_f32_16x16x32_bf16 v[88:91], v[64:67], v[36:39], v[88:91]
  v_mfma_f32_16x16x32_bf16 v[92:95], v[68:71], v[36:39], v[92:95]
  v_mfma_f32_16x16x32_bf16 v[96:99], v[60:63], v[40:43], v[96:99]
  v_mfma_f32_16x16x32_bf16 v[100:103], v[64:67], v[40:43], v[100:103]
  v_mfma_f32_16x16x32_bf16 v[104:107], v[68:71], v[40:43], v[104:107]
  v_mfma_f32_16x16x32_bf16 v[108:111], v[60:63], v[44:47], v[108:111]
  v_mfma_f32_16x16x32_bf16 v[112:115], v[64:67], v[44:47], v[112:115]
  v_mfma_f32_16x16x32_bf16 v[116:119], v[68:71], v[44:47], v[116:119]
  s_waitcnt vmcnt(5)
  s_barrier
  s_add_u32 m0, s43, 0
  s_nop 0
  buffer_load_dwordx4 v4, s[24:27], s44 offen lds
  s_add_u32 s44, s44, 128
  s_add_u32 m0, s43, 8192
  s_nop 0
  buffer_load_dwordx4 v4, s[24:27], s45 offen lds
  s_add_u32 s45, s45, 128
  s_add_u32 m0, s43, 16384
  s_nop 0
  buffer_load_dwordx4 v5, s[28:31], s46 offen lds
  s_add_u32 s46, s46, 393216
  s_add_u32 m0, s43, 24576
  s_nop 0
  buffer_load_dwordx4 v5, s[28:31], s47 offen lds
  s_add_u32 s47, s47, 393216
  s_add_u32 m0, s43, 32768
  s_nop 0
  buffer_load_dwordx4 v5, s[28:31], s48 offen lds
  s_add_u32 s48, s48, 393216
  ds_read_b128 v[16:19], v130 offset:0
  ds_read_b128 v[20:23], v130 offset:2048
  ds_read_b128 v[24:27], v130 offset:4096
  ds_read_b128 v[28:31], v130 offset:6144
  ds_read_b64_tr_b16 v[48:49], v137 offset:0
  ds_read_b64_tr_b16 v[50:51], v137 offset:512
  ds_read_b64_tr_b16 v[52:53], v138 offset:0
  ds_read_b64_tr_b16 v[54:55], v138 offset:512
  ds_read_b64_tr_b16 v[56:57], v139 offset:0
  ds_read_b64_tr_b16 v[58:59], v139 offset:512
  ds_read_b128 v[32:35], v131 offset:0
  ds_read_b128 v[36:39], v131 offset:2048
  ds_read_b128 v[40:43], v131 offset:4096
  ds_read_b128 v[44:47], v131 offset:6144
  ds_read_b64_tr_b16 v[60:61], v137 offset:4096
  ds_read_b64_tr_b16 v[62:63], v137 offset:4608
  ds_read_b64_tr_b16 v[64:65], v138 offset:4096
  ds_read_b64_tr_b16 v[66:67], v138 offset:4608
  ds_read_b64_tr_b16 v[68:69], v139 offset:4096
  ds_read_b64_tr_b16 v[70:71], v139 offset:4608
  s_waitcnt lgkmcnt(10)
  v_mfma_f32_16x16x32_bf16 v[72:75], v[48:51], v[16:19], v[72:75]
  v_mfma_f32_16x16x32_bf16 v[76:79], v[52:55], v[16:19], v[76:79]
  v_mfma_f32_16x16x32_bf16 v[80:83], v[56:59], v[16:19], v[80:83]
  v_mfma_f32_16x16x32_bf16 v[84:87], v[48:51], v[20:23], v[84:87]
  v_mfma_f32_16x16x32_bf16 v[88:91], v[52:55], v[20:23], v[88:91]
  v_mfma_f32_16x16x32_bf16 v[92:95], v[56:59], v[20:23], v[92:95]
  v_mfma_f32_16x16x32_bf16 v[96:99], v[48:51], v[24:27], v[96:99]
  v_mfma_f32_16x16x32_bf16 v[100:103], v[52:55], v[24:27], v[100:103]
  v_mfma_f32_16x16x32_bf16 v[104:107], v[56:59], v[24:27], v[104:107]
  v_mfma_f32_16x16x32_bf16 v[108:111], v[48:51], v[28:31], v[108:111]
  v_mfma_f32_16x16x32_bf16 v[112:115], v[52:55], v[28:31], v[112:115]
  v_mfma_f32_16x16x32_bf16 v[116:119], v[56:59], v[28:31], v[116:119]
  s_waitcnt lgkmcnt(0)
  v_mfma_f32_16x16x32_bf16 v[72:75], v[60:63], v[32:35], v[72:75]
  v_mfma_f32_16x16x32_bf16 v[76:79], v[64:67], v[32:35], v[76:79]
  v_mfma_f32_16x16x32_bf16 v[80:83], v[68:71], v[32:35], v[80:83]
  v_mfma_f32_16x16x32_bf16 v[84:87], v[60:63], v[36:39], v[84:87]
  v_mfma_f32_16x16x32_bf16 v[88:91], v[64:67], v[36:39], v[88:91]
  v_mfma_f32_16x16x32_bf16 v[92:95], v[68:71], v[36:39], v[92:95]
  v_mfma_f32_16x16x32_bf16 v[96:99], v[60:63], v[40:43], v[96:99]
  v_mfma_f32_16x16x32_bf16 v[100:103], v[64:67], v[40:43], v[100:103]
  v_mfma_f32_16x16x32_bf16 v[104:107], v[68:71], v[40:43], v[104:107]
  v_mfma_f32_16x16x32_bf16 v[108:111], v[60:63], v[44:47], v[108:111]
  v_mfma_f32_16x16x32_bf16 v[112:115], v[64:67], v[44:47], v[112:115]
  v_mfma_f32_16x16x32_bf16 v[116:119], v[68:71], v[44:47], v[116:119]
  s_waitcnt vmcnt(5)
  s_barrier
  s_add_u32 m0, s43, 40960
  s_nop 0
  buffer_load_dwordx4 v4, s[24:27], s44 offen lds
  s_add_u32 s44, s44, 128
  s_add_u32 m0, s43, 49152
  s_nop 0
  buffer_load_dwordx4 v4, s[24:27], s45 offen lds
  s_add_u32 s45, s45, 128
  s_add_u32 m0, s43, 57344
  s_nop 0
  buffer_load_dwordx4 v5, s[28:31], s46 offen lds
  s_add_u32 s46, s46, 393216
  s_add_u32 m0, s43, 65536
  s_nop 0
  buffer_load_dwordx4 v5, s[28:31], s47 offen lds
  s_add_u32 s47, s47, 393216
  s_add_u32 m0, s43, 73728
  s_nop 0
  buffer_load_dwordx4 v5, s[28:31], s48 offen lds
  s_add_u32 s48, s48, 393216
  ds_read_b128 v[16:19], v132 offset:0
  ds_read_b128 v[20:23], v132 offset:2048
  ds_read_b128 v[24:27], v132 offset:4096
  ds_read_b128 v[28:31], v132 offset:6144
  ds_read_b64_tr_b16 v[48:49], v140 offset:0
  ds_read_b64_tr_b16 v[50:51], v140 offset:512
  ds_read_b64_tr_b16 v[52:53], v141 offset:0
  ds_read_b64_tr_b16 v[54:55], v141 offset:512
  ds_read_b64_tr_b16 v[56:57], v142 offset:0
  ds_read_b64_tr_b16 v[58:59], v142 offset:512
  ds_read_b128 v[32:35], v133 offset:0
  ds_read_b128 v[36:39], v133 offset:2048
  ds_read_b128 v[40:43], v133 offset:4096
  ds_read_b128 v[44:47], v133 offset:6144
  ds_read_b64_tr_b16 v[60:61], v140 offset:4096
  ds_read_b64_tr_b16 v[62:63], v140 offset:4608
  ds_read_b64_tr_b16 v[64:65], v141 offset:4096
  ds_read_b64_tr_b16 v[66:67], v141 offset:4608
  ds_read_b64_tr_b16 v[68:69], v142 offset:4096
  ds_read_b64_tr_b16 v[70:71], v142 offset:4608
  s_waitcnt lgkmcnt(10)
  v_mfma_f32_16x16x32_bf16 v[72:75], v[48:51], v[16:19], v[72:75]
  v_mfma_f32_16x16x32_bf16 v[76:79], v[52:55], v[16:19], v[76:79]
  v_mfma_f32_16x16x32_bf16 v[80:83], v[56:59], v[16:19], v[80:83]
  v_mfma_f32_16x16x32_bf16 v[84:87], v[48:51], v[20:23], v[84:87]
  v_mfma_f32_16x16x32_bf16 v[88:91], v[52:55], v[20:23], v[88:91]
  v_mfma_f32_16x16x32_bf16 v[92:95], v[56:59], v[20:23], v[92:95]
  v_mfma_f32_16x16x32_bf16 v[96:99], v[48:51], v[24:27], v[96:99]
  v_mfma_f32_16x16x32_bf16 v[100:103], v[52:55], v[24:27], v[100:103]
  v_mfma_f32_16x16x32_bf16 v[104:107], v[56:59], v[24:27], v[104:107]
  v_mfma_f32_16x16x32_bf16 v[108:111], v[48:51], v[28:31], v[108:111]
  v_mfma_f32_16x16x32_bf16 v[112:115], v[52:55], v[28:31], v[112:115]
  v_mfma_f32_16x16x32_bf16 v[116:119], v[56:59], v[28:31], v[116:119]
  s_waitcnt lgkmcnt(0)
  v_mfma_f32_16x16x32_bf16 v[72:75], v[60:63], v[32:35], v[72:75]
  v_mfma_f32_16x16x32_bf16 v[76:79], v[64:67], v[32:35], v[76:79]
  v_mfma_f32_16x16x32_bf16 v[80:83], v[68:71], v[32:35], v[80:83]
  v_mfma_f32_16x16x32_bf16 v[84:87], v[60:63], v[36:39], v[84:87]
  v_mfma_f32_16x16x32_bf16 v[88:91], v[64:67], v[36:39], v[88:91]
  v_mfma_f32_16x16x32_bf16 v[92:95], v[68:71], v[36:39], v[92:95]
  v_mfma_f32_16x16x32_bf16 v[96:99], v[60:63], v[40:43], v[96:99]
  v_mfma_f32_16x16x32_bf16 v[100:103], v[64:67], v[40:43], v[100:103]
  v_mfma_f32_16x16x32_bf16 v[104:107], v[68:71], v[40:43], v[104:107]
  v_mfma_f32_16x16x32_bf16 v[108:111], v[60:63], v[44:47], v[108:111]
  v_mfma_f32_16x16x32_bf16 v[112:115], v[64:67], v[44:47], v[112:115]
  v_mfma_f32_16x16x32_bf16 v[116:119], v[68:71], v[44:47], v[116:119]
  s_waitcnt vmcnt(5)
  s_barrier
  s_add_u32 m0, s43, 81920
  s_nop 0
  buffer_load_dwordx4 v4, s[24:27], s44 offen lds
  s_add_u32 s44, s44, 128
  s_add_u32 m0, s43, 90112
  s_nop 0
  buffer_load_dwordx4 v4, s[24:27], s45 offen lds
  s_add_u32 s45, s45, 128
  s_add_u32 m0, s43, 98304
  s_nop 0
  buffer_load_dwordx4 v5, s[28:31], s46 offen lds
  s_add_u32 s46, s46, 393216
  s_add_u32 m0, s43, 106496
  s_nop 0
  buffer_load_dwordx4 v5, s[28:31], s47 offen lds
  s_add_u32 s47, s47, 393216
  s_add_u32 m0, s43, 114688
  s_nop 0
  buffer_load_dwordx4 v5, s[28:31], s48 offen lds
  s_add_u32 s48, s48, 393216
  ds_read_b128 v[16:19], v128 offset:0
  ds_read_b128 v[20:23], v128 offset:2048
  ds_read_b128 v[24:27], v128 offset:4096
  ds_read_b128 v[28:31], v128 offset:6144
  ds_read_b64_tr_b16 v[48:49], v134 offset:0
  ds_read_b64_tr_b16 v[50:51], v134 offset:512
  ds_read_b64_tr_b16 v[52:53], v135 offset:0
  ds_read_b64_tr_b16 v[54:55], v135 offset:512
  ds_read_b64_tr_b16 v[56:57], v136 offset:0
  ds_read_b64_tr_b16 v[58:59], v136 offset:512
  ds_read_b128 v[32:35], v129 offset:0
  ds_read_b128 v[36:39], v129 offset:2048
  ds_read_b128 v[40:43], v129 offset:4096
  ds_read_b128 v[44:47], v129 offset:6144
  ds_read_b64_tr_b16 v[60:61], v134 offset:4096
  ds_read_b64_tr_b16 v[62:63], v134 offset:4608
  ds_read_b64_tr_b16 v[64:65], v135 offset:4096
  ds_read_b64_tr_b16 v[66:67], v135 offset:4608
  ds_read_b64_tr_b16 v[68:69], v136 offset:4096
  ds_read_b64_tr_b16 v[70:71], v136 offset:4608
  s_waitcnt lgkmcnt(10)
  v_mfma_f32_16x16x32_bf16 v[72:75], v[48:51], v[16:19], v[72:75]
  v_mfma_f32_16x16x32_bf16 v[76:79], v[52:55], v[16:19], v[76:79]
  v_mfma_f32_16x16x32_bf16 v[80:83], v[56:59], v[16:19], v[80:83]
  v_mfma_f32_16x16x32_bf16 v[84:87], v[48:51], v[20:23], v[84:87]
  v_mfma_f32_16x16x32_bf16 v[88:91], v[52:55], v[20:23], v[88:91]
  v_mfma_f32_16x16x32_bf16 v[92:95], v[56:59], v[20:23], v[92:95]
  v_mfma_f32_16x16x32_bf16 v[96:99], v[48:51], v[24:27], v[96:99]
  v_mfma_f32_16x16x32_bf16 v[100:103], v[52:55], v[24:27], v[100:103]
  v_mfma_f32_16x16x32_bf16 v[104:107], v[56:59], v[24:27], v[104:107]
  v_mfma_f32_16x16x32_bf16 v[108:111], v[48:51], v[28:31], v[108:111]
  v_mfma_f32_16x16x32_bf16 v[112:115], v[52:55], v[28:31], v[112:115]
  v_mfma_f32_16x16x32_bf16 v[116:119], v[56:59], v[28:31], v[116:119]
  s_waitcnt lgkmcnt(0)
  v_mfma_f32_16x16x32_bf16 v[72:75], v[60:63], v[32:35], v[72:75]
  v_mfma_f32_16x16x32_bf16 v[76:79], v[64:67], v[32:35], v[76:79]
  v_mfma_f32_16x16x32_bf16 v[80:83], v[68:71], v[32:35], v[80:83]
  v_mfma_f32_16x16x32_bf16 v[84:87], v[60:63], v[36:39], v[84:87]
  v_mfma_f32_16x16x32_bf16 v[88:91], v[64:67], v[36:39], v[88:91]
  v_mfma_f32_16x16x32_bf16 v[92:95], v[68:71], v[36:39], v[92:95]
  v_mfma_f32_16x16x32_bf16 v[96:99], v[60:63], v[40:43], v[96:99]
  v_mfma_f32_16x16x32_bf16 v[100:103], v[64:67], v[40:43], v[100:103]
  v_mfma_f32_16x16x32_bf16 v[104:107], v[68:71], v[40:43], v[104:107]
  v_mfma_f32_16x16x32_bf16 v[108:111], v[60:63], v[44:47], v[108:111]
  v_mfma_f32_16x16x32_bf16 v[112:115], v[64:67], v[44:47], v[112:115]
  v_mfma_f32_16x16x32_bf16 v[116:119], v[68:71], v[44:47], v[116:119]
  s_waitcnt vmcnt(5)
  s_barrier
  s_add_u32 m0, s43, 0
  s_nop 0
  buffer_load_dwordx4 v4, s[24:27], s44 offen lds
  s_add_u32 s44, s44, 128
  s_add_u32 m0, s43, 8192
  s_nop 0
  buffer_load_dwordx4 v4, s[24:27], s45 offen lds
  s_add_u32 s45, s45, 128
  s_add_u32 m0, s43, 16384
  s_nop 0
  buffer_load_dwordx4 v5, s[28:31], s46 offen lds
  s_add_u32 s46, s46, 393216
  s_add_u32 m0, s43, 24576
  s_nop 0
  buffer_load_dwordx4 v5, s[28:31], s47 offen lds
  s_add_u32 s47, s47, 393216
  s_add_u32 m0, s43, 32768
  s_nop 0
  buffer_load_dwordx4 v5, s[28:31], s48 offen lds
  s_add_u32 s48, s48, 393216
  ds_read_b128 v[16:19], v130 offset:0
  ds_read_b128 v[20:23], v130 offset:2048
  ds_read_b128 v[24:27], v130 offset:4096
  ds_read_b128 v[28:31], v130 offset:6144
  ds_read_b64_tr_b16 v[48:49], v137 offset:0
  ds_read_b64_tr_b16 v[50:51], v137 offset:512
  ds_read_b64_tr_b16 v[52:53], v138 offset:0
  ds_read_b64_tr_b16 v[54:55], v138 offset:512
  ds_read_b64_tr_b16 v[56:57], v139 offset:0
  ds_read_b64_tr_b16 v[58:59], v139 offset:512
  ds_read_b128 v[32:35], v131 offset:0
  ds_read_b128 v[36:39], v131 offset:2048
  ds_read_b128 v[40:43], v131 offset:4096
  ds_read_b128 v[44:47], v131 offset:6144
  ds_read_b64_tr_b16 v[60:61], v137 offset:4096
  ds_read_b64_tr_b16 v[62:63], v137 offset:4608
  ds_read_b64_tr_b16 v[64:65], v138 offset:4096
  ds_read_b64_tr_b16 v[66:67], v138 offset:4608
  ds_read_b64_tr_b16 v[68:69], v139 offset:4096
  ds_read_b64_tr_b16 v[70:71], v139 offset:4608
  s_waitcnt lgkmcnt(10)
  v_mfma_f32_16x16x32_bf16 v[72:75], v[48:51], v[16:19], v[72:75]
  v_mfma_f32_16x16x32_bf16 v[76:79], v[52:55], v[16:19], v[76:79]
  v_mfma_f32_16x16x32_bf16 v[80:83], v[56:59], v[16:19], v[80:83]
  v_mfma_f32_16x16x32_bf16 v[84:87], v[48:51], v[20:23], v[84:87]
  v_mfma_f32_16x16x32_bf16 v[88:91], v[52:55], v[20:23], v[88:91]
  v_mfma_f32_16x16x32_bf16 v[92:95], v[56:59], v[20:23], v[92:95]
  v_mfma_f32_16x16x32_bf16 v[96:99], v[48:51], v[24:27], v[96:99]
  v_mfma_f32_16x16x32_bf16 v[100:103], v[52:55], v[24:27], v[100:103]
  v_mfma_f32_16x16x32_bf16 v[104:107], v[56:59], v[24:27], v[104:107]
  v_mfma_f32_16x16x32_bf16 v[108:111], v[48:51], v[28:31], v[108:111]
  v_mfma_f32_16x16x32_bf16 v[112:115], v[52:55], v[28:31], v[112:115]
  v_mfma_f32_16x16x32_bf16 v[116:119], v[56:59], v[28:31], v[116:119]
  s_waitcnt lgkmcnt(0)
  v_mfma_f32_16x16x32_bf16 v[72:75], v[60:63], v[32:35], v[72:75]
  v_mfma_f32_16x16x32_bf16 v[76:79], v[64:67], v[32:35], v[76:79]
  v_mfma_f32_16x16x32_bf16 v[80:83], v[68:71], v[32:35], v[80:83]
  v_mfma_f32_16x16x32_bf16 v[84:87], v[60:63], v[36:39], v[84:87]
  v_mfma_f32_16x16x32_bf16 v[88:91], v[64:67], v[36:39], v[88:91]
  v_mfma_f32_16x16x32_bf16 v[92:95], v[68:71], v[36:39], v[92:95]
  v_mfma_f32_16x16x32_bf16 v[96:99], v[60:63], v[40:43], v[96:99]
  v_mfma_f32_16x16x32_bf16 v[100:103], v[64:67], v[40:43], v[100:103]
  v_mfma_f32_16x16x32_bf16 v[104:107], v[68:71], v[40:43], v[104:107]
  v_mfma_f32_16x16x32_bf16 v[108:111], v[60:63], v[44:47], v[108:111]
  v_mfma_f32_16x16x32_bf16 v[112:115], v[64:67], v[44:47], v[112:115]
  v_mfma_f32_16x16x32_bf16 v[116:119], v[68:71], v[44:47], v[116:119]
  s_waitcnt vmcnt(5)
  s_barrier
  s_add_u32 m0, s43, 40960
  s_nop 0
  buffer_load_dwordx4 v4, s[24:27], s44 offen lds
  s_add_u32 s44, s44, 128
  s_add_u32 m0, s43, 49152
  s_nop 0
  buffer_load_dwordx4 v4, s[24:27], s45 offen lds
  s_add_u32 s45, s45, 128
  s_add_u32 m0, s43, 57344
  s_nop 0
  buffer_load_dwordx4 v5, s[28:31], s46 offen lds
  s_add_u32 s46, s46, 393216
  s_add_u32 m0, s43, 65536
  s_nop 0
  buffer_load_dwordx4 v5, s[28:31], s47 offen lds
  s_add_u32 s47, s47, 393216
  s_add_u32 m0, s43, 73728
  s_nop 0
  buffer_load_dwordx4 v5, s[28:31], s48 offen lds
  s_add_u32 s48, s48, 393216
  ds_read_b128 v[16:19], v132 offset:0
  ds_read_b128 v[20:23], v132 offset:2048
  ds_read_b128 v[24:27], v132 offset:4096
  ds_read_b128 v[28:31], v132 offset:6144
  ds_read_b64_tr_b16 v[48:49], v140 offset:0
  ds_read_b64_tr_b16 v[50:51], v140 offset:512
  ds_read_b64_tr_b16 v[52:53], v141 offset:0
  ds_read_b64_tr_b16 v[54:55], v141 offset:512
  ds_read_b64_tr_b16 v[56:57], v142 offset:0
  ds_read_b64_tr_b16 v[58:59], v142 offset:512
  ds_read_b128 v[32:35], v133 offset:0
  ds_read_b128 v[36:39], v133 offset:2048
  ds_read_b128 v[40:43], v133 offset:4096
  ds_read_b128 v[44:47], v133 offset:6144
  ds_read_b64_tr_b16 v[60:61], v140 offset:4096
  ds_read_b64_tr_b16 v[62:63], v140 offset:4608
  ds_read_b64_tr_b16 v[64:65], v141 offset:4096
  ds_read_b64_tr_b16 v[66:67], v141 offset:4608
  ds_read_b64_tr_b16 v[68:69], v142 offset:4096
  ds_read_b64_tr_b16 v[70:71], v142 offset:4608
  s_waitcnt lgkmcnt(10)
  v_mfma_f32_16x16x32_bf16 v[72:75], v[48:51], v[16:19], v[72:75]
  v_mfma_f32_16x16x32_bf16 v[76:79], v[52:55], v[16:19], v[76:79]
  v_mfma_f32_16x16x32_bf16 v[80:83], v[56:59], v[16:19], v[80:83]
  v_mfma_f32_16x16x32_bf16 v[84:87], v[48:51], v[20:23], v[84:87]
  v_mfma_f32_16x16x32_bf16 v[88:91], v[52:55], v[20:23], v[88:91]
  v_mfma_f32_16x16x32_bf16 v[92:95], v[56:59], v[20:23], v[92:95]
  v_mfma_f32_16x16x32_bf16 v[96:99], v[48:51], v[24:27], v[96:99]
  v_mfma_f32_16x16x32_bf16 v[100:103], v[52:55], v[24:27], v[100:103]
  v_mfma_f32_16x16x32_bf16 v[104:107], v[56:59], v[24:27], v[104:107]
  v_mfma_f32_16x16x32_bf16 v[108:111], v[48:51], v[28:31], v[108:111]
  v_mfma_f32_16x16x32_bf16 v[112:115], v[52:55], v[28:31], v[112:115]
  v_mfma_f32_16x16x32_bf16 v[116:119], v[56:59], v[28:31], v[116:119]
  s_waitcnt lgkmcnt(0)
  v_mfma_f32_16x16x32_bf16 v[72:75], v[60:63], v[32:35], v[72:75]
  v_mfma_f32_16x16x32_bf16 v[76:79], v[64:67], v[32:35], v[76:79]
  v_mfma_f32_16x16x32_bf16 v[80:83], v[68:71], v[32:35], v[80:83]
  v_mfma_f32_16x16x32_bf16 v[84:87], v[60:63], v[36:39], v[84:87]
  v_mfma_f32_16x16x32_bf16 v[88:91], v[64:67], v[36:39], v[88:91]
  v_mfma_f32_16x16x32_bf16 v[92:95], v[68:71], v[36:39], v[92:95]
  v_mfma_f32_16x16x32_bf16 v[96:99], v[60:63], v[40:43], v[96:99]
  v_mfma_f32_16x16x32_bf16 v[100:103], v[64:67], v[40:43], v[100:103]
  v_mfma_f32_16x16x32_bf16 v[104:107], v[68:71], v[40:43], v[104:107]
  v_mfma_f32_16x16x32_bf16 v[108:111], v[60:63], v[44:47], v[108:111]
  v_mfma_f32_16x16x32_bf16 v[112:115], v[64:67], v[44:47], v[112:115]
  v_mfma_f32_16x16x32_bf16 v[116:119], v[68:71], v[44:47], v[116:119]
  s_waitcnt vmcnt(5)
  s_barrier
  s_add_u32 m0, s43, 81920
  s_nop 0
  buffer_load_dwordx4 v4, s[24:27], s44 offen lds
  s_add_u32 s44, s44, 128
  s_add_u32 m0, s43, 90112
  s_nop 0
  buffer_load_dwordx4 v4, s[24:27], s45 offen lds
  s_add_u32 s45, s45, 128
  s_add_u32 m0, s43, 98304
  s_nop 0
  buffer_load_dwordx4 v5, s[28:31], s46 offen lds
  s_add_u32 s46, s46, 393216
  s_add_u32 m0, s43, 106496
  s_nop 0
  buffer_load_dwordx4 v5, s[28:31], s47 offen lds
  s_add_u32 s47, s47, 393216
  s_add_u32 m0, s43, 114688
  s_nop 0
  buffer_load_dwordx4 v5, s[28:31], s48 offen lds
  s_add_u32 s48, s48, 393216
  ds_read_b128 v[16:19], v128 offset:0
  ds_read_b128 v[20:23], v128 offset:2048
  ds_read_b128 v[24:27], v128 offset:4096
  ds_read_b128 v[28:31], v128 offset:6144
  ds_read_b64_tr_b16 v[48:49], v134 offset:0
  ds_read_b64_tr_b16 v[50:51], v134 offset:512
  ds_read_b64_tr_b16 v[52:53], v135 offset:0
  ds_read_b64_tr_b16 v[54:55], v135 offset:512
  ds_read_b64_tr_b16 v[56:57], v136 offset:0
  ds_read_b64_tr_b16 v[58:59], v136 offset:512
  ds_read_b128 v[32:35], v129 offset:0
  ds_read_b128 v[36:39], v129 offset:2048
  ds_read_b128 v[40:43], v129 offset:4096
  ds_read_b128 v[44:47], v129 offset:6144
  ds_read_b64_tr_b16 v[60:61], v134 offset:4096
  ds_read_b64_tr_b16 v[62:63], v134 offset:4608
  ds_read_b64_tr_b16 v[64:65], v135 offset:4096
  ds_read_b64_tr_b16 v[66:67], v135 offset:4608
  ds_read_b64_tr_b16 v[68:69], v136 offset:4096
  ds_read_b64_tr_b16 v[70:71], v136 offset:4608
  s_waitcnt lgkmcnt(10)
  v_mfma_f32_16x16x32_bf16 v[72:75], v[48:51], v[16:19], v[72:75]
  v_mfma_f32_16x16x32_bf16 v[76:79], v[52:55], v[16:19], v[76:79]
  v_mfma_f32_16x16x32_bf16 v[80:83], v[56:59], v[16:19], v[80:83]
  v_mfma_f32_16x16x32_bf16 v[84:87], v[48:51], v[20:23], v[84:87]
  v_mfma_f32_16x16x32_bf16 v[88:91], v[52:55], v[20:23], v[88:91]
  v_mfma_f32_16x16x32_bf16 v[92:95], v[56:59], v[20:23], v[92:95]
  v_mfma_f32_16x16x32_bf16 v[96:99], v[48:51], v[24:27], v[96:99]
  v_mfma_f32_16x16x32_bf16 v[100:103], v[52:55], v[24:27], v[100:103]
  v_mfma_f32_16x16x32_bf16 v[104:107], v[56:59], v[24:27], v[104:107]
  v_mfma_f32_16x16x32_bf16 v[108:111], v[48:51], v[28:31], v[108:111]
  v_mfma_f32_16x16x32_bf16 v[112:115], v[52:55], v[28:31], v[112:115]
  v_mfma_f32_16x16x32_bf16 v[116:119], v[56:59], v[28:31], v[116:119]
  s_waitcnt lgkmcnt(0)
  v_mfma_f32_16x16x32_bf16 v[72:75], v[60:63], v[32:35], v[72:75]
  v_mfma_f32_16x16x32_bf16 v[76:79], v[64:67], v[32:35], v[76:79]
  v_mfma_f32_16x16x32_bf16 v[80:83], v[68:71], v[32:35], v[80:83]
  v_mfma_f32_16x16x32_bf16 v[84:87], v[60:63], v[36:39], v[84:87]
  v_mfma_f32_16x16x32_bf16 v[88:91], v[64:67], v[36:39], v[88:91]
  v_mfma_f32_16x16x32_bf16 v[92:95], v[68:71], v[36:39], v[92:95]
  v_mfma_f32_16x16x32_bf16 v[96:99], v[60:63], v[40:43], v[96:99]
  v_mfma_f32_16x16x32_bf16 v[100:103], v[64:67], v[40:43], v[100:103]
  v_mfma_f32_16x16x32_bf16 v[104:107], v[68:71], v[40:43], v[104:107]
  v_mfma_f32_16x16x32_bf16 v[108:111], v[60:63], v[44:47], v[108:111]
  v_mfma_f32_16x16x32_bf16 v[112:115], v[64:67], v[44:47], v[112:115]
  v_mfma_f32_16x16x32_bf16 v[116:119], v[68:71], v[44:47], v[116:119]
  s_waitcnt vmcnt(5)
  s_barrier
  s_add_u32 m0, s43, 0
  s_nop 0
  buffer_load_dwordx4 v4, s[24:27], s44 offen lds
  s_add_u32 s44, s44, 128
  s_add_u32 m0, s43, 8192
  s_nop 0
  buffer_load_dwordx4 v4, s[24:27], s45 offen lds
  s_add_u32 s45, s45, 128
  s_add_u32 m0, s43, 16384
  s_nop 0
  buffer_load_dwordx4 v5, s[28:31], s46 offen lds
  s_add_u32 s46, s46, 393216
  s_add_u32 m0, s43, 24576
  s_nop 0
  buffer_load_dwordx4 v5, s[28:31], s47 offen lds
  s_add_u32 s47, s47, 393216
  s_add_u32 m0, s43, 32768
  s_nop 0
  buffer_load_dwordx4 v5, s[28:31], s48 offen lds
  s_add_u32 s48, s48, 393216
  ds_read_b128 v[16:19], v130 offset:0
  ds_read_b128 v[20:23], v130 offset:2048
  ds_read_b128 v[24:27], v130 offset:4096
  ds_read_b128 v[28:31], v130 offset:6144
  ds_read_b64_tr_b16 v[48:49], v137 offset:0
  ds_read_b64_tr_b16 v[50:51], v137 offset:512
  ds_read_b64_tr_b16 v[52:53], v138 offset:0
  ds_read_b64_tr_b16 v[54:55], v138 offset:512
  ds_read_b64_tr_b16 v[56:57], v139 offset:0
  ds_read_b64_tr_b16 v[58:59], v139 offset:512
  ds_read_b128 v[32:35], v131 offset:0
  ds_read_b128 v[36:39], v131 offset:2048
  ds_read_b128 v[40:43], v131 offset:4096
  ds_read_b128 v[44:47], v131 offset:6144
  ds_read_b64_tr_b16 v[60:61], v137 offset:4096
  ds_read_b64_tr_b16 v[62:63], v137 offset:4608
  ds_read_b64_tr_b16 v[64:65], v138 offset:4096
  ds_read_b64_tr_b16 v[66:67], v138 offset:4608
  ds_read_b64_tr_b16 v[68:69], v139 offset:4096
  ds_read_b64_tr_b16 v[70:71], v139 offset:4608
  s_waitcnt lgkmcnt(10)
  v_mfma_f32_16x16x32_bf16 v[72:75], v[48:51], v[16:19], v[72:75]
  v_mfma_f32_16x16x32_bf16 v[76:79], v[52:55], v[16:19], v[76:79]
  v_mfma_f32_16x16x32_bf16 v[80:83], v[56:59], v[16:19], v[80:83]
  v_mfma_f32_16x16x32_bf16 v[84:87], v[48:51], v[20:23], v[84:87]
  v_mfma_f32_16x16x32_bf16 v[88:91], v[52:55], v[20:23], v[88:91]
  v_mfma_f32_16x16x32_bf16 v[92:95], v[56:59], v[20:23], v[92:95]
  v_mfma_f32_16x16x32_bf16 v[96:99], v[48:51], v[24:27], v[96:99]
  v_mfma_f32_16x16x32_bf16 v[100:103], v[52:55], v[24:27], v[100:103]
  v_mfma_f32_16x16x32_bf16 v[104:107], v[56:59], v[24:27], v[104:107]
  v_mfma_f32_16x16x32_bf16 v[108:111], v[48:51], v[28:31], v[108:111]
  v_mfma_f32_16x16x32_bf16 v[112:115], v[52:55], v[28:31], v[112:115]
  v_mfma_f32_16x16x32_bf16 v[116:119], v[56:59], v[28:31], v[116:119]
  s_waitcnt lgkmcnt(0)
  v_mfma_f32_16x16x32_bf16 v[72:75], v[60:63], v[32:35], v[72:75]
  v_mfma_f32_16x16x32_bf16 v[76:79], v[64:67], v[32:35], v[76:79]
  v_mfma_f32_16x16x32_bf16 v[80:83], v[68:71], v[32:35], v[80:83]
  v_mfma_f32_16x16x32_bf16 v[84:87], v[60:63], v[36:39], v[84:87]
  v_mfma_f32_16x16x32_bf16 v[88:91], v[64:67], v[36:39], v[88:91]
  v_mfma_f32_16x16x32_bf16 v[92:95], v[68:71], v[36:39], v[92:95]
  v_mfma_f32_16x16x32_bf16 v[96:99], v[60:63], v[40:43], v[96:99]
  v_mfma_f32_16x16x32_bf16 v[100:103], v[64:67], v[40:43], v[100:103]
  v_mfma_f32_16x16x32_bf16 v[104:107], v[68:71], v[40:43], v[104:107]
  v_mfma_f32_16x16x32_bf16 v[108:111], v[60:63], v[44:47], v[108:111]
  v_mfma_f32_16x16x32_bf16 v[112:115], v[64:67], v[44:47], v[112:115]
  v_mfma_f32_16x16x32_bf16 v[116:119], v[68:71], v[44:47], v[116:119]
  s_waitcnt vmcnt(5)
  s_barrier
  ds_read_b128 v[16:19], v132 offset:0
  ds_read_b128 v[20:23], v132 offset:2048
  ds_read_b128 v[24:27], v132 offset:4096
  ds_read_b128 v[28:31], v132 offset:6144
  ds_read_b64_tr_b16 v[48:49], v140 offset:0
  ds_read_b64_tr_b16 v[50:51], v140 offset:512
  ds_read_b64_tr_b16 v[52:53], v141 offset:0
  ds_read_b64_tr_b16 v[54:55], v141 offset:512
  ds_read_b64_tr_b16 v[56:57], v142 offset:0
  ds_read_b64_tr_b16 v[58:59], v142 offset:512
  ds_read_b128 v[32:35], v133 offset:0
  ds_read_b128 v[36:39], v133 offset:2048
  ds_read_b128 v[40:43], v133 offset:4096
  ds_read_b128 v[44:47], v133 offset:6144
  ds_read_b64_tr_b16 v[60:61], v140 offset:4096
  ds_read_b64_tr_b16 v[62:63], v140 offset:4608
  ds_read_b64_tr_b16 v[64:65], v141 offset:4096
  ds_read_b64_tr_b16 v[66:67], v141 offset:4608
  ds_read_b64_tr_b16 v[68:69], v142 offset:4096
  ds_read_b64_tr_b16 v[70:71], v142 offset:4608
  s_waitcnt lgkmcnt(10)
  v_mfma_f32_16x16x32_bf16 v[72:75], v[48:51], v[16:19], v[72:75]
  v_mfma_f32_16x16x32_bf16 v[76:79], v[52:55], v[16:19], v[76:79]
  v_mfma_f32_16x16x32_bf16 v[80:83], v[56:59], v[16:19], v[80:83]
  v_mfma_f32_16x16x32_bf16 v[84:87], v[48:51], v[20:23], v[84:87]
  v_mfma_f32_16x16x32_bf16 v[88:91], v[52:55], v[20:23], v[88:91]
  v_mfma_f32_16x16x32_bf16 v[92:95], v[56:59], v[20:23], v[92:95]
  v_mfma_f32_16x16x32_bf16 v[96:99], v[48:51], v[24:27], v[96:99]
  v_mfma_f32_16x16x32_bf16 v[100:103], v[52:55], v[24:27], v[100:103]
  v_mfma_f32_16x16x32_bf16 v[104:107], v[56:59], v[24:27], v[104:107]
  v_mfma_f32_16x16x32_bf16 v[108:111], v[48:51], v[28:31], v[108:111]
  v_mfma_f32_16x16x32_bf16 v[112:115], v[52:55], v[28:31], v[112:115]
  v_mfma_f32_16x16x32_bf16 v[116:119], v[56:59], v[28:31], v[116:119]
  s_waitcnt lgkmcnt(0)
  v_mfma_f32_16x16x32_bf16 v[72:75], v[60:63], v[32:35], v[72:75]
  v_mfma_f32_16x16x32_bf16 v[76:79], v[64:67], v[32:35], v[76:79]
  v_mfma_f32_16x16x32_bf16 v[80:83], v[68:71], v[32:35], v[80:83]
  v_mfma_f32_16x16x32_bf16 v[84:87], v[60:63], v[36:39], v[84:87]
  v_mfma_f32_16x16x32_bf16 v[88:91], v[64:67], v[36:39], v[88:91]
  v_mfma_f32_16x16x32_bf16 v[92:95], v[68:71], v[36:39], v[92:95]
  v_mfma_f32_16x16x32_bf16 v[96:99], v[60:63], v[40:43], v[96:99]
  v_mfma_f32_16x16x32_bf16 v[100:103], v[64:67], v[40:43], v[100:103]
  v_mfma_f32_16x16x32_bf16 v[104:107], v[68:71], v[40:43], v[104:107]
  v_mfma_f32_16x16x32_bf16 v[108:111], v[60:63], v[44:47], v[108:111]
  v_mfma_f32_16x16x32_bf16 v[112:115], v[64:67], v[44:47], v[112:115]
  v_mfma_f32_16x16x32_bf16 v[116:119], v[68:71], v[44:47], v[116:119]
  s_waitcnt vmcnt(0)
  s_barrier
  ds_read_b128 v[16:19], v128 offset:0
  ds_read_b128 v[20:23], v128 offset:2048
  ds_read_b128 v[24:27], v128 offset:4096
  ds_read_b128 v[28:31], v128 offset:6144
  ds_read_b64_tr_b16 v[48:49], v134 offset:0
  ds_read_b64_tr_b16 v[50:51], v134 offset:512
  ds_read_b64_tr_b16 v[52:53], v135 offset:0
  ds_read_b64_tr_b16 v[54:55], v135 offset:512
  ds_read_b64_tr_b16 v[56:57], v136 offset:0
  ds_read_b64_tr_b16 v[58:59], v136 offset:512
  ds_read_b128 v[32:35], v129 offset:0
  ds_read_b128 v[36:39], v129 offset:2048
  ds_read_b128 v[40:43], v129 offset:4096
  ds_read_b128 v[44:47], v129 offset:6144
  ds_read_b64_tr_b16 v[60:61], v134 offset:4096
  ds_read_b64_tr_b16 v[62:63], v134 offset:4608
  ds_read_b64_tr_b16 v[64:65], v135 offset:4096
  ds_read_b64_tr_b16 v[66:67], v135 offset:4608
  ds_read_b64_tr_b16 v[68:69], v136 offset:4096
  ds_read_b64_tr_b16 v[70:71], v136 offset:4608
  s_waitcnt lgkmcnt(10)
  v_mfma_f32_16x16x32_bf16 v[72:75], v[48:51], v[16:19], v[72:75]
  v_mfma_f32_16x16x32_bf16 v[76:79], v[52:55], v[16:19], v[76:79]
  v_mfma_f32_16x16x32_bf16 v[80:83], v[56:59], v[16:19], v[80:83]
  v_mfma_f32_16x16x32_bf16 v[84:87], v[48:51], v[20:23], v[84:87]
  v_mfma_f32_16x16x32_bf16 v[88:91], v[52:55], v[20:23], v[88:91]
  v_mfma_f32_16x16x32_bf16 v[92:95], v[56:59], v[20:23], v[92:95]
  v_mfma_f32_16x16x32_bf16 v[96:99], v[48:51], v[24:27], v[96:99]
  v_mfma_f32_16x16x32_bf16 v[100:103], v[52:55], v[24:27], v[100:103]
  v_mfma_f32_16x16x32_bf16 v[104:107], v[56:59], v[24:27], v[104:107]
  v_mfma_f32_16x16x32_bf16 v[108:111], v[48:51], v[28:31], v[108:111]
  v_mfma_f32_16x16x32_bf16 v[112:115], v[52:55], v[28:31], v[112:115]
  v_mfma_f32_16x16x32_bf16 v[116:119], v[56:59], v[28:31], v[116:119]
  s_waitcnt lgkmcnt(0)
  v_mfma_f32_16x16x32_bf16 v[72:75], v[60:63], v[32:35], v[72:75]
  v_mfma_f32_16x16x32_bf16 v[76:79], v[64:67], v[32:35], v[76:79]
  v_mfma_f32_16x16x32_bf16 v[80:83], v[68:71], v[32:35], v[80:83]
  v_mfma_f32_16x16x32_bf16 v[84:87], v[60:63], v[36:39], v[84:87]
  v_mfma_f32_16x16x32_bf16 v[88:91], v[64:67], v[36:39], v[88:91]
  v_mfma_f32_16x16x32_bf16 v[92:95], v[68:71], v[36:39], v[92:95]
  v_mfma_f32_16x16x32_bf16 v[96:99], v[60:63], v[40:43], v[96:99]
  v_mfma_f32_16x16x32_bf16 v[100:103], v[64:67], v[40:43], v[100:103]
  v_mfma_f32_16x16x32_bf16 v[104:107], v[68:71], v[40:43], v[104:107]
  v_mfma_f32_16x16x32_bf16 v[108:111], v[60:63], v[44:47], v[108:111]
  v_mfma_f32_16x16x32_bf16 v[112:115], v[64:67], v[44:47], v[112:115]
  v_mfma_f32_16x16x32_bf16 v[116:119], v[68:71], v[44:47], v[116:119]
  s_nop 7
  s_nop 7
  v_cvt_pk_bf16_f32 v72, v72, v73
  v_cvt_pk_bf16_f32 v73, v74, v75
  buffer_store_dwordx2 v[72:73], v13, s[32:35], 0 offen offset:0
  v_cvt_pk_bf16_f32 v76, v76, v77
  v_cvt_pk_bf16_f32 v77, v78, v79
  buffer_store_dwordx2 v[76:77], v13, s[32:35], 0 offen offset:32
  v_cvt_pk_bf16_f32 v80, v80, v81
  v_cvt_pk_bf16_f32 v81, v82, v83
  buffer_store_dwordx2 v[80:81], v13, s[32:35], 0 offen offset:64
  v_add_u32 v13, 98304, v13
  v_cvt_pk_bf16_f32 v84, v84, v85
  v_cvt_pk_bf16_f32 v85, v86, v87
  buffer_store_dwordx2 v[84:85], v13, s[32:35], 0 offen offset:0
  v_cvt_pk_bf16_f32 v88, v88, v89
  v_cvt_pk_bf16_f32 v89, v90, v91
  buffer_store_dwordx2 v[88:89], v13, s[32:35], 0 offen offset:32
  v_cvt_pk_bf16_f32 v92, v92, v93
  v_cvt_pk_bf16_f32 v93, v94, v95
  buffer_store_dwordx2 v[92:93], v13, s[32:35], 0 offen offset:64
  v_add_u32 v13, 98304, v13
  v_cvt_pk_bf16_f32 v96, v96, v97
  v_cvt_pk_bf16_f32 v97, v98, v99
  buffer_store_dwordx2 v[96:97], v13, s[32:35], 0 offen offset:0
  v_cvt_pk_bf16_f32 v100, v100, v101
  v_cvt_pk_bf16_f32 v101, v102, v103
  buffer_store_dwordx2 v[100:101], v13, s[32:35], 0 offen offset:32
  v_cvt_pk_bf16_f32 v104, v104, v105
  v_cvt_pk_bf16_f32 v105, v106, v107
  buffer_store_dwordx2 v[104:105], v13, s[32:35], 0 offen offset:64
  v_add_u32 v13, 98304, v13
  v_cvt_pk_bf16_f32 v108, v108, v109
  v_cvt_pk_bf16_f32 v109, v110, v111
  buffer_store_dwordx2 v[108:109], v13, s[32:35], 0 offen offset:0
  v_cvt_pk_bf16_f32 v112, v112, v113
  v_cvt_pk_bf16_f32 v113, v114, v115
  buffer_store_dwordx2 v[112:113], v13, s[32:35], 0 offen offset:32
  v_cvt_pk_bf16_f32 v116, v116, v117
  v_cvt_pk_bf16_f32 v117, v118, v119
  buffer_store_dwordx2 v[116:117], v13, s[32:35], 0 offen offset:64
L_gemmq3_kernel_end:
  s_endpgm
.globl slide3_kernel
.p2align 8
.type slide3_kernel,@function
slide3_kernel:
  s_cmp_ge_u32 s2, 256
  s_cbranch_scc1 L_slide3_kernel_end
  s_load_dwordx16 s[4:19], s[0:1], 0
  s_load_dwordx2 s[20:21], s[0:1], 64
  s_waitcnt lgkmcnt(0)
  s_add_u32 s24, s20, 4194304
  s_addc_u32 s25, s21, 0
  s_and_b32 s25, s25, 0xffff
  s_mov_b32 s26, 12582912
  s_mov_b32 s27, 0x00020000
  s_add_u32 s32, s20, 16777216
  s_addc_u32 s33, s21, 0
  s_and_b32 s33, s33, 0xffff
  s_mov_b32 s34, 4194304
  s_mov_b32 s35, 0x00020000
  s_lshr_b32 s40, s2, 3
  v_and_b32 v1, 63, v0
  v_lshrrev_b32 v2, 6, v0
  s_nop 0
  v_readfirstlane_b32 s41, v2
  s_and_b32 s3, s2, 7
  s_lshl_b32 s3, s3, 2
  s_add_u32 s41, s41, s3
  s_lshl_b32 s41, s41, 6
  s_lshl_b32 s43, s40, 6
  v_and_b32 v3, 15, v1
  v_lshrrev_b32 v4, 4, v1
  v_mul_u32_u24 v5, 6144, v3
  v_lshl_add_u32 v5, v4, 4, v5
  v_lshrrev_b32 v6, 2, v1
  v_and_b32 v7, 3, v1
  v_mul_u32_u24 v8, 6144, v6
  v_lshl_add_u32 v8, v7, 4, v8
  v_lshlrev_b32 v9, 6, v6
  v_lshl_add_u32 v9, v7, 4, v9
  v_lshl_add_u32 v9, v2, 11, v9
  v_lshlrev_b32 v10, 2, v4
  v_bfe_u32 v11, v1, 2, 2
  v_add_u32 v10, v10, v11
  v_lshlrev_b32 v10, 6, v10
  v_lshl_add_u32 v10, v7, 3, v10
  v_lshl_add_u32 v10, v2, 11, v10
  v_lshlrev_b32 v12, 2, v4
  v_sub_u32 v12, v3, v12
  s_mul_i32 s44, s41, 6144
  s_add_u32 s44, s44, s43
  buffer_load_dwordx4 v[16:19], v5, s[24:27], s44 offen
  s_add_u32 s44, s44, 98304
  buffer_load_dwordx4 v[20:23], v5, s[24:27], s44 offen
  s_add_u32 s44, s44, 98304
  buffer_load_dwordx4 v[24:27], v5, s[24:27], s44 offen
  s_add_u32 s44, s44, 98304
  buffer_load_dwordx4 v[28:31], v5, s[24:27], s44 offen
  s_add_u32 s44, s44, 98304
  v_mov_b32 v104, 0
  v_mov_b32 v105, 0
  v_mov_b32 v106, 0
  v_mov_b32 v107, 0
  v_mov_b32 v108, 0
  v_mov_b32 v109, 0
  v_mov_b32 v110, 0
  v_mov_b32 v111, 0
  v_mov_b32 v112, 0
  v_mov_b32 v113, 0
  v_mov_b32 v114, 0
  v_mov_b32 v115, 0
  v_mov_b32 v116, 0
  v_mov_b32 v117, 0
  v_mov_b32 v118, 0
  v_mov_b32 v119, 0
  v_mov_b32 v120, 0
  v_mov_b32 v121, 0
  v_mov_b32 v122, 0
  v_mov_b32 v123, 0
  v_mov_b32 v124, 0
  v_mov_b32 v125, 0
  v_mov_b32 v126, 0
  v_mov_b32 v127, 0
  v_mov_b32 v128, 0
  v_mov_b32 v129, 0
  v_mov_b32 v130, 0
  v_mov_b32 v131, 0
  v_mov_b32 v132, 0
  v_mov_b32 v133, 0
  v_mov_b32 v134, 0
  v_mov_b32 v135, 0
  v_mov_b32 v136, 0xff7fffff
  v_mov_b32 v140, 0
  v_mov_b32 v137, 0xff7fffff
  v_mov_b32 v141, 0
  v_mov_b32 v138, 0xff7fffff
  v_mov_b32 v142, 0
  v_mov_b32 v139, 0xff7fffff
  v_mov_b32 v143, 0
  s_sub_u32 s42, s41, 256
  s_max_i32 s42, s42, 0
  s_add_u32 s45, s41, 64
  s_mul_i32 s44, s42, 6144
  s_add_u32 s44, s44, s43
  s_add_u32 s46, s44, 2048
  buffer_load_dwordx4 v[32:35], v5, s[24:27], s46 offen
  s_add_u32 s46, s44, 100352
  buffer_load_dwordx4 v[36:39], v5, s[24:27], s46 offen
  s_add_u32 s46, s44, 4096
  buffer_load_dwordx4 v[40:43], v8, s[24:27], s46 offen
  s_add_u32 s46, s44, 102400
  buffer_load_dwordx4 v[44:47], v8, s[24:27], s46 offen
L_slide3_kernel_loop:
  s_sub_u32 s47, s41, s42
  v_add_u32 v13, s47, v12
  s_waitcnt vmcnt(0)
  ds_write_b128 v9, v[40:43]
  ds_write_b128 v9, v[44:47] offset:1024
  v_mfma_f32_16x16x32_bf16 v[48:51], v[32:35], v[16:19], 0
  v_mfma_f32_16x16x32_bf16 v[52:55], v[32:35], v[20:23], 0
  v_mfma_f32_16x16x32_bf16 v[56:59], v[32:35], v[24:27], 0
  v_mfma_f32_16x16x32_bf16 v[60:63], v[32:35], v[28:31], 0
  v_mfma_f32_16x16x32_bf16 v[64:67], v[36:39], v[16:19], 0
  v_mfma_f32_16x16x32_bf16 v[68:71], v[36:39], v[20:23], 0
  v_mfma_f32_16x16x32_bf16 v[72:75], v[36:39], v[24:27], 0
  v_mfma_f32_16x16x32_bf16 v[76:79], v[36:39], v[28:31], 0
  s_waitcnt lgkmcnt(0)
  ds_read_b64_tr_b16 v[96:97], v10 offset:0
  ds_read_b64_tr_b16 v[98:99], v10 offset:1024
  ds_read_b64_tr_b16 v[100:101], v10 offset:32
  ds_read_b64_tr_b16 v[102:103], v10 offset:1056
  s_mul_i32 s44, s42, 6144
  s_add_u32 s44, s44, 196608
  s_add_u32 s44, s44, s43
  s_add_u32 s46, s44, 2048
  buffer_load_dwordx4 v[32:35], v5, s[24:27], s46 offen
  s_add_u32 s46, s44, 100352
  buffer_load_dwordx4 v[36:39], v5, s[24:27], s46 offen
  s_add_u32 s46, s44, 4096
  buffer_load_dwordx4 v[40:43], v8, s[24:27], s46 offen
  s_add_u32 s46, s44, 102400
  buffer_load_dwordx4 v[44:47], v8, s[24:27], s46 offen
  s_nop 7
  v_cvt_pk_bf16_f32 v48, v48, v48
  v_and_b32 v48, 0xffff0000, v48
  v_mul_f32 v48, 0x3e3504f3, v48
  v_cvt_pk_bf16_f32 v48, v48, v48
  v_and_b32 v48, 0xffff0000, v48
  v_add_u32 v148, 0, v13
  v_cmp_gt_u32 vcc, 256, v148
  v_mov_b32 v149, 0xce6e6b28
  s_nop 0
  v_cndmask_b32 v48, v149, v48, vcc
  v_cvt_pk_bf16_f32 v49, v49, v49
  v_and_b32 v49, 0xffff0000, v49
  v_mul_f32 v49, 0x3e3504f3, v49
  v_cvt_pk_bf16_f32 v49, v49, v49
  v_and_b32 v49, 0xffff0000, v49
  v_add_u32 v148, 4294967295, v13
  v_cmp_gt_u32 vcc, 256, v148
  v_mov_b32 v149, 0xce6e6b28
  s_nop 0
  v_cndmask_b32 v49, v149, v49, vcc
  v_cvt_pk_bf16_f32 v50, v50, v50
  v_and_b32 v50, 0xffff0000, v50
  v_mul_f32 v50, 0x3e3504f3, v50
  v_cvt_pk_bf16_f32 v50, v50, v50
  v_and_b32 v50, 0xffff0000, v50
  v_add_u32 v148, 4294967294, v13
  v_cmp_gt_u32 vcc, 256, v148
  v_mov_b32 v149, 0xce6e6b28
  s_nop 0
  v_cndmask_b32 v50, v149, v50, vcc
  v_cvt_pk_bf16_f32 v51, v51, v51
  v_and_b32 v51, 0xffff0000, v51
  v_mul_f32 v51, 0x3e3504f3, v51
  v_cvt_pk_bf16_f32 v51, v51, v51
  v_and_b32 v51, 0xffff0000, v51
  v_add_u32 v148, 4294967293, v13
  v_cmp_gt_u32 vcc, 256, v148
  v_mov_b32 v149, 0xce6e6b28
  s_nop 0
  v_cndmask_b32 v51, v149, v51, vcc
  v_cvt_pk_bf16_f32 v64, v64, v64
  v_and_b32 v64, 0xffff0000, v64
  v_mul_f32 v64, 0x3e3504f3, v64
  v_cvt_pk_bf16_f32 v64, v64, v64
  v_and_b32 v64, 0xffff0000, v64
  v_add_u32 v148, 4294967280, v13
  v_cmp_gt_u32 vcc, 256, v148
  v_mov_b32 v149, 0xce6e6b28
  s_nop 0
  v_cndmask_b32 v64, v149, v64, vcc
  v_cvt_pk_bf16_f32 v65, v65, v65
  v_and_b32 v65, 0xffff0000, v65
  v_mul_f32 v65, 0x3e3504f3, v65
  v_cvt_pk_bf16_f32 v65, v65, v65
  v_and_b32 v65, 0xffff0000, v65
  v_add_u32 v148, 4294967279, v13
  v_cmp_gt_u32 vcc, 256, v148
  v_mov_b32 v149, 0xce6e6b28
  s_nop 0
  v_cndmask_b32 v65, v149, v65, vcc
  v_cvt_pk_bf16_f32 v66, v66, v66
  v_and_b32 v66, 0xffff0000, v66
  v_mul_f32 v66, 0x3e3504f3, v66
  v_cvt_pk_bf16_f32 v66, v66, v66
  v_and_b32 v66, 0xffff0000, v66
  v_add_u32 v148, 4294967278, v13
  v_cmp_gt_u32 vcc, 256, v148
  v_mov_b32 v149, 0xce6e6b28
  s_nop 0
  v_cndmask_b32 v66, v149, v66, vcc
  v_cvt_pk_bf16_f32 v67, v67, v67
  v_and_b32 v67, 0xffff0000, v67
  v_mul_f32 v67, 0x3e3504f3, v67
  v_cvt_pk_bf16_f32 v67, v67, v67
  v_and_b32 v67, 0xffff0000, v67
  v_add_u32 v148, 4294967277, v13
  v_cmp_gt_u32 vcc, 256, v148
  v_mov_b32 v149, 0xce6e6b28
  s_nop 0
  v_cndmask_b32 v67, v149, v67, vcc
  v_max_f32 v150, v48, v49
  v_max_f32 v150, v150, v50
  v_max_f32 v150, v150, v51
  v_max_f32 v150, v150, v64
  v_max_f32 v150, v150, v65
  v_max_f32 v150, v150, v66
  v_max_f32 v150, v150, v67
  v_mov_b32 v151, v150
  s_nop 1
  v_permlane32_swap_b32 v150, v151
  s_nop 1
  v_max_f32 v150, v150, v151
  v_mov_b32 v151, v150
  s_nop 1
  v_permlane16_swap_b32 v150, v151
  s_nop 1
  v_max_f32 v150, v150, v151
  v_max_f32 v150, v150, v136
  v_sub_f32 v151, v136, v150
  v_mul_f32 v151, 0x3fb8aa3b, v151
  v_exp_f32 v151, v151
  v_mov_b32 v136, v150
  v_mul_f32 v152, v140, v151
  v_sub_f32 v48, v48, v150
  v_mul_f32 v48, 0x3fb8aa3b, v48
  v_exp_f32 v48, v48
  s_nop 0
  v_add_f32 v152, v152, v48
  v_sub_f32 v49, v49, v150
  v_mul_f32 v49, 0x3fb8aa3b, v49
  v_exp_f32 v49, v49
  s_nop 0
  v_add_f32 v152, v152, v49
  v_sub_f32 v50, v50, v150
  v_mul_f32 v50, 0x3fb8aa3b, v50
  v_exp_f32 v50, v50
  s_nop 0
  v_add_f32 v152, v152, v50
  v_sub_f32 v51, v51, v150
  v_mul_f32 v51, 0x3fb8aa3b, v51
  v_exp_f32 v51, v51
  s_nop 0
  v_add_f32 v152, v152, v51
  v_sub_f32 v64, v64, v150
  v_mul_f32 v64, 0x3fb8aa3b, v64
  v_exp_f32 v64, v64
  s_nop 0
  v_add_f32 v152, v152, v64
  v_sub_f32 v65, v65, v150
  v_mul_f32 v65, 0x3fb8aa3b, v65
  v_exp_f32 v65, v65
  s_nop 0
  v_add_f32 v152, v152, v65
  v_sub_f32 v66, v66, v150
  v_mul_f32 v66, 0x3fb8aa3b, v66
  v_exp_f32 v66, v66
  s_nop 0
  v_add_f32 v152, v152, v66
  v_sub_f32 v67, v67, v150
  v_mul_f32 v67, 0x3fb8aa3b, v67
  v_exp_f32 v67, v67
  s_nop 0
  v_add_f32 v152, v152, v67
  v_mov_b32 v140, v152
  v_cvt_pk_bf16_f32 v80, v48, v49
  v_cvt_pk_bf16_f32 v81, v50, v51
  v_cvt_pk_bf16_f32 v82, v64, v65
  v_cvt_pk_bf16_f32 v83, v66, v67
  v_mul_f32 v104, v104, v151
  v_mul_f32 v105, v105, v151
  v_mul_f32 v106, v106, v151
  v_mul_f32 v107, v107, v151
  v_mul_f32 v120, v120, v151
  v_mul_f32 v121, v121, v151
  v_mul_f32 v122, v122, v151
  v_mul_f32 v123, v123, v151
  v_cvt_pk_bf16_f32 v52, v52, v52
  v_and_b32 v52, 0xffff0000, v52
  v_mul_f32 v52, 0x3e3504f3, v52
  v_cvt_pk_bf16_f32 v52, v52, v52
  v_and_b32 v52, 0xffff0000, v52
  v_add_u32 v148, 16, v13
  v_cmp_gt_u32 vcc, 256, v148
  v_mov_b32 v149, 0xce6e6b28
  s_nop 0
  v_cndmask_b32 v52, v149, v52, vcc
  v_cvt_pk_bf16_f32 v53, v53, v53
  v_and_b32 v53, 0xffff0000, v53
  v_mul_f32 v53, 0x3e3504f3, v53
  v_cvt_pk_bf16_f32 v53, v53, v53
  v_and_b32 v53, 0xffff0000, v53
  v_add_u32 v148, 15, v13
  v_cmp_gt_u32 vcc, 256, v148
  v_mov_b32 v149, 0xce6e6b28
  s_nop 0
  v_cndmask_b32 v53, v149, v53, vcc
  v_cvt_pk_bf16_f32 v54, v54, v54
  v_and_b32 v54, 0xffff0000, v54
  v_mul_f32 v54, 0x3e3504f3, v54
  v_cvt_pk_bf16_f32 v54, v54, v54
  v_and_b32 v54, 0xffff0000, v54
  v_add_u32 v148, 14, v13
  v_cmp_gt_u32 vcc, 256, v148
  v_mov_b32 v149, 0xce6e6b28
  s_nop 0
  v_cndmask_b32 v54, v149, v54, vcc
  v_cvt_pk_bf16_f32 v55, v55, v55
  v_and_b32 v55, 0xffff0000, v55
  v_mul_f32 v55, 0x3e3504f3, v55
  v_cvt_pk_bf16_f32 v55, v55, v55
  v_and_b32 v55, 0xffff0000, v55
  v_add_u32 v148, 13, v13
  v_cmp_gt_u32 vcc, 256, v148
  v_mov_b32 v149, 0xce6e6b28
  s_nop 0
  v_cndmask_b32 v55, v149, v55, vcc
  v_cvt_pk_bf16_f32 v68, v68, v68
  v_and_b32 v68, 0xffff0000, v68
  v_mul_f32 v68, 0x3e3504f3, v68
  v_cvt_pk_bf16_f32 v68, v68, v68
  v_and_b32 v68, 0xffff0000, v68
  v_add_u32 v148, 0, v13
  v_cmp_gt_u32 vcc, 256, v148
  v_mov_b32 v149, 0xce6e6b28
  s_nop 0
  v_cndmask_b32 v68, v149, v68, vcc
  v_cvt_pk_bf16_f32 v69, v69, v69
  v_and_b32 v69, 0xffff0000, v69
  v_mul_f32 v69, 0x3e3504f3, v69
  v_cvt_pk_bf16_f32 v69, v69, v69
  v_and_b32 v69, 0xffff0000, v69
  v_add_u32 v148, 4294967295, v13
  v_cmp_gt_u32 vcc, 256, v148
  v_mov_b32 v149, 0xce6e6b28
  s_nop 0
  v_cndmask_b32 v69, v149, v69, vcc
  v_cvt_pk_bf16_f32 v70, v70, v70
  v_and_b32 v70, 0xffff0000, v70
  v_mul_f32 v70, 0x3e3504f3, v70
  v_cvt_pk_bf16_f32 v70, v70, v70
  v_and_b32 v70, 0xffff0000, v70
  v_add_u32 v148, 4294967294, v13
  v_cmp_gt_u32 vcc, 256, v148
  v_mov_b32 v149, 0xce6e6b28
  s_nop 0
  v_cndmask_b32 v70, v149, v70, vcc
  v_cvt_pk_bf16_f32 v71, v71, v71
  v_and_b32 v71, 0xffff0000, v71
  v_mul_f32 v71, 0x3e3504f3, v71
  v_cvt_pk_bf16_f32 v71, v71, v71
  v_and_b32 v71, 0xffff0000, v71
  v_add_u32 v148, 4294967293, v13
  v_cmp_gt_u32 vcc, 256, v148
  v_mov_b32 v149, 0xce6e6b28
  s_nop 0
  v_cndmask_b32 v71, v149, v71, vcc
  v_max_f32 v150, v52, v53
  v_max_f32 v150, v150, v54
  v_max_f32 v150, v150, v55
  v_max_f32 v150, v150, v68
  v_max_f32 v150, v150, v69
  v_max_f32 v150, v150, v70
  v_max_f32 v150, v150, v71
  v_mov_b32 v151, v150
  s_nop 1
  v_permlane32_swap_b32 v150, v151
  s_nop 1
  v_max_f32 v150, v150, v151
  v_mov_b32 v151, v150
  s_nop 1
  v_permlane16_swap_b32 v150, v151
  s_nop 1
  v_max_f32 v150, v150, v151
  v_max_f32 v150, v150, v137
  v_sub_f32 v151, v137, v150
  v_mul_f32 v151, 0x3fb8aa3b, v151
  v_exp_f32 v151, v151
  v_mov_b32 v137, v150
  v_mul_f32 v152, v141, v151
  v_sub_f32 v52, v52, v150
  v_mul_f32 v52, 0x3fb8aa3b, v52
  v_exp_f32 v52, v52
  s_nop 0
  v_add_f32 v152, v152, v52
  v_sub_f32 v53, v53, v150
  v_mul_f32 v53, 0x3fb8aa3b, v53
  v_exp_f32 v53, v53
  s_nop 0
  v_add_f32 v152, v152, v53
  v_sub_f32 v54, v54, v150
  v_mul_f32 v54, 0x3fb8aa3b, v54
  v_exp_f32 v54, v54
  s_nop 0
  v_add_f32 v152, v152, v54
  v_sub_f32 v55, v55, v150
  v_mul_f32 v55, 0x3fb8aa3b, v55
  v_exp_f32 v55, v55
  s_nop 0
  v_add_f32 v152, v152, v55
  v_sub_f32 v68, v68, v150
  v_mul_f32 v68, 0x3fb8aa3b, v68
  v_exp_f32 v68, v68
  s_nop 0
  v_add_f32 v152, v152, v68
  v_sub_f32 v69, v69, v150
  v_mul_f32 v69, 0x3fb8aa3b, v69
  v_exp_f32 v69, v69
  s_nop 0
  v_add_f32 v152, v152, v69
  v_sub_f32 v70, v70, v150
  v_mul_f32 v70, 0x3fb8aa3b, v70
  v_exp_f32 v70, v70
  s_nop 0
  v_add_f32 v152, v152, v70
  v_sub_f32 v71, v71, v150
  v_mul_f32 v71, 0x3fb8aa3b, v71
  v_exp_f32 v71, v71
  s_nop 0
  v_add_f32 v152, v152, v71
  v_mov_b32 v141, v152
  v_cvt_pk_bf16_f32 v84, v52, v53
  v_cvt_pk_bf16_f32 v85, v54, v55
  v_cvt_pk_bf16_f32 v86, v68, v69
  v_cvt_pk_bf16_f32 v87, v70, v71
  v_mul_f32 v108, v108, v151
  v_mul_f32 v109, v109, v151
  v_mul_f32 v110, v110, v151
  v_mul_f32 v111, v111, v151
  v_mul_f32 v124, v124, v151
  v_mul_f32 v125, v125, v151
  v_mul_f32 v126, v126, v151
  v_mul_f32 v127, v127, v151
  v_cvt_pk_bf16_f32 v56, v56, v56
  v_and_b32 v56, 0xffff0000, v56
  v_mul_f32 v56, 0x3e3504f3, v56
  v_cvt_pk_bf16_f32 v56, v56, v56
  v_and_b32 v56, 0xffff0000, v56
  v_add_u32 v148, 32, v13
  v_cmp_gt_u32 vcc, 256, v148
  v_mov_b32 v149, 0xce6e6b28
  s_nop 0
  v_cndmask_b32 v56, v149, v56, vcc
  v_cvt_pk_bf16_f32 v57, v57, v57
  v_and_b32 v57, 0xffff0000, v57
  v_mul_f32 v57, 0x3e3504f3, v57
  v_cvt_pk_bf16_f32 v57, v57, v57
  v_and_b32 v57, 0xffff0000, v57
  v_add_u32 v148, 31, v13
  v_cmp_gt_u32 vcc, 256, v148
  v_mov_b32 v149, 0xce6e6b28
  s_nop 0
  v_cndmask_b32 v57, v149, v57, vcc
  v_cvt_pk_bf16_f32 v58, v58, v58
  v_and_b32 v58, 0xffff0000, v58
  v_mul_f32 v58, 0x3e3504f3, v58
  v_cvt_pk_bf16_f32 v58, v58, v58
  v_and_b32 v58, 0xffff0000, v58
  v_add_u32 v148, 30, v13
  v_cmp_gt_u32 vcc, 256, v148
  v_mov_b32 v149, 0xce6e6b28
  s_nop 0
  v_cndmask_b32 v58, v149, v58, vcc
  v_cvt_pk_bf16_f32 v59, v59, v59
  v_and_b32 v59, 0xffff0000, v59
  v_mul_f32 v59, 0x3e3504f3, v59
  v_cvt_pk_bf16_f32 v59, v59, v59
  v_and_b32 v59, 0xffff0000, v59
  v_add_u32 v148, 29, v13
  v_cmp_gt_u32 vcc, 256, v148
  v_mov_b32 v149, 0xce6e6b28
  s_nop 0
  v_cndmask_b32 v59, v149, v59, vcc
  v_cvt_pk_bf16_f32 v72, v72, v72
  v_and_b32 v72, 0xffff0000, v72
  v_mul_f32 v72, 0x3e3504f3, v72
  v_cvt_pk_bf16_f32 v72, v72, v72
  v_and_b32 v72, 0xffff0000, v72
  v_add_u32 v148, 16, v13
  v_cmp_gt_u32 vcc, 256, v148
  v_mov_b32 v149, 0xce6e6b28
  s_nop 0
  v_cndmask_b32 v72, v149, v72, vcc
  v_cvt_pk_bf16_f32 v73, v73, v73
  v_and_b32 v73, 0xffff0000, v73
  v_mul_f32 v73, 0x3e3504f3, v73
  v_cvt_pk_bf16_f32 v73, v73, v73
  v_and_b32 v73, 0xffff0000, v73
  v_add_u32 v148, 15, v13
  v_cmp_gt_u32 vcc, 256, v148
  v_mov_b32 v149, 0xce6e6b28
  s_nop 0
  v_cndmask_b32 v73, v149, v73, vcc
  v_cvt_pk_bf16_f32 v74, v74, v74
  v_and_b32 v74, 0xffff0000, v74
  v_mul_f32 v74, 0x3e3504f3, v74
  v_cvt_pk_bf16_f32 v74, v74, v74
  v_and_b32 v74, 0xffff0000, v74
  v_add_u32 v148, 14, v13
  v_cmp_gt_u32 vcc, 256, v148
  v_mov_b32 v149, 0xce6e6b28
  s_nop 0
  v_cndmask_b32 v74, v149, v74, vcc
  v_cvt_pk_bf16_f32 v75, v75, v75
  v_and_b32 v75, 0xffff0000, v75
  v_mul_f32 v75, 0x3e3504f3, v75
  v_cvt_pk_bf16_f32 v75, v75, v75
  v_and_b32 v75, 0xffff0000, v75
  v_add_u32 v148, 13, v13
  v_cmp_gt_u32 vcc, 256, v148
  v_mov_b32 v149, 0xce6e6b28
  s_nop 0
  v_cndmask_b32 v75, v149, v75, vcc
  v_max_f32 v150, v56, v57
  v_max_f32 v150, v150, v58
  v_max_f32 v150, v150, v59
  v_max_f32 v150, v150, v72
  v_max_f32 v150, v150, v73
  v_max_f32 v150, v150, v74
  v_max_f32 v150, v150, v75
  v_mov_b32 v151, v150
  s_nop 1
  v_permlane32_swap_b32 v150, v151
  s_nop 1
  v_max_f32 v150, v150, v151
  v_mov_b32 v151, v150
  s_nop 1
  v_permlane16_swap_b32 v150, v151
  s_nop 1
  v_max_f32 v150, v150, v151
  v_max_f32 v150, v150, v138
  v_sub_f32 v151, v138, v150
  v_mul_f32 v151, 0x3fb8aa3b, v151
  v_exp_f32 v151, v151
  v_mov_b32 v138, v150
  v_mul_f32 v152, v142, v151
  v_sub_f32 v56, v56, v150
  v_mul_f32 v56, 0x3fb8aa3b, v56
  v_exp_f32 v56, v56
  s_nop 0
  v_add_f32 v152, v152, v56
  v_sub_f32 v57, v57, v150
  v_mul_f32 v57, 0x3fb8aa3b, v57
  v_exp_f32 v57, v57
  s_nop 0
  v_add_f32 v152, v152, v57
  v_sub_f32 v58, v58, v150
  v_mul_f32 v58, 0x3fb8aa3b, v58
  v_exp_f32 v58, v58
  s_nop 0
  v_add_f32 v152, v152, v58
  v_sub_f32 v59, v59, v150
  v_mul_f32 v59, 0x3fb8aa3b, v59
  v_exp_f32 v59, v59
  s_nop 0
  v_add_f32 v152, v152, v59
  v_sub_f32 v72, v72, v150
  v_mul_f32 v72, 0x3fb8aa3b, v72
  v_exp_f32 v72, v72
  s_nop 0
  v_add_f32 v152, v152, v72
  v_sub_f32 v73, v73, v150
  v_mul_f32 v73, 0x3fb8aa3b, v73
  v_exp_f32 v73, v73
  s_nop 0
  v_add_f32 v152, v152, v73
  v_sub_f32 v74, v74, v150
  v_mul_f32 v74, 0x3fb8aa3b, v74
  v_exp_f32 v74, v74
  s_nop 0
  v_add_f32 v152, v152, v74
  v_sub_f32 v75, v75, v150
  v_mul_f32 v75, 0x3fb8aa3b, v75
  v_exp_f32 v75, v75
  s_nop 0
  v_add_f32 v152, v152, v75
  v_mov_b32 v142, v152
  v_cvt_pk_bf16_f32 v88, v56, v57
  v_cvt_pk_bf16_f32 v89, v58, v59
  v_cvt_pk_bf16_f32 v90, v72, v73
  v_cvt_pk_bf16_f32 v91, v74, v75
  v_mul_f32 v112, v112, v151
  v_mul_f32 v113, v113, v151
  v_mul_f32 v114, v114, v151
  v_mul_f32 v115, v115, v151
  v_mul_f32 v128, v128, v151
  v_mul_f32 v129, v129, v151
  v_mul_f32 v130, v130, v151
  v_mul_f32 v131, v131, v151
  v_cvt_pk_bf16_f32 v60, v60, v60
  v_and_b32 v60, 0xffff0000, v60
  v_mul_f32 v60, 0x3e3504f3, v60
  v_cvt_pk_bf16_f32 v60, v60, v60
  v_and_b32 v60, 0xffff0000, v60
  v_add_u32 v148, 48, v13
  v_cmp_gt_u32 vcc, 256, v148
  v_mov_b32 v149, 0xce6e6b28
  s_nop 0
  v_cndmask_b32 v60, v149, v60, vcc
  v_cvt_pk_bf16_f32 v61, v61, v61
  v_and_b32 v61, 0xffff0000, v61
  v_mul_f32 v61, 0x3e3504f3, v61
  v_cvt_pk_bf16_f32 v61, v61, v61
  v_and_b32 v61, 0xffff0000, v61
  v_add_u32 v148, 47, v13
  v_cmp_gt_u32 vcc, 256, v148
  v_mov_b32 v149, 0xce6e6b28
  s_nop 0
  v_cndmask_b32 v61, v149, v61, vcc
  v_cvt_pk_bf16_f32 v62, v62, v62
  v_and_b32 v62, 0xffff0000, v62
  v_mul_f32 v62, 0x3e3504f3, v62
  v_cvt_pk_bf16_f32 v62, v62, v62
  v_and_b32 v62, 0xffff0000, v62
  v_add_u32 v148, 46, v13
  v_cmp_gt_u32 vcc, 256, v148
  v_mov_b32 v149, 0xce6e6b28
  s_nop 0
  v_cndmask_b32 v62, v149, v62, vcc
  v_cvt_pk_bf16_f32 v63, v63, v63
  v_and_b32 v63, 0xffff0000, v63
  v_mul_f32 v63, 0x3e3504f3, v63
  v_cvt_pk_bf16_f32 v63, v63, v63
  v_and_b32 v63, 0xffff0000, v63
  v_add_u32 v148, 45, v13
  v_cmp_gt_u32 vcc, 256, v148
  v_mov_b32 v149, 0xce6e6b28
  s_nop 0
  v_cndmask_b32 v63, v149, v63, vcc
  v_cvt_pk_bf16_f32 v76, v76, v76
  v_and_b32 v76, 0xffff0000, v76
  v_mul_f32 v76, 0x3e3504f3, v76
  v_cvt_pk_bf16_f32 v76, v76, v76
  v_and_b32 v76, 0xffff0000, v76
  v_add_u32 v148, 32, v13
  v_cmp_gt_u32 vcc, 256, v148
  v_mov_b32 v149, 0xce6e6b28
  s_nop 0
  v_cndmask_b32 v76, v149, v76, vcc
  v_cvt_pk_bf16_f32 v77, v77, v77
  v_and_b32 v77, 0xffff0000, v77
  v_mul_f32 v77, 0x3e3504f3, v77
  v_cvt_pk_bf16_f32 v77, v77, v77
  v_and_b32 v77, 0xffff0000, v77
  v_add_u32 v148, 31, v13
  v_cmp_gt_u32 vcc, 256, v148
  v_mov_b32 v149, 0xce6e6b28
  s_nop 0
  v_cndmask_b32 v77, v149, v77, vcc
  v_cvt_pk_bf16_f32 v78, v78, v78
  v_and_b32 v78, 0xffff0000, v78
  v_mul_f32 v78, 0x3e3504f3, v78
  v_cvt_pk_bf16_f32 v78, v78, v78
  v_and_b32 v78, 0xffff0000, v78
  v_add_u32 v148, 30, v13
  v_cmp_gt_u32 vcc, 256, v148
  v_mov_b32 v149, 0xce6e6b28
  s_nop 0
  v_cndmask_b32 v78, v149, v78, vcc
  v_cvt_pk_bf16_f32 v79, v79, v79
  v_and_b32 v79, 0xffff0000, v79
  v_mul_f32 v79, 0x3e3504f3, v79
  v_cvt_pk_bf16_f32 v79, v79, v79
  v_and_b32 v79, 0xffff0000, v79
  v_add_u32 v148, 29, v13
  v_cmp_gt_u32 vcc, 256, v148
  v_mov_b32 v149, 0xce6e6b28
  s_nop 0
  v_cndmask_b32 v79, v149, v79, vcc
  v_max_f32 v150, v60, v61
  v_max_f32 v150, v150, v62
  v_max_f32 v150, v150, v63
  v_max_f32 v150, v150, v76
  v_max_f32 v150, v150, v77
  v_max_f32 v150, v150, v78
  v_max_f32 v150, v150, v79
  v_mov_b32 v151, v150
  s_nop 1
  v_permlane32_swap_b32 v150, v151
  s_nop 1
  v_max_f32 v150, v150, v151
  v_mov_b32 v151, v150
  s_nop 1
  v_permlane16_swap_b32 v150, v151
  s_nop 1
  v_max_f32 v150, v150, v151
  v_max_f32 v150, v150, v139
  v_sub_f32 v151, v139, v150
  v_mul_f32 v151, 0x3fb8aa3b, v151
  v_exp_f32 v151, v151
  v_mov_b32 v139, v150
  v_mul_f32 v152, v143, v151
  v_sub_f32 v60, v60, v150
  v_mul_f32 v60, 0x3fb8aa3b, v60
  v_exp_f32 v60, v60
  s_nop 0
  v_add_f32 v152, v152, v60
  v_sub_f32 v61, v61, v150
  v_mul_f32 v61, 0x3fb8aa3b, v61
  v_exp_f32 v61, v61
  s_nop 0
  v_add_f32 v152, v152, v61
  v_sub_f32 v62, v62, v150
  v_mul_f32 v62, 0x3fb8aa3b, v62
  v_exp_f32 v62, v62
  s_nop 0
  v_add_f32 v152, v152, v62
  v_sub_f32 v63, v63, v150
  v_mul_f32 v63, 0x3fb8aa3b, v63
  v_exp_f32 v63, v63
  s_nop 0
  v_add_f32 v152, v152, v63
  v_sub_f32 v76, v76, v150
  v_mul_f32 v76, 0x3fb8aa3b, v76
  v_exp_f32 v76, v76
  s_nop 0
  v_add_f32 v152, v152, v76
  v_sub_f32 v77, v77, v150
  v_mul_f32 v77, 0x3fb8aa3b, v77
  v_exp_f32 v77, v77
  s_nop 0
  v_add_f32 v152, v152, v77
  v_sub_f32 v78, v78, v150
  v_mul_f32 v78, 0x3fb8aa3b, v78
  v_exp_f32 v78, v78
  s_nop 0
  v_add_f32 v152, v152, v78
  v_sub_f32 v79, v79, v150
  v_mul_f32 v79, 0x3fb8aa3b, v79
  v_exp_f32 v79, v79
  s_nop 0
  v_add_f32 v152, v152, v79
  v_mov_b32 v143, v152
  v_cvt_pk_bf16_f32 v92, v60, v61
  v_cvt_pk_bf16_f32 v93, v62, v63
  v_cvt_pk_bf16_f32 v94, v76, v77
  v_cvt_pk_bf16_f32 v95, v78, v79
  v_mul_f32 v116, v116, v151
  v_mul_f32 v117, v117, v151
  v_mul_f32 v118, v118, v151
  v_mul_f32 v119, v119, v151
  v_mul_f32 v132, v132, v151
  v_mul_f32 v133, v133, v151
  v_mul_f32 v134, v134, v151
  v_mul_f32 v135, v135, v151
  s_waitcnt lgkmcnt(0)
  s_nop 1
  v_mfma_f32_16x16x32_bf16 v[104:107], v[96:99], v[80:83], v[104:107]
  v_mfma_f32_16x16x32_bf16 v[120:123], v[100:103], v[80:83], v[120:123]
  v_mfma_f32_16x16x32_bf16 v[108:111], v[96:99], v[84:87], v[108:111]
  v_mfma_f32_16x16x32_bf16 v[124:127], v[100:103], v[84:87], v[124:127]
  v_mfma_f32_16x16x32_bf16 v[112:115], v[96:99], v[88:91], v[112:115]
  v_mfma_f32_16x16x32_bf16 v[128:131], v[100:103], v[88:91], v[128:131]
  v_mfma_f32_16x16x32_bf16 v[116:119], v[96:99], v[92:95], v[116:119]
  v_mfma_f32_16x16x32_bf16 v[132:135], v[100:103], v[92:95], v[132:135]
  s_add_u32 s42, s42, 32
  s_cmp_lt_u32 s42, s45
  s_nop 7
  s_cbranch_scc1 L_slide3_kernel_loop
  s_nop 7
  v_add_u32 v14, s41, v3
  v_lshlrev_b32 v14, 11, v14
  v_lshl_add_u32 v14, v4, 3, v14
  v_add_u32 v14, s43, v14
  v_mov_b32 v151, v140
  s_nop 1
  v_permlane32_swap_b32 v140, v151
  s_nop 1
  v_add_f32 v140, v140, v151
  v_mov_b32 v151, v140
  s_nop 1
  v_permlane16_swap_b32 v140, v151
  s_nop 1
  v_add_f32 v140, v140, v151
  v_rcp_f32 v152, v140
  s_nop 0
  v_mul_f32 v153, v104, v152
  v_fma_f32 v154, -v153, v140, v104
  v_fma_f32 v104, v154, v152, v153
  v_mul_f32 v153, v105, v152
  v_fma_f32 v154, -v153, v140, v105
  v_fma_f32 v105, v154, v152, v153
  v_mul_f32 v153, v106, v152
  v_fma_f32 v154, -v153, v140, v106
  v_fma_f32 v106, v154, v152, v153
  v_mul_f32 v153, v107, v152
  v_fma_f32 v154, -v153, v140, v107
  v_fma_f32 v107, v154, v152, v153
  v_cvt_pk_bf16_f32 v104, v104, v105
  v_cvt_pk_bf16_f32 v105, v106, v107
  buffer_store_dwordx2 v[104:105], v14, s[32:35], 0 offen offset:0
  v_mul_f32 v153, v120, v152
  v_fma_f32 v154, -v153, v140, v120
  v_fma_f32 v120, v154, v152, v153
  v_mul_f32 v153, v121, v152
  v_fma_f32 v154, -v153, v140, v121
  v_fma_f32 v121, v154, v152, v153
  v_mul_f32 v153, v122, v152
  v_fma_f32 v154, -v153, v140, v122
  v_fma_f32 v122, v154, v152, v153
  v_mul_f32 v153, v123, v152
  v_fma_f32 v154, -v153, v140, v123
  v_fma_f32 v123, v154, v152, v153
  v_cvt_pk_bf16_f32 v120, v120, v121
  v_cvt_pk_bf16_f32 v121, v122, v123
  buffer_store_dwordx2 v[120:121], v14, s[32:35], 0 offen offset:32
  v_add_u32 v14, 32768, v14
  v_mov_b32 v151, v141
  s_nop 1
  v_permlane32_swap_b32 v141, v151
  s_nop 1
  v_add_f32 v141, v141, v151
  v_mov_b32 v151, v141
  s_nop 1
  v_permlane16_swap_b32 v141, v151
  s_nop 1
  v_add_f32 v141, v141, v151
  v_rcp_f32 v152, v141
  s_nop 0
  v_mul_f32 v153, v108, v152
  v_fma_f32 v154, -v153, v141, v108
  v_fma_f32 v108, v154, v152, v153
  v_mul_f32 v153, v109, v152
  v_fma_f32 v154, -v153, v141, v109
  v_fma_f32 v109, v154, v152, v153
  v_mul_f32 v153, v110, v152
  v_fma_f32 v154, -v153, v141, v110
  v_fma_f32 v110, v154, v152, v153
  v_mul_f32 v153, v111, v152
  v_fma_f32 v154, -v153, v141, v111
  v_fma_f32 v111, v154, v152, v153
  v_cvt_pk_bf16_f32 v108, v108, v109
  v_cvt_pk_bf16_f32 v109, v110, v111
  buffer_store_dwordx2 v[108:109], v14, s[32:35], 0 offen offset:0
  v_mul_f32 v153, v124, v152
  v_fma_f32 v154, -v153, v141, v124
  v_fma_f32 v124, v154, v152, v153
  v_mul_f32 v153, v125, v152
  v_fma_f32 v154, -v153, v141, v125
  v_fma_f32 v125, v154, v152, v153
  v_mul_f32 v153, v126, v152
  v_fma_f32 v154, -v153, v141, v126
  v_fma_f32 v126, v154, v152, v153
  v_mul_f32 v153, v127, v152
  v_fma_f32 v154, -v153, v141, v127
  v_fma_f32 v127, v154, v152, v153
  v_cvt_pk_bf16_f32 v124, v124, v125
  v_cvt_pk_bf16_f32 v125, v126, v127
  buffer_store_dwordx2 v[124:125], v14, s[32:35], 0 offen offset:32
  v_add_u32 v14, 32768, v14
  v_mov_b32 v151, v142
  s_nop 1
  v_permlane32_swap_b32 v142, v151
  s_nop 1
  v_add_f32 v142, v142, v151
  v_mov_b32 v151, v142
  s_nop 1
  v_permlane16_swap_b32 v142, v151
  s_nop 1
  v_add_f32 v142, v142, v151
  v_rcp_f32 v152, v142
  s_nop 0
  v_mul_f32 v153, v112, v152
  v_fma_f32 v154, -v153, v142, v112
  v_fma_f32 v112, v154, v152, v153
  v_mul_f32 v153, v113, v152
  v_fma_f32 v154, -v153, v142, v113
  v_fma_f32 v113, v154, v152, v153
  v_mul_f32 v153, v114, v152
  v_fma_f32 v154, -v153, v142, v114
  v_fma_f32 v114, v154, v152, v153
  v_mul_f32 v153, v115, v152
  v_fma_f32 v154, -v153, v142, v115
  v_fma_f32 v115, v154, v152, v153
  v_cvt_pk_bf16_f32 v112, v112, v113
  v_cvt_pk_bf16_f32 v113, v114, v115
  buffer_store_dwordx2 v[112:113], v14, s[32:35], 0 offen offset:0
  v_mul_f32 v153, v128, v152
  v_fma_f32 v154, -v153, v142, v128
  v_fma_f32 v128, v154, v152, v153
  v_mul_f32 v153, v129, v152
  v_fma_f32 v154, -v153, v142, v129
  v_fma_f32 v129, v154, v152, v153
  v_mul_f32 v153, v130, v152
  v_fma_f32 v154, -v153, v142, v130
  v_fma_f32 v130, v154, v152, v153
  v_mul_f32 v153, v131, v152
  v_fma_f32 v154, -v153, v142, v131
  v_fma_f32 v131, v154, v152, v153
  v_cvt_pk_bf16_f32 v128, v128, v129
  v_cvt_pk_bf16_f32 v129, v130, v131
  buffer_store_dwordx2 v[128:129], v14, s[32:35], 0 offen offset:32
  v_add_u32 v14, 32768, v14
  v_mov_b32 v151, v143
  s_nop 1
  v_permlane32_swap_b32 v143, v151
  s_nop 1
  v_add_f32 v143, v143, v151
  v_mov_b32 v151, v143
  s_nop 1
  v_permlane16_swap_b32 v143, v151
  s_nop 1
  v_add_f32 v143, v143, v151
  v_rcp_f32 v152, v143
  s_nop 0
  v_mul_f32 v153, v116, v152
  v_fma_f32 v154, -v153, v143, v116
  v_fma_f32 v116, v154, v152, v153
  v_mul_f32 v153, v117, v152
  v_fma_f32 v154, -v153, v143, v117
  v_fma_f32 v117, v154, v152, v153
  v_mul_f32 v153, v118, v152
  v_fma_f32 v154, -v153, v143, v118
  v_fma_f32 v118, v154, v152, v153
  v_mul_f32 v153, v119, v152
  v_fma_f32 v154, -v153, v143, v119
  v_fma_f32 v119, v154, v152, v153
  v_cvt_pk_bf16_f32 v116, v116, v117
  v_cvt_pk_bf16_f32 v117, v118, v119
  buffer_store_dwordx2 v[116:117], v14, s[32:35], 0 offen offset:0
  v_mul_f32 v153, v132, v152
  v_fma_f32 v154, -v153, v143, v132
  v_fma_f32 v132, v154, v152, v153
  v_mul_f32 v153, v133, v152
  v_fma_f32 v154, -v153, v143, v133
  v_fma_f32 v133, v154, v152, v153
  v_mul_f32 v153, v134, v152
  v_fma_f32 v154, -v153, v143, v134
  v_fma_f32 v134, v154, v152, v153
  v_mul_f32 v153, v135, v152
  v_fma_f32 v154, -v153, v143, v135
  v_fma_f32 v135, v154, v152, v153
  v_cvt_pk_bf16_f32 v132, v132, v133
  v_cvt_pk_bf16_f32 v133, v134, v135
  buffer_store_dwordx2 v[132:133], v14, s[32:35], 0 offen offset:32
L_slide3_kernel_end:
  s_endpgm
.globl gemmo3_kernel
.p2align 8
.type gemmo3_kernel,@function
gemmo3_kernel:
  s_cmp_ge_u32 s2, 256
  s_cbranch_scc1 L_gemmo3_kernel_end
  s_load_dwordx16 s[4:19], s[0:1], 0
  s_load_dwordx2 s[20:21], s[0:1], 64
  s_waitcnt lgkmcnt(0)
  s_add_u32 s24, s20, 16777216
  s_addc_u32 s25, s21, 0
  s_and_b32 s25, s25, 0xffff
  s_mov_b32 s26, 4194304
  s_mov_b32 s27, 0x00020000
  s_mov_b32 s28, s14
  s_and_b32 s29, s15, 0xffff
  s_mov_b32 s30, 2097152
  s_mov_b32 s31, 0x00020000
  s_mov_b32 s32, s16
  s_and_b32 s33, s17, 0xffff
  s_mov_b32 s34, 4194304
  s_mov_b32 s35, 0x00020000
  s_add_u32 s36, s20, 29360128
  s_addc_u32 s37, s21, 0
  s_and_b32 s37, s37, 0xffff
  s_mov_b32 s38, 4194304
  s_mov_b32 s39, 0x00020000
  s_mov_b32 s3, 268435457
  s_mul_hi_u32 s40, s2, s3
  s_mul_i32 s3, s40, 16
  s_sub_u32 s41, s2, s3
  v_and_b32 v1, 63, v0
  v_lshrrev_b32 v2, 6, v0
  s_nop 0
  v_readfirstlane_b32 s42, v2
  v_lshrrev_b32 v14, 3, v1
  v_and_b32 v15, 7, v1
  v_xor_b32 v3, v14, v15
  v_lshlrev_b32 v4, 11, v14
  v_lshl_add_u32 v4, v3, 4, v4
  v_bfe_u32 v3, v1, 4, 1
  v_and_b32 v5, 1, v2
  v_lshl_add_u32 v3, v5, 1, v3
  v_lshrrev_b32 v5, 1, v15
  v_xor_b32 v3, v3, v5
  v_lshlrev_b32 v3, 1, v3
  v_and_b32 v5, 1, v15
  v_or_b32 v3, v3, v5
  v_lshl_add_u32 v5, v2, 3, v14
  v_mul_u32_u24 v5, 2048, v5
  v_lshl_add_u32 v5, v3, 4, v5
  s_mul_i32 s44, s40, 262144
  s_lshl_b32 s3, s42, 14
  s_add_u32 s44, s44, s3
  s_add_u32 s45, s44, 131072
  s_mul_i32 s46, s41, 128
  s_lshl_b32 s43, s42, 10
  v_and_b32 v6, 1, v2
  v_lshrrev_b32 v7, 1, v2
  v_and_b32 v14, 15, v1
  v_lshrrev_b32 v15, 4, v1
  v_mul_u32_u24 v8, 32, v7
  v_add_u32 v8, v8, v14
  v_lshlrev_b32 v8, 7, v8
  v_and_b32 v3, 7, v1
  v_xor_b32 v3, v3, v15
  v_lshl_add_u32 v9, v3, 4, v8
  v_xor_b32 v3, 4, v3
  v_lshl_add_u32 v8, v3, 4, v8
  v_mov_b32 v3, v9
  v_mov_b32 v9, v8
  v_mov_b32 v8, v3
  v_bfe_u32 v3, v1, 2, 2
  v_lshl_add_u32 v10, v15, 3, v3
  v_lshlrev_b32 v10, 7, v10
  v_and_b32 v11, 3, v1
  v_lshl_add_u32 v10, v11, 3, v10
  v_lshrrev_b32 v3, 1, v3
  v_and_b32 v11, 1, v15
  v_lshl_add_u32 v3, v11, 1, v3
  v_mul_u32_u24 v11, 2, v6
  v_add_u32 v120, 0, v11
  v_and_b32 v121, 3, v120
  v_xor_b32 v121, v121, v3
  v_lshlrev_b32 v121, 5, v121
  v_lshrrev_b32 v120, 2, v120
  v_lshl_add_u32 v121, v120, 13, v121
  v_add_u32 v122, v10, v121
  v_add_u32 v122, 16384, v122
  v_add_u32 v120, 1, v11
  v_and_b32 v121, 3, v120
  v_xor_b32 v121, v121, v3
  v_lshlrev_b32 v121, 5, v121
  v_lshrrev_b32 v120, 2, v120
  v_lshl_add_u32 v121, v120, 13, v121
  v_add_u32 v123, v10, v121
  v_add_u32 v123, 16384, v123
  v_add_u32 v128, 0, v8
  v_add_u32 v129, 0, v9
  v_add_u32 v134, 0, v122
  v_add_u32 v135, 0, v123
  v_add_u32 v130, 24576, v8
  v_add_u32 v131, 24576, v9
  v_add_u32 v136, 24576, v122
  v_add_u32 v137, 24576, v123
  v_add_u32 v132, 49152, v8
  v_add_u32 v133, 49152, v9
  v_add_u32 v138, 49152, v122
  v_add_u32 v139, 49152, v123
  s_mul_i32 s3, s40, 128
  v_mul_u32_u24 v13, 32, v7
  v_add_u32 v13, v13, v14
  v_add_u32 v13, s3, v13
  v_mul_u32_u24 v13, 2048, v13
  s_mul_i32 s3, s41, 128
  v_mul_u32_u24 v3, 64, v6
  v_add_u32 v13, v13, v3
  v_lshl_add_u32 v13, v15, 3, v13
  v_add_u32 v13, s3, v13
  v_mov_b32 v72, 0
  v_mov_b32 v73, 0
  v_mov_b32 v74, 0
  v_mov_b32 v75, 0
  v_mov_b32 v76, 0
  v_mov_b32 v77, 0
  v_mov_b32 v78, 0
  v_mov_b32 v79, 0
  v_mov_b32 v80, 0
  v_mov_b32 v81, 0
  v_mov_b32 v82, 0
  v_mov_b32 v83, 0
  v_mov_b32 v84, 0
  v_mov_b32 v85, 0
  v_mov_b32 v86, 0
  v_mov_b32 v87, 0
  s_add_u32 m0, s43, 0
  s_nop 0
  buffer_load_dwordx4 v4, s[24:27], s44 offen lds
  s_add_u32 s44, s44, 128
  s_add_u32 m0, s43, 8192
  s_nop 0
  buffer_load_dwordx4 v4, s[24:27], s45 offen lds
  s_add_u32 s45, s45, 128
  s_add_u32 m0, s43, 16384
  s_nop 0
  buffer_load_dwordx4 v5, s[28:31], s46 offen lds
  s_add_u32 s46, s46, 131072
  s_add_u32 m0, s43, 24576
  s_nop 0
  buffer_load_dwordx4 v4, s[24:27], s44 offen lds
  s_add_u32 s44, s44, 128
  s_add_u32 m0, s43, 32768
  s_nop 0
  buffer_load_dwordx4 v4, s[24:27], s45 offen lds
  s_add_u32 s45, s45, 128
  s_add_u32 m0, s43, 40960
  s_nop 0
  buffer_load_dwordx4 v5, s[28:31], s46 offen lds
  s_add_u32 s46, s46, 131072
  s_waitcnt vmcnt(3)
  s_barrier
  s_add_u32 m0, s43, 49152
  s_nop 0
  buffer_load_dwordx4 v4, s[24:27], s44 offen lds
  s_add_u32 s44, s44, 128
  s_add_u32 m0, s43, 57344
  s_nop 0
  buffer_load_dwordx4 v4, s[24:27], s45 offen lds
  s_add_u32 s45, s45, 128
  s_add_u32 m0, s43, 65536
  s_nop 0
  buffer_load_dwordx4 v5, s[28:31], s46 offen lds
  s_add_u32 s46, s46, 131072
  ds_read_b128 v[16:19], v128 offset:0
  ds_read_b128 v[20:23], v128 offset:2048
  ds_read_b64_tr_b16 v[48:49], v134 offset:0
  ds_read_b64_tr_b16 v[50:51], v134 offset:512
  ds_read_b64_tr_b16 v[52:53], v135 offset:0
  ds_read_b64_tr_b16 v[54:55], v135 offset:512
  ds_read_b128 v[32:35], v129 offset:0
  ds_read_b128 v[36:39], v129 offset:2048
  ds_read_b64_tr_b16 v[60:61], v134 offset:4096
  ds_read_b64_tr_b16 v[62:63], v134 offset:4608
  ds_read_b64_tr_b16 v[64:65], v135 offset:4096
  ds_read_b64_tr_b16 v[66:67], v135 offset:4608
  s_waitcnt lgkmcnt(6)
  v_mfma_f32_16x16x32_bf16 v[72:75], v[48:51], v[16:19], v[72:75]
  v_mfma_f32_16x16x32_bf16 v[76:79], v[52:55], v[16:19], v[76:79]
  v_mfma_f32_16x16x32_bf16 v[80:83], v[48:51], v[20:23], v[80:83]
  v_mfma_f32_16x16x32_bf16 v[84:87], v[52:55], v[20:23], v[84:87]
  s_waitcnt lgkmcnt(0)
  v_mfma_f32_16x16x32_bf16 v[72:75], v[60:63], v[32:35], v[72:75]
  v_mfma_f32_16x16x32_bf16 v[76:79], v[64:67], v[32:35], v[76:79]
  v_mfma_f32_16x16x32_bf16 v[80:83], v[60:63], v[36:39], v[80:83]
  v_mfma_f32_16x16x32_bf16 v[84:87], v[64:67], v[36:39], v[84:87]
  s_waitcnt vmcnt(3)
  s_barrier
  s_add_u32 m0, s43, 0
  s_nop 0
  buffer_load_dwordx4 v4, s[24:27], s44 offen lds
  s_add_u32 s44, s44, 128
  s_add_u32 m0, s43, 8192
  s_nop 0
  buffer_load_dwordx4 v4, s[24:27], s45 offen lds
  s_add_u32 s45, s45, 128
  s_add_u32 m0, s43, 16384
  s_nop 0
  buffer_load_dwordx4 v5, s[28:31], s46 offen lds
  s_add_u32 s46, s46, 131072
  ds_read_b128 v[16:19], v130 offset:0
  ds_read_b128 v[20:23], v130 offset:2048
  ds_read_b64_tr_b16 v[48:49], v136 offset:0
  ds_read_b64_tr_b16 v[50:51], v136 offset:512
  ds_read_b64_tr_b16 v[52:53], v137 offset:0
  ds_read_b64_tr_b16 v[54:55], v137 offset:512
  ds_read_b128 v[32:35], v131 offset:0
  ds_read_b128 v[36:39], v131 offset:2048
  ds_read_b64_tr_b16 v[60:61], v136 offset:4096
  ds_read_b64_tr_b16 v[62:63], v136 offset:4608
  ds_read_b64_tr_b16 v[64:65], v137 offset:4096
  ds_read_b64_tr_b16 v[66:67], v137 offset:4608
  s_waitcnt lgkmcnt(6)
  v_mfma_f32_16x16x32_bf16 v[72:75], v[48:51], v[16:19], v[72:75]
  v_mfma_f32_16x16x32_bf16 v[76:79], v[52:55], v[16:19], v[76:79]
  v_mfma_f32_16x16x32_bf16 v[80:83], v[48:51], v[20:23], v[80:83]
  v_mfma_f32_16x16x32_bf16 v[84:87], v[52:55], v[20:23], v[84:87]
  s_waitcnt lgkmcnt(0)
  v_mfma_f32_16x16x32_bf16 v[72:75], v[60:63], v[32:35], v[72:75]
  v_mfma_f32_16x16x32_bf16 v[76:79], v[64:67], v[32:35], v[76:79]
  v_mfma_f32_16x16x32_bf16 v[80:83], v[60:63], v[36:39], v[80:83]
  v_mfma_f32_16x16x32_bf16 v[84:87], v[64:67], v[36:39], v[84:87]
  s_waitcnt vmcnt(3)
  s_barrier
  s_add_u32 m0, s43, 24576
  s_nop 0
  buffer_load_dwordx4 v4, s[24:27], s44 offen lds
  s_add_u32 s44, s44, 128
  s_add_u32 m0, s43, 32768
  s_nop 0
  buffer_load_dwordx4 v4, s[24:27], s45 offen lds
  s_add_u32 s45, s45, 128
  s_add_u32 m0, s43, 40960
  s_nop 0
  buffer_load_dwordx4 v5, s[28:31], s46 offen lds
  s_add_u32 s46, s46, 131072
  ds_read_b128 v[16:19], v132 offset:0
  ds_read_b128 v[20:23], v132 offset:2048
  ds_read_b64_tr_b16 v[48:49], v138 offset:0
  ds_read_b64_tr_b16 v[50:51], v138 offset:512
  ds_read_b64_tr_b16 v[52:53], v139 offset:0
  ds_read_b64_tr_b16 v[54:55], v139 offset:512
  ds_read_b128 v[32:35], v133 offset:0
  ds_read_b128 v[36:39], v133 offset:2048
  ds_read_b64_tr_b16 v[60:61], v138 offset:4096
  ds_read_b64_tr_b16 v[62:63], v138 offset:4608
  ds_read_b64_tr_b16 v[64:65], v139 offset:4096
  ds_read_b64_tr_b16 v[66:67], v139 offset:4608
  s_waitcnt lgkmcnt(6)
  v_mfma_f32_16x16x32_bf16 v[72:75], v[48:51], v[16:19], v[72:75]
  v_mfma_f32_16x16x32_bf16 v[76:79], v[52:55], v[16:19], v[76:79]
  v_mfma_f32_16x16x32_bf16 v[80:83], v[48:51], v[20:23], v[80:83]
  v_mfma_f32_16x16x32_bf16 v[84:87], v[52:55], v[20:23], v[84:87]
  s_waitcnt lgkmcnt(0)
  v_mfma_f32_16x16x32_bf16 v[72:75], v[60:63], v[32:35], v[72:75]
  v_mfma_f32_16x16x32_bf16 v[76:79], v[64:67], v[32:35], v[76:79]
  v_mfma_f32_16x16x32_bf16 v[80:83], v[60:63], v[36:39], v[80:83]
  v_mfma_f32_16x16x32_bf16 v[84:87], v[64:67], v[36:39], v[84:87]
  s_waitcnt vmcnt(3)
  s_barrier
  s_add_u32 m0, s43, 49152
  s_nop 0
  buffer_load_dwordx4 v4, s[24:27], s44 offen lds
  s_add_u32 s44, s44, 128
  s_add_u32 m0, s43, 57344
  s_nop 0
  buffer_load_dwordx4 v4, s[24:27], s45 offen lds
  s_add_u32 s45, s45, 128
  s_add_u32 m0, s43, 65536
  s_nop 0
  buffer_load_dwordx4 v5, s[28:31], s46 offen lds
  s_add_u32 s46, s46, 131072
  ds_read_b128 v[16:19], v128 offset:0
  ds_read_b128 v[20:23], v128 offset:2048
  ds_read_b64_tr_b16 v[48:49], v134 offset:0
  ds_read_b64_tr_b16 v[50:51], v134 offset:512
  ds_read_b64_tr_b16 v[52:53], v135 offset:0
  ds_read_b64_tr_b16 v[54:55], v135 offset:512
  ds_read_b128 v[32:35], v129 offset:0
  ds_read_b128 v[36:39], v129 offset:2048
  ds_read_b64_tr_b16 v[60:61], v134 offset:4096
  ds_read_b64_tr_b16 v[62:63], v134 offset:4608
  ds_read_b64_tr_b16 v[64:65], v135 offset:4096
  ds_read_b64_tr_b16 v[66:67], v135 offset:4608
  s_waitcnt lgkmcnt(6)
  v_mfma_f32_16x16x32_bf16 v[72:75], v[48:51], v[16:19], v[72:75]
  v_mfma_f32_16x16x32_bf16 v[76:79], v[52:55], v[16:19], v[76:79]
  v_mfma_f32_16x16x32_bf16 v[80:83], v[48:51], v[20:23], v[80:83]
  v_mfma_f32_16x16x32_bf16 v[84:87], v[52:55], v[20:23], v[84:87]
  s_waitcnt lgkmcnt(0)
  v_mfma_f32_16x16x32_bf16 v[72:75], v[60:63], v[32:35], v[72:75]
  v_mfma_f32_16x16x32_bf16 v[76:79], v[64:67], v[32:35], v[76:79]
  v_mfma_f32_16x16x32_bf16 v[80:83], v[60:63], v[36:39], v[80:83]
  v_mfma_f32_16x16x32_bf16 v[84:87], v[64:67], v[36:39], v[84:87]
  s_waitcnt vmcnt(3)
  s_barrier
  s_add_u32 m0, s43, 0
  s_nop 0
  buffer_load_dwordx4 v4, s[24:27], s44 offen lds
  s_add_u32 s44, s44, 128
  s_add_u32 m0, s43, 8192
  s_nop 0
  buffer_load_dwordx4 v4, s[24:27], s45 offen lds
  s_add_u32 s45, s45, 128
  s_add_u32 m0, s43, 16384
  s_nop 0
  buffer_load_dwordx4 v5, s[28:31], s46 offen lds
  s_add_u32 s46, s46, 131072
  ds_read_b128 v[16:19], v130 offset:0
  ds_read_b128 v[20:23], v130 offset:2048
  ds_read_b64_tr_b16 v[48:49], v136 offset:0
  ds_read_b64_tr_b16 v[50:51], v136 offset:512
  ds_read_b64_tr_b16 v[52:53], v137 offset:0
  ds_read_b64_tr_b16 v[54:55], v137 offset:512
  ds_read_b128 v[32:35], v131 offset:0
  ds_read_b128 v[36:39], v131 offset:2048
  ds_read_b64_tr_b16 v[60:61], v136 offset:4096
  ds_read_b64_tr_b16 v[62:63], v136 offset:4608
  ds_read_b64_tr_b16 v[64:65], v137 offset:4096
  ds_read_b64_tr_b16 v[66:67], v137 offset:4608
  s_waitcnt lgkmcnt(6)
  v_mfma_f32_16x16x32_bf16 v[72:75], v[48:51], v[16:19], v[72:75]
  v_mfma_f32_16x16x32_bf16 v[76:79], v[52:55], v[16:19], v[76:79]
  v_mfma_f32_16x16x32_bf16 v[80:83], v[48:51], v[20:23], v[80:83]
  v_mfma_f32_16x16x32_bf16 v[84:87], v[52:55], v[20:23], v[84:87]
  s_waitcnt lgkmcnt(0)
  v_mfma_f32_16x16x32_bf16 v[72:75], v[60:63], v[32:35], v[72:75]
  v_mfma_f32_16x16x32_bf16 v[76:79], v[64:67], v[32:35], v[76:79]
  v_mfma_f32_16x16x32_bf16 v[80:83], v[60:63], v[36:39], v[80:83]
  v_mfma_f32_16x16x32_bf16 v[84:87], v[64:67], v[36:39], v[84:87]
  s_waitcnt vmcnt(3)
  s_barrier
  s_add_u32 m0, s43, 24576
  s_nop 0
  buffer_load_dwordx4 v4, s[24:27], s44 offen lds
  s_add_u32 s44, s44, 128
  s_add_u32 m0, s43, 32768
  s_nop 0
  buffer_load_dwordx4 v4, s[24:27], s45 offen lds
  s_add_u32 s45, s45, 128
  s_add_u32 m0, s43, 40960
  s_nop 0
  buffer_load_dwordx4 v5, s[28:31], s46 offen lds
  s_add_u32 s46, s46, 131072
  ds_read_b128 v[16:19], v132 offset:0
  ds_read_b128 v[20:23], v132 offset:2048
  ds_read_b64_tr_b16 v[48:49], v138 offset:0
  ds_read_b64_tr_b16 v[50:51], v138 offset:512
  ds_read_b64_tr_b16 v[52:53], v139 offset:0
  ds_read_b64_tr_b16 v[54:55], v139 offset:512
  ds_read_b128 v[32:35], v133 offset:0
  ds_read_b128 v[36:39], v133 offset:2048
  ds_read_b64_tr_b16 v[60:61], v138 offset:4096
  ds_read_b64_tr_b16 v[62:63], v138 offset:4608
  ds_read_b64_tr_b16 v[64:65], v139 offset:4096
  ds_read_b64_tr_b16 v[66:67], v139 offset:4608
  s_waitcnt lgkmcnt(6)
  v_mfma_f32_16x16x32_bf16 v[72:75], v[48:51], v[16:19], v[72:75]
  v_mfma_f32_16x16x32_bf16 v[76:79], v[52:55], v[16:19], v[76:79]
  v_mfma_f32_16x16x32_bf16 v[80:83], v[48:51], v[20:23], v[80:83]
  v_mfma_f32_16x16x32_bf16 v[84:87], v[52:55], v[20:23], v[84:87]
  s_waitcnt lgkmcnt(0)
  v_mfma_f32_16x16x32_bf16 v[72:75], v[60:63], v[32:35], v[72:75]
  v_mfma_f32_16x16x32_bf16 v[76:79], v[64:67], v[32:35], v[76:79]
  v_mfma_f32_16x16x32_bf16 v[80:83], v[60:63], v[36:39], v[80:83]
  v_mfma_f32_16x16x32_bf16 v[84:87], v[64:67], v[36:39], v[84:87]
  s_waitcnt vmcnt(3)
  s_barrier
  s_add_u32 m0, s43, 49152
  s_nop 0
  buffer_load_dwordx4 v4, s[24:27], s44 offen lds
  s_add_u32 s44, s44, 128
  s_add_u32 m0, s43, 57344
  s_nop 0
  buffer_load_dwordx4 v4, s[24:27], s45 offen lds
  s_add_u32 s45, s45, 128
  s_add_u32 m0, s43, 65536
  s_nop 0
  buffer_load_dwordx4 v5, s[28:31], s46 offen lds
  s_add_u32 s46, s46, 131072
  ds_read_b128 v[16:19], v128 offset:0
  ds_read_b128 v[20:23], v128 offset:2048
  ds_read_b64_tr_b16 v[48:49], v134 offset:0
  ds_read_b64_tr_b16 v[50:51], v134 offset:512
  ds_read_b64_tr_b16 v[52:53], v135 offset:0
  ds_read_b64_tr_b16 v[54:55], v135 offset:512
  ds_read_b128 v[32:35], v129 offset:0
  ds_read_b128 v[36:39], v129 offset:2048
  ds_read_b64_tr_b16 v[60:61], v134 offset:4096
  ds_read_b64_tr_b16 v[62:63], v134 offset:4608
  ds_read_b64_tr_b16 v[64:65], v135 offset:4096
  ds_read_b64_tr_b16 v[66:67], v135 offset:4608
  s_waitcnt lgkmcnt(6)
  v_mfma_f32_16x16x32_bf16 v[72:75], v[48:51], v[16:19], v[72:75]
  v_mfma_f32_16x16x32_bf16 v[76:79], v[52:55], v[16:19], v[76:79]
  v_mfma_f32_16x16x32_bf16 v[80:83], v[48:51], v[20:23], v[80:83]
  v_mfma_f32_16x16x32_bf16 v[84:87], v[52:55], v[20:23], v[84:87]
  s_waitcnt lgkmcnt(0)
  v_mfma_f32_16x16x32_bf16 v[72:75], v[60:63], v[32:35], v[72:75]
  v_mfma_f32_16x16x32_bf16 v[76:79], v[64:67], v[32:35], v[76:79]
  v_mfma_f32_16x16x32_bf16 v[80:83], v[60:63], v[36:39], v[80:83]
  v_mfma_f32_16x16x32_bf16 v[84:87], v[64:67], v[36:39], v[84:87]
  s_waitcnt vmcnt(3)
  s_barrier
  s_add_u32 m0, s43, 0
  s_nop 0
  buffer_load_dwordx4 v4, s[24:27], s44 offen lds
  s_add_u32 s44, s44, 128
  s_add_u32 m0, s43, 8192
  s_nop 0
  buffer_load_dwordx4 v4, s[24:27], s45 offen lds
  s_add_u32 s45, s45, 128
  s_add_u32 m0, s43, 16384
  s_nop 0
  buffer_load_dwordx4 v5, s[28:31], s46 offen lds
  s_add_u32 s46, s46, 131072
  ds_read_b128 v[16:19], v130 offset:0
  ds_read_b128 v[20:23], v130 offset:2048
  ds_read_b64_tr_b16 v[48:49], v136 offset:0
  ds_read_b64_tr_b16 v[50:51], v136 offset:512
  ds_read_b64_tr_b16 v[52:53], v137 offset:0
  ds_read_b64_tr_b16 v[54:55], v137 offset:512
  ds_read_b128 v[32:35], v131 offset:0
  ds_read_b128 v[36:39], v131 offset:2048
  ds_read_b64_tr_b16 v[60:61], v136 offset:4096
  ds_read_b64_tr_b16 v[62:63], v136 offset:4608
  ds_read_b64_tr_b16 v[64:65], v137 offset:4096
  ds_read_b64_tr_b16 v[66:67], v137 offset:4608
  s_waitcnt lgkmcnt(6)
  v_mfma_f32_16x16x32_bf16 v[72:75], v[48:51], v[16:19], v[72:75]
  v_mfma_f32_16x16x32_bf16 v[76:79], v[52:55], v[16:19], v[76:79]
  v_mfma_f32_16x16x32_bf16 v[80:83], v[48:51], v[20:23], v[80:83]
  v_mfma_f32_16x16x32_bf16 v[84:87], v[52:55], v[20:23], v[84:87]
  s_waitcnt lgkmcnt(0)
  v_mfma_f32_16x16x32_bf16 v[72:75], v[60:63], v[32:35], v[72:75]
  v_mfma_f32_16x16x32_bf16 v[76:79], v[64:67], v[32:35], v[76:79]
  v_mfma_f32_16x16x32_bf16 v[80:83], v[60:63], v[36:39], v[80:83]
  v_mfma_f32_16x16x32_bf16 v[84:87], v[64:67], v[36:39], v[84:87]
  s_waitcnt vmcnt(3)
  s_barrier
  s_add_u32 m0, s43, 24576
  s_nop 0
  buffer_load_dwordx4 v4, s[24:27], s44 offen lds
  s_add_u32 s44, s44, 128
  s_add_u32 m0, s43, 32768
  s_nop 0
  buffer_load_dwordx4 v4, s[24:27], s45 offen lds
  s_add_u32 s45, s45, 128
  s_add_u32 m0, s43, 40960
  s_nop 0
  buffer_load_dwordx4 v5, s[28:31], s46 offen lds
  s_add_u32 s46, s46, 131072
  ds_read_b128 v[16:19], v132 offset:0
  ds_read_b128 v[20:23], v132 offset:2048
  ds_read_b64_tr_b16 v[48:49], v138 offset:0
  ds_read_b64_tr_b16 v[50:51], v138 offset:512
  ds_read_b64_tr_b16 v[52:53], v139 offset:0
  ds_read_b64_tr_b16 v[54:55], v139 offset:512
  ds_read_b128 v[32:35], v133 offset:0
  ds_read_b128 v[36:39], v133 offset:2048
  ds_read_b64_tr_b16 v[60:61], v138 offset:4096
  ds_read_b64_tr_b16 v[62:63], v138 offset:4608
  ds_read_b64_tr_b16 v[64:65], v139 offset:4096
  ds_read_b64_tr_b16 v[66:67], v139 offset:4608
  s_waitcnt lgkmcnt(6)
  v_mfma_f32_16x16x32_bf16 v[72:75], v[48:51], v[16:19], v[72:75]
  v_mfma_f32_16x16x32_bf16 v[76:79], v[52:55], v[16:19], v[76:79]
  v_mfma_f32_16x16x32_bf16 v[80:83], v[48:51], v[20:23], v[80:83]
  v_mfma_f32_16x16x32_bf16 v[84:87], v[52:55], v[20:23], v[84:87]
  s_waitcnt lgkmcnt(0)
  v_mfma_f32_16x16x32_bf16 v[72:75], v[60:63], v[32:35], v[72:75]
  v_mfma_f32_16x16x32_bf16 v[76:79], v[64:67], v[32:35], v[76:79]
  v_mfma_f32_16x16x32_bf16 v[80:83], v[60:63], v[36:39], v[80:83]
  v_mfma_f32_16x16x32_bf16 v[84:87], v[64:67], v[36:39], v[84:87]
  s_waitcnt vmcnt(3)
  s_barrier
  s_add_u32 m0, s43, 49152
  s_nop 0
  buffer_load_dwordx4 v4, s[24:27], s44 offen lds
  s_add_u32 s44, s44, 128
  s_add_u32 m0, s43, 57344
  s_nop 0
  buffer_load_dwordx4 v4, s[24:27], s45 offen lds
  s_add_u32 s45, s45, 128
  s_add_u32 m0, s43, 65536
  s_nop 0
  buffer_load_dwordx4 v5, s[28:31], s46 offen lds
  s_add_u32 s46, s46, 131072
  ds_read_b128 v[16:19], v128 offset:0
  ds_read_b128 v[20:23], v128 offset:2048
  ds_read_b64_tr_b16 v[48:49], v134 offset:0
  ds_read_b64_tr_b16 v[50:51], v134 offset:512
  ds_read_b64_tr_b16 v[52:53], v135 offset:0
  ds_read_b64_tr_b16 v[54:55], v135 offset:512
  ds_read_b128 v[32:35], v129 offset:0
  ds_read_b128 v[36:39], v129 offset:2048
  ds_read_b64_tr_b16 v[60:61], v134 offset:4096
  ds_read_b64_tr_b16 v[62:63], v134 offset:4608
  ds_read_b64_tr_b16 v[64:65], v135 offset:4096
  ds_read_b64_tr_b16 v[66:67], v135 offset:4608
  s_waitcnt lgkmcnt(6)
  v_mfma_f32_16x16x32_bf16 v[72:75], v[48:51], v[16:19], v[72:75]
  v_mfma_f32_16x16x32_bf16 v[76:79], v[52:55], v[16:19], v[76:79]
  v_mfma_f32_16x16x32_bf16 v[80:83], v[48:51], v[20:23], v[80:83]
  v_mfma_f32_16x16x32_bf16 v[84:87], v[52:55], v[20:23], v[84:87]
  s_waitcnt lgkmcnt(0)
  v_mfma_f32_16x16x32_bf16 v[72:75], v[60:63], v[32:35], v[72:75]
  v_mfma_f32_16x16x32_bf16 v[76:79], v[64:67], v[32:35], v[76:79]
  v_mfma_f32_16x16x32_bf16 v[80:83], v[60:63], v[36:39], v[80:83]
  v_mfma_f32_16x16x32_bf16 v[84:87], v[64:67], v[36:39], v[84:87]
  s_waitcnt vmcnt(3)
  s_barrier
  s_add_u32 m0, s43, 0
  s_nop 0
  buffer_load_dwordx4 v4, s[24:27], s44 offen lds
  s_add_u32 s44, s44, 128
  s_add_u32 m0, s43, 8192
  s_nop 0
  buffer_load_dwordx4 v4, s[24:27], s45 offen lds
  s_add_u32 s45, s45, 128
  s_add_u32 m0, s43, 16384
  s_nop 0
  buffer_load_dwordx4 v5, s[28:31], s46 offen lds
  s_add_u32 s46, s46, 131072
  ds_read_b128 v[16:19], v130 offset:0
  ds_read_b128 v[20:23], v130 offset:2048
  ds_read_b64_tr_b16 v[48:49], v136 offset:0
  ds_read_b64_tr_b16 v[50:51], v136 offset:512
  ds_read_b64_tr_b16 v[52:53], v137 offset:0
  ds_read_b64_tr_b16 v[54:55], v137 offset:512
  ds_read_b128 v[32:35], v131 offset:0
  ds_read_b128 v[36:39], v131 offset:2048
  ds_read_b64_tr_b16 v[60:61], v136 offset:4096
  ds_read_b64_tr_b16 v[62:63], v136 offset:4608
  ds_read_b64_tr_b16 v[64:65], v137 offset:4096
  ds_read_b64_tr_b16 v[66:67], v137 offset:4608
  s_waitcnt lgkmcnt(6)
  v_mfma_f32_16x16x32_bf16 v[72:75], v[48:51], v[16:19], v[72:75]
  v_mfma_f32_16x16x32_bf16 v[76:79], v[52:55], v[16:19], v[76:79]
  v_mfma_f32_16x16x32_bf16 v[80:83], v[48:51], v[20:23], v[80:83]
  v_mfma_f32_16x16x32_bf16 v[84:87], v[52:55], v[20:23], v[84:87]
  s_waitcnt lgkmcnt(0)
  v_mfma_f32_16x16x32_bf16 v[72:75], v[60:63], v[32:35], v[72:75]
  v_mfma_f32_16x16x32_bf16 v[76:79], v[64:67], v[32:35], v[76:79]
  v_mfma_f32_16x16x32_bf16 v[80:83], v[60:63], v[36:39], v[80:83]
  v_mfma_f32_16x16x32_bf16 v[84:87], v[64:67], v[36:39], v[84:87]
  s_waitcnt vmcnt(3)
  s_barrier
  s_add_u32 m0, s43, 24576
  s_nop 0
  buffer_load_dwordx4 v4, s[24:27], s44 offen lds
  s_add_u32 s44, s44, 128
  s_add_u32 m0, s43, 32768
  s_nop 0
  buffer_load_dwordx4 v4, s[24:27], s45 offen lds
  s_add_u32 s45, s45, 128
  s_add_u32 m0, s43, 40960
  s_nop 0
  buffer_load_dwordx4 v5, s[28:31], s46 offen lds
  s_add_u32 s46, s46, 131072
  ds_read_b128 v[16:19], v132 offset:0
  ds_read_b128 v[20:23], v132 offset:2048
  ds_read_b64_tr_b16 v[48:49], v138 offset:0
  ds_read_b64_tr_b16 v[50:51], v138 offset:512
  ds_read_b64_tr_b16 v[52:53], v139 offset:0
  ds_read_b64_tr_b16 v[54:55], v139 offset:512
  ds_read_b128 v[32:35], v133 offset:0
  ds_read_b128 v[36:39], v133 offset:2048
  ds_read_b64_tr_b16 v[60:61], v138 offset:4096
  ds_read_b64_tr_b16 v[62:63], v138 offset:4608
  ds_read_b64_tr_b16 v[64:65], v139 offset:4096
  ds_read_b64_tr_b16 v[66:67], v139 offset:4608
  s_waitcnt lgkmcnt(6)
  v_mfma_f32_16x16x32_bf16 v[72:75], v[48:51], v[16:19], v[72:75]
  v_mfma_f32_16x16x32_bf16 v[76:79], v[52:55], v[16:19], v[76:79]
  v_mfma_f32_16x16x32_bf16 v[80:83], v[48:51], v[20:23], v[80:83]
  v_mfma_f32_16x16x32_bf16 v[84:87], v[52:55], v[20:23], v[84:87]
  s_waitcnt lgkmcnt(0)
  v_mfma_f32_16x16x32_bf16 v[72:75], v[60:63], v[32:35], v[72:75]
  v_mfma_f32_16x16x32_bf16 v[76:79], v[64:67], v[32:35], v[76:79]
  v_mfma_f32_16x16x32_bf16 v[80:83], v[60:63], v[36:39], v[80:83]
  v_mfma_f32_16x16x32_bf16 v[84:87], v[64:67], v[36:39], v[84:87]
  s_waitcnt vmcnt(3)
  s_barrier
  s_add_u32 m0, s43, 49152
  s_nop 0
  buffer_load_dwordx4 v4, s[24:27], s44 offen lds
  s_add_u32 s44, s44, 128
  s_add_u32 m0, s43, 57344
  s_nop 0
  buffer_load_dwordx4 v4, s[24:27], s45 offen lds
  s_add_u32 s45, s45, 128
  s_add_u32 m0, s43, 65536
  s_nop 0
  buffer_load_dwordx4 v5, s[28:31], s46 offen lds
  s_add_u32 s46, s46, 131072
  ds_read_b128 v[16:19], v128 offset:0
  ds_read_b128 v[20:23], v128 offset:2048
  ds_read_b64_tr_b16 v[48:49], v134 offset:0
  ds_read_b64_tr_b16 v[50:51], v134 offset:512
  ds_read_b64_tr_b16 v[52:53], v135 offset:0
  ds_read_b64_tr_b16 v[54:55], v135 offset:512
  ds_read_b128 v[32:35], v129 offset:0
  ds_read_b128 v[36:39], v129 offset:2048
  ds_read_b64_tr_b16 v[60:61], v134 offset:4096
  ds_read_b64_tr_b16 v[62:63], v134 offset:4608
  ds_read_b64_tr_b16 v[64:65], v135 offset:4096
  ds_read_b64_tr_b16 v[66:67], v135 offset:4608
  s_waitcnt lgkmcnt(6)
  v_mfma_f32_16x16x32_bf16 v[72:75], v[48:51], v[16:19], v[72:75]
  v_mfma_f32_16x16x32_bf16 v[76:79], v[52:55], v[16:19], v[76:79]
  v_mfma_f32_16x16x32_bf16 v[80:83], v[48:51], v[20:23], v[80:83]
  v_mfma_f32_16x16x32_bf16 v[84:87], v[52:55], v[20:23], v[84:87]
  s_waitcnt lgkmcnt(0)
  v_mfma_f32_16x16x32_bf16 v[72:75], v[60:63], v[32:35], v[72:75]
  v_mfma_f32_16x16x32_bf16 v[76:79], v[64:67], v[32:35], v[76:79]
  v_mfma_f32_16x16x32_bf16 v[80:83], v[60:63], v[36:39], v[80:83]
  v_mfma_f32_16x16x32_bf16 v[84:87], v[64:67], v[36:39], v[84:87]
  s_waitcnt vmcnt(3)
  s_barrier
  s_add_u32 m0, s43, 0
  s_nop 0
  buffer_load_dwordx4 v4, s[24:27], s44 offen lds
  s_add_u32 s44, s44, 128
  s_add_u32 m0, s43, 8192
  s_nop 0
  buffer_load_dwordx4 v4, s[24:27], s45 offen lds
  s_add_u32 s45, s45, 128
  s_add_u32 m0, s43, 16384
  s_nop 0
  buffer_load_dwordx4 v5, s[28:31], s46 offen lds
  s_add_u32 s46, s46, 131072
  ds_read_b128 v[16:19], v130 offset:0
  ds_read_b128 v[20:23], v130 offset:2048
  ds_read_b64_tr_b16 v[48:49], v136 offset:0
  ds_read_b64_tr_b16 v[50:51], v136 offset:512
  ds_read_b64_tr_b16 v[52:53], v137 offset:0
  ds_read_b64_tr_b16 v[54:55], v137 offset:512
  ds_read_b128 v[32:35], v131 offset:0
  ds_read_b128 v[36:39], v131 offset:2048
  ds_read_b64_tr_b16 v[60:61], v136 offset:4096
  ds_read_b64_tr_b16 v[62:63], v136 offset:4608
  ds_read_b64_tr_b16 v[64:65], v137 offset:4096
  ds_read_b64_tr_b16 v[66:67], v137 offset:4608
  s_waitcnt lgkmcnt(6)
  v_mfma_f32_16x16x32_bf16 v[72:75], v[48:51], v[16:19], v[72:75]
  v_mfma_f32_16x16x32_bf16 v[76:79], v[52:55], v[16:19], v[76:79]
  v_mfma_f32_16x16x32_bf16 v[80:83], v[48:51], v[20:23], v[80:83]
  v_mfma_f32_16x16x32_bf16 v[84:87], v[52:55], v[20:23], v[84:87]
  s_waitcnt lgkmcnt(0)
  v_mfma_f32_16x16x32_bf16 v[72:75], v[60:63], v[32:35], v[72:75]
  v_mfma_f32_16x16x32_bf16 v[76:79], v[64:67], v[32:35], v[76:79]
  v_mfma_f32_16x16x32_bf16 v[80:83], v[60:63], v[36:39], v[80:83]
  v_mfma_f32_16x16x32_bf16 v[84:87], v[64:67], v[36:39], v[84:87]
  s_waitcnt vmcnt(3)
  s_barrier
  ds_read_b128 v[16:19], v132 offset:0
  ds_read_b128 v[20:23], v132 offset:2048
  ds_read_b64_tr_b16 v[48:49], v138 offset:0
  ds_read_b64_tr_b16 v[50:51], v138 offset:512
  ds_read_b64_tr_b16 v[52:53], v139 offset:0
  ds_read_b64_tr_b16 v[54:55], v139 offset:512
  ds_read_b128 v[32:35], v133 offset:0
  ds_read_b128 v[36:39], v133 offset:2048
  ds_read_b64_tr_b16 v[60:61], v138 offset:4096
  ds_read_b64_tr_b16 v[62:63], v138 offset:4608
  ds_read_b64_tr_b16 v[64:65], v139 offset:4096
  ds_read_b64_tr_b16 v[66:67], v139 offset:4608
  s_waitcnt lgkmcnt(6)
  v_mfma_f32_16x16x32_bf16 v[72:75], v[48:51], v[16:19], v[72:75]
  v_mfma_f32_16x16x32_bf16 v[76:79], v[52:55], v[16:19], v[76:79]
  v_mfma_f32_16x16x32_bf16 v[80:83], v[48:51], v[20:23], v[80:83]
  v_mfma_f32_16x16x32_bf16 v[84:87], v[52:55], v[20:23], v[84:87]
  s_waitcnt lgkmcnt(0)
  v_mfma_f32_16x16x32_bf16 v[72:75], v[60:63], v[32:35], v[72:75]
  v_mfma_f32_16x16x32_bf16 v[76:79], v[64:67], v[32:35], v[76:79]
  v_mfma_f32_16x16x32_bf16 v[80:83], v[60:63], v[36:39], v[80:83]
  v_mfma_f32_16x16x32_bf16 v[84:87], v[64:67], v[36:39], v[84:87]
  s_waitcnt vmcnt(0)
  s_barrier
  ds_read_b128 v[16:19], v128 offset:0
  ds_read_b128 v[20:23], v128 offset:2048
  ds_read_b64_tr_b16 v[48:49], v134 offset:0
  ds_read_b64_tr_b16 v[50:51], v134 offset:512
  ds_read_b64_tr_b16 v[52:53], v135 offset:0
  ds_read_b64_tr_b16 v[54:55], v135 offset:512
  ds_read_b128 v[32:35], v129 offset:0
  ds_read_b128 v[36:39], v129 offset:2048
  ds_read_b64_tr_b16 v[60:61], v134 offset:4096
  ds_read_b64_tr_b16 v[62:63], v134 offset:4608
  ds_read_b64_tr_b16 v[64:65], v135 offset:4096
  ds_read_b64_tr_b16 v[66:67], v135 offset:4608
  s_waitcnt lgkmcnt(6)
  v_mfma_f32_16x16x32_bf16 v[72:75], v[48:51], v[16:19], v[72:75]
  v_mfma_f32_16x16x32_bf16 v[76:79], v[52:55], v[16:19], v[76:79]
  v_mfma_f32_16x16x32_bf16 v[80:83], v[48:51], v[20:23], v[80:83]
  v_mfma_f32_16x16x32_bf16 v[84:87], v[52:55], v[20:23], v[84:87]
  s_waitcnt lgkmcnt(0)
  v_mfma_f32_16x16x32_bf16 v[72:75], v[60:63], v[32:35], v[72:75]
  v_mfma_f32_16x16x32_bf16 v[76:79], v[64:67], v[32:35], v[76:79]
  v_mfma_f32_16x16x32_bf16 v[80:83], v[60:63], v[36:39], v[80:83]
  v_mfma_f32_16x16x32_bf16 v[84:87], v[64:67], v[36:39], v[84:87]
  s_nop 7
  s_nop 7
  buffer_load_dwordx2 v[16:17], v13, s[36:39], 0 offen offset:0
  buffer_load_dwordx2 v[18:19], v13, s[36:39], 0 offen offset:32
  s_waitcnt vmcnt(0)
  v_cvt_pk_bf16_f32 v72, v72, v73
  v_cvt_pk_bf16_f32 v73, v74, v75
  v_lshlrev_b32 v32, 16, v72
  v_and_b32 v33, 0xffff0000, v72
  v_lshlrev_b32 v34, 16, v16
  v_and_b32 v35, 0xffff0000, v16
  v_add_f32 v32, v32, v34
  v_add_f32 v33, v33, v35
  v_cvt_pk_bf16_f32 v72, v32, v33
  v_lshlrev_b32 v32, 16, v73
  v_and_b32 v33, 0xffff0000, v73
  v_lshlrev_b32 v34, 16, v17
  v_and_b32 v35, 0xffff0000, v17
  v_add_f32 v32, v32, v34
  v_add_f32 v33, v33, v35
  v_cvt_pk_bf16_f32 v73, v32, v33
  buffer_store_dwordx2 v[72:73], v13, s[32:35], 0 offen offset:0
  v_cvt_pk_bf16_f32 v76, v76, v77
  v_cvt_pk_bf16_f32 v77, v78, v79
  v_lshlrev_b32 v32, 16, v76
  v_and_b32 v33, 0xffff0000, v76
  v_lshlrev_b32 v34, 16, v18
  v_and_b32 v35, 0xffff0000, v18
  v_add_f32 v32, v32, v34
  v_add_f32 v33, v33, v35
  v_cvt_pk_bf16_f32 v76, v32, v33
  v_lshlrev_b32 v32, 16, v77
  v_and_b32 v33, 0xffff0000, v77
  v_lshlrev_b32 v34, 16, v19
  v_and_b32 v35, 0xffff0000, v19
  v_add_f32 v32, v32, v34
  v_add_f32 v33, v33, v35
  v_cvt_pk_bf16_f32 v77, v32, v33
  buffer_store_dwordx2 v[76:77], v13, s[32:35], 0 offen offset:32
  v_add_u32 v13, 32768, v13
  buffer_load_dwordx2 v[16:17], v13, s[36:39], 0 offen offset:0
  buffer_load_dwordx2 v[18:19], v13, s[36:39], 0 offen offset:32
  s_waitcnt vmcnt(0)
  v_cvt_pk_bf16_f32 v80, v80, v81
  v_cvt_pk_bf16_f32 v81, v82, v83
  v_lshlrev_b32 v32, 16, v80
  v_and_b32 v33, 0xffff0000, v80
  v_lshlrev_b32 v34, 16, v16
  v_and_b32 v35, 0xffff0000, v16
  v_add_f32 v32, v32, v34
  v_add_f32 v33, v33, v35
  v_cvt_pk_bf16_f32 v80, v32, v33
  v_lshlrev_b32 v32, 16, v81
  v_and_b32 v33, 0xffff0000, v81
  v_lshlrev_b32 v34, 16, v17
  v_and_b32 v35, 0xffff0000, v17
  v_add_f32 v32, v32, v34
  v_add_f32 v33, v33, v35
  v_cvt_pk_bf16_f32 v81, v32, v33
  buffer_store_dwordx2 v[80:81], v13, s[32:35], 0 offen offset:0
  v_cvt_pk_bf16_f32 v84, v84, v85
  v_cvt_pk_bf16_f32 v85, v86, v87
  v_lshlrev_b32 v32, 16, v84
  v_and_b32 v33, 0xffff0000, v84
  v_lshlrev_b32 v34, 16, v18
  v_and_b32 v35, 0xffff0000, v18
  v_add_f32 v32, v32, v34
  v_add_f32 v33, v33, v35
  v_cvt_pk_bf16_f32 v84, v32, v33
  v_lshlrev_b32 v32, 16, v85
  v_and_b32 v33, 0xffff0000, v85
  v_lshlrev_b32 v34, 16, v19
  v_and_b32 v35, 0xffff0000, v19
  v_add_f32 v32, v32, v34
  v_add_f32 v33, v33, v35
  v_cvt_pk_bf16_f32 v85, v32, v33
  buffer_store_dwordx2 v[84:85], v13, s[32:35], 0 offen offset:32
L_gemmo3_kernel_end:
  s_endpgm
.section .rodata,"a"
.p2align 6
.amdhsa_kernel ln0_kernel
  .amdhsa_next_free_vgpr 64
  .amdhsa_next_free_sgpr 102
  .amdhsa_accum_offset 64
  .amdhsa_group_segment_fixed_size 0
  .amdhsa_kernarg_size 72
  .amdhsa_user_sgpr_count 2
  .amdhsa_user_sgpr_kernarg_segment_ptr 1
  .amdhsa_system_sgpr_workgroup_id_x 1
.end_amdhsa_kernel
.p2align 6
.amdhsa_kernel gemmq0_kernel
  .amdhsa_next_free_vgpr 192
  .amdhsa_next_free_sgpr 102
  .amdhsa_accum_offset 192
  .amdhsa_group_segment_fixed_size 0
  .amdhsa_kernarg_size 72
  .amdhsa_user_sgpr_count 2
  .amdhsa_user_sgpr_kernarg_segment_ptr 1
  .amdhsa_system_sgpr_workgroup_id_x 1
.end_amdhsa_kernel
.p2align 6
.amdhsa_kernel kvpart0_kernel
  .amdhsa_next_free_vgpr 256
  .amdhsa_next_free_sgpr 102
  .amdhsa_accum_offset 256
  .amdhsa_group_segment_fixed_size 0
  .amdhsa_kernarg_size 72
  .amdhsa_user_sgpr_count 2
  .amdhsa_user_sgpr_kernarg_segment_ptr 1
  .amdhsa_system_sgpr_workgroup_id_x 1
.end_amdhsa_kernel
.p2align 6
.amdhsa_kernel linapply0_kernel
  .amdhsa_next_free_vgpr 256
  .amdhsa_next_free_sgpr 102
  .amdhsa_accum_offset 256
  .amdhsa_group_segment_fixed_size 0
  .amdhsa_kernarg_size 72
  .amdhsa_user_sgpr_count 2
  .amdhsa_user_sgpr_kernarg_segment_ptr 1
  .amdhsa_system_sgpr_workgroup_id_x 1
.end_amdhsa_kernel
.p2align 6
.amdhsa_kernel gemmo0_kernel
  .amdhsa_next_free_vgpr 192
  .amdhsa_next_free_sgpr 102
  .amdhsa_accum_offset 192
  .amdhsa_group_segment_fixed_size 0
  .amdhsa_kernarg_size 72
  .amdhsa_user_sgpr_count 2
  .amdhsa_user_sgpr_kernarg_segment_ptr 1
  .amdhsa_system_sgpr_workgroup_id_x 1
.end_amdhsa_kernel
.p2align 6
.amdhsa_kernel ln1_kernel
  .amdhsa_next_free_vgpr 64
  .amdhsa_next_free_sgpr 102
  .amdhsa_accum_offset 64
  .amdhsa_group_segment_fixed_size 0
  .amdhsa_kernarg_size 72
  .amdhsa_user_sgpr_count 2
  .amdhsa_user_sgpr_kernarg_segment_ptr 1
  .amdhsa_system_sgpr_workgroup_id_x 1
.end_amdhsa_kernel
.p2align 6
.amdhsa_kernel gemmq1_kernel
  .amdhsa_next_free_vgpr 192
  .amdhsa_next_free_sgpr 102
  .amdhsa_accum_offset 192
  .amdhsa_group_segment_fixed_size 0
  .amdhsa_kernarg_size 72
  .amdhsa_user_sgpr_count 2
  .amdhsa_user_sgpr_kernarg_segment_ptr 1
  .amdhsa_system_sgpr_workgroup_id_x 1
.end_amdhsa_kernel
.p2align 6
.amdhsa_kernel slide1_kernel
  .amdhsa_next_free_vgpr 256
  .amdhsa_next_free_sgpr 102
  .amdhsa_accum_offset 256
  .amdhsa_group_segment_fixed_size 0
  .amdhsa_kernarg_size 72
  .amdhsa_user_sgpr_count 2
  .amdhsa_user_sgpr_kernarg_segment_ptr 1
  .amdhsa_system_sgpr_workgroup_id_x 1
.end_amdhsa_kernel
.p2align 6
.amdhsa_kernel gemmo1_kernel
  .amdhsa_next_free_vgpr 192
  .amdhsa_next_free_sgpr 102
  .amdhsa_accum_offset 192
  .amdhsa_group_segment_fixed_size 0
  .amdhsa_kernarg_size 72
  .amdhsa_user_sgpr_count 2
  .amdhsa_user_sgpr_kernarg_segment_ptr 1
  .amdhsa_system_sgpr_workgroup_id_x 1
.end_amdhsa_kernel
.p2align 6
.amdhsa_kernel ln2_kernel
  .amdhsa_next_free_vgpr 64
  .amdhsa_next_free_sgpr 102
  .amdhsa_accum_offset 64
  .amdhsa_group_segment_fixed_size 0
  .amdhsa_kernarg_size 72
  .amdhsa_user_sgpr_count 2
  .amdhsa_user_sgpr_kernarg_segment_ptr 1
  .amdhsa_system_sgpr_workgroup_id_x 1
.end_amdhsa_kernel
.p2align 6
.amdhsa_kernel gemmq2_kernel
  .amdhsa_next_free_vgpr 192
  .amdhsa_next_free_sgpr 102
  .amdhsa_accum_offset 192
  .amdhsa_group_segment_fixed_size 0
  .amdhsa_kernarg_size 72
  .amdhsa_user_sgpr_count 2
  .amdhsa_user_sgpr_kernarg_segment_ptr 1
  .amdhsa_system_sgpr_workgroup_id_x 1
.end_amdhsa_kernel
.p2align 6
.amdhsa_kernel kvpart2_kernel
  .amdhsa_next_free_vgpr 256
  .amdhsa_next_free_sgpr 102
  .amdhsa_accum_offset 256
  .amdhsa_group_segment_fixed_size 0
  .amdhsa_kernarg_size 72
  .amdhsa_user_sgpr_count 2
  .amdhsa_user_sgpr_kernarg_segment_ptr 1
  .amdhsa_system_sgpr_workgroup_id_x 1
.end_amdhsa_kernel
.p2align 6
.amdhsa_kernel linapply2_kernel
  .amdhsa_next_free_vgpr 256
  .amdhsa_next_free_sgpr 102
  .amdhsa_accum_offset 256
  .amdhsa_group_segment_fixed_size 0
  .amdhsa_kernarg_size 72
  .amdhsa_user_sgpr_count 2
  .amdhsa_user_sgpr_kernarg_segment_ptr 1
  .amdhsa_system_sgpr_workgroup_id_x 1
.end_amdhsa_kernel
.p2align 6
.amdhsa_kernel gemmo2_kernel
  .amdhsa_next_free_vgpr 192
  .amdhsa_next_free_sgpr 102
  .amdhsa_accum_offset 192
  .amdhsa_group_segment_fixed_size 0
  .amdhsa_kernarg_size 72
  .amdhsa_user_sgpr_count 2
  .amdhsa_user_sgpr_kernarg_segment_ptr 1
  .amdhsa_system_sgpr_workgroup_id_x 1
.end_amdhsa_kernel
.p2align 6
.amdhsa_kernel ln3_kernel
  .amdhsa_next_free_vgpr 64
  .amdhsa_next_free_sgpr 102
  .amdhsa_accum_offset 64
  .amdhsa_group_segment_fixed_size 0
  .amdhsa_kernarg_size 72
  .amdhsa_user_sgpr_count 2
  .amdhsa_user_sgpr_kernarg_segment_ptr 1
  .amdhsa_system_sgpr_workgroup_id_x 1
.end_amdhsa_kernel
.p2align 6
.amdhsa_kernel gemmq3_kernel
  .amdhsa_next_free_vgpr 192
  .amdhsa_next_free_sgpr 102
  .amdhsa_accum_offset 192
  .amdhsa_group_segment_fixed_size 0
  .amdhsa_kernarg_size 72
  .amdhsa_user_sgpr_count 2
  .amdhsa_user_sgpr_kernarg_segment_ptr 1
  .amdhsa_system_sgpr_workgroup_id_x 1
.end_amdhsa_kernel
.p2align 6
.amdhsa_kernel slide3_kernel
  .amdhsa_next_free_vgpr 256
  .amdhsa_next_free_sgpr 102
  .amdhsa_accum_offset 256
  .amdhsa_group_segment_fixed_size 0
  .amdhsa_kernarg_size 72
  .amdhsa_user_sgpr_count 2
  .amdhsa_user_sgpr_kernarg_segment_ptr 1
  .amdhsa_system_sgpr_workgroup_id_x 1
.end_amdhsa_kernel
.p2align 6
.amdhsa_kernel gemmo3_kernel
  .amdhsa_next_free_vgpr 192
  .amdhsa_next_free_sgpr 102
  .amdhsa_accum_offset 192
  .amdhsa_group_segment_fixed_size 0
  .amdhsa_kernarg_size 72
  .amdhsa_user_sgpr_count 2
  .amdhsa_user_sgpr_kernarg_segment_ptr 1
  .amdhsa_system_sgpr_workgroup_id_x 1
.end_amdhsa_kernel
```
